```python
import torch

def _softmax(x, axis=-1):
    return torch.softmax(x, dim=axis)
def _gelu(x):
    return torch.nn.functional.gelu(x, approximate="tanh")
def _silu(x):
    return torch.nn.functional.silu(x)
def _sigmoid(x):
    return torch.sigmoid(x)
def _layernorm(x, axis=-1, eps=1e-5):
    m = x.mean(dim=axis, keepdim=True)
    v = x.var(dim=axis, keepdim=True, unbiased=False)
    return (x - m) / torch.sqrt(v + eps)
def _scatter_add(tgt, idx, src, axis=0):
    return tgt.clone().index_add_(axis, idx, src)
def _segment_sum(src, seg, n):
    out = torch.zeros((n,) + src.shape[1:], dtype=src.dtype)
    return out.index_add_(0, seg, src)
def _pad(x, pw):
    flat = tuple(v for pair in reversed(pw) for v in pair)
    return torch.nn.functional.pad(x, flat)

kernel_name = 'sequential_preLN__sliding_block__mixer_s_mlp__prompt'

def setup_inputs():

    _w = (lambda a: (lambda t: t.to(torch.bfloat16) if t.is_floating_point() else t)(torch.as_tensor(a)))
    def _A_setup():
        B, S, D = 1, 2048, 576
        return {
            "x": _w((lambda *s: torch.randn(*s, dtype=torch.bfloat16) * 0.05)(B, S, D)),
            "wqkv": _w((lambda *s: torch.randn(*s, dtype=torch.bfloat16) * 0.05)(D, 3 * D)),
            "wo": _w((lambda *s: torch.randn(*s, dtype=torch.bfloat16) * 0.05)(D, D)),
        }
    _A_in = _A_setup()

    def _B_setup():
        B, S, D, F = 1, 2048, 576, 4608
        return {
            "x":  _w((lambda *s: torch.randn(*s, dtype=torch.bfloat16) * 0.05)(B, S, D)),
            "w1": _w((lambda *s: torch.randn(*s, dtype=torch.bfloat16) * 3.2)(D, D) * (D ** -0.5)),
            "w2": _w((lambda *s: torch.randn(*s, dtype=torch.bfloat16) * 3.2)(D, D) * (D ** -0.5)),
            "w3": _w((lambda *s: torch.randn(*s, dtype=torch.bfloat16) * 3.2)(D, F) * (D ** -0.5)),
            "w4": _w((lambda *s: torch.randn(*s, dtype=torch.bfloat16) * 3.2)(F, D) * (F ** -0.5)),
        }
    _B_in = _B_setup()

    return {
        "A_x": _A_in["x"],
        "A_wqkv": _A_in["wqkv"],
        "A_wo": _A_in["wo"],
        "B_x": _B_in["x"],
        "B_w1": _B_in["w1"],
        "B_w2": _B_in["w2"],
        "B_w3": _B_in["w3"],
        "B_w4": _B_in["w4"],
    }

def reference(A_x, A_wqkv, A_wo, B_x, B_w1, B_w2, B_w3, B_w4):
    def _A_ref(x, wqkv, wo):
        B, S, D = x.shape
        H = 32; Dh = D // H; W = 256
        qkv = (lambda x, *d: x.permute(*d))((x @ wqkv).reshape(B, S, 3, H, Dh), 2, 0, 3, 1, 4)
        q, k, v = qkv[0], qkv[1], qkv[2]
        scores = torch.einsum("bhqd,bhkd->bhqk", q, k) * (Dh ** -0.5)
        idx = torch.arange(S)
        mask = (idx[:, None] - idx[None, :] >= 0) & (idx[:, None] - idx[None, :] < W)
        scores = torch.where(mask[None, None], scores, -1e9)
        p = _softmax(scores, axis=-1)
        o = torch.einsum("bhqk,bhkd->bhqd", p, v)
        return (lambda x, *d: x.permute(*d))(o, 0, 2, 1, 3).reshape(B, S, D) @ wo

    def _B_ref(x, w1, w2, w3, w4):
        B, S, D = x.shape
        h = _gelu(_layernorm(x, axis=-1) @ w1)
        c = D // 4
        g0 = _pad(h[:, :, 0*c:1*c], ((0, 0), (1, 0), (0, 0)))[:, :S, :]
        g1 = _pad(h[:, :, 1*c:2*c], ((0, 0), (0, 1), (0, 0)))[:, 1:, :]
        g2 = _pad(h[:, :, 2*c:3*c], ((0, 0), (2, 0), (0, 0)))[:, :S, :]
        g3 = _pad(h[:, :, 3*c:   ], ((0, 0), (0, 2), (0, 0)))[:, 2:, :]
        hs = torch.concatenate([g0, g1, g2, g3], axis=-1) @ w2
        x1 = x + hs
        h2 = _gelu(_layernorm(x1, axis=-1) @ w3) @ w4
        return x1 + h2

    x = A_x
    h = x + _A_ref(_layernorm(x, axis=-1), A_wqkv, A_wo)
    h2 = h + _B_ref(_layernorm(h, axis=-1), B_w1, B_w2, B_w3, B_w4)
    return h2
```

```asm
; @launch grid=(256,1,1) block=(256,1,1) lds=163840
.amdgcn_target "amdgcn-amd-amdhsa--gfx950"
.text
.globl sequential_preLN__sliding_block__mixer_s_mlp__prompt_kernel
.p2align 8
.type sequential_preLN__sliding_block__mixer_s_mlp__prompt_kernel,@function
sequential_preLN__sliding_block__mixer_s_mlp__prompt_kernel:
  s_cmp_ge_u32 s2, 256
  s_cbranch_scc1 L_end
  s_load_dwordx4 s[4:7], s[0:1], 0
  s_load_dwordx2 s[24:25], s[0:1], 80
  s_load_dwordx2 s[8:9], s[0:1], 16
  s_load_dwordx8 s[12:19], s[0:1], 32
  s_load_dwordx4 s[20:23], s[0:1], 64
  v_and_b32 v1, 63, v0
  v_lshrrev_b32 v5, 6, v0
  v_and_b32 v2, 15, v0
  v_readfirstlane_b32 s40, v5
  v_lshrrev_b32 v3, 4, v1
  v_lshlrev_b32 v4, 4, v1
  s_and_b32 s41, s2, 7
  s_lshr_b32 s42, s2, 3
  s_mov_b32 s44, 0x3f803f80
  s_getpc_b64 s[46:47]
L_pc:
  s_mul_i32 s48, s42, 3072
  v_lshl_add_u32 v5, v0, 7, s48
  v_cmp_gt_u32 vcc, 24, v0
  s_mov_b32 s48, L_last-L_pc
  v_cmp_gt_u32 s[48:49], s48, v5
  s_and_b64 vcc, vcc, s[48:49]
  s_and_saveexec_b64 s[48:49], vcc
  s_cbranch_execz L_pcd
  global_load_dword v253, v5, s[46:47]
L_pcd:
  s_mov_b64 exec, -1
  s_cmp_ge_u32 s42, 28
  s_cbranch_scc1 L_p1_helper
  s_mul_hi_u32 s46, s42, 613566757
  s_mul_i32 s47, s46, 7
  s_sub_u32 s47, s42, s47
  s_lshr_b32 s48, s41, 1
  s_lshl_b32 s48, s48, 2
  s_add_u32 s50, s48, s46
  s_and_b32 s48, s41, 1
  s_mul_i32 s48, s48, 7
  s_add_u32 s51, s48, s47
  s_lshr_b32 s52, s40, 1
  s_and_b32 s53, s40, 1
  v_lshrrev_b32 v20, 3, v1
  v_and_b32 v21, 7, v1
  v_xor_b32 v22, v21, v3
  v_mul_u32_u24 v20, 1152, v20
  v_lshl_add_u32 v10, v22, 4, v20
  v_xor_b32 v22, 4, v22
  v_lshl_add_u32 v11, v22, 4, v20
  v_add_u32 v12, 20480, v10
  v_add_u32 v13, 28672, v11
  v_add_u32 v11, 12288, v11
  v_add_u32 v10, 4096, v10
  v_lshrrev_b32 v20, 1, v2
  v_xor_b32 v20, v20, v3
  v_and_b32 v21, 1, v1
  v_lshl_add_u32 v21, v20, 1, v21
  v_mul_u32_u24 v22, 3456, v3
  v_lshl_add_u32 v14, v21, 4, v22
  v_xor_b32 v21, 8, v21
  v_lshl_add_u32 v16, v21, 4, v22
  v_add_u32 v15, 16896, v14
  v_add_u32 v17, 42496, v16
  v_add_u32 v16, 29696, v16
  v_add_u32 v14, 4096, v14
  s_lshl_b32 s54, s50, 2
  s_add_u32 s54, s54, s40
  s_mul_i32 s54, s54, 36864
  s_mul_i32 s55, s40, 55296
  s_lshl_b32 s46, s51, 8
  s_add_u32 s55, s55, s46
  s_lshl_b32 s56, s40, 12
  s_waitcnt lgkmcnt(0)
  s_sub_u32 s32, s4, 4096
  s_subb_u32 s33, s5, 0
  s_mov_b32 s34, 2363392
  s_mov_b32 s35, 0x20000
  s_sub_u32 s36, s6, 4096
  s_subb_u32 s37, s7, 0
  s_mov_b32 s38, 1994752
  s_mov_b32 s39, 0x20000
  s_mul_hi_u32 s46, s42, 613566757
  s_mul_i32 s47, s46, 7
  s_sub_u32 s47, s42, s47
  s_and_b32 s48, s41, 1
  s_add_u32 s46, s46, s48
  s_lshl_b32 s46, s46, 1
  s_add_u32 s46, s46, s47
  s_bfe_u32 s47, s41, 0x10001
  s_add_u32 s46, s46, s47
  s_and_b32 s47, s41, 4
  s_lshl_b32 s47, s47, 1
  s_add_u32 s46, s46, s47
  s_mul_hi_u32 s47, s46, 477218589
  s_mul_i32 s67, s47, 9
  s_sub_u32 s67, s46, s67
  s_mov_b32 m0, s56
  s_lshl_b32 s68, s67, 7
  s_add_u32 s68, s68, s54
  buffer_load_dwordx4 v10, s[32:35], s68 offen offset:0 lds
  s_mul_i32 s69, s67, 221184
  s_add_u32 s69, s69, s55
  buffer_load_dwordx4 v11, s[32:35], s68 offen offset:1024 lds
  s_add_u32 s67, s67, 1
  s_cmp_eq_u32 s67, 9
  s_cselect_b32 s67, 0, s67
  buffer_load_dwordx4 v12, s[32:35], s68 offen offset:2048 lds
  buffer_load_dwordx4 v13, s[32:35], s68 offen offset:3072 lds
  s_add_u32 m0, s56, 16384
  s_nop 0
  buffer_load_dwordx4 v14, s[36:39], s69 offen offset:0 lds
  buffer_load_dwordx4 v15, s[36:39], s69 offen offset:1024 lds
  buffer_load_dwordx4 v16, s[36:39], s69 offen offset:2048 lds
  buffer_load_dwordx4 v17, s[36:39], s69 offen offset:3072 lds
  s_add_u32 s56, s56, 32768
  s_add_u32 s28, s24, 0
  s_addc_u32 s29, s25, 0
  s_mov_b32 s30, 48783360
  s_mov_b32 s31, 0x20000
  v_lshrrev_b32 v30, 2, v2
  v_and_b32 v31, 3, v2
  v_lshl_add_u32 v32, v3, 3, v30
  v_lshlrev_b32 v32, 8, v32
  v_lshl_add_u32 v32, v31, 3, v32
  v_add_u32 v32, 16384, v32
  v_and_b32 v33, 1, v3
  v_lshl_add_u32 v33, v33, 2, v30
  s_lshl_b32 s46, s53, 2
  s_lshl_b32 s47, s52, 1
  s_or_b32 s57, s46, s47
  s_xor_b32 s46, s57, 0
  v_xor_b32 v34, s46, v33
  v_lshl_add_u32 v20, v34, 5, v32
  s_xor_b32 s46, s57, 1
  v_xor_b32 v34, s46, v33
  v_lshl_add_u32 v21, v34, 5, v32
  s_xor_b32 s46, s57, 2
  v_xor_b32 v34, s46, v33
  v_lshl_add_u32 v22, v34, 5, v32
  s_xor_b32 s46, s57, 3
  v_xor_b32 v34, s46, v33
  v_lshl_add_u32 v23, v34, 5, v32
  v_lshrrev_b32 v30, 1, v2
  v_xor_b32 v30, v30, v3
  v_lshlrev_b32 v31, 7, v2
  s_lshl_b32 s46, s52, 13
  s_lshl_b32 s47, s53, 12
  s_add_u32 s46, s46, s47
  s_xor_b32 s47, s46, 4096
  v_lshl_add_u32 v32, v30, 4, v31
  v_xor_b32 v33, 64, v32
  v_add_u32 v24, s46, v32
  v_add_u32 v25, s47, v32
  v_add_u32 v26, s46, v33
  v_add_u32 v27, s47, v33
  v_mov_b32 v48, 0
  v_mov_b32 v49, 0
  v_mov_b32 v50, 0
  v_mov_b32 v51, 0
  v_mov_b32 v52, 0
  v_mov_b32 v53, 0
  v_mov_b32 v54, 0
  v_mov_b32 v55, 0
  v_mov_b32 v56, 0
  v_mov_b32 v57, 0
  v_mov_b32 v58, 0
  v_mov_b32 v59, 0
  v_mov_b32 v60, 0
  v_mov_b32 v61, 0
  v_mov_b32 v62, 0
  v_mov_b32 v63, 0
  v_mov_b32 v64, 0
  v_mov_b32 v65, 0
  v_mov_b32 v66, 0
  v_mov_b32 v67, 0
  v_mov_b32 v68, 0
  v_mov_b32 v69, 0
  v_mov_b32 v70, 0
  v_mov_b32 v71, 0
  v_mov_b32 v72, 0
  v_mov_b32 v73, 0
  v_mov_b32 v74, 0
  v_mov_b32 v75, 0
  v_mov_b32 v76, 0
  v_mov_b32 v77, 0
  v_mov_b32 v78, 0
  v_mov_b32 v79, 0
  v_mov_b32 v80, 0
  v_mov_b32 v81, 0
  v_mov_b32 v82, 0
  v_mov_b32 v83, 0
  v_mov_b32 v84, 0
  v_mov_b32 v85, 0
  v_mov_b32 v86, 0
  v_mov_b32 v87, 0
  v_mov_b32 v88, 0
  v_mov_b32 v89, 0
  v_mov_b32 v90, 0
  v_mov_b32 v91, 0
  v_mov_b32 v92, 0
  v_mov_b32 v93, 0
  v_mov_b32 v94, 0
  v_mov_b32 v95, 0
  v_mov_b32 v96, 0
  v_mov_b32 v97, 0
  v_mov_b32 v98, 0
  v_mov_b32 v99, 0
  v_mov_b32 v100, 0
  v_mov_b32 v101, 0
  v_mov_b32 v102, 0
  v_mov_b32 v103, 0
  v_mov_b32 v104, 0
  v_mov_b32 v105, 0
  v_mov_b32 v106, 0
  v_mov_b32 v107, 0
  v_mov_b32 v108, 0
  v_mov_b32 v109, 0
  v_mov_b32 v110, 0
  v_mov_b32 v111, 0
  v_mov_b32 v112, 0
  v_mov_b32 v113, 0
  v_mov_b32 v114, 0
  v_mov_b32 v115, 0
  v_mov_b32 v116, 0
  v_mov_b32 v117, 0
  v_mov_b32 v118, 0
  v_mov_b32 v119, 0
  v_mov_b32 v120, 0
  v_mov_b32 v121, 0
  v_mov_b32 v122, 0
  v_mov_b32 v123, 0
  v_mov_b32 v124, 0
  v_mov_b32 v125, 0
  v_mov_b32 v126, 0
  v_mov_b32 v127, 0
  v_mov_b32 v128, 0
  v_mov_b32 v129, 0
  v_mov_b32 v130, 0
  v_mov_b32 v131, 0
  v_mov_b32 v132, 0
  v_mov_b32 v133, 0
  v_mov_b32 v134, 0
  v_mov_b32 v135, 0
  v_mov_b32 v136, 0
  v_mov_b32 v137, 0
  v_mov_b32 v138, 0
  v_mov_b32 v139, 0
  v_mov_b32 v140, s44
  v_mov_b32 v141, s44
  v_mov_b32 v142, s44
  v_mov_b32 v143, s44
  v_add_u32 v28, 0, v20
  v_add_u32 v29, 0, v21
  v_add_u32 v30, 0, v22
  v_add_u32 v31, 0, v23
  v_add_u32 v32, 0, v24
  v_add_u32 v33, 0, v25
  v_add_u32 v34, 0, v26
  v_add_u32 v35, 0, v27
  s_lshl_b32 s60, s51, 1
  s_add_u32 s60, s60, s53
  s_lshl_b32 s46, s50, 1
  s_add_u32 s46, s46, s52
  s_lshl_b32 s46, s46, 1
  s_add_u32 s47, s46, s53
  s_xor_b32 s46, s47, 1
  s_mul_i32 s65, s47, 2304
  s_mul_i32 s66, s46, 2304
  s_mov_b32 s64, 147456
  s_mov_b32 s58, 0
  s_mov_b32 s59, 0
  s_cmp_ge_u32 s51, 9
  s_cbranch_scc1 L_p1_v0
L_p1_qk0:
  s_mov_b32 s62, 589824
  s_cmp_ge_u32 s60, 9
  s_cselect_b32 s61, 144, 0
  s_cselect_b32 s62, 2949120, s62
  s_cselect_b32 s73, 1.0, 1051597459
  s_lshl_b32 s63, s60, 4
  s_sub_u32 s63, s63, s61
  s_lshl_b32 s46, s52, 1
  s_xor_b32 s46, s46, 0
  s_lshl_b32 s46, s46, 2
  s_add_u32 s46, s46, s63
  v_add_u32 v212, s46, v3
  v_mul_u32_u24 v213, 7282, v212
  v_lshrrev_b32 v213, 16, v213
  v_mul_u32_u24 v214, 9, v213
  v_sub_u32 v212, v212, v214
  v_cmp_lt_u32 vcc, 4, v212
  s_nop 1
  v_subb_co_u32 v214, vcc, v212, 0, vcc
  v_cmp_eq_u32 vcc, 4, v212
  s_nop 1
  v_cndmask_b32 v214, v214, 8, vcc
  v_mul_lo_u32 v213, v213, s64
  v_lshl_add_u32 v213, v214, 8, v213
  v_lshl_add_u32 v208, v2, 4, v213
  s_lshl_b32 s46, s52, 1
  s_xor_b32 s46, s46, 1
  s_lshl_b32 s46, s46, 2
  s_add_u32 s46, s46, s63
  v_add_u32 v212, s46, v3
  v_mul_u32_u24 v213, 7282, v212
  v_lshrrev_b32 v213, 16, v213
  v_mul_u32_u24 v214, 9, v213
  v_sub_u32 v212, v212, v214
  v_cmp_lt_u32 vcc, 4, v212
  s_nop 1
  v_subb_co_u32 v214, vcc, v212, 0, vcc
  v_cmp_eq_u32 vcc, 4, v212
  s_nop 1
  v_cndmask_b32 v214, v214, 8, vcc
  v_mul_lo_u32 v213, v213, s64
  v_lshl_add_u32 v213, v214, 8, v213
  v_lshl_add_u32 v209, v2, 4, v213
  s_lshl_b32 s46, s52, 1
  s_xor_b32 s46, s46, 2
  s_lshl_b32 s46, s46, 2
  s_add_u32 s46, s46, s63
  v_add_u32 v212, s46, v3
  v_mul_u32_u24 v213, 7282, v212
  v_lshrrev_b32 v213, 16, v213
  v_mul_u32_u24 v214, 9, v213
  v_sub_u32 v212, v212, v214
  v_cmp_lt_u32 vcc, 4, v212
  s_nop 1
  v_subb_co_u32 v214, vcc, v212, 0, vcc
  v_cmp_eq_u32 vcc, 4, v212
  s_nop 1
  v_cndmask_b32 v214, v214, 8, vcc
  v_mul_lo_u32 v213, v213, s64
  v_lshl_add_u32 v213, v214, 8, v213
  v_lshl_add_u32 v210, v2, 4, v213
  s_lshl_b32 s46, s52, 1
  s_xor_b32 s46, s46, 3
  s_lshl_b32 s46, s46, 2
  s_add_u32 s46, s46, s63
  v_add_u32 v212, s46, v3
  v_mul_u32_u24 v213, 7282, v212
  v_lshrrev_b32 v213, 16, v213
  v_mul_u32_u24 v214, 9, v213
  v_sub_u32 v212, v212, v214
  v_cmp_lt_u32 vcc, 4, v212
  s_nop 1
  v_subb_co_u32 v214, vcc, v212, 0, vcc
  v_cmp_eq_u32 vcc, 4, v212
  s_nop 1
  v_cndmask_b32 v214, v214, 8, vcc
  v_mul_lo_u32 v213, v213, s64
  v_lshl_add_u32 v213, v214, 8, v213
  v_lshl_add_u32 v211, v2, 4, v213
  s_add_u32 s65, s65, s62
  s_add_u32 s66, s66, s62
  s_mov_b32 m0, s56
  s_lshl_b32 s68, s67, 7
  s_add_u32 s68, s68, s54
  buffer_load_dwordx4 v10, s[32:35], s68 offen offset:0 lds
  s_mul_i32 s69, s67, 221184
  s_add_u32 s69, s69, s55
  buffer_load_dwordx4 v11, s[32:35], s68 offen offset:1024 lds
  s_add_u32 s67, s67, 1
  s_cmp_eq_u32 s67, 9
  s_cselect_b32 s67, 0, s67
  buffer_load_dwordx4 v12, s[32:35], s68 offen offset:2048 lds
  buffer_load_dwordx4 v13, s[32:35], s68 offen offset:3072 lds
  s_add_u32 m0, s56, 16384
  s_nop 0
  buffer_load_dwordx4 v14, s[36:39], s69 offen offset:0 lds
  buffer_load_dwordx4 v15, s[36:39], s69 offen offset:1024 lds
  buffer_load_dwordx4 v16, s[36:39], s69 offen offset:2048 lds
  buffer_load_dwordx4 v17, s[36:39], s69 offen offset:3072 lds
  s_add_u32 s56, s56, 32768
  s_waitcnt vmcnt(8)
  s_barrier
  ds_read_b128 v[144:147], v32 offset:0
  ds_read_b64_tr_b16 v[176:177], v28 offset:0
  ds_read_b64_tr_b16 v[178:179], v28 offset:1024
  ds_read_b128 v[148:151], v32 offset:2048
  ds_read_b64_tr_b16 v[180:181], v29 offset:0
  ds_read_b64_tr_b16 v[182:183], v29 offset:1024
  ds_read_b128 v[152:155], v33 offset:0
  ds_read_b64_tr_b16 v[184:185], v30 offset:0
  ds_read_b64_tr_b16 v[186:187], v30 offset:1024
  ds_read_b128 v[156:159], v33 offset:2048
  ds_read_b64_tr_b16 v[188:189], v31 offset:0
  ds_read_b64_tr_b16 v[190:191], v31 offset:1024
L_p1_qk:
  s_cmp_ge_u32 s58, 7
  s_cbranch_scc1 L_p1_qk_n
  s_waitcnt lgkmcnt(0)
  v_mfma_f32_16x16x32_bf16 v[48:51], v[176:179], v[144:147], v[48:51]
  ds_read_b128 v[160:163], v34 offset:0
  v_mfma_f32_16x16x32_bf16 v[52:55], v[176:179], v[148:151], v[52:55]
  ds_read_b64_tr_b16 v[192:193], v28 offset:8192
  v_mfma_f32_16x16x32_bf16 v[56:59], v[176:179], v[152:155], v[56:59]
  ds_read_b64_tr_b16 v[194:195], v28 offset:9216
  v_mfma_f32_16x16x32_bf16 v[60:63], v[176:179], v[156:159], v[60:63]
  ds_read_b128 v[164:167], v34 offset:2048
  v_mfma_f32_16x16x32_bf16 v[112:115], v[176:179], v[140:143], v[112:115]
  ds_read_b64_tr_b16 v[196:197], v29 offset:8192
  v_mfma_f32_16x16x32_bf16 v[120:123], v[140:143], v[144:147], v[120:123]
  ds_read_b64_tr_b16 v[198:199], v29 offset:9216
  v_mfma_f32_16x16x32_bf16 v[64:67], v[180:183], v[144:147], v[64:67]
  v_mfma_f32_16x16x32_bf16 v[68:71], v[180:183], v[148:151], v[68:71]
  ds_read_b128 v[168:171], v35 offset:0
  v_mfma_f32_16x16x32_bf16 v[72:75], v[180:183], v[152:155], v[72:75]
  ds_read_b64_tr_b16 v[200:201], v30 offset:8192
  v_mfma_f32_16x16x32_bf16 v[76:79], v[180:183], v[156:159], v[76:79]
  ds_read_b64_tr_b16 v[202:203], v30 offset:9216
  v_mfma_f32_16x16x32_bf16 v[116:119], v[180:183], v[140:143], v[116:119]
  ds_read_b128 v[172:175], v35 offset:2048
  v_mfma_f32_16x16x32_bf16 v[124:127], v[144:147], v[144:147], v[124:127]
  ds_read_b64_tr_b16 v[204:205], v31 offset:8192
  v_mfma_f32_16x16x32_bf16 v[80:83], v[184:187], v[144:147], v[80:83]
  ds_read_b64_tr_b16 v[206:207], v31 offset:9216
  v_mfma_f32_16x16x32_bf16 v[84:87], v[184:187], v[148:151], v[84:87]
  v_mfma_f32_16x16x32_bf16 v[88:91], v[184:187], v[152:155], v[88:91]
  s_mov_b32 m0, s56
  s_lshl_b32 s68, s67, 7
  s_add_u32 s68, s68, s54
  buffer_load_dwordx4 v10, s[32:35], s68 offen offset:0 lds
  v_mfma_f32_16x16x32_bf16 v[92:95], v[184:187], v[156:159], v[92:95]
  v_mfma_f32_16x16x32_bf16 v[128:131], v[140:143], v[148:151], v[128:131]
  s_mul_i32 s69, s67, 221184
  s_add_u32 s69, s69, s55
  buffer_load_dwordx4 v11, s[32:35], s68 offen offset:1024 lds
  v_mfma_f32_16x16x32_bf16 v[96:99], v[188:191], v[144:147], v[96:99]
  v_mfma_f32_16x16x32_bf16 v[100:103], v[188:191], v[148:151], v[100:103]
  s_add_u32 s67, s67, 1
  s_cmp_eq_u32 s67, 9
  s_cselect_b32 s67, 0, s67
  buffer_load_dwordx4 v12, s[32:35], s68 offen offset:2048 lds
  v_mfma_f32_16x16x32_bf16 v[104:107], v[188:191], v[152:155], v[104:107]
  v_mfma_f32_16x16x32_bf16 v[108:111], v[188:191], v[156:159], v[108:111]
  buffer_load_dwordx4 v13, s[32:35], s68 offen offset:3072 lds
  v_mfma_f32_16x16x32_bf16 v[132:135], v[148:151], v[148:151], v[132:135]
  s_add_u32 s58, s58, 1
  s_add_u32 s59, s59, 32768
  s_cmp_eq_u32 s59, 163840
  s_cselect_b32 s59, 0, s59
  s_waitcnt vmcnt(4) lgkmcnt(0)
  s_barrier
  v_mfma_f32_16x16x32_bf16 v[48:51], v[192:195], v[160:163], v[48:51]
  v_add_u32 v32, s59, v24
  v_add_u32 v33, s59, v25
  v_mfma_f32_16x16x32_bf16 v[52:55], v[192:195], v[164:167], v[52:55]
  v_add_u32 v28, s59, v20
  v_add_u32 v29, s59, v21
  v_mfma_f32_16x16x32_bf16 v[56:59], v[192:195], v[168:171], v[56:59]
  v_add_u32 v30, s59, v22
  v_add_u32 v31, s59, v23
  v_mfma_f32_16x16x32_bf16 v[60:63], v[192:195], v[172:175], v[60:63]
  ds_read_b128 v[144:147], v32 offset:0
  ds_read_b64_tr_b16 v[176:177], v28 offset:0
  v_mfma_f32_16x16x32_bf16 v[112:115], v[192:195], v[140:143], v[112:115]
  ds_read_b64_tr_b16 v[178:179], v28 offset:1024
  v_mfma_f32_16x16x32_bf16 v[120:123], v[140:143], v[160:163], v[120:123]
  ds_read_b128 v[148:151], v32 offset:2048
  v_mfma_f32_16x16x32_bf16 v[64:67], v[196:199], v[160:163], v[64:67]
  ds_read_b64_tr_b16 v[180:181], v29 offset:0
  v_mfma_f32_16x16x32_bf16 v[68:71], v[196:199], v[164:167], v[68:71]
  ds_read_b64_tr_b16 v[182:183], v29 offset:1024
  v_mfma_f32_16x16x32_bf16 v[72:75], v[196:199], v[168:171], v[72:75]
  ds_read_b128 v[152:155], v33 offset:0
  v_mfma_f32_16x16x32_bf16 v[76:79], v[196:199], v[172:175], v[76:79]
  ds_read_b64_tr_b16 v[184:185], v30 offset:0
  ds_read_b64_tr_b16 v[186:187], v30 offset:1024
  v_mfma_f32_16x16x32_bf16 v[116:119], v[196:199], v[140:143], v[116:119]
  ds_read_b128 v[156:159], v33 offset:2048
  v_mfma_f32_16x16x32_bf16 v[124:127], v[160:163], v[160:163], v[124:127]
  ds_read_b64_tr_b16 v[188:189], v31 offset:0
  v_mfma_f32_16x16x32_bf16 v[80:83], v[200:203], v[160:163], v[80:83]
  ds_read_b64_tr_b16 v[190:191], v31 offset:1024
  v_mfma_f32_16x16x32_bf16 v[84:87], v[200:203], v[164:167], v[84:87]
  v_add_u32 v34, s59, v26
  v_mfma_f32_16x16x32_bf16 v[88:91], v[200:203], v[168:171], v[88:91]
  v_add_u32 v35, s59, v27
  v_mfma_f32_16x16x32_bf16 v[92:95], v[200:203], v[172:175], v[92:95]
  s_add_u32 m0, s56, 16384
  s_nop 0
  buffer_load_dwordx4 v14, s[36:39], s69 offen offset:0 lds
  v_mfma_f32_16x16x32_bf16 v[128:131], v[140:143], v[164:167], v[128:131]
  buffer_load_dwordx4 v15, s[36:39], s69 offen offset:1024 lds
  v_mfma_f32_16x16x32_bf16 v[96:99], v[204:207], v[160:163], v[96:99]
  v_mfma_f32_16x16x32_bf16 v[100:103], v[204:207], v[164:167], v[100:103]
  buffer_load_dwordx4 v16, s[36:39], s69 offen offset:2048 lds
  v_mfma_f32_16x16x32_bf16 v[104:107], v[204:207], v[168:171], v[104:107]
  v_mfma_f32_16x16x32_bf16 v[108:111], v[204:207], v[172:175], v[108:111]
  buffer_load_dwordx4 v17, s[36:39], s69 offen offset:3072 lds
  v_mfma_f32_16x16x32_bf16 v[132:135], v[164:167], v[164:167], v[132:135]
  s_add_u32 s56, s56, 32768
  s_cmp_ge_u32 s56, 163840
  s_cselect_b32 s46, 163840, 0
  s_sub_u32 s56, s56, s46
  s_branch L_p1_qk
L_p1_qk_n:
  s_waitcnt lgkmcnt(0)
  v_mfma_f32_16x16x32_bf16 v[48:51], v[176:179], v[144:147], v[48:51]
  ds_read_b128 v[160:163], v34 offset:0
  v_mfma_f32_16x16x32_bf16 v[52:55], v[176:179], v[148:151], v[52:55]
  ds_read_b64_tr_b16 v[192:193], v28 offset:8192
  v_mfma_f32_16x16x32_bf16 v[56:59], v[176:179], v[152:155], v[56:59]
  ds_read_b64_tr_b16 v[194:195], v28 offset:9216
  v_mfma_f32_16x16x32_bf16 v[60:63], v[176:179], v[156:159], v[60:63]
  ds_read_b128 v[164:167], v34 offset:2048
  v_mfma_f32_16x16x32_bf16 v[112:115], v[176:179], v[140:143], v[112:115]
  ds_read_b64_tr_b16 v[196:197], v29 offset:8192
  v_mfma_f32_16x16x32_bf16 v[120:123], v[140:143], v[144:147], v[120:123]
  ds_read_b64_tr_b16 v[198:199], v29 offset:9216
  v_mfma_f32_16x16x32_bf16 v[64:67], v[180:183], v[144:147], v[64:67]
  v_mfma_f32_16x16x32_bf16 v[68:71], v[180:183], v[148:151], v[68:71]
  ds_read_b128 v[168:171], v35 offset:0
  v_mfma_f32_16x16x32_bf16 v[72:75], v[180:183], v[152:155], v[72:75]
  ds_read_b64_tr_b16 v[200:201], v30 offset:8192
  v_mfma_f32_16x16x32_bf16 v[76:79], v[180:183], v[156:159], v[76:79]
  ds_read_b64_tr_b16 v[202:203], v30 offset:9216
  v_mfma_f32_16x16x32_bf16 v[116:119], v[180:183], v[140:143], v[116:119]
  ds_read_b128 v[172:175], v35 offset:2048
  v_mfma_f32_16x16x32_bf16 v[124:127], v[144:147], v[144:147], v[124:127]
  ds_read_b64_tr_b16 v[204:205], v31 offset:8192
  v_mfma_f32_16x16x32_bf16 v[80:83], v[184:187], v[144:147], v[80:83]
  ds_read_b64_tr_b16 v[206:207], v31 offset:9216
  v_mfma_f32_16x16x32_bf16 v[84:87], v[184:187], v[148:151], v[84:87]
  v_mfma_f32_16x16x32_bf16 v[88:91], v[184:187], v[152:155], v[88:91]
  v_mfma_f32_16x16x32_bf16 v[92:95], v[184:187], v[156:159], v[92:95]
  v_mfma_f32_16x16x32_bf16 v[128:131], v[140:143], v[148:151], v[128:131]
  v_mfma_f32_16x16x32_bf16 v[96:99], v[188:191], v[144:147], v[96:99]
  v_mfma_f32_16x16x32_bf16 v[100:103], v[188:191], v[148:151], v[100:103]
  v_mfma_f32_16x16x32_bf16 v[104:107], v[188:191], v[152:155], v[104:107]
  v_mfma_f32_16x16x32_bf16 v[108:111], v[188:191], v[156:159], v[108:111]
  v_mfma_f32_16x16x32_bf16 v[132:135], v[148:151], v[148:151], v[132:135]
  s_add_u32 s58, s58, 1
  s_add_u32 s59, s59, 32768
  s_cmp_eq_u32 s59, 163840
  s_cselect_b32 s59, 0, s59
  s_waitcnt vmcnt(0) lgkmcnt(0)
  s_barrier
  s_cmp_eq_u32 s58, 9
  s_cbranch_scc1 L_p1_qk_e
  v_mfma_f32_16x16x32_bf16 v[48:51], v[192:195], v[160:163], v[48:51]
  v_add_u32 v32, s59, v24
  v_add_u32 v33, s59, v25
  v_mfma_f32_16x16x32_bf16 v[52:55], v[192:195], v[164:167], v[52:55]
  v_add_u32 v28, s59, v20
  v_add_u32 v29, s59, v21
  v_mfma_f32_16x16x32_bf16 v[56:59], v[192:195], v[168:171], v[56:59]
  v_add_u32 v30, s59, v22
  v_add_u32 v31, s59, v23
  v_mfma_f32_16x16x32_bf16 v[60:63], v[192:195], v[172:175], v[60:63]
  ds_read_b128 v[144:147], v32 offset:0
  ds_read_b64_tr_b16 v[176:177], v28 offset:0
  v_mfma_f32_16x16x32_bf16 v[112:115], v[192:195], v[140:143], v[112:115]
  ds_read_b64_tr_b16 v[178:179], v28 offset:1024
  v_mfma_f32_16x16x32_bf16 v[120:123], v[140:143], v[160:163], v[120:123]
  ds_read_b128 v[148:151], v32 offset:2048
  v_mfma_f32_16x16x32_bf16 v[64:67], v[196:199], v[160:163], v[64:67]
  ds_read_b64_tr_b16 v[180:181], v29 offset:0
  v_mfma_f32_16x16x32_bf16 v[68:71], v[196:199], v[164:167], v[68:71]
  ds_read_b64_tr_b16 v[182:183], v29 offset:1024
  v_mfma_f32_16x16x32_bf16 v[72:75], v[196:199], v[168:171], v[72:75]
  ds_read_b128 v[152:155], v33 offset:0
  v_mfma_f32_16x16x32_bf16 v[76:79], v[196:199], v[172:175], v[76:79]
  ds_read_b64_tr_b16 v[184:185], v30 offset:0
  ds_read_b64_tr_b16 v[186:187], v30 offset:1024
  v_mfma_f32_16x16x32_bf16 v[116:119], v[196:199], v[140:143], v[116:119]
  ds_read_b128 v[156:159], v33 offset:2048
  v_mfma_f32_16x16x32_bf16 v[124:127], v[160:163], v[160:163], v[124:127]
  ds_read_b64_tr_b16 v[188:189], v31 offset:0
  v_mfma_f32_16x16x32_bf16 v[80:83], v[200:203], v[160:163], v[80:83]
  ds_read_b64_tr_b16 v[190:191], v31 offset:1024
  v_mfma_f32_16x16x32_bf16 v[84:87], v[200:203], v[164:167], v[84:87]
  v_add_u32 v34, s59, v26
  v_mfma_f32_16x16x32_bf16 v[88:91], v[200:203], v[168:171], v[88:91]
  v_add_u32 v35, s59, v27
  v_mfma_f32_16x16x32_bf16 v[92:95], v[200:203], v[172:175], v[92:95]
  v_mfma_f32_16x16x32_bf16 v[128:131], v[140:143], v[164:167], v[128:131]
  v_mfma_f32_16x16x32_bf16 v[96:99], v[204:207], v[160:163], v[96:99]
  v_mfma_f32_16x16x32_bf16 v[100:103], v[204:207], v[164:167], v[100:103]
  v_mfma_f32_16x16x32_bf16 v[104:107], v[204:207], v[168:171], v[104:107]
  v_mfma_f32_16x16x32_bf16 v[108:111], v[204:207], v[172:175], v[108:111]
  v_mfma_f32_16x16x32_bf16 v[132:135], v[164:167], v[164:167], v[132:135]
  s_branch L_p1_qk_n
L_p1_qk_e:
  v_mfma_f32_16x16x32_bf16 v[112:115], v[192:195], v[140:143], v[112:115]
  v_mfma_f32_16x16x32_bf16 v[120:123], v[140:143], v[160:163], v[120:123]
  v_mfma_f32_16x16x32_bf16 v[116:119], v[196:199], v[140:143], v[116:119]
  v_mfma_f32_16x16x32_bf16 v[124:127], v[160:163], v[160:163], v[124:127]
  v_mfma_f32_16x16x32_bf16 v[128:131], v[140:143], v[164:167], v[128:131]
  v_mfma_f32_16x16x32_bf16 v[132:135], v[164:167], v[164:167], v[132:135]
  v_mfma_f32_16x16x32_bf16 v[48:51], v[192:195], v[160:163], v[48:51]
  v_and_b32 v40, 1, v2
  v_cmp_eq_u32 s[74:75], 1, v40
  v_and_b32 v40, 2, v2
  v_mfma_f32_16x16x32_bf16 v[52:55], v[192:195], v[164:167], v[52:55]
  v_cmp_eq_u32 s[76:77], 2, v40
  v_lshrrev_b32 v40, 2, v2
  v_cmp_eq_u32 s[78:79], v40, v3
  v_mfma_f32_16x16x32_bf16 v[56:59], v[192:195], v[168:171], v[56:59]
  s_mov_b32 s46, 987991609
  s_mov_b32 s47, 925353388
  v_mfma_f32_16x16x32_bf16 v[60:63], v[192:195], v[172:175], v[60:63]
  v_cndmask_b32 v124, v124, v125, s[74:75]
  v_cndmask_b32 v126, v126, v127, s[74:75]
  v_mul_f32 v120, s46, v120
  v_mfma_f32_16x16x32_bf16 v[64:67], v[196:199], v[160:163], v[64:67]
  v_cndmask_b32 v124, v124, v126, s[76:77]
  v_mul_f32 v42, v120, v120
  v_mfma_f32_16x16x32_bf16 v[68:71], v[196:199], v[164:167], v[68:71]
  v_fma_f32 v124, v124, s46, -v42
  v_max_f32 v124, 0, v124
  v_mfma_f32_16x16x32_bf16 v[72:75], v[196:199], v[168:171], v[72:75]
  v_add_f32 v124, s47, v124
  v_rsq_f32 v36, v124
  v_mfma_f32_16x16x32_bf16 v[76:79], v[196:199], v[172:175], v[76:79]
  v_mul_f32 v37, v36, -v120
  v_cndmask_b32 v132, v132, v133, s[74:75]
  v_cndmask_b32 v134, v134, v135, s[74:75]
  v_mfma_f32_16x16x32_bf16 v[80:83], v[200:203], v[160:163], v[80:83]
  v_mul_f32 v128, s46, v128
  v_cndmask_b32 v132, v132, v134, s[76:77]
  v_mfma_f32_16x16x32_bf16 v[84:87], v[200:203], v[164:167], v[84:87]
  v_mul_f32 v42, v128, v128
  v_fma_f32 v132, v132, s46, -v42
  v_mfma_f32_16x16x32_bf16 v[88:91], v[200:203], v[168:171], v[88:91]
  v_max_f32 v132, 0, v132
  v_add_f32 v132, s47, v132
  v_mfma_f32_16x16x32_bf16 v[92:95], v[200:203], v[172:175], v[92:95]
  v_rsq_f32 v38, v132
  s_nop 0
  v_mul_f32 v39, v38, -v128
  s_lshl_b32 s46, s52, 9
  v_mfma_f32_16x16x32_bf16 v[96:99], v[204:207], v[160:163], v[96:99]
  s_lshl_b32 s47, s53, 8
  s_add_u32 s46, s46, s47
  v_mfma_f32_16x16x32_bf16 v[100:103], v[204:207], v[164:167], v[100:103]
  v_lshl_add_u32 v40, v2, 3, s46
  s_mov_b64 exec, s[78:79]
  ds_write_b64 v40, v[36:37]
  ds_write_b64 v40, v[38:39] offset:128
  s_mov_b64 exec, -1
  v_mfma_f32_16x16x32_bf16 v[104:107], v[204:207], v[168:171], v[104:107]
  s_lshl_b32 s47, s57, 6
  v_lshl_add_u32 v41, v3, 4, s47
  v_mfma_f32_16x16x32_bf16 v[108:111], v[204:207], v[172:175], v[108:111]
  ds_write_b128 v41, v[112:115] offset:1024
  ds_write_b128 v41, v[116:119] offset:1088
  s_waitcnt lgkmcnt(0)
  s_barrier
  v_mov_b32 v36, 0
  v_mov_b32 v37, 0
  s_cmp_ge_u32 s60, 27
  s_cbranch_scc1 L_p1_qk_s
  v_xor_b32 v42, 256, v40
  v_xor_b32 v43, 128, v41
  ds_read_b64 v[144:145], v40
  ds_read_b64 v[146:147], v40 offset:128
  ds_read_b64 v[148:149], v42
  ds_read_b64 v[150:151], v42 offset:128
  ds_read_b128 v[160:163], v41 offset:1024
  ds_read_b128 v[164:167], v41 offset:1088
  ds_read_b128 v[168:171], v43 offset:1024
  ds_read_b128 v[172:175], v43 offset:1088
  s_waitcnt lgkmcnt(0)
  v_pk_mul_f32 v[144:145], v[144:145], s[72:73] op_sel:[0,1] op_sel_hi:[1,1]
  v_pk_mul_f32 v[146:147], v[146:147], s[72:73] op_sel:[0,1] op_sel_hi:[1,1]
  v_pk_mul_f32 v[148:149], v[148:149], s[72:73] op_sel:[0,1] op_sel_hi:[1,1]
  v_pk_mul_f32 v[150:151], v[150:151], s[72:73] op_sel:[0,1] op_sel_hi:[1,1]
  v_pk_mul_f32 v[216:217], v[160:161], v[144:145] op_sel:[0,1] op_sel_hi:[1,1]
  v_pk_mul_f32 v[218:219], v[162:163], v[144:145] op_sel:[0,1] op_sel_hi:[1,1]
  v_pk_fma_f32 v[48:49], v[48:49], v[144:145], v[216:217] op_sel_hi:[1,0,1]
  v_pk_fma_f32 v[50:51], v[50:51], v[144:145], v[218:219] op_sel_hi:[1,0,1]
  v_max3_f32 v36, |v48|, |v49|, v36
  v_max3_f32 v37, |v50|, |v51|, v37
  v_cvt_pk_bf16_f32 v48, v48, v49
  v_cvt_pk_bf16_f32 v49, v50, v51
  v_pk_mul_f32 v[216:217], v[160:161], v[146:147] op_sel:[0,1] op_sel_hi:[1,1]
  v_pk_mul_f32 v[218:219], v[162:163], v[146:147] op_sel:[0,1] op_sel_hi:[1,1]
  v_pk_fma_f32 v[52:53], v[52:53], v[146:147], v[216:217] op_sel_hi:[1,0,1]
  v_pk_fma_f32 v[54:55], v[54:55], v[146:147], v[218:219] op_sel_hi:[1,0,1]
  v_max3_f32 v36, |v52|, |v53|, v36
  v_max3_f32 v37, |v54|, |v55|, v37
  v_cvt_pk_bf16_f32 v50, v52, v53
  v_cvt_pk_bf16_f32 v51, v54, v55
  buffer_store_dwordx4 v[48:51], v208, s[28:31], s65 offen sc1
  v_pk_mul_f32 v[216:217], v[160:161], v[148:149] op_sel:[0,1] op_sel_hi:[1,1]
  v_pk_mul_f32 v[218:219], v[162:163], v[148:149] op_sel:[0,1] op_sel_hi:[1,1]
  v_pk_fma_f32 v[56:57], v[56:57], v[148:149], v[216:217] op_sel_hi:[1,0,1]
  v_pk_fma_f32 v[58:59], v[58:59], v[148:149], v[218:219] op_sel_hi:[1,0,1]
  v_max3_f32 v36, |v56|, |v57|, v36
  v_max3_f32 v37, |v58|, |v59|, v37
  v_cvt_pk_bf16_f32 v56, v56, v57
  v_cvt_pk_bf16_f32 v57, v58, v59
  v_pk_mul_f32 v[216:217], v[160:161], v[150:151] op_sel:[0,1] op_sel_hi:[1,1]
  v_pk_mul_f32 v[218:219], v[162:163], v[150:151] op_sel:[0,1] op_sel_hi:[1,1]
  v_pk_fma_f32 v[60:61], v[60:61], v[150:151], v[216:217] op_sel_hi:[1,0,1]
  v_pk_fma_f32 v[62:63], v[62:63], v[150:151], v[218:219] op_sel_hi:[1,0,1]
  v_max3_f32 v36, |v60|, |v61|, v36
  v_max3_f32 v37, |v62|, |v63|, v37
  v_cvt_pk_bf16_f32 v58, v60, v61
  v_cvt_pk_bf16_f32 v59, v62, v63
  buffer_store_dwordx4 v[56:59], v208, s[28:31], s66 offen sc1
  v_pk_mul_f32 v[216:217], v[164:165], v[144:145] op_sel:[0,1] op_sel_hi:[1,1]
  v_pk_mul_f32 v[218:219], v[166:167], v[144:145] op_sel:[0,1] op_sel_hi:[1,1]
  v_pk_fma_f32 v[64:65], v[64:65], v[144:145], v[216:217] op_sel_hi:[1,0,1]
  v_pk_fma_f32 v[66:67], v[66:67], v[144:145], v[218:219] op_sel_hi:[1,0,1]
  v_max3_f32 v36, |v64|, |v65|, v36
  v_max3_f32 v37, |v66|, |v67|, v37
  v_cvt_pk_bf16_f32 v64, v64, v65
  v_cvt_pk_bf16_f32 v65, v66, v67
  v_pk_mul_f32 v[216:217], v[164:165], v[146:147] op_sel:[0,1] op_sel_hi:[1,1]
  v_pk_mul_f32 v[218:219], v[166:167], v[146:147] op_sel:[0,1] op_sel_hi:[1,1]
  v_pk_fma_f32 v[68:69], v[68:69], v[146:147], v[216:217] op_sel_hi:[1,0,1]
  v_pk_fma_f32 v[70:71], v[70:71], v[146:147], v[218:219] op_sel_hi:[1,0,1]
  v_max3_f32 v36, |v68|, |v69|, v36
  v_max3_f32 v37, |v70|, |v71|, v37
  v_cvt_pk_bf16_f32 v66, v68, v69
  v_cvt_pk_bf16_f32 v67, v70, v71
  buffer_store_dwordx4 v[64:67], v209, s[28:31], s65 offen sc1
  v_pk_mul_f32 v[216:217], v[164:165], v[148:149] op_sel:[0,1] op_sel_hi:[1,1]
  v_pk_mul_f32 v[218:219], v[166:167], v[148:149] op_sel:[0,1] op_sel_hi:[1,1]
  v_pk_fma_f32 v[72:73], v[72:73], v[148:149], v[216:217] op_sel_hi:[1,0,1]
  v_pk_fma_f32 v[74:75], v[74:75], v[148:149], v[218:219] op_sel_hi:[1,0,1]
  v_max3_f32 v36, |v72|, |v73|, v36
  v_max3_f32 v37, |v74|, |v75|, v37
  v_cvt_pk_bf16_f32 v72, v72, v73
  v_cvt_pk_bf16_f32 v73, v74, v75
  v_pk_mul_f32 v[216:217], v[164:165], v[150:151] op_sel:[0,1] op_sel_hi:[1,1]
  v_pk_mul_f32 v[218:219], v[166:167], v[150:151] op_sel:[0,1] op_sel_hi:[1,1]
  v_pk_fma_f32 v[76:77], v[76:77], v[150:151], v[216:217] op_sel_hi:[1,0,1]
  v_pk_fma_f32 v[78:79], v[78:79], v[150:151], v[218:219] op_sel_hi:[1,0,1]
  v_max3_f32 v36, |v76|, |v77|, v36
  v_max3_f32 v37, |v78|, |v79|, v37
  v_cvt_pk_bf16_f32 v74, v76, v77
  v_cvt_pk_bf16_f32 v75, v78, v79
  buffer_store_dwordx4 v[72:75], v209, s[28:31], s66 offen sc1
  v_pk_mul_f32 v[216:217], v[168:169], v[144:145] op_sel:[0,1] op_sel_hi:[1,1]
  v_pk_mul_f32 v[218:219], v[170:171], v[144:145] op_sel:[0,1] op_sel_hi:[1,1]
  v_pk_fma_f32 v[80:81], v[80:81], v[144:145], v[216:217] op_sel_hi:[1,0,1]
  v_pk_fma_f32 v[82:83], v[82:83], v[144:145], v[218:219] op_sel_hi:[1,0,1]
  v_max3_f32 v36, |v80|, |v81|, v36
  v_max3_f32 v37, |v82|, |v83|, v37
  v_cvt_pk_bf16_f32 v80, v80, v81
  v_cvt_pk_bf16_f32 v81, v82, v83
  v_pk_mul_f32 v[216:217], v[168:169], v[146:147] op_sel:[0,1] op_sel_hi:[1,1]
  v_pk_mul_f32 v[218:219], v[170:171], v[146:147] op_sel:[0,1] op_sel_hi:[1,1]
  v_pk_fma_f32 v[84:85], v[84:85], v[146:147], v[216:217] op_sel_hi:[1,0,1]
  v_pk_fma_f32 v[86:87], v[86:87], v[146:147], v[218:219] op_sel_hi:[1,0,1]
  v_max3_f32 v36, |v84|, |v85|, v36
  v_max3_f32 v37, |v86|, |v87|, v37
  v_cvt_pk_bf16_f32 v82, v84, v85
  v_cvt_pk_bf16_f32 v83, v86, v87
  buffer_store_dwordx4 v[80:83], v210, s[28:31], s65 offen sc1
  v_pk_mul_f32 v[216:217], v[168:169], v[148:149] op_sel:[0,1] op_sel_hi:[1,1]
  v_pk_mul_f32 v[218:219], v[170:171], v[148:149] op_sel:[0,1] op_sel_hi:[1,1]
  v_pk_fma_f32 v[88:89], v[88:89], v[148:149], v[216:217] op_sel_hi:[1,0,1]
  v_pk_fma_f32 v[90:91], v[90:91], v[148:149], v[218:219] op_sel_hi:[1,0,1]
  v_max3_f32 v36, |v88|, |v89|, v36
  v_max3_f32 v37, |v90|, |v91|, v37
  v_cvt_pk_bf16_f32 v88, v88, v89
  v_cvt_pk_bf16_f32 v89, v90, v91
  v_pk_mul_f32 v[216:217], v[168:169], v[150:151] op_sel:[0,1] op_sel_hi:[1,1]
  v_pk_mul_f32 v[218:219], v[170:171], v[150:151] op_sel:[0,1] op_sel_hi:[1,1]
  v_pk_fma_f32 v[92:93], v[92:93], v[150:151], v[216:217] op_sel_hi:[1,0,1]
  v_pk_fma_f32 v[94:95], v[94:95], v[150:151], v[218:219] op_sel_hi:[1,0,1]
  v_max3_f32 v36, |v92|, |v93|, v36
  v_max3_f32 v37, |v94|, |v95|, v37
  v_cvt_pk_bf16_f32 v90, v92, v93
  v_cvt_pk_bf16_f32 v91, v94, v95
  buffer_store_dwordx4 v[88:91], v210, s[28:31], s66 offen sc1
  v_pk_mul_f32 v[216:217], v[172:173], v[144:145] op_sel:[0,1] op_sel_hi:[1,1]
  v_pk_mul_f32 v[218:219], v[174:175], v[144:145] op_sel:[0,1] op_sel_hi:[1,1]
  v_pk_fma_f32 v[96:97], v[96:97], v[144:145], v[216:217] op_sel_hi:[1,0,1]
  v_pk_fma_f32 v[98:99], v[98:99], v[144:145], v[218:219] op_sel_hi:[1,0,1]
  v_max3_f32 v36, |v96|, |v97|, v36
  v_max3_f32 v37, |v98|, |v99|, v37
  v_cvt_pk_bf16_f32 v96, v96, v97
  v_cvt_pk_bf16_f32 v97, v98, v99
  v_pk_mul_f32 v[216:217], v[172:173], v[146:147] op_sel:[0,1] op_sel_hi:[1,1]
  v_pk_mul_f32 v[218:219], v[174:175], v[146:147] op_sel:[0,1] op_sel_hi:[1,1]
  v_pk_fma_f32 v[100:101], v[100:101], v[146:147], v[216:217] op_sel_hi:[1,0,1]
  v_pk_fma_f32 v[102:103], v[102:103], v[146:147], v[218:219] op_sel_hi:[1,0,1]
  v_max3_f32 v36, |v100|, |v101|, v36
  v_max3_f32 v37, |v102|, |v103|, v37
  v_cvt_pk_bf16_f32 v98, v100, v101
  v_cvt_pk_bf16_f32 v99, v102, v103
  buffer_store_dwordx4 v[96:99], v211, s[28:31], s65 offen sc1
  v_pk_mul_f32 v[216:217], v[172:173], v[148:149] op_sel:[0,1] op_sel_hi:[1,1]
  v_pk_mul_f32 v[218:219], v[174:175], v[148:149] op_sel:[0,1] op_sel_hi:[1,1]
  v_pk_fma_f32 v[104:105], v[104:105], v[148:149], v[216:217] op_sel_hi:[1,0,1]
  v_pk_fma_f32 v[106:107], v[106:107], v[148:149], v[218:219] op_sel_hi:[1,0,1]
  v_max3_f32 v36, |v104|, |v105|, v36
  v_max3_f32 v37, |v106|, |v107|, v37
  v_cvt_pk_bf16_f32 v104, v104, v105
  v_cvt_pk_bf16_f32 v105, v106, v107
  v_pk_mul_f32 v[216:217], v[172:173], v[150:151] op_sel:[0,1] op_sel_hi:[1,1]
  v_pk_mul_f32 v[218:219], v[174:175], v[150:151] op_sel:[0,1] op_sel_hi:[1,1]
  v_pk_fma_f32 v[108:109], v[108:109], v[150:151], v[216:217] op_sel_hi:[1,0,1]
  v_pk_fma_f32 v[110:111], v[110:111], v[150:151], v[218:219] op_sel_hi:[1,0,1]
  v_max3_f32 v36, |v108|, |v109|, v36
  v_max3_f32 v37, |v110|, |v111|, v37
  v_cvt_pk_bf16_f32 v106, v108, v109
  v_cvt_pk_bf16_f32 v107, v110, v111
  buffer_store_dwordx4 v[104:107], v211, s[28:31], s66 offen sc1
L_p1_qk_s:
  s_branch L_p1_pub
L_p1_v0:
  s_mov_b32 s62, 5308416
  s_sub_u32 s63, s60, 18
  s_lshl_b32 s63, s63, 6
  s_lshl_b32 s46, s52, 1
  s_xor_b32 s46, s46, 0
  s_lshl_b32 s46, s46, 4
  s_add_u32 s46, s46, s63
  v_add_u32 v212, s46, v2
  v_mul_u32_u24 v213, 1821, v212
  v_lshrrev_b32 v213, 16, v213
  v_mul_u32_u24 v214, 36, v213
  v_sub_u32 v212, v212, v214
  v_lshl_add_u32 v214, v3, 4, v212
  v_add_u32 v215, 44, v214
  v_cmp_lt_u32 vcc, 19, v212
  s_nop 1
  v_cndmask_b32 v214, v214, v215, vcc
  v_lshl_add_u32 v215, v212, 2, v3
  v_add_u32 v215, 64, v215
  v_lshrrev_b32 v212, 2, v212
  v_cmp_eq_u32 vcc, 4, v212
  s_nop 1
  v_cndmask_b32 v214, v214, v215, vcc
  v_mul_lo_u32 v213, v213, s64
  v_lshl_add_u32 v208, v214, 4, v213
  s_lshl_b32 s46, s52, 1
  s_xor_b32 s46, s46, 1
  s_lshl_b32 s46, s46, 4
  s_add_u32 s46, s46, s63
  v_add_u32 v212, s46, v2
  v_mul_u32_u24 v213, 1821, v212
  v_lshrrev_b32 v213, 16, v213
  v_mul_u32_u24 v214, 36, v213
  v_sub_u32 v212, v212, v214
  v_lshl_add_u32 v214, v3, 4, v212
  v_add_u32 v215, 44, v214
  v_cmp_lt_u32 vcc, 19, v212
  s_nop 1
  v_cndmask_b32 v214, v214, v215, vcc
  v_lshl_add_u32 v215, v212, 2, v3
  v_add_u32 v215, 64, v215
  v_lshrrev_b32 v212, 2, v212
  v_cmp_eq_u32 vcc, 4, v212
  s_nop 1
  v_cndmask_b32 v214, v214, v215, vcc
  v_mul_lo_u32 v213, v213, s64
  v_lshl_add_u32 v209, v214, 4, v213
  s_lshl_b32 s46, s52, 1
  s_xor_b32 s46, s46, 2
  s_lshl_b32 s46, s46, 4
  s_add_u32 s46, s46, s63
  v_add_u32 v212, s46, v2
  v_mul_u32_u24 v213, 1821, v212
  v_lshrrev_b32 v213, 16, v213
  v_mul_u32_u24 v214, 36, v213
  v_sub_u32 v212, v212, v214
  v_lshl_add_u32 v214, v3, 4, v212
  v_add_u32 v215, 44, v214
  v_cmp_lt_u32 vcc, 19, v212
  s_nop 1
  v_cndmask_b32 v214, v214, v215, vcc
  v_lshl_add_u32 v215, v212, 2, v3
  v_add_u32 v215, 64, v215
  v_lshrrev_b32 v212, 2, v212
  v_cmp_eq_u32 vcc, 4, v212
  s_nop 1
  v_cndmask_b32 v214, v214, v215, vcc
  v_mul_lo_u32 v213, v213, s64
  v_lshl_add_u32 v210, v214, 4, v213
  s_lshl_b32 s46, s52, 1
  s_xor_b32 s46, s46, 3
  s_lshl_b32 s46, s46, 4
  s_add_u32 s46, s46, s63
  v_add_u32 v212, s46, v2
  v_mul_u32_u24 v213, 1821, v212
  v_lshrrev_b32 v213, 16, v213
  v_mul_u32_u24 v214, 36, v213
  v_sub_u32 v212, v212, v214
  v_lshl_add_u32 v214, v3, 4, v212
  v_add_u32 v215, 44, v214
  v_cmp_lt_u32 vcc, 19, v212
  s_nop 1
  v_cndmask_b32 v214, v214, v215, vcc
  v_lshl_add_u32 v215, v212, 2, v3
  v_add_u32 v215, 64, v215
  v_lshrrev_b32 v212, 2, v212
  v_cmp_eq_u32 vcc, 4, v212
  s_nop 1
  v_cndmask_b32 v214, v214, v215, vcc
  v_mul_lo_u32 v213, v213, s64
  v_lshl_add_u32 v211, v214, 4, v213
  s_add_u32 s65, s65, s62
  s_add_u32 s66, s66, s62
  s_mov_b32 m0, s56
  s_lshl_b32 s68, s67, 7
  s_add_u32 s68, s68, s54
  buffer_load_dwordx4 v10, s[32:35], s68 offen offset:0 lds
  s_mul_i32 s69, s67, 221184
  s_add_u32 s69, s69, s55
  buffer_load_dwordx4 v11, s[32:35], s68 offen offset:1024 lds
  s_add_u32 s67, s67, 1
  s_cmp_eq_u32 s67, 9
  s_cselect_b32 s67, 0, s67
  buffer_load_dwordx4 v12, s[32:35], s68 offen offset:2048 lds
  buffer_load_dwordx4 v13, s[32:35], s68 offen offset:3072 lds
  s_add_u32 m0, s56, 16384
  s_nop 0
  buffer_load_dwordx4 v14, s[36:39], s69 offen offset:0 lds
  buffer_load_dwordx4 v15, s[36:39], s69 offen offset:1024 lds
  buffer_load_dwordx4 v16, s[36:39], s69 offen offset:2048 lds
  buffer_load_dwordx4 v17, s[36:39], s69 offen offset:3072 lds
  s_add_u32 s56, s56, 32768
  s_waitcnt vmcnt(8)
  s_barrier
  ds_read_b128 v[144:147], v32 offset:0
  ds_read_b64_tr_b16 v[176:177], v28 offset:0
  ds_read_b64_tr_b16 v[178:179], v28 offset:1024
  ds_read_b128 v[148:151], v32 offset:2048
  ds_read_b64_tr_b16 v[180:181], v29 offset:0
  ds_read_b64_tr_b16 v[182:183], v29 offset:1024
  ds_read_b128 v[152:155], v33 offset:0
  ds_read_b64_tr_b16 v[184:185], v30 offset:0
  ds_read_b64_tr_b16 v[186:187], v30 offset:1024
  ds_read_b128 v[156:159], v33 offset:2048
  ds_read_b64_tr_b16 v[188:189], v31 offset:0
  ds_read_b64_tr_b16 v[190:191], v31 offset:1024
L_p1_v:
  s_cmp_ge_u32 s58, 7
  s_cbranch_scc1 L_p1_v_n
  s_waitcnt lgkmcnt(0)
  v_mfma_f32_16x16x32_bf16 v[48:51], v[144:147], v[176:179], v[48:51]
  ds_read_b128 v[160:163], v34 offset:0
  v_mfma_f32_16x16x32_bf16 v[52:55], v[148:151], v[176:179], v[52:55]
  ds_read_b64_tr_b16 v[192:193], v28 offset:8192
  v_mfma_f32_16x16x32_bf16 v[56:59], v[152:155], v[176:179], v[56:59]
  ds_read_b64_tr_b16 v[194:195], v28 offset:9216
  v_mfma_f32_16x16x32_bf16 v[60:63], v[156:159], v[176:179], v[60:63]
  ds_read_b128 v[164:167], v34 offset:2048
  v_mfma_f32_16x16x32_bf16 v[112:115], v[140:143], v[176:179], v[112:115]
  ds_read_b64_tr_b16 v[196:197], v29 offset:8192
  v_mfma_f32_16x16x32_bf16 v[120:123], v[140:143], v[144:147], v[120:123]
  ds_read_b64_tr_b16 v[198:199], v29 offset:9216
  v_mfma_f32_16x16x32_bf16 v[64:67], v[144:147], v[180:183], v[64:67]
  v_mfma_f32_16x16x32_bf16 v[68:71], v[148:151], v[180:183], v[68:71]
  ds_read_b128 v[168:171], v35 offset:0
  v_mfma_f32_16x16x32_bf16 v[72:75], v[152:155], v[180:183], v[72:75]
  ds_read_b64_tr_b16 v[200:201], v30 offset:8192
  v_mfma_f32_16x16x32_bf16 v[76:79], v[156:159], v[180:183], v[76:79]
  ds_read_b64_tr_b16 v[202:203], v30 offset:9216
  v_mfma_f32_16x16x32_bf16 v[116:119], v[140:143], v[180:183], v[116:119]
  ds_read_b128 v[172:175], v35 offset:2048
  v_mfma_f32_16x16x32_bf16 v[124:127], v[144:147], v[144:147], v[124:127]
  ds_read_b64_tr_b16 v[204:205], v31 offset:8192
  v_mfma_f32_16x16x32_bf16 v[80:83], v[144:147], v[184:187], v[80:83]
  ds_read_b64_tr_b16 v[206:207], v31 offset:9216
  v_mfma_f32_16x16x32_bf16 v[84:87], v[148:151], v[184:187], v[84:87]
  v_mfma_f32_16x16x32_bf16 v[88:91], v[152:155], v[184:187], v[88:91]
  s_mov_b32 m0, s56
  s_lshl_b32 s68, s67, 7
  s_add_u32 s68, s68, s54
  buffer_load_dwordx4 v10, s[32:35], s68 offen offset:0 lds
  v_mfma_f32_16x16x32_bf16 v[92:95], v[156:159], v[184:187], v[92:95]
  v_mfma_f32_16x16x32_bf16 v[128:131], v[140:143], v[148:151], v[128:131]
  s_mul_i32 s69, s67, 221184
  s_add_u32 s69, s69, s55
  buffer_load_dwordx4 v11, s[32:35], s68 offen offset:1024 lds
  v_mfma_f32_16x16x32_bf16 v[96:99], v[144:147], v[188:191], v[96:99]
  v_mfma_f32_16x16x32_bf16 v[100:103], v[148:151], v[188:191], v[100:103]
  s_add_u32 s67, s67, 1
  s_cmp_eq_u32 s67, 9
  s_cselect_b32 s67, 0, s67
  buffer_load_dwordx4 v12, s[32:35], s68 offen offset:2048 lds
  v_mfma_f32_16x16x32_bf16 v[104:107], v[152:155], v[188:191], v[104:107]
  v_mfma_f32_16x16x32_bf16 v[108:111], v[156:159], v[188:191], v[108:111]
  buffer_load_dwordx4 v13, s[32:35], s68 offen offset:3072 lds
  v_mfma_f32_16x16x32_bf16 v[132:135], v[148:151], v[148:151], v[132:135]
  s_add_u32 s58, s58, 1
  s_add_u32 s59, s59, 32768
  s_cmp_eq_u32 s59, 163840
  s_cselect_b32 s59, 0, s59
  s_waitcnt vmcnt(4) lgkmcnt(0)
  s_barrier
  v_mfma_f32_16x16x32_bf16 v[48:51], v[160:163], v[192:195], v[48:51]
  v_add_u32 v32, s59, v24
  v_add_u32 v33, s59, v25
  v_mfma_f32_16x16x32_bf16 v[52:55], v[164:167], v[192:195], v[52:55]
  v_add_u32 v28, s59, v20
  v_add_u32 v29, s59, v21
  v_mfma_f32_16x16x32_bf16 v[56:59], v[168:171], v[192:195], v[56:59]
  v_add_u32 v30, s59, v22
  v_add_u32 v31, s59, v23
  v_mfma_f32_16x16x32_bf16 v[60:63], v[172:175], v[192:195], v[60:63]
  ds_read_b128 v[144:147], v32 offset:0
  ds_read_b64_tr_b16 v[176:177], v28 offset:0
  v_mfma_f32_16x16x32_bf16 v[112:115], v[140:143], v[192:195], v[112:115]
  ds_read_b64_tr_b16 v[178:179], v28 offset:1024
  v_mfma_f32_16x16x32_bf16 v[120:123], v[140:143], v[160:163], v[120:123]
  ds_read_b128 v[148:151], v32 offset:2048
  v_mfma_f32_16x16x32_bf16 v[64:67], v[160:163], v[196:199], v[64:67]
  ds_read_b64_tr_b16 v[180:181], v29 offset:0
  v_mfma_f32_16x16x32_bf16 v[68:71], v[164:167], v[196:199], v[68:71]
  ds_read_b64_tr_b16 v[182:183], v29 offset:1024
  v_mfma_f32_16x16x32_bf16 v[72:75], v[168:171], v[196:199], v[72:75]
  ds_read_b128 v[152:155], v33 offset:0
  v_mfma_f32_16x16x32_bf16 v[76:79], v[172:175], v[196:199], v[76:79]
  ds_read_b64_tr_b16 v[184:185], v30 offset:0
  ds_read_b64_tr_b16 v[186:187], v30 offset:1024
  v_mfma_f32_16x16x32_bf16 v[116:119], v[140:143], v[196:199], v[116:119]
  ds_read_b128 v[156:159], v33 offset:2048
  v_mfma_f32_16x16x32_bf16 v[124:127], v[160:163], v[160:163], v[124:127]
  ds_read_b64_tr_b16 v[188:189], v31 offset:0
  v_mfma_f32_16x16x32_bf16 v[80:83], v[160:163], v[200:203], v[80:83]
  ds_read_b64_tr_b16 v[190:191], v31 offset:1024
  v_mfma_f32_16x16x32_bf16 v[84:87], v[164:167], v[200:203], v[84:87]
  v_add_u32 v34, s59, v26
  v_mfma_f32_16x16x32_bf16 v[88:91], v[168:171], v[200:203], v[88:91]
  v_add_u32 v35, s59, v27
  v_mfma_f32_16x16x32_bf16 v[92:95], v[172:175], v[200:203], v[92:95]
  s_add_u32 m0, s56, 16384
  s_nop 0
  buffer_load_dwordx4 v14, s[36:39], s69 offen offset:0 lds
  v_mfma_f32_16x16x32_bf16 v[128:131], v[140:143], v[164:167], v[128:131]
  buffer_load_dwordx4 v15, s[36:39], s69 offen offset:1024 lds
  v_mfma_f32_16x16x32_bf16 v[96:99], v[160:163], v[204:207], v[96:99]
  v_mfma_f32_16x16x32_bf16 v[100:103], v[164:167], v[204:207], v[100:103]
  buffer_load_dwordx4 v16, s[36:39], s69 offen offset:2048 lds
  v_mfma_f32_16x16x32_bf16 v[104:107], v[168:171], v[204:207], v[104:107]
  v_mfma_f32_16x16x32_bf16 v[108:111], v[172:175], v[204:207], v[108:111]
  buffer_load_dwordx4 v17, s[36:39], s69 offen offset:3072 lds
  v_mfma_f32_16x16x32_bf16 v[132:135], v[164:167], v[164:167], v[132:135]
  s_add_u32 s56, s56, 32768
  s_cmp_ge_u32 s56, 163840
  s_cselect_b32 s46, 163840, 0
  s_sub_u32 s56, s56, s46
  s_branch L_p1_v
L_p1_v_n:
  s_waitcnt lgkmcnt(0)
  v_mfma_f32_16x16x32_bf16 v[48:51], v[144:147], v[176:179], v[48:51]
  ds_read_b128 v[160:163], v34 offset:0
  v_mfma_f32_16x16x32_bf16 v[52:55], v[148:151], v[176:179], v[52:55]
  ds_read_b64_tr_b16 v[192:193], v28 offset:8192
  v_mfma_f32_16x16x32_bf16 v[56:59], v[152:155], v[176:179], v[56:59]
  ds_read_b64_tr_b16 v[194:195], v28 offset:9216
  v_mfma_f32_16x16x32_bf16 v[60:63], v[156:159], v[176:179], v[60:63]
  ds_read_b128 v[164:167], v34 offset:2048
  v_mfma_f32_16x16x32_bf16 v[112:115], v[140:143], v[176:179], v[112:115]
  ds_read_b64_tr_b16 v[196:197], v29 offset:8192
  v_mfma_f32_16x16x32_bf16 v[120:123], v[140:143], v[144:147], v[120:123]
  ds_read_b64_tr_b16 v[198:199], v29 offset:9216
  v_mfma_f32_16x16x32_bf16 v[64:67], v[144:147], v[180:183], v[64:67]
  v_mfma_f32_16x16x32_bf16 v[68:71], v[148:151], v[180:183], v[68:71]
  ds_read_b128 v[168:171], v35 offset:0
  v_mfma_f32_16x16x32_bf16 v[72:75], v[152:155], v[180:183], v[72:75]
  ds_read_b64_tr_b16 v[200:201], v30 offset:8192
  v_mfma_f32_16x16x32_bf16 v[76:79], v[156:159], v[180:183], v[76:79]
  ds_read_b64_tr_b16 v[202:203], v30 offset:9216
  v_mfma_f32_16x16x32_bf16 v[116:119], v[140:143], v[180:183], v[116:119]
  ds_read_b128 v[172:175], v35 offset:2048
  v_mfma_f32_16x16x32_bf16 v[124:127], v[144:147], v[144:147], v[124:127]
  ds_read_b64_tr_b16 v[204:205], v31 offset:8192
  v_mfma_f32_16x16x32_bf16 v[80:83], v[144:147], v[184:187], v[80:83]
  ds_read_b64_tr_b16 v[206:207], v31 offset:9216
  v_mfma_f32_16x16x32_bf16 v[84:87], v[148:151], v[184:187], v[84:87]
  v_mfma_f32_16x16x32_bf16 v[88:91], v[152:155], v[184:187], v[88:91]
  v_mfma_f32_16x16x32_bf16 v[92:95], v[156:159], v[184:187], v[92:95]
  v_mfma_f32_16x16x32_bf16 v[128:131], v[140:143], v[148:151], v[128:131]
  v_mfma_f32_16x16x32_bf16 v[96:99], v[144:147], v[188:191], v[96:99]
  v_mfma_f32_16x16x32_bf16 v[100:103], v[148:151], v[188:191], v[100:103]
  v_mfma_f32_16x16x32_bf16 v[104:107], v[152:155], v[188:191], v[104:107]
  v_mfma_f32_16x16x32_bf16 v[108:111], v[156:159], v[188:191], v[108:111]
  v_mfma_f32_16x16x32_bf16 v[132:135], v[148:151], v[148:151], v[132:135]
  s_add_u32 s58, s58, 1
  s_add_u32 s59, s59, 32768
  s_cmp_eq_u32 s59, 163840
  s_cselect_b32 s59, 0, s59
  s_waitcnt vmcnt(0) lgkmcnt(0)
  s_barrier
  s_cmp_eq_u32 s58, 9
  s_cbranch_scc1 L_p1_v_e
  v_mfma_f32_16x16x32_bf16 v[48:51], v[160:163], v[192:195], v[48:51]
  v_add_u32 v32, s59, v24
  v_add_u32 v33, s59, v25
  v_mfma_f32_16x16x32_bf16 v[52:55], v[164:167], v[192:195], v[52:55]
  v_add_u32 v28, s59, v20
  v_add_u32 v29, s59, v21
  v_mfma_f32_16x16x32_bf16 v[56:59], v[168:171], v[192:195], v[56:59]
  v_add_u32 v30, s59, v22
  v_add_u32 v31, s59, v23
  v_mfma_f32_16x16x32_bf16 v[60:63], v[172:175], v[192:195], v[60:63]
  ds_read_b128 v[144:147], v32 offset:0
  ds_read_b64_tr_b16 v[176:177], v28 offset:0
  v_mfma_f32_16x16x32_bf16 v[112:115], v[140:143], v[192:195], v[112:115]
  ds_read_b64_tr_b16 v[178:179], v28 offset:1024
  v_mfma_f32_16x16x32_bf16 v[120:123], v[140:143], v[160:163], v[120:123]
  ds_read_b128 v[148:151], v32 offset:2048
  v_mfma_f32_16x16x32_bf16 v[64:67], v[160:163], v[196:199], v[64:67]
  ds_read_b64_tr_b16 v[180:181], v29 offset:0
  v_mfma_f32_16x16x32_bf16 v[68:71], v[164:167], v[196:199], v[68:71]
  ds_read_b64_tr_b16 v[182:183], v29 offset:1024
  v_mfma_f32_16x16x32_bf16 v[72:75], v[168:171], v[196:199], v[72:75]
  ds_read_b128 v[152:155], v33 offset:0
  v_mfma_f32_16x16x32_bf16 v[76:79], v[172:175], v[196:199], v[76:79]
  ds_read_b64_tr_b16 v[184:185], v30 offset:0
  ds_read_b64_tr_b16 v[186:187], v30 offset:1024
  v_mfma_f32_16x16x32_bf16 v[116:119], v[140:143], v[196:199], v[116:119]
  ds_read_b128 v[156:159], v33 offset:2048
  v_mfma_f32_16x16x32_bf16 v[124:127], v[160:163], v[160:163], v[124:127]
  ds_read_b64_tr_b16 v[188:189], v31 offset:0
  v_mfma_f32_16x16x32_bf16 v[80:83], v[160:163], v[200:203], v[80:83]
  ds_read_b64_tr_b16 v[190:191], v31 offset:1024
  v_mfma_f32_16x16x32_bf16 v[84:87], v[164:167], v[200:203], v[84:87]
  v_add_u32 v34, s59, v26
  v_mfma_f32_16x16x32_bf16 v[88:91], v[168:171], v[200:203], v[88:91]
  v_add_u32 v35, s59, v27
  v_mfma_f32_16x16x32_bf16 v[92:95], v[172:175], v[200:203], v[92:95]
  v_mfma_f32_16x16x32_bf16 v[128:131], v[140:143], v[164:167], v[128:131]
  v_mfma_f32_16x16x32_bf16 v[96:99], v[160:163], v[204:207], v[96:99]
  v_mfma_f32_16x16x32_bf16 v[100:103], v[164:167], v[204:207], v[100:103]
  v_mfma_f32_16x16x32_bf16 v[104:107], v[168:171], v[204:207], v[104:107]
  v_mfma_f32_16x16x32_bf16 v[108:111], v[172:175], v[204:207], v[108:111]
  v_mfma_f32_16x16x32_bf16 v[132:135], v[164:167], v[164:167], v[132:135]
  s_branch L_p1_v_n
L_p1_v_e:
  v_mfma_f32_16x16x32_bf16 v[112:115], v[140:143], v[192:195], v[112:115]
  v_mfma_f32_16x16x32_bf16 v[120:123], v[140:143], v[160:163], v[120:123]
  v_mfma_f32_16x16x32_bf16 v[116:119], v[140:143], v[196:199], v[116:119]
  v_mfma_f32_16x16x32_bf16 v[124:127], v[160:163], v[160:163], v[124:127]
  v_mfma_f32_16x16x32_bf16 v[128:131], v[140:143], v[164:167], v[128:131]
  v_mfma_f32_16x16x32_bf16 v[132:135], v[164:167], v[164:167], v[132:135]
  v_mfma_f32_16x16x32_bf16 v[48:51], v[160:163], v[192:195], v[48:51]
  v_and_b32 v40, 1, v2
  v_cmp_eq_u32 s[74:75], 1, v40
  v_and_b32 v40, 2, v2
  v_mfma_f32_16x16x32_bf16 v[52:55], v[164:167], v[192:195], v[52:55]
  v_cmp_eq_u32 s[76:77], 2, v40
  v_lshrrev_b32 v40, 2, v2
  v_cmp_eq_u32 s[78:79], v40, v3
  v_mfma_f32_16x16x32_bf16 v[56:59], v[168:171], v[192:195], v[56:59]
  s_mov_b32 s46, 987991609
  s_mov_b32 s47, 925353388
  v_mfma_f32_16x16x32_bf16 v[60:63], v[172:175], v[192:195], v[60:63]
  v_cndmask_b32 v124, v124, v125, s[74:75]
  v_cndmask_b32 v126, v126, v127, s[74:75]
  v_mul_f32 v120, s46, v120
  v_mfma_f32_16x16x32_bf16 v[64:67], v[160:163], v[196:199], v[64:67]
  v_cndmask_b32 v124, v124, v126, s[76:77]
  v_mul_f32 v42, v120, v120
  v_mfma_f32_16x16x32_bf16 v[68:71], v[164:167], v[196:199], v[68:71]
  v_fma_f32 v124, v124, s46, -v42
  v_max_f32 v124, 0, v124
  v_mfma_f32_16x16x32_bf16 v[72:75], v[168:171], v[196:199], v[72:75]
  v_add_f32 v124, s47, v124
  v_rsq_f32 v36, v124
  v_mfma_f32_16x16x32_bf16 v[76:79], v[172:175], v[196:199], v[76:79]
  v_mul_f32 v37, v36, -v120
  v_cndmask_b32 v132, v132, v133, s[74:75]
  v_cndmask_b32 v134, v134, v135, s[74:75]
  v_mfma_f32_16x16x32_bf16 v[80:83], v[160:163], v[200:203], v[80:83]
  v_mul_f32 v128, s46, v128
  v_cndmask_b32 v132, v132, v134, s[76:77]
  v_mfma_f32_16x16x32_bf16 v[84:87], v[164:167], v[200:203], v[84:87]
  v_mul_f32 v42, v128, v128
  v_fma_f32 v132, v132, s46, -v42
  v_mfma_f32_16x16x32_bf16 v[88:91], v[168:171], v[200:203], v[88:91]
  v_max_f32 v132, 0, v132
  v_add_f32 v132, s47, v132
  v_mfma_f32_16x16x32_bf16 v[92:95], v[172:175], v[200:203], v[92:95]
  v_rsq_f32 v38, v132
  s_nop 0
  v_mul_f32 v39, v38, -v128
  s_lshl_b32 s46, s52, 9
  v_mfma_f32_16x16x32_bf16 v[96:99], v[160:163], v[204:207], v[96:99]
  s_lshl_b32 s47, s53, 8
  s_add_u32 s46, s46, s47
  v_mfma_f32_16x16x32_bf16 v[100:103], v[164:167], v[204:207], v[100:103]
  v_lshl_add_u32 v40, v2, 3, s46
  s_mov_b64 exec, s[78:79]
  v_lshrrev_b32 v42, 1, v40
  ds_write_b32 v42, v36 offset:0
  ds_write_b32 v42, v37 offset:512
  ds_write_b32 v42, v38 offset:64
  ds_write_b32 v42, v39 offset:576
  s_mov_b64 exec, -1
  v_mfma_f32_16x16x32_bf16 v[104:107], v[168:171], v[204:207], v[104:107]
  s_lshl_b32 s47, s57, 6
  v_lshl_add_u32 v41, v2, 2, s47
  v_mfma_f32_16x16x32_bf16 v[108:111], v[172:175], v[204:207], v[108:111]
  ds_write_b32 v41, v112 offset:1024
  ds_write_b32 v41, v116 offset:1088
  s_waitcnt lgkmcnt(0)
  s_barrier
  v_mov_b32 v36, 0
  v_mov_b32 v37, 0
  s_cmp_ge_u32 s60, 27
  s_cbranch_scc1 L_p1_v_s
  v_xor_b32 v42, 256, v40
  v_xor_b32 v43, 128, v41
  s_lshr_b32 s46, s46, 1
  v_lshl_add_u32 v40, v3, 4, s46
  v_xor_b32 v42, 128, v40
  ds_read_b128 v[144:147], v40 offset:0
  ds_read_b128 v[148:151], v40 offset:512
  ds_read_b128 v[152:155], v40 offset:64
  ds_read_b128 v[156:159], v40 offset:576
  ds_read_b128 v[160:163], v42 offset:0
  ds_read_b128 v[164:167], v42 offset:512
  ds_read_b128 v[168:171], v42 offset:64
  ds_read_b128 v[172:175], v42 offset:576
  ds_read_b32 v176, v41 offset:1024
  ds_read_b32 v178, v41 offset:1088
  ds_read_b32 v180, v43 offset:1024
  ds_read_b32 v182, v43 offset:1088
  s_waitcnt lgkmcnt(0)
  v_pk_mul_f32 v[216:217], v[148:149], v[176:177] op_sel_hi:[1,0]
  v_pk_mul_f32 v[218:219], v[150:151], v[176:177] op_sel_hi:[1,0]
  v_pk_fma_f32 v[48:49], v[48:49], v[144:145], v[216:217]
  v_pk_fma_f32 v[50:51], v[50:51], v[146:147], v[218:219]
  v_max3_f32 v36, |v48|, |v49|, v36
  v_max3_f32 v37, |v50|, |v51|, v37
  v_cvt_pk_bf16_f32 v48, v48, v49
  v_cvt_pk_bf16_f32 v49, v50, v51
  v_pk_mul_f32 v[216:217], v[156:157], v[176:177] op_sel_hi:[1,0]
  v_pk_mul_f32 v[218:219], v[158:159], v[176:177] op_sel_hi:[1,0]
  v_pk_fma_f32 v[52:53], v[52:53], v[152:153], v[216:217]
  v_pk_fma_f32 v[54:55], v[54:55], v[154:155], v[218:219]
  v_max3_f32 v36, |v52|, |v53|, v36
  v_max3_f32 v37, |v54|, |v55|, v37
  v_cvt_pk_bf16_f32 v50, v52, v53
  v_cvt_pk_bf16_f32 v51, v54, v55
  buffer_store_dwordx4 v[48:51], v208, s[28:31], s65 offen sc1
  v_pk_mul_f32 v[216:217], v[164:165], v[176:177] op_sel_hi:[1,0]
  v_pk_mul_f32 v[218:219], v[166:167], v[176:177] op_sel_hi:[1,0]
  v_pk_fma_f32 v[56:57], v[56:57], v[160:161], v[216:217]
  v_pk_fma_f32 v[58:59], v[58:59], v[162:163], v[218:219]
  v_max3_f32 v36, |v56|, |v57|, v36
  v_max3_f32 v37, |v58|, |v59|, v37
  v_cvt_pk_bf16_f32 v56, v56, v57
  v_cvt_pk_bf16_f32 v57, v58, v59
  v_pk_mul_f32 v[216:217], v[172:173], v[176:177] op_sel_hi:[1,0]
  v_pk_mul_f32 v[218:219], v[174:175], v[176:177] op_sel_hi:[1,0]
  v_pk_fma_f32 v[60:61], v[60:61], v[168:169], v[216:217]
  v_pk_fma_f32 v[62:63], v[62:63], v[170:171], v[218:219]
  v_max3_f32 v36, |v60|, |v61|, v36
  v_max3_f32 v37, |v62|, |v63|, v37
  v_cvt_pk_bf16_f32 v58, v60, v61
  v_cvt_pk_bf16_f32 v59, v62, v63
  buffer_store_dwordx4 v[56:59], v208, s[28:31], s66 offen sc1
  v_pk_mul_f32 v[216:217], v[148:149], v[178:179] op_sel_hi:[1,0]
  v_pk_mul_f32 v[218:219], v[150:151], v[178:179] op_sel_hi:[1,0]
  v_pk_fma_f32 v[64:65], v[64:65], v[144:145], v[216:217]
  v_pk_fma_f32 v[66:67], v[66:67], v[146:147], v[218:219]
  v_max3_f32 v36, |v64|, |v65|, v36
  v_max3_f32 v37, |v66|, |v67|, v37
  v_cvt_pk_bf16_f32 v64, v64, v65
  v_cvt_pk_bf16_f32 v65, v66, v67
  v_pk_mul_f32 v[216:217], v[156:157], v[178:179] op_sel_hi:[1,0]
  v_pk_mul_f32 v[218:219], v[158:159], v[178:179] op_sel_hi:[1,0]
  v_pk_fma_f32 v[68:69], v[68:69], v[152:153], v[216:217]
  v_pk_fma_f32 v[70:71], v[70:71], v[154:155], v[218:219]
  v_max3_f32 v36, |v68|, |v69|, v36
  v_max3_f32 v37, |v70|, |v71|, v37
  v_cvt_pk_bf16_f32 v66, v68, v69
  v_cvt_pk_bf16_f32 v67, v70, v71
  buffer_store_dwordx4 v[64:67], v209, s[28:31], s65 offen sc1
  v_pk_mul_f32 v[216:217], v[164:165], v[178:179] op_sel_hi:[1,0]
  v_pk_mul_f32 v[218:219], v[166:167], v[178:179] op_sel_hi:[1,0]
  v_pk_fma_f32 v[72:73], v[72:73], v[160:161], v[216:217]
  v_pk_fma_f32 v[74:75], v[74:75], v[162:163], v[218:219]
  v_max3_f32 v36, |v72|, |v73|, v36
  v_max3_f32 v37, |v74|, |v75|, v37
  v_cvt_pk_bf16_f32 v72, v72, v73
  v_cvt_pk_bf16_f32 v73, v74, v75
  v_pk_mul_f32 v[216:217], v[172:173], v[178:179] op_sel_hi:[1,0]
  v_pk_mul_f32 v[218:219], v[174:175], v[178:179] op_sel_hi:[1,0]
  v_pk_fma_f32 v[76:77], v[76:77], v[168:169], v[216:217]
  v_pk_fma_f32 v[78:79], v[78:79], v[170:171], v[218:219]
  v_max3_f32 v36, |v76|, |v77|, v36
  v_max3_f32 v37, |v78|, |v79|, v37
  v_cvt_pk_bf16_f32 v74, v76, v77
  v_cvt_pk_bf16_f32 v75, v78, v79
  buffer_store_dwordx4 v[72:75], v209, s[28:31], s66 offen sc1
  v_pk_mul_f32 v[216:217], v[148:149], v[180:181] op_sel_hi:[1,0]
  v_pk_mul_f32 v[218:219], v[150:151], v[180:181] op_sel_hi:[1,0]
  v_pk_fma_f32 v[80:81], v[80:81], v[144:145], v[216:217]
  v_pk_fma_f32 v[82:83], v[82:83], v[146:147], v[218:219]
  v_max3_f32 v36, |v80|, |v81|, v36
  v_max3_f32 v37, |v82|, |v83|, v37
  v_cvt_pk_bf16_f32 v80, v80, v81
  v_cvt_pk_bf16_f32 v81, v82, v83
  v_pk_mul_f32 v[216:217], v[156:157], v[180:181] op_sel_hi:[1,0]
  v_pk_mul_f32 v[218:219], v[158:159], v[180:181] op_sel_hi:[1,0]
  v_pk_fma_f32 v[84:85], v[84:85], v[152:153], v[216:217]
  v_pk_fma_f32 v[86:87], v[86:87], v[154:155], v[218:219]
  v_max3_f32 v36, |v84|, |v85|, v36
  v_max3_f32 v37, |v86|, |v87|, v37
  v_cvt_pk_bf16_f32 v82, v84, v85
  v_cvt_pk_bf16_f32 v83, v86, v87
  buffer_store_dwordx4 v[80:83], v210, s[28:31], s65 offen sc1
  v_pk_mul_f32 v[216:217], v[164:165], v[180:181] op_sel_hi:[1,0]
  v_pk_mul_f32 v[218:219], v[166:167], v[180:181] op_sel_hi:[1,0]
  v_pk_fma_f32 v[88:89], v[88:89], v[160:161], v[216:217]
  v_pk_fma_f32 v[90:91], v[90:91], v[162:163], v[218:219]
  v_max3_f32 v36, |v88|, |v89|, v36
  v_max3_f32 v37, |v90|, |v91|, v37
  v_cvt_pk_bf16_f32 v88, v88, v89
  v_cvt_pk_bf16_f32 v89, v90, v91
  v_pk_mul_f32 v[216:217], v[172:173], v[180:181] op_sel_hi:[1,0]
  v_pk_mul_f32 v[218:219], v[174:175], v[180:181] op_sel_hi:[1,0]
  v_pk_fma_f32 v[92:93], v[92:93], v[168:169], v[216:217]
  v_pk_fma_f32 v[94:95], v[94:95], v[170:171], v[218:219]
  v_max3_f32 v36, |v92|, |v93|, v36
  v_max3_f32 v37, |v94|, |v95|, v37
  v_cvt_pk_bf16_f32 v90, v92, v93
  v_cvt_pk_bf16_f32 v91, v94, v95
  buffer_store_dwordx4 v[88:91], v210, s[28:31], s66 offen sc1
  v_pk_mul_f32 v[216:217], v[148:149], v[182:183] op_sel_hi:[1,0]
  v_pk_mul_f32 v[218:219], v[150:151], v[182:183] op_sel_hi:[1,0]
  v_pk_fma_f32 v[96:97], v[96:97], v[144:145], v[216:217]
  v_pk_fma_f32 v[98:99], v[98:99], v[146:147], v[218:219]
  v_max3_f32 v36, |v96|, |v97|, v36
  v_max3_f32 v37, |v98|, |v99|, v37
  v_cvt_pk_bf16_f32 v96, v96, v97
  v_cvt_pk_bf16_f32 v97, v98, v99
  v_pk_mul_f32 v[216:217], v[156:157], v[182:183] op_sel_hi:[1,0]
  v_pk_mul_f32 v[218:219], v[158:159], v[182:183] op_sel_hi:[1,0]
  v_pk_fma_f32 v[100:101], v[100:101], v[152:153], v[216:217]
  v_pk_fma_f32 v[102:103], v[102:103], v[154:155], v[218:219]
  v_max3_f32 v36, |v100|, |v101|, v36
  v_max3_f32 v37, |v102|, |v103|, v37
  v_cvt_pk_bf16_f32 v98, v100, v101
  v_cvt_pk_bf16_f32 v99, v102, v103
  buffer_store_dwordx4 v[96:99], v211, s[28:31], s65 offen sc1
  v_pk_mul_f32 v[216:217], v[164:165], v[182:183] op_sel_hi:[1,0]
  v_pk_mul_f32 v[218:219], v[166:167], v[182:183] op_sel_hi:[1,0]
  v_pk_fma_f32 v[104:105], v[104:105], v[160:161], v[216:217]
  v_pk_fma_f32 v[106:107], v[106:107], v[162:163], v[218:219]
  v_max3_f32 v36, |v104|, |v105|, v36
  v_max3_f32 v37, |v106|, |v107|, v37
  v_cvt_pk_bf16_f32 v104, v104, v105
  v_cvt_pk_bf16_f32 v105, v106, v107
  v_pk_mul_f32 v[216:217], v[172:173], v[182:183] op_sel_hi:[1,0]
  v_pk_mul_f32 v[218:219], v[174:175], v[182:183] op_sel_hi:[1,0]
  v_pk_fma_f32 v[108:109], v[108:109], v[168:169], v[216:217]
  v_pk_fma_f32 v[110:111], v[110:111], v[170:171], v[218:219]
  v_max3_f32 v36, |v108|, |v109|, v36
  v_max3_f32 v37, |v110|, |v111|, v37
  v_cvt_pk_bf16_f32 v106, v108, v109
  v_cvt_pk_bf16_f32 v107, v110, v111
  buffer_store_dwordx4 v[104:107], v211, s[28:31], s66 offen sc1
L_p1_v_s:
L_p1_pub:
  v_max_f32 v36, v36, v37
  v_mov_b32 v37, v36
  s_nop 1
  v_permlane32_swap_b32 v36, v37
  v_max_f32 v36, v36, v37
  v_mov_b32 v37, v36
  s_nop 1
  v_permlane16_swap_b32 v36, v37
  v_max_f32 v36, v36, v37
  s_nop 1
  v_max_f32_dpp v36, v36, v36 row_ror:8 row_mask:0xf bank_mask:0xf
  s_nop 1
  v_max_f32_dpp v36, v36, v36 row_ror:4 row_mask:0xf bank_mask:0xf
  s_nop 1
  v_max_f32_dpp v36, v36, v36 row_ror:2 row_mask:0xf bank_mask:0xf
  s_nop 1
  v_max_f32_dpp v36, v36, v36 row_ror:1 row_mask:0xf bank_mask:0xf
  s_lshl_b32 s46, s40, 2
  v_mov_b32 v37, s46
  ds_write_b32 v37, v36 offset:2048
  s_cmp_lg_u32 s40, 0
  s_cbranch_scc1 Lp1f_1_a
  s_mov_b32 s46, 200000
  v_mov_b32 v38, 0
Lnon_2:
  global_load_dwordx2 v[36:37], v38, s[22:23] sc1
  s_waitcnt vmcnt(0)
  v_readfirstlane_b32 s47, v37
  v_readfirstlane_b32 s43, v36
  s_sub_u32 s46, s46, 1
  s_cbranch_scc1 Lnon_2_x
  s_cmp_eq_u32 s47, 0
  s_cbranch_scc1 Lnon_2
Lnon_2_x:
Lp1f_1_a:
  s_waitcnt vmcnt(0) lgkmcnt(0)
  s_barrier
  s_cmp_lg_u32 s40, 0
  s_cbranch_scc1 L_p1_done
  v_mov_b32 v38, 0
  ds_read_b128 v[40:43], v38 offset:2048
  s_lshl_b32 s46, s50, 4
  s_add_u32 s46, s46, s51
  s_lshl_b32 s46, s46, 7
  s_add_u32 s46, s46, 128
  v_mov_b32 v36, s43
  s_mov_b64 exec, 1
  s_waitcnt lgkmcnt(0)
  v_max3_f32 v37, v40, v41, v42
  v_max_f32 v37, v37, v43
  buffer_store_dwordx2 v[36:37], v38, s[28:31], s46 offen sc1
  s_mov_b64 exec, -1
  s_branch L_p1_done
L_p1_helper:
  v_add_u32 v40, 0, v1
  v_mul_u32_u24 v10, 911, v40
  v_lshrrev_b32 v10, 16, v10
  v_mul_u32_u24 v41, 72, v10
  v_sub_u32 v41, v40, v41
  v_lshlrev_b32 v20, 4, v41
  v_add_u32 v40, 64, v1
  v_mul_u32_u24 v11, 911, v40
  v_lshrrev_b32 v11, 16, v11
  v_mul_u32_u24 v41, 72, v11
  v_sub_u32 v41, v40, v41
  v_lshlrev_b32 v21, 4, v41
  v_add_u32 v40, 128, v1
  v_mul_u32_u24 v12, 911, v40
  v_lshrrev_b32 v12, 16, v12
  v_mul_u32_u24 v41, 72, v12
  v_sub_u32 v41, v40, v41
  v_lshlrev_b32 v22, 4, v41
  v_add_u32 v40, 192, v1
  v_mul_u32_u24 v13, 911, v40
  v_lshrrev_b32 v13, 16, v13
  v_mul_u32_u24 v41, 72, v13
  v_sub_u32 v41, v40, v41
  v_lshlrev_b32 v23, 4, v41
  v_add_u32 v40, 256, v1
  v_mul_u32_u24 v14, 911, v40
  v_lshrrev_b32 v14, 16, v14
  v_mul_u32_u24 v41, 72, v14
  v_sub_u32 v41, v40, v41
  v_lshlrev_b32 v24, 4, v41
  v_add_u32 v40, 320, v1
  v_mul_u32_u24 v15, 911, v40
  v_lshrrev_b32 v15, 16, v15
  v_mul_u32_u24 v41, 72, v15
  v_sub_u32 v41, v40, v41
  v_lshlrev_b32 v25, 4, v41
  v_add_u32 v40, 384, v1
  v_mul_u32_u24 v16, 911, v40
  v_lshrrev_b32 v16, 16, v16
  v_mul_u32_u24 v41, 72, v16
  v_sub_u32 v41, v40, v41
  v_lshlrev_b32 v26, 4, v41
  v_add_u32 v40, 448, v1
  v_mul_u32_u24 v17, 911, v40
  v_lshrrev_b32 v17, 16, v17
  v_mul_u32_u24 v41, 72, v17
  v_sub_u32 v41, v40, v41
  v_lshlrev_b32 v27, 4, v41
  v_add_u32 v40, 512, v1
  v_mul_u32_u24 v18, 911, v40
  v_lshrrev_b32 v18, 16, v18
  v_mul_u32_u24 v41, 72, v18
  v_sub_u32 v41, v40, v41
  v_lshlrev_b32 v28, 4, v41
  v_lshrrev_b32 v40, 2, v2
  v_lshl_add_u32 v40, v3, 3, v40
  v_mul_u32_u24 v40, 1152, v40
  v_and_b32 v41, 3, v2
  v_lshl_add_u32 v30, v41, 4, v40
  s_lshr_b32 s46, s40, 1
  s_lshl_b32 s46, s46, 6
  s_and_b32 s47, s40, 1
  s_lshl_b32 s47, s47, 3
  s_add_u32 s46, s46, s47
  v_add_u32 v30, s46, v30
  s_lshl_b32 s48, s41, 2
  s_add_u32 s48, s48, s42
  s_sub_u32 s48, s48, 28
  s_waitcnt lgkmcnt(0)
  s_add_u32 s28, s24, 0
  s_addc_u32 s29, s25, 0
  s_mov_b32 s30, 48783360
  s_mov_b32 s31, 0x20000
  s_xor_b32 s46, s2, 224
  s_or_b32 s46, s46, s40
  s_cmp_lg_u32 s46, 0
  s_cbranch_scc1 Lpn_3
  v_mov_b32 v252, 0
  buffer_load_dword v250, v252, s[28:31], 0 offen sc1
  s_mov_b32 s46, 0x9E3779B1
  s_waitcnt vmcnt(0)
  v_mul_lo_u32 v250, v250, s46
  v_add_u32 v250, 0x7F4A7C15, v250
  v_mov_b32 v251, 1
  s_mov_b64 exec, 1
  buffer_store_dword v250, v252, s[28:31], 0 offen sc1
  global_store_dwordx2 v252, v[250:251], s[22:23] sc1
  s_mov_b64 exec, -1
Lpn_3:
  s_add_u32 s49, s48, 32
  s_cmp_lt_u32 s49, 54
  s_cselect_b32 s49, s49, s48
  s_add_u32 s76, s24, 7667712
  s_addc_u32 s77, s25, 0
  s_mov_b32 s78, 4816896
  s_mov_b32 s79, 0x20000
  v_mov_b32 v220, -1
  v_mov_b32 v221, -1
  v_mov_b32 v222, -1
  v_mov_b32 v223, -1
  s_sub_u32 s74, s2, 224
  s_lshl_b32 s74, s74, 2
  s_add_u32 s74, s74, s40
  s_mul_i32 s74, s74, 38912
  s_cmp_ge_u32 s48, 54
  s_cbranch_scc1 Lsw_4_big
  s_mul_hi_u32 s51, s48, 238609295
  s_mul_i32 s52, s51, 18
  s_sub_u32 s52, s48, s52
  s_cmp_eq_u32 s51, 1
  s_cselect_b32 s54, s12, s14
  s_cselect_b32 s55, s13, s15
  s_cmp_eq_u32 s51, 0
  s_cselect_b32 s54, s8, s54
  s_cselect_b32 s55, s9, s55
  s_mul_i32 s60, s51, 663552
  s_add_u32 s60, s60, 17301504
  s_mul_i32 s53, s40, 18432
  s_add_u32 s60, s60, s53
  s_mov_b32 s61, 73728
  s_lshl_b32 s56, s52, 5
  s_lshl_b32 s53, s40, 3
  s_add_u32 s56, s56, s53
  s_mov_b32 s57, 0
  s_mov_b32 s59, 1152
  s_cmp_lg_u32 s51, 0
  s_cbranch_scc1 Lsw_4_j
  s_mul_i32 s56, s52, 36
  s_lshl_b32 s53, s40, 2
  s_add_u32 s56, s56, s53
  s_mov_b32 s57, 16
  s_cmp_lt_u32 s52, 16
  s_cbranch_scc1 Lsw_4_j
  s_sub_u32 s56, s52, 16
  s_lshl_b32 s56, s56, 2
  s_add_u32 s56, s56, s40
  s_mul_i32 s56, s56, 72
  s_add_u32 s56, s56, 16
  s_mov_b32 s57, 32
  s_branch Lsw_4_j
Lsw_4_big:
  s_sub_u32 s53, s48, 54
  s_mul_hi_u32 s51, s53, 238609295
  s_mul_i32 s52, s51, 18
  s_sub_u32 s52, s53, s52
  s_mul_i32 s60, s51, 663552
  s_add_u32 s60, s60, 19292160
  s_mul_i32 s53, s40, 165888
  s_add_u32 s60, s60, s53
  s_mov_b32 s61, 18432
  s_lshl_b32 s56, s52, 5
  s_lshl_b32 s53, s40, 3
  s_add_u32 s56, s56, s53
  s_mov_b32 s57, 0
  s_cmp_ge_u32 s51, 8
  s_cbranch_scc1 Lsw_4_w4
  s_mul_i32 s53, s51, 1152
  s_add_u32 s54, s16, s53
  s_addc_u32 s55, s17, 0
  s_mov_b32 s59, 9216
  s_branch Lsw_4_j
Lsw_4_w4:
  s_sub_u32 s53, s51, 8
  s_mul_i32 s53, s53, 663552
  s_add_u32 s54, s18, s53
  s_addc_u32 s55, s19, 0
  s_mov_b32 s59, 1152
Lsw_4_j:
  s_lshl_b32 s53, s52, 10
  s_add_u32 s60, s60, s53
  s_add_u32 s62, s48, 256
  s_mov_b32 s32, s54
  s_mov_b32 s33, s55
  s_mul_i32 s34, s59, 575
  s_add_u32 s34, s34, 1152
  s_mov_b32 s35, 0x20000
  s_mul_i32 s53, s40, 9216
  s_add_u32 m0, s53, 0
  v_lshrrev_b32 v40, 2, v10
  v_mul_lo_u32 v40, v40, s57
  v_add3_u32 v40, v40, v10, s56
  v_mul_lo_u32 v40, v40, s59
  v_add_u32 v40, v40, v20
  buffer_load_dwordx4 v40, s[32:35], 0 offen lds
  s_add_u32 m0, m0, 1024
  v_lshrrev_b32 v40, 2, v11
  v_mul_lo_u32 v40, v40, s57
  v_add3_u32 v40, v40, v11, s56
  v_mul_lo_u32 v40, v40, s59
  v_add_u32 v40, v40, v21
  buffer_load_dwordx4 v40, s[32:35], 0 offen lds
  s_add_u32 m0, m0, 1024
  v_lshrrev_b32 v40, 2, v12
  v_mul_lo_u32 v40, v40, s57
  v_add3_u32 v40, v40, v12, s56
  v_mul_lo_u32 v40, v40, s59
  v_add_u32 v40, v40, v22
  buffer_load_dwordx4 v40, s[32:35], 0 offen lds
  s_add_u32 m0, m0, 1024
  v_lshrrev_b32 v40, 2, v13
  v_mul_lo_u32 v40, v40, s57
  v_add3_u32 v40, v40, v13, s56
  v_mul_lo_u32 v40, v40, s59
  v_add_u32 v40, v40, v23
  buffer_load_dwordx4 v40, s[32:35], 0 offen lds
  s_add_u32 m0, m0, 1024
  v_lshrrev_b32 v40, 2, v14
  v_mul_lo_u32 v40, v40, s57
  v_add3_u32 v40, v40, v14, s56
  v_mul_lo_u32 v40, v40, s59
  v_add_u32 v40, v40, v24
  buffer_load_dwordx4 v40, s[32:35], 0 offen lds
  s_add_u32 m0, m0, 1024
  v_lshrrev_b32 v40, 2, v15
  v_mul_lo_u32 v40, v40, s57
  v_add3_u32 v40, v40, v15, s56
  v_mul_lo_u32 v40, v40, s59
  v_add_u32 v40, v40, v25
  buffer_load_dwordx4 v40, s[32:35], 0 offen lds
  s_add_u32 m0, m0, 1024
  v_lshrrev_b32 v40, 2, v16
  v_mul_lo_u32 v40, v40, s57
  v_add3_u32 v40, v40, v16, s56
  v_mul_lo_u32 v40, v40, s59
  v_add_u32 v40, v40, v26
  buffer_load_dwordx4 v40, s[32:35], 0 offen lds
  s_add_u32 m0, m0, 1024
  v_lshrrev_b32 v40, 2, v17
  v_mul_lo_u32 v40, v40, s57
  v_add3_u32 v40, v40, v17, s56
  v_mul_lo_u32 v40, v40, s59
  v_add_u32 v40, v40, v27
  buffer_load_dwordx4 v40, s[32:35], 0 offen lds
  s_add_u32 m0, m0, 1024
  v_lshrrev_b32 v40, 2, v18
  v_mul_lo_u32 v40, v40, s57
  v_add3_u32 v40, v40, v18, s56
  v_mul_lo_u32 v40, v40, s59
  v_add_u32 v40, v40, v28
  buffer_load_dwordx4 v40, s[32:35], 0 offen lds
  s_add_u32 m0, m0, 1024
  s_cmp_ge_u32 s49, 54
  s_cbranch_scc1 Lsw_5_big
  s_mul_hi_u32 s51, s49, 238609295
  s_mul_i32 s52, s51, 18
  s_sub_u32 s52, s49, s52
  s_cmp_eq_u32 s51, 1
  s_cselect_b32 s54, s12, s14
  s_cselect_b32 s55, s13, s15
  s_cmp_eq_u32 s51, 0
  s_cselect_b32 s54, s8, s54
  s_cselect_b32 s55, s9, s55
  s_mul_i32 s63, s51, 663552
  s_add_u32 s63, s63, 17301504
  s_mul_i32 s53, s40, 18432
  s_add_u32 s63, s63, s53
  s_mov_b32 s64, 73728
  s_lshl_b32 s56, s52, 5
  s_lshl_b32 s53, s40, 3
  s_add_u32 s56, s56, s53
  s_mov_b32 s57, 0
  s_mov_b32 s59, 1152
  s_cmp_lg_u32 s51, 0
  s_cbranch_scc1 Lsw_5_j
  s_mul_i32 s56, s52, 36
  s_lshl_b32 s53, s40, 2
  s_add_u32 s56, s56, s53
  s_mov_b32 s57, 16
  s_cmp_lt_u32 s52, 16
  s_cbranch_scc1 Lsw_5_j
  s_sub_u32 s56, s52, 16
  s_lshl_b32 s56, s56, 2
  s_add_u32 s56, s56, s40
  s_mul_i32 s56, s56, 72
  s_add_u32 s56, s56, 16
  s_mov_b32 s57, 32
  s_branch Lsw_5_j
Lsw_5_big:
  s_sub_u32 s53, s49, 54
  s_mul_hi_u32 s51, s53, 238609295
  s_mul_i32 s52, s51, 18
  s_sub_u32 s52, s53, s52
  s_mul_i32 s63, s51, 663552
  s_add_u32 s63, s63, 19292160
  s_mul_i32 s53, s40, 165888
  s_add_u32 s63, s63, s53
  s_mov_b32 s64, 18432
  s_lshl_b32 s56, s52, 5
  s_lshl_b32 s53, s40, 3
  s_add_u32 s56, s56, s53
  s_mov_b32 s57, 0
  s_cmp_ge_u32 s51, 8
  s_cbranch_scc1 Lsw_5_w4
  s_mul_i32 s53, s51, 1152
  s_add_u32 s54, s16, s53
  s_addc_u32 s55, s17, 0
  s_mov_b32 s59, 9216
  s_branch Lsw_5_j
Lsw_5_w4:
  s_sub_u32 s53, s51, 8
  s_mul_i32 s53, s53, 663552
  s_add_u32 s54, s18, s53
  s_addc_u32 s55, s19, 0
  s_mov_b32 s59, 1152
Lsw_5_j:
  s_lshl_b32 s53, s52, 10
  s_add_u32 s63, s63, s53
  s_add_u32 s65, s49, 256
  s_mov_b32 s32, s54
  s_mov_b32 s33, s55
  s_mul_i32 s34, s59, 575
  s_add_u32 s34, s34, 1152
  s_mov_b32 s35, 0x20000
  s_mul_i32 s53, s40, 9216
  s_add_u32 m0, s53, 36864
  v_lshrrev_b32 v40, 2, v10
  v_mul_lo_u32 v40, v40, s57
  v_add3_u32 v40, v40, v10, s56
  v_mul_lo_u32 v40, v40, s59
  v_add_u32 v40, v40, v20
  buffer_load_dwordx4 v40, s[32:35], 0 offen lds
  s_add_u32 m0, m0, 1024
  v_lshrrev_b32 v40, 2, v11
  v_mul_lo_u32 v40, v40, s57
  v_add3_u32 v40, v40, v11, s56
  v_mul_lo_u32 v40, v40, s59
  v_add_u32 v40, v40, v21
  buffer_load_dwordx4 v40, s[32:35], 0 offen lds
  s_add_u32 m0, m0, 1024
  v_lshrrev_b32 v40, 2, v12
  v_mul_lo_u32 v40, v40, s57
  v_add3_u32 v40, v40, v12, s56
  v_mul_lo_u32 v40, v40, s59
  v_add_u32 v40, v40, v22
  buffer_load_dwordx4 v40, s[32:35], 0 offen lds
  s_add_u32 m0, m0, 1024
  v_lshrrev_b32 v40, 2, v13
  v_mul_lo_u32 v40, v40, s57
  v_add3_u32 v40, v40, v13, s56
  v_mul_lo_u32 v40, v40, s59
  v_add_u32 v40, v40, v23
  buffer_load_dwordx4 v40, s[32:35], 0 offen lds
  s_add_u32 m0, m0, 1024
  v_lshrrev_b32 v40, 2, v14
  v_mul_lo_u32 v40, v40, s57
  v_add3_u32 v40, v40, v14, s56
  v_mul_lo_u32 v40, v40, s59
  v_add_u32 v40, v40, v24
  buffer_load_dwordx4 v40, s[32:35], 0 offen lds
  s_add_u32 m0, m0, 1024
  v_lshrrev_b32 v40, 2, v15
  v_mul_lo_u32 v40, v40, s57
  v_add3_u32 v40, v40, v15, s56
  v_mul_lo_u32 v40, v40, s59
  v_add_u32 v40, v40, v25
  buffer_load_dwordx4 v40, s[32:35], 0 offen lds
  s_add_u32 m0, m0, 1024
  v_lshrrev_b32 v40, 2, v16
  v_mul_lo_u32 v40, v40, s57
  v_add3_u32 v40, v40, v16, s56
  v_mul_lo_u32 v40, v40, s59
  v_add_u32 v40, v40, v26
  buffer_load_dwordx4 v40, s[32:35], 0 offen lds
  s_add_u32 m0, m0, 1024
  v_lshrrev_b32 v40, 2, v17
  v_mul_lo_u32 v40, v40, s57
  v_add3_u32 v40, v40, v17, s56
  v_mul_lo_u32 v40, v40, s59
  v_add_u32 v40, v40, v27
  buffer_load_dwordx4 v40, s[32:35], 0 offen lds
  s_add_u32 m0, m0, 1024
  v_lshrrev_b32 v40, 2, v18
  v_mul_lo_u32 v40, v40, s57
  v_add3_u32 v40, v40, v18, s56
  v_mul_lo_u32 v40, v40, s59
  v_add_u32 v40, v40, v28
  buffer_load_dwordx4 v40, s[32:35], 0 offen lds
  s_add_u32 m0, m0, 1024
  s_waitcnt vmcnt(0)
  s_barrier
  v_add_u32 v31, 0, v30
  ds_read_b64_tr_b16 v[44:45], v31 offset:0
  ds_read_b64_tr_b16 v[46:47], v31 offset:4608
  ds_read_b64_tr_b16 v[48:49], v31 offset:128
  ds_read_b64_tr_b16 v[50:51], v31 offset:4736
  ds_read_b64_tr_b16 v[52:53], v31 offset:256
  ds_read_b64_tr_b16 v[54:55], v31 offset:4864
  ds_read_b64_tr_b16 v[56:57], v31 offset:384
  ds_read_b64_tr_b16 v[58:59], v31 offset:4992
  ds_read_b64_tr_b16 v[60:61], v31 offset:512
  ds_read_b64_tr_b16 v[62:63], v31 offset:5120
  ds_read_b64_tr_b16 v[64:65], v31 offset:640
  ds_read_b64_tr_b16 v[66:67], v31 offset:5248
  ds_read_b64_tr_b16 v[68:69], v31 offset:768
  ds_read_b64_tr_b16 v[70:71], v31 offset:5376
  ds_read_b64_tr_b16 v[72:73], v31 offset:896
  ds_read_b64_tr_b16 v[74:75], v31 offset:5504
  ds_read_b64_tr_b16 v[76:77], v31 offset:1024
  ds_read_b64_tr_b16 v[78:79], v31 offset:5632
  s_mov_b32 s53, s60
  s_waitcnt lgkmcnt(15)
  buffer_store_dwordx4 v[44:47], v4, s[28:31], s53 offen sc1
  s_add_u32 s53, s53, s61
  s_waitcnt lgkmcnt(14)
  buffer_store_dwordx4 v[48:51], v4, s[28:31], s53 offen sc1
  s_add_u32 s53, s53, s61
  s_waitcnt lgkmcnt(12)
  buffer_store_dwordx4 v[52:55], v4, s[28:31], s53 offen sc1
  s_add_u32 s53, s53, s61
  s_waitcnt lgkmcnt(10)
  buffer_store_dwordx4 v[56:59], v4, s[28:31], s53 offen sc1
  s_add_u32 s53, s53, s61
  s_waitcnt lgkmcnt(8)
  buffer_store_dwordx4 v[60:63], v4, s[28:31], s53 offen sc1
  s_add_u32 s53, s53, s61
  s_waitcnt lgkmcnt(6)
  buffer_store_dwordx4 v[64:67], v4, s[28:31], s53 offen sc1
  s_add_u32 s53, s53, s61
  s_waitcnt lgkmcnt(4)
  buffer_store_dwordx4 v[68:71], v4, s[28:31], s53 offen sc1
  s_add_u32 s53, s53, s61
  s_waitcnt lgkmcnt(2)
  buffer_store_dwordx4 v[72:75], v4, s[28:31], s53 offen sc1
  s_add_u32 s53, s53, s61
  s_waitcnt lgkmcnt(0)
  buffer_store_dwordx4 v[76:79], v4, s[28:31], s53 offen sc1
  s_add_u32 s53, s53, s61
  v_add_u32 v31, 36864, v30
  ds_read_b64_tr_b16 v[44:45], v31 offset:0
  ds_read_b64_tr_b16 v[46:47], v31 offset:4608
  ds_read_b64_tr_b16 v[48:49], v31 offset:128
  ds_read_b64_tr_b16 v[50:51], v31 offset:4736
  ds_read_b64_tr_b16 v[52:53], v31 offset:256
  ds_read_b64_tr_b16 v[54:55], v31 offset:4864
  ds_read_b64_tr_b16 v[56:57], v31 offset:384
  ds_read_b64_tr_b16 v[58:59], v31 offset:4992
  ds_read_b64_tr_b16 v[60:61], v31 offset:512
  ds_read_b64_tr_b16 v[62:63], v31 offset:5120
  ds_read_b64_tr_b16 v[64:65], v31 offset:640
  ds_read_b64_tr_b16 v[66:67], v31 offset:5248
  ds_read_b64_tr_b16 v[68:69], v31 offset:768
  ds_read_b64_tr_b16 v[70:71], v31 offset:5376
  ds_read_b64_tr_b16 v[72:73], v31 offset:896
  ds_read_b64_tr_b16 v[74:75], v31 offset:5504
  ds_read_b64_tr_b16 v[76:77], v31 offset:1024
  ds_read_b64_tr_b16 v[78:79], v31 offset:5632
  s_mov_b32 s53, s63
  s_waitcnt lgkmcnt(15)
  buffer_store_dwordx4 v[44:47], v4, s[28:31], s53 offen sc1
  s_add_u32 s53, s53, s64
  s_waitcnt lgkmcnt(14)
  buffer_store_dwordx4 v[48:51], v4, s[28:31], s53 offen sc1
  s_add_u32 s53, s53, s64
  s_waitcnt lgkmcnt(12)
  buffer_store_dwordx4 v[52:55], v4, s[28:31], s53 offen sc1
  s_add_u32 s53, s53, s64
  s_waitcnt lgkmcnt(10)
  buffer_store_dwordx4 v[56:59], v4, s[28:31], s53 offen sc1
  s_add_u32 s53, s53, s64
  s_waitcnt lgkmcnt(8)
  buffer_store_dwordx4 v[60:63], v4, s[28:31], s53 offen sc1
  s_add_u32 s53, s53, s64
  s_waitcnt lgkmcnt(6)
  buffer_store_dwordx4 v[64:67], v4, s[28:31], s53 offen sc1
  s_add_u32 s53, s53, s64
  s_waitcnt lgkmcnt(4)
  buffer_store_dwordx4 v[68:71], v4, s[28:31], s53 offen sc1
  s_add_u32 s53, s53, s64
  s_waitcnt lgkmcnt(2)
  buffer_store_dwordx4 v[72:75], v4, s[28:31], s53 offen sc1
  s_add_u32 s53, s53, s64
  s_waitcnt lgkmcnt(0)
  buffer_store_dwordx4 v[76:79], v4, s[28:31], s53 offen sc1
  s_add_u32 s53, s53, s64
  s_cmp_lg_u32 s40, 0
  s_cbranch_scc1 Lhn_6
  s_mov_b32 s46, 200000
  v_mov_b32 v38, 0
Lnon_7:
  global_load_dwordx2 v[36:37], v38, s[22:23] sc1
  s_waitcnt vmcnt(0)
  v_readfirstlane_b32 s47, v37
  v_readfirstlane_b32 s43, v36
  s_sub_u32 s46, s46, 1
  s_cbranch_scc1 Lnon_7_x
  s_cmp_eq_u32 s47, 0
  s_cbranch_scc1 Lnon_7
Lnon_7_x:
Lhn_6:
  s_waitcnt vmcnt(0)
  s_barrier
  s_cmp_lg_u32 s40, 0
  s_cbranch_scc1 Lswf_8
  s_lshl_b32 s62, s62, 7
  s_add_u32 s62, s62, 128
  v_mov_b32 v40, s43
  v_mov_b32 v41, 0
  s_mov_b64 exec, 1
  buffer_store_dword v40, v41, s[28:31], s62 offen sc1
  s_mov_b64 exec, -1
  s_lshl_b32 s65, s65, 7
  s_add_u32 s65, s65, 128
  v_mov_b32 v40, s43
  v_mov_b32 v41, 0
  s_mov_b64 exec, 1
  buffer_store_dword v40, v41, s[28:31], s65 offen sc1
  s_mov_b64 exec, -1
Lswf_8:
  s_mov_b32 s75, 19
Lmk_9:
  buffer_store_dwordx4 v[220:223], v4, s[76:79], s74 offen offset:0 sc1
  buffer_store_dwordx4 v[220:223], v4, s[76:79], s74 offen offset:1024 sc1
  s_add_u32 s74, s74, 2048
  s_waitcnt vmcnt(40)
  s_sub_u32 s75, s75, 1
  s_cmp_lg_u32 s75, 0
  s_cbranch_scc1 Lmk_9
  s_waitcnt vmcnt(0)
  s_barrier
  s_cmp_lg_u32 s40, 0
  s_cbranch_scc1 Lswf_10
  s_lshl_b32 s46, s2, 2
  s_add_u32 s46, s46, 519296
  v_mov_b32 v40, s43
  v_mov_b32 v41, 0
  s_mov_b64 exec, 1
  buffer_store_dword v40, v41, s[28:31], s46 offen sc1
  s_mov_b64 exec, -1
Lswf_10:
L_p1_done:
  s_lshr_b32 s50, s42, 1
  s_and_b32 s51, s42, 1
  s_lshl_b32 s46, s41, 1
  s_add_u32 s51, s51, s46
  s_mul_i32 s52, s51, 147456
  s_add_u32 s46, s52, 2949120
  s_add_u32 s32, s24, s46
  s_addc_u32 s33, s25, 0
  s_mov_b32 s34, 147456
  s_mov_b32 s35, 0x20000
  s_add_u32 s46, s52, 5308416
  s_add_u32 s36, s24, s46
  s_addc_u32 s37, s25, 0
  s_mov_b32 s38, 147456
  s_mov_b32 s39, 0x20000
  s_mul_i32 s46, s50, 9216
  s_sub_u32 s46, s46, 18432
  s_lshl_b32 s47, s40, 10
  s_add_u32 s46, s46, s47
  v_add_u32 v10, s46, v4
  v_add_u32 v11, 4096, v10
  v_add_u32 v12, 8192, v10
  v_add_u32 v13, 12288, v10
  v_add_u32 v14, 16384, v10
  v_add_u32 v15, 20480, v10
  v_add_u32 v16, 24576, v10
  s_lshl_b32 s46, s50, 3
  s_lshl_b32 s53, s40, 1
  s_add_u32 s53, s53, s46
  s_mul_i32 s54, s53, 1152
  s_add_u32 s54, s54, s52
  s_add_u32 s54, s54, 589824
  v_lshlrev_b32 v18, 4, v2
  s_mul_i32 s46, s40, 2304
  v_add_u32 v20, s46, v4
  s_add_u32 s47, s46, 2048
  v_add_u32 v21, s47, v18
  s_add_u32 s47, s46, 27648
  v_add_u32 v22, s47, v4
  v_lshl_add_u32 v23, v2, 2, v3
  s_add_u32 s47, s47, 2048
  v_lshl_add_u32 v23, v23, 4, s47
  v_lshl_add_u32 v24, v3, 2, 0
  v_cmp_gt_u32 s[60:61], v24, v2
  v_lshl_add_u32 v24, v3, 2, 1
  v_cmp_gt_u32 s[62:63], v24, v2
  v_lshl_add_u32 v24, v3, 2, 2
  v_cmp_gt_u32 s[64:65], v24, v2
  v_lshl_add_u32 v24, v3, 2, 3
  v_cmp_gt_u32 s[66:67], v24, v2
  v_cmp_eq_u32 s[68:69], 0, v3
  v_mov_b32 v25, 0xf149f2ca
  v_mov_b32 v228, -1
  v_mov_b32 v229, -1
  v_mov_b32 v230, -1
  v_mov_b32 v231, -1
  v_and_b32 v225, 31, v1
  v_lshlrev_b32 v225, 2, v225
  v_accvgpr_write_b32 a0, s44
  v_accvgpr_write_b32 a1, s44
  v_accvgpr_write_b32 a2, s44
  v_accvgpr_write_b32 a3, s44
  v_accvgpr_write_b32 a4, s44
  v_accvgpr_write_b32 a5, s44
  v_accvgpr_write_b32 a6, s44
  v_accvgpr_write_b32 a7, s44
  v_accvgpr_write_b32 a8, s44
  v_accvgpr_write_b32 a9, s44
  v_accvgpr_write_b32 a10, s44
  v_accvgpr_write_b32 a11, s44
  v_accvgpr_write_b32 a12, s44
  v_accvgpr_write_b32 a13, s44
  v_accvgpr_write_b32 a14, s44
  v_accvgpr_write_b32 a15, s44
  v_accvgpr_write_b32 a16, s44
  v_accvgpr_write_b32 a17, s44
  v_accvgpr_write_b32 a18, s44
  v_accvgpr_write_b32 a19, s44
  v_accvgpr_write_b32 a20, s44
  v_accvgpr_write_b32 a21, s44
  v_accvgpr_write_b32 a22, s44
  v_accvgpr_write_b32 a23, s44
  v_accvgpr_write_b32 a24, s44
  v_accvgpr_write_b32 a25, s44
  v_accvgpr_write_b32 a26, s44
  v_accvgpr_write_b32 a27, s44
  v_accvgpr_write_b32 a28, s44
  v_accvgpr_write_b32 a29, s44
  v_accvgpr_write_b32 a30, s44
  v_accvgpr_write_b32 a31, s44
  v_accvgpr_write_b32 a32, s44
  v_accvgpr_write_b32 a33, s44
  v_accvgpr_write_b32 a34, s44
  v_accvgpr_write_b32 a35, s44
  s_lshr_b32 s46, s42, 3
  s_lshl_b32 s74, s41, 2
  s_add_u32 s74, s74, s46
  s_add_u32 s75, s42, 6
  s_and_b32 s75, s75, 7
  s_lshl_b32 s76, s74, 2
  s_add_u32 s76, s76, s40
  s_mul_i32 s46, s75, 110592
  s_mul_i32 s47, s40, 27648
  s_add_u32 s70, s46, s47
  s_add_u32 s70, s70, 17301504
  s_add_u32 s71, s70, 663552
  s_add_u32 s72, s71, 663552
  s_cmp_ge_u32 s75, 6
  s_cbranch_scc1 L_p2_hs
  s_add_u32 s73, s47, 53248
  s_mov_b32 s79, 9216
  s_add_u32 s3, s70, 0
  s_add_u32 s27, s70, 9216
  s_add_u32 s45, s70, 18432
  v_add_u32 v244, 0, v4
  v_add_u32 v245, 0, v4
  v_add_u32 v246, 0, v4
  v_add_u32 v247, 3072, v4
  v_add_u32 v248, 3072, v4
  v_add_u32 v249, 3072, v4
  v_add_u32 v250, 6144, v4
  v_add_u32 v251, 6144, v4
  v_add_u32 v252, 6144, v4
  s_mov_b32 s10, s24
  s_mov_b32 s11, s25
  s_mov_b32 s26, 48783360
  s_branch L_p2_hd
L_p2_hs:
  s_mov_b32 s71, 0x70000000
  s_mul_i32 s47, s40, 9216
  s_add_u32 s73, s47, 53248
  s_mov_b32 s79, 36864
  s_lshl_b32 s48, s74, 1
  s_add_u32 s48, s48, s75
  s_sub_u32 s48, s48, 6
  s_mul_i32 s48, s48, 3
  s_mov_b32 s10, s16
  s_mov_b32 s11, s17
  s_mov_b32 s78, 9216
  s_cmp_lt_u32 s48, 144
  s_cselect_b32 s26, 5308416, 0
  s_add_u32 s46, s48, 0
  s_mul_hi_u32 s47, s46, 238609295
  s_mul_i32 s56, s47, 18
  s_sub_u32 s56, s46, s56
  s_lshl_b32 s56, s56, 2
  s_add_u32 s56, s56, s40
  s_mul_i32 s56, s56, 73728
  s_mul_i32 s47, s47, 1152
  s_add_u32 s3, s56, s47
  s_add_u32 s46, s48, 1
  s_mul_hi_u32 s47, s46, 238609295
  s_mul_i32 s56, s47, 18
  s_sub_u32 s56, s46, s56
  s_lshl_b32 s56, s56, 2
  s_add_u32 s56, s56, s40
  s_mul_i32 s56, s56, 73728
  s_mul_i32 s47, s47, 1152
  s_add_u32 s27, s56, s47
  s_add_u32 s46, s48, 2
  s_mul_hi_u32 s47, s46, 238609295
  s_mul_i32 s56, s47, 18
  s_sub_u32 s56, s46, s56
  s_lshl_b32 s56, s56, 2
  s_add_u32 s56, s56, s40
  s_mul_i32 s56, s56, 73728
  s_mul_i32 s47, s47, 1152
  s_add_u32 s45, s56, s47
  v_add_u32 v24, 0, v1
  v_mul_u32_u24 v26, 911, v24
  v_lshrrev_b32 v26, 16, v26
  v_mul_u32_u24 v27, 72, v26
  v_sub_u32 v27, v24, v27
  v_mul_lo_u32 v26, v26, s78
  v_lshl_add_u32 v244, v27, 4, v26
  v_add_u32 v24, 64, v1
  v_mul_u32_u24 v26, 911, v24
  v_lshrrev_b32 v26, 16, v26
  v_mul_u32_u24 v27, 72, v26
  v_sub_u32 v27, v24, v27
  v_mul_lo_u32 v26, v26, s78
  v_lshl_add_u32 v245, v27, 4, v26
  v_subrev_u32 v245, 1024, v245
  v_add_u32 v24, 128, v1
  v_mul_u32_u24 v26, 911, v24
  v_lshrrev_b32 v26, 16, v26
  v_mul_u32_u24 v27, 72, v26
  v_sub_u32 v27, v24, v27
  v_mul_lo_u32 v26, v26, s78
  v_lshl_add_u32 v246, v27, 4, v26
  v_subrev_u32 v246, 2048, v246
  v_add_u32 v24, 192, v1
  v_mul_u32_u24 v26, 911, v24
  v_lshrrev_b32 v26, 16, v26
  v_mul_u32_u24 v27, 72, v26
  v_sub_u32 v27, v24, v27
  v_mul_lo_u32 v26, v26, s78
  v_lshl_add_u32 v247, v27, 4, v26
  v_add_u32 v24, 256, v1
  v_mul_u32_u24 v26, 911, v24
  v_lshrrev_b32 v26, 16, v26
  v_mul_u32_u24 v27, 72, v26
  v_sub_u32 v27, v24, v27
  v_mul_lo_u32 v26, v26, s78
  v_lshl_add_u32 v248, v27, 4, v26
  v_subrev_u32 v248, 1024, v248
  v_add_u32 v24, 320, v1
  v_mul_u32_u24 v26, 911, v24
  v_lshrrev_b32 v26, 16, v26
  v_mul_u32_u24 v27, 72, v26
  v_sub_u32 v27, v24, v27
  v_mul_lo_u32 v26, v26, s78
  v_lshl_add_u32 v249, v27, 4, v26
  v_subrev_u32 v249, 2048, v249
  v_add_u32 v24, 384, v1
  v_mul_u32_u24 v26, 911, v24
  v_lshrrev_b32 v26, 16, v26
  v_mul_u32_u24 v27, 72, v26
  v_sub_u32 v27, v24, v27
  v_mul_lo_u32 v26, v26, s78
  v_lshl_add_u32 v250, v27, 4, v26
  v_add_u32 v24, 448, v1
  v_mul_u32_u24 v26, 911, v24
  v_lshrrev_b32 v26, 16, v26
  v_mul_u32_u24 v27, 72, v26
  v_sub_u32 v27, v24, v27
  v_mul_lo_u32 v26, v26, s78
  v_lshl_add_u32 v251, v27, 4, v26
  v_subrev_u32 v251, 1024, v251
  v_add_u32 v24, 512, v1
  v_mul_u32_u24 v26, 911, v24
  v_lshrrev_b32 v26, 16, v26
  v_mul_u32_u24 v27, 72, v26
  v_sub_u32 v27, v24, v27
  v_mul_lo_u32 v26, v26, s78
  v_lshl_add_u32 v252, v27, 4, v26
  v_subrev_u32 v252, 2048, v252
L_p2_hd:
  v_mul_u32_u24 v7, 1152, v2
  v_lshl_add_u32 v7, v3, 4, v7
  s_mul_i32 s46, s76, 18432
  s_mul_i32 s47, s75, 192
  s_add_u32 s77, s46, s47
  s_cmp_ge_u32 s75, 6
  s_cselect_b32 s77, 0x70000000, s77
  v_mov_b32 v19, 57344
  s_cmp_lg_u32 s40, 0
  s_cbranch_scc1 Lp2w_11
  v_and_b32 v30, 2, v1
  v_cmp_eq_u32 s[58:59], 0, v30
  v_cmp_gt_u32 vcc, 12, v1
  s_andn2_b64 s[56:57], vcc, s[58:59]
  s_and_b64 s[58:59], vcc, s[58:59]
  v_mov_b32 v34, 0x49800000
  v_mov_b32 v35, 0x7f800000
  v_lshrrev_b32 v30, 2, v1
  v_min_u32 v30, 2, v30
  v_add_u32 v30, s50, v30
  v_subrev_u32 v30, 2, v30
  v_max_i32 v30, 0, v30
  v_bfe_u32 v31, v1, 1, 1
  v_add_u32 v31, 1, v31
  v_cmp_gt_u32 vcc, 12, v1
  s_nop 1
  v_cndmask_b32 v31, 0, v31, vcc
  v_mul_u32_u24 v31, 576, v31
  v_and_b32 v32, 1, v1
  v_mul_u32_u24 v32, 35, v32
  s_mul_i32 s46, s51, 36
  v_add3_u32 v31, v31, v32, s46
  v_lshrrev_b32 v31, 7, v31
  v_lshl_add_u32 v30, v30, 4, v31
  v_add_u32 v30, 0, v30
  v_lshlrev_b32 v30, 7, v30
  s_mov_b32 s46, 100000
Lpoll_12:
  buffer_load_dwordx2 v[32:33], v30, s[28:31], 0 offen offset:128 sc1
  s_waitcnt vmcnt(0)
  v_cmp_ne_u32 vcc, s43, v32
  s_cbranch_vccz Lpoll_12_x
  s_sleep 2
  s_sub_u32 s46, s46, 1
  s_cbranch_scc0 Lpoll_12
Lpoll_12_x:
  v_cndmask_b32 v30, 0, v33, s[58:59]
  v_cndmask_b32 v31, 0, v33, s[56:57]
  v_cmp_nle_f32 vcc, v31, v34
  s_nop 1
  v_cndmask_b32 v30, v30, v35, vcc
  s_nop 1
  v_max_f32_dpp v30, v30, v30 row_ror:8 row_mask:0xf bank_mask:0xf
  s_nop 1
  v_max_f32_dpp v30, v30, v30 row_ror:4 row_mask:0xf bank_mask:0xf
  s_nop 1
  v_max_f32_dpp v30, v30, v30 row_ror:2 row_mask:0xf bank_mask:0xf
  s_nop 1
  v_max_f32_dpp v30, v30, v30 row_ror:1 row_mask:0xf bank_mask:0xf
  s_mov_b64 exec, 1
  ds_write_b32 v19, v30
  s_mov_b64 exec, -1
  s_waitcnt lgkmcnt(0)
Lp2w_11:
  s_barrier
  ds_read_b32 v19, v19
  v_min_u32 v38, 53, v1
  v_add_u32 v38, 256, v38
  v_lshlrev_b32 v38, 7, v38
  buffer_load_dwordx4 v[26:29], v4, s[28:31], s54 offen sc1
  buffer_load_dwordx4 v[30:33], v18, s[28:31], s54 offen offset:2048 sc1
  buffer_load_dwordx4 v[34:37], v4, s[28:31], s54 offen offset:1024 sc1
  buffer_load_dword v39, v38, s[28:31], 0 offen offset:128 sc1
  s_lshl_b32 s46, s40, 10
  s_add_u32 m0, s46, 0
  s_nop 0
  buffer_load_dwordx4 v10, s[32:35], 0 offen sc1 lds
  s_add_u32 m0, s46, 4096
  s_nop 0
  buffer_load_dwordx4 v11, s[32:35], 0 offen sc1 lds
  s_add_u32 m0, s46, 8192
  s_nop 0
  buffer_load_dwordx4 v12, s[32:35], 0 offen sc1 lds
  s_add_u32 m0, s46, 12288
  s_nop 0
  buffer_load_dwordx4 v13, s[32:35], 0 offen sc1 lds
  s_add_u32 m0, s46, 16384
  s_nop 0
  buffer_load_dwordx4 v14, s[32:35], 0 offen sc1 lds
  s_add_u32 m0, s46, 20480
  s_nop 0
  buffer_load_dwordx4 v15, s[32:35], 0 offen sc1 lds
  s_cmp_eq_u32 s40, 3
  s_cbranch_scc1 Lp2d_19
  s_add_u32 m0, s46, 24576
  s_nop 0
  buffer_load_dwordx4 v16, s[32:35], 0 offen sc1 lds
Lp2d_19:
  s_add_u32 m0, s46, 27648
  s_nop 0
  buffer_load_dwordx4 v10, s[36:39], 0 offen sc1 lds
  s_add_u32 m0, s46, 31744
  s_nop 0
  buffer_load_dwordx4 v11, s[36:39], 0 offen sc1 lds
  s_add_u32 m0, s46, 35840
  s_nop 0
  buffer_load_dwordx4 v12, s[36:39], 0 offen sc1 lds
  s_add_u32 m0, s46, 39936
  s_nop 0
  buffer_load_dwordx4 v13, s[36:39], 0 offen sc1 lds
  s_add_u32 m0, s46, 44032
  s_nop 0
  buffer_load_dwordx4 v14, s[36:39], 0 offen sc1 lds
  s_add_u32 m0, s46, 48128
  s_nop 0
  buffer_load_dwordx4 v15, s[36:39], 0 offen sc1 lds
  s_cmp_eq_u32 s40, 3
  s_cbranch_scc1 Lp2d_26
  s_add_u32 m0, s46, 52224
  s_nop 0
  buffer_load_dwordx4 v16, s[36:39], 0 offen sc1 lds
Lp2d_26:
  s_add_u32 s32, s4, 0
  s_addc_u32 s33, s5, 0
  s_mov_b32 s34, 2359296
  s_mov_b32 s35, 0x20000
  s_mov_b32 s36, s10
  s_mov_b32 s37, s11
  s_mov_b32 s38, s26
  s_mov_b32 s39, 0x20000
  s_waitcnt vmcnt(12)
  v_mov_b32 v42, v26
  v_mov_b32 v43, v27
  v_cndmask_b32 v40, 0, v30, s[68:69]
  v_mov_b32 v41, 0
  v_mov_b32 v44, v40
  v_mov_b32 v45, v41
  v_mov_b32 v48, v28
  v_mov_b32 v49, v29
  v_cndmask_b32 v46, 0, v32, s[68:69]
  v_mov_b32 v47, 0
  v_mov_b32 v50, v46
  v_mov_b32 v51, v47
  v_mov_b32 v54, v34
  v_mov_b32 v55, v35
  v_cndmask_b32 v53, 0, v31, s[68:69]
  v_mov_b32 v52, 0
  v_mov_b32 v56, v52
  v_mov_b32 v57, v53
  v_mov_b32 v60, v36
  v_mov_b32 v61, v37
  v_cndmask_b32 v59, 0, v33, s[68:69]
  v_mov_b32 v58, 0
  v_mov_b32 v62, v58
  v_mov_b32 v63, v59
  v_mov_b32 v216, 0
  v_and_b32 v24, 0x7fff7fff, v40
  v_dot2c_f32_bf16 v216, s44, v24
  v_and_b32 v24, 0x7fff7fff, v41
  v_dot2c_f32_bf16 v216, s44, v24
  v_and_b32 v24, 0x7fff7fff, v42
  v_dot2c_f32_bf16 v216, s44, v24
  v_and_b32 v24, 0x7fff7fff, v43
  v_dot2c_f32_bf16 v216, s44, v24
  v_mov_b32 v217, 0
  v_and_b32 v24, 0x7fff7fff, v46
  v_dot2c_f32_bf16 v217, s44, v24
  v_and_b32 v24, 0x7fff7fff, v47
  v_dot2c_f32_bf16 v217, s44, v24
  v_and_b32 v24, 0x7fff7fff, v48
  v_dot2c_f32_bf16 v217, s44, v24
  v_and_b32 v24, 0x7fff7fff, v49
  v_dot2c_f32_bf16 v217, s44, v24
  v_mov_b32 v218, 0
  v_and_b32 v24, 0x7fff7fff, v52
  v_dot2c_f32_bf16 v218, s44, v24
  v_and_b32 v24, 0x7fff7fff, v53
  v_dot2c_f32_bf16 v218, s44, v24
  v_and_b32 v24, 0x7fff7fff, v54
  v_dot2c_f32_bf16 v218, s44, v24
  v_and_b32 v24, 0x7fff7fff, v55
  v_dot2c_f32_bf16 v218, s44, v24
  v_mov_b32 v219, 0
  v_and_b32 v24, 0x7fff7fff, v58
  v_dot2c_f32_bf16 v219, s44, v24
  v_and_b32 v24, 0x7fff7fff, v59
  v_dot2c_f32_bf16 v219, s44, v24
  v_and_b32 v24, 0x7fff7fff, v60
  v_dot2c_f32_bf16 v219, s44, v24
  v_and_b32 v24, 0x7fff7fff, v61
  v_dot2c_f32_bf16 v219, s44, v24
  v_max3_f32 v216, v216, v217, v218
  s_nop 1
  v_max_f32 v216, v216, v219
  v_mov_b32 v217, v216
  s_nop 1
  v_permlane32_swap_b32 v216, v217
  v_add_f32 v216, v216, v217
  v_mov_b32 v217, v216
  s_nop 1
  v_permlane16_swap_b32 v216, v217
  v_add_f32 v216, v216, v217
  s_waitcnt lgkmcnt(0)
  v_mul_f32 v216, v19, v216
  v_mov_b32 v217, 0x42c00000
  v_cmp_nle_f32 s[58:59], v216, v217
  v_cndmask_b32 v8, v25, 0, s[60:61]
  v_cndmask_b32 v12, 0, v25, s[60:61]
  v_cndmask_b32 v9, v25, 0, s[62:63]
  v_cndmask_b32 v13, 0, v25, s[62:63]
  v_cndmask_b32 v10, v25, 0, s[64:65]
  v_cndmask_b32 v14, 0, v25, s[64:65]
  v_cndmask_b32 v11, v25, 0, s[66:67]
  v_cndmask_b32 v15, 0, v25, s[66:67]
  s_lshl_b32 s55, s50, 3
  s_lshl_b32 s46, s40, 1
  s_add_u32 s55, s55, s46
  s_sub_u32 s55, 16, s55
  s_max_i32 s55, s55, 0
  s_lshl_b32 s56, s2, 2
  s_add_u32 s56, s56, s40
  s_mul_i32 s56, s56, 5120
  s_min_u32 s56, s56, 4811776
  s_add_u32 s56, s56, 12484608
  s_cmp_lg_u32 s40, 0
  s_cbranch_scc1 Lfs_27
  v_cmp_ne_u32 vcc, s43, v39
  s_cbranch_vccz Lfs_27
  v_lshrrev_b32 v38, 7, v38
  v_lshlrev_b32 v38, 7, v38
  s_mov_b32 s46, 100000
Lpoll_28:
  buffer_load_dword v39, v38, s[28:31], 0 offen offset:128 sc1
  s_waitcnt vmcnt(0)
  v_cmp_ne_u32 vcc, s43, v39
  s_cbranch_vccz Lpoll_28_x
  s_sleep 2
  s_sub_u32 s46, s46, 1
  s_cbranch_scc0 Lpoll_28
Lpoll_28_x:
Lfs_27:
  s_waitcnt vmcnt(6)
  s_barrier
  s_cmp_lg_u64 s[58:59], 0
  s_cbranch_scc1 L_p2_slow
  s_cmp_lt_u32 s50, 2
  s_cbranch_scc1 L_p2_edge
  ds_read_b128 v[66:69], v20 offset:0
  ds_read_b64 v[64:65], v21 offset:0
  ds_read_b64 v[70:71], v21 offset:8
  ds_read_b128 v[74:77], v20 offset:2304
  ds_read_b64 v[72:73], v21 offset:2304
  ds_read_b64 v[78:79], v21 offset:2312
  s_waitcnt lgkmcnt(3)
  v_mfma_f32_16x16x32_bf16 v[136:139], v[64:67], v[40:43], v[8:11]
  v_mfma_f32_16x16x32_bf16 v[140:143], v[68:71], v[42:45], 0
  v_mfma_f32_16x16x32_bf16 v[148:151], v[68:71], v[48:51], v[8:11]
  s_waitcnt lgkmcnt(0)
  v_mfma_f32_16x16x32_bf16 v[152:155], v[72:75], v[40:43], 0
  ds_read_b128 v[82:85], v20 offset:4608
  ds_read_b64 v[80:81], v21 offset:4608
  ds_read_b64 v[86:87], v21 offset:4616
  s_nop 0
  v_exp_f32 v136, v136
  v_exp_f32 v137, v137
  v_exp_f32 v138, v138
  v_mfma_f32_16x16x32_bf16 v[156:159], v[76:79], v[42:45], 0
  v_exp_f32 v139, v139
  v_exp_f32 v140, v140
  v_exp_f32 v141, v141
  v_exp_f32 v142, v142
  v_exp_f32 v143, v143
  v_cvt_pk_bf16_f32 v168, v136, v137
  v_mfma_f32_16x16x32_bf16 v[160:163], v[72:75], v[46:49], 0
  v_cvt_pk_bf16_f32 v169, v138, v139
  v_cvt_pk_bf16_f32 v170, v140, v141
  v_cvt_pk_bf16_f32 v171, v142, v143
  v_exp_f32 v148, v148
  v_exp_f32 v149, v149
  v_exp_f32 v150, v150
  v_mfma_f32_16x16x32_bf16 v[164:167], v[76:79], v[48:51], 0
  v_exp_f32 v151, v151
  v_mov_b32 v172, 0
  v_mov_b32 v173, 0
  v_cvt_pk_bf16_f32 v174, v148, v149
  v_cvt_pk_bf16_f32 v175, v150, v151
  s_waitcnt vmcnt(0)
  s_barrier
  buffer_store_dwordx4 v[228:231], v4, s[28:31], s56 offen offset:0 sc1
  buffer_store_dwordx4 v[228:231], v4, s[28:31], s56 offen offset:1024 sc1
  buffer_store_dwordx4 v[228:231], v4, s[28:31], s56 offen offset:2048 sc1
  buffer_store_dwordx4 v[228:231], v4, s[28:31], s56 offen offset:3072 sc1
  s_add_u32 s56, s56, 4096
  buffer_store_dwordx4 v[228:231], v4, s[28:31], s56 offen offset:0 sc1
  s_mov_b32 s46, 520192
  buffer_load_dword v224, v225, s[28:31], s46 offen sc1
  s_mov_b32 exec_lo, 0x00030003
  s_mov_b32 exec_hi, 0x00030003
  ds_read_b128 a[0:3], v23 offset:0
  ds_read_b128 a[4:7], v23 offset:2304
  ds_read_b128 a[8:11], v23 offset:4608
  ds_read_b128 a[12:15], v23 offset:6912
  ds_read_b128 a[16:19], v23 offset:9216
  ds_read_b128 a[20:23], v23 offset:11520
  ds_read_b128 a[24:27], v23 offset:13824
  ds_read_b128 a[28:31], v23 offset:16128
  ds_read_b128 a[32:35], v23 offset:18432
  s_mov_b64 exec, -1
  ds_read_b128 v[184:187], v22 offset:0
  ds_read_b128 v[188:191], v22 offset:2304
  s_waitcnt lgkmcnt(11)
  v_mfma_f32_16x16x32_bf16 v[136:139], v[80:83], v[40:43], 0
  ds_read_b128 v[90:93], v20 offset:6912
  ds_read_b64 v[88:89], v21 offset:6912
  ds_read_b64 v[94:95], v21 offset:6920
  v_exp_f32 v152, v152
  v_mfma_f32_16x16x32_bf16 v[140:143], v[84:87], v[42:45], 0
  v_exp_f32 v153, v153
  v_exp_f32 v154, v154
  v_exp_f32 v155, v155
  s_mul_i32 s58, s79, 0
  s_add_u32 s58, s58, s73
  s_mov_b32 m0, s58
  s_nop 0
  buffer_load_dwordx4 v246, s[36:39], s3 offen offset:2048 sc1 lds
  s_add_u32 m0, m0, 3072
  v_mfma_f32_16x16x32_bf16 v[144:147], v[80:83], v[46:49], 0
  v_exp_f32 v156, v156
  v_exp_f32 v157, v157
  v_exp_f32 v158, v158
  v_exp_f32 v159, v159
  v_mfma_f32_16x16x32_bf16 v[148:151], v[84:87], v[48:51], 0
  buffer_load_dwordx4 v247, s[36:39], s3 offen offset:0 sc1 lds
  v_cvt_pk_bf16_f32 v176, v152, v153
  v_cvt_pk_bf16_f32 v177, v154, v155
  s_waitcnt lgkmcnt(4)
  v_mfma_f32_16x16x32_bf16 v[192:195], v[184:187], v[168:171], 0
  v_cvt_pk_bf16_f32 v178, v156, v157
  v_cvt_pk_bf16_f32 v179, v158, v159
  v_exp_f32 v160, v160
  v_exp_f32 v161, v161
  v_mfma_f32_16x16x32_bf16 v[200:203], a[0:3], v[168:171], 0
  v_exp_f32 v162, v162
  v_exp_f32 v163, v163
  buffer_load_dwordx4 v248, s[36:39], s3 offen offset:1024 sc1 lds
  v_exp_f32 v164, v164
  v_mfma_f32_16x16x32_bf16 v[196:199], v[184:187], v[172:175], 0
  v_exp_f32 v165, v165
  v_exp_f32 v166, v166
  v_exp_f32 v167, v167
  buffer_load_dwordx4 v249, s[36:39], s3 offen offset:2048 sc1 lds
  s_add_u32 m0, m0, 3072
  v_mfma_f32_16x16x32_bf16 v[204:207], a[0:3], v[172:175], 0
  v_cvt_pk_bf16_f32 v180, v160, v161
  v_cvt_pk_bf16_f32 v181, v162, v163
  v_cvt_pk_bf16_f32 v182, v164, v165
  v_cvt_pk_bf16_f32 v183, v166, v167
  ds_read_b128 v[184:187], v22 offset:4608
  s_waitcnt lgkmcnt(1)
  v_mfma_f32_16x16x32_bf16 v[152:155], v[88:91], v[40:43], 0
  ds_read_b128 v[98:101], v20 offset:9216
  ds_read_b64 v[96:97], v21 offset:9216
  ds_read_b64 v[102:103], v21 offset:9224
  v_exp_f32 v136, v136
  v_mfma_f32_16x16x32_bf16 v[156:159], v[92:95], v[42:45], 0
  v_exp_f32 v137, v137
  v_exp_f32 v138, v138
  v_exp_f32 v139, v139
  buffer_load_dwordx4 v250, s[36:39], s3 offen offset:0 sc1 lds
  v_mfma_f32_16x16x32_bf16 v[160:163], v[88:91], v[46:49], 0
  v_exp_f32 v140, v140
  v_exp_f32 v141, v141
  v_exp_f32 v142, v142
  v_exp_f32 v143, v143
  v_mfma_f32_16x16x32_bf16 v[164:167], v[92:95], v[48:51], 0
  buffer_load_dwordx4 v251, s[36:39], s3 offen offset:1024 sc1 lds
  v_cvt_pk_bf16_f32 v168, v136, v137
  v_cvt_pk_bf16_f32 v169, v138, v139
  v_cvt_pk_bf16_f32 v170, v140, v141
  v_mfma_f32_16x16x32_bf16 v[192:195], v[188:191], v[176:179], v[192:195]
  v_cvt_pk_bf16_f32 v171, v142, v143
  v_exp_f32 v144, v144
  v_exp_f32 v145, v145
  v_exp_f32 v146, v146
  v_mfma_f32_16x16x32_bf16 v[200:203], a[4:7], v[176:179], v[200:203]
  v_exp_f32 v147, v147
  buffer_load_dwordx4 v252, s[36:39], s3 offen offset:2048 sc1 lds
  v_exp_f32 v148, v148
  v_exp_f32 v149, v149
  v_mfma_f32_16x16x32_bf16 v[196:199], v[188:191], v[180:183], v[196:199]
  v_exp_f32 v150, v150
  v_exp_f32 v151, v151
  s_mul_i32 s58, s79, 1
  s_add_u32 s58, s58, s73
  s_mov_b32 m0, s58
  s_nop 0
  buffer_load_dwordx4 v244, s[36:39], s27 offen offset:0 sc1 lds
  v_cvt_pk_bf16_f32 v172, v144, v145
  v_mfma_f32_16x16x32_bf16 v[204:207], a[4:7], v[180:183], v[204:207]
  v_cvt_pk_bf16_f32 v173, v146, v147
  v_cvt_pk_bf16_f32 v174, v148, v149
  v_cvt_pk_bf16_f32 v175, v150, v151
  ds_read_b128 v[188:191], v22 offset:6912
  s_waitcnt lgkmcnt(1)
  v_mfma_f32_16x16x32_bf16 v[136:139], v[96:99], v[40:43], 0
  ds_read_b128 v[106:109], v20 offset:11520
  ds_read_b64 v[104:105], v21 offset:11520
  ds_read_b64 v[110:111], v21 offset:11528
  v_exp_f32 v152, v152
  v_mfma_f32_16x16x32_bf16 v[140:143], v[100:103], v[42:45], 0
  v_exp_f32 v153, v153
  v_exp_f32 v154, v154
  v_exp_f32 v155, v155
  buffer_load_dwordx4 v245, s[36:39], s27 offen offset:1024 sc1 lds
  v_mfma_f32_16x16x32_bf16 v[144:147], v[96:99], v[46:49], 0
  v_exp_f32 v156, v156
  v_exp_f32 v157, v157
  v_exp_f32 v158, v158
  v_exp_f32 v159, v159
  v_mfma_f32_16x16x32_bf16 v[148:151], v[100:103], v[48:51], 0
  buffer_load_dwordx4 v246, s[36:39], s27 offen offset:2048 sc1 lds
  s_add_u32 m0, m0, 3072
  v_cvt_pk_bf16_f32 v176, v152, v153
  v_cvt_pk_bf16_f32 v177, v154, v155
  v_cvt_pk_bf16_f32 v178, v156, v157
  v_mfma_f32_16x16x32_bf16 v[192:195], v[184:187], v[168:171], v[192:195]
  v_cvt_pk_bf16_f32 v179, v158, v159
  v_exp_f32 v160, v160
  v_exp_f32 v161, v161
  v_exp_f32 v162, v162
  v_mfma_f32_16x16x32_bf16 v[200:203], a[8:11], v[168:171], v[200:203]
  v_exp_f32 v163, v163
  buffer_load_dwordx4 v247, s[36:39], s27 offen offset:0 sc1 lds
  v_exp_f32 v164, v164
  v_exp_f32 v165, v165
  v_mfma_f32_16x16x32_bf16 v[196:199], v[184:187], v[172:175], v[196:199]
  v_exp_f32 v166, v166
  v_exp_f32 v167, v167
  buffer_load_dwordx4 v248, s[36:39], s27 offen offset:1024 sc1 lds
  v_cvt_pk_bf16_f32 v180, v160, v161
  v_mfma_f32_16x16x32_bf16 v[204:207], a[8:11], v[172:175], v[204:207]
  v_cvt_pk_bf16_f32 v181, v162, v163
  v_cvt_pk_bf16_f32 v182, v164, v165
  v_cvt_pk_bf16_f32 v183, v166, v167
  ds_read_b128 v[184:187], v22 offset:9216
  s_waitcnt lgkmcnt(1)
  v_mfma_f32_16x16x32_bf16 v[152:155], v[104:107], v[40:43], 0
  ds_read_b128 v[114:117], v20 offset:13824
  ds_read_b64 v[112:113], v21 offset:13824
  ds_read_b64 v[118:119], v21 offset:13832
  v_exp_f32 v136, v136
  v_mfma_f32_16x16x32_bf16 v[156:159], v[108:111], v[42:45], 0
  v_exp_f32 v137, v137
  v_exp_f32 v138, v138
  v_exp_f32 v139, v139
  buffer_load_dwordx4 v249, s[36:39], s27 offen offset:2048 sc1 lds
  s_add_u32 m0, m0, 3072
  v_mfma_f32_16x16x32_bf16 v[160:163], v[104:107], v[46:49], 0
  v_exp_f32 v140, v140
  v_exp_f32 v141, v141
  v_exp_f32 v142, v142
  v_exp_f32 v143, v143
  v_mfma_f32_16x16x32_bf16 v[164:167], v[108:111], v[48:51], 0
  buffer_load_dwordx4 v250, s[36:39], s27 offen offset:0 sc1 lds
  v_cvt_pk_bf16_f32 v168, v136, v137
  v_cvt_pk_bf16_f32 v169, v138, v139
  v_cvt_pk_bf16_f32 v170, v140, v141
  v_mfma_f32_16x16x32_bf16 v[192:195], v[188:191], v[176:179], v[192:195]
  v_cvt_pk_bf16_f32 v171, v142, v143
  v_exp_f32 v144, v144
  v_exp_f32 v145, v145
  v_exp_f32 v146, v146
  v_mfma_f32_16x16x32_bf16 v[200:203], a[12:15], v[176:179], v[200:203]
  v_exp_f32 v147, v147
  buffer_load_dwordx4 v251, s[36:39], s27 offen offset:1024 sc1 lds
  v_exp_f32 v148, v148
  v_exp_f32 v149, v149
  v_mfma_f32_16x16x32_bf16 v[196:199], v[188:191], v[180:183], v[196:199]
  v_exp_f32 v150, v150
  v_exp_f32 v151, v151
  buffer_load_dwordx4 v252, s[36:39], s27 offen offset:2048 sc1 lds
  v_cvt_pk_bf16_f32 v172, v144, v145
  v_mfma_f32_16x16x32_bf16 v[204:207], a[12:15], v[180:183], v[204:207]
  v_cvt_pk_bf16_f32 v173, v146, v147
  v_cvt_pk_bf16_f32 v174, v148, v149
  v_cvt_pk_bf16_f32 v175, v150, v151
  ds_read_b128 v[188:191], v22 offset:11520
  s_waitcnt lgkmcnt(1)
  v_mfma_f32_16x16x32_bf16 v[136:139], v[112:115], v[40:43], 0
  ds_read_b128 v[122:125], v20 offset:16128
  ds_read_b64 v[120:121], v21 offset:16128
  ds_read_b64 v[126:127], v21 offset:16136
  v_exp_f32 v152, v152
  v_mfma_f32_16x16x32_bf16 v[140:143], v[116:119], v[42:45], 0
  v_exp_f32 v153, v153
  v_exp_f32 v154, v154
  v_exp_f32 v155, v155
  s_mul_i32 s58, s79, 2
  s_add_u32 s58, s58, s73
  s_mov_b32 m0, s58
  s_nop 0
  buffer_load_dwordx4 v244, s[36:39], s45 offen offset:0 sc1 lds
  v_mfma_f32_16x16x32_bf16 v[144:147], v[112:115], v[46:49], 0
  v_exp_f32 v156, v156
  v_exp_f32 v157, v157
  v_exp_f32 v158, v158
  v_exp_f32 v159, v159
  v_mfma_f32_16x16x32_bf16 v[148:151], v[116:119], v[48:51], 0
  buffer_load_dwordx4 v245, s[36:39], s45 offen offset:1024 sc1 lds
  v_cvt_pk_bf16_f32 v176, v152, v153
  v_cvt_pk_bf16_f32 v177, v154, v155
  v_mfma_f32_16x16x32_bf16 v[192:195], v[184:187], v[168:171], v[192:195]
  v_cvt_pk_bf16_f32 v178, v156, v157
  v_cvt_pk_bf16_f32 v179, v158, v159
  v_exp_f32 v160, v160
  v_exp_f32 v161, v161
  v_mfma_f32_16x16x32_bf16 v[200:203], a[16:19], v[168:171], v[200:203]
  v_exp_f32 v162, v162
  v_exp_f32 v163, v163
  buffer_load_dwordx4 v246, s[36:39], s45 offen offset:2048 sc1 lds
  s_add_u32 m0, m0, 3072
  v_exp_f32 v164, v164
  v_mfma_f32_16x16x32_bf16 v[196:199], v[184:187], v[172:175], v[196:199]
  v_exp_f32 v165, v165
  v_exp_f32 v166, v166
  v_exp_f32 v167, v167
  v_cvt_pk_bf16_f32 v180, v160, v161
  v_mfma_f32_16x16x32_bf16 v[204:207], a[16:19], v[172:175], v[204:207]
  v_cvt_pk_bf16_f32 v181, v162, v163
  v_cvt_pk_bf16_f32 v182, v164, v165
  v_cvt_pk_bf16_f32 v183, v166, v167
  ds_read_b128 v[184:187], v22 offset:13824
  s_waitcnt lgkmcnt(1)
  v_mfma_f32_16x16x32_bf16 v[152:155], v[120:123], v[40:43], 0
  ds_read_b128 v[130:133], v20 offset:18432
  ds_read_b64 v[128:129], v21 offset:18432
  ds_read_b64 v[134:135], v21 offset:18440
  v_exp_f32 v136, v136
  v_mfma_f32_16x16x32_bf16 v[156:159], v[124:127], v[42:45], 0
  v_exp_f32 v137, v137
  v_exp_f32 v138, v138
  v_exp_f32 v139, v139
  buffer_load_dwordx4 v247, s[36:39], s45 offen offset:0 sc1 lds
  v_mfma_f32_16x16x32_bf16 v[160:163], v[120:123], v[46:49], 0
  v_exp_f32 v140, v140
  v_exp_f32 v141, v141
  v_exp_f32 v142, v142
  v_exp_f32 v143, v143
  v_mfma_f32_16x16x32_bf16 v[164:167], v[124:127], v[48:51], 0
  buffer_load_dwordx4 v248, s[36:39], s45 offen offset:1024 sc1 lds
  v_cvt_pk_bf16_f32 v168, v136, v137
  v_cvt_pk_bf16_f32 v169, v138, v139
  v_mfma_f32_16x16x32_bf16 v[192:195], v[188:191], v[176:179], v[192:195]
  v_cvt_pk_bf16_f32 v170, v140, v141
  v_cvt_pk_bf16_f32 v171, v142, v143
  v_exp_f32 v144, v144
  v_exp_f32 v145, v145
  v_mfma_f32_16x16x32_bf16 v[200:203], a[20:23], v[176:179], v[200:203]
  v_exp_f32 v146, v146
  v_exp_f32 v147, v147
  buffer_load_dwordx4 v249, s[36:39], s45 offen offset:2048 sc1 lds
  s_add_u32 m0, m0, 3072
  v_exp_f32 v148, v148
  v_mfma_f32_16x16x32_bf16 v[196:199], v[188:191], v[180:183], v[196:199]
  v_exp_f32 v149, v149
  v_exp_f32 v150, v150
  v_exp_f32 v151, v151
  v_cvt_pk_bf16_f32 v172, v144, v145
  v_mfma_f32_16x16x32_bf16 v[204:207], a[20:23], v[180:183], v[204:207]
  v_cvt_pk_bf16_f32 v173, v146, v147
  v_cvt_pk_bf16_f32 v174, v148, v149
  v_cvt_pk_bf16_f32 v175, v150, v151
  ds_read_b128 v[188:191], v22 offset:16128
  s_waitcnt lgkmcnt(1)
  v_mfma_f32_16x16x32_bf16 v[136:139], v[128:131], v[40:43], v[12:15]
  v_exp_f32 v152, v152
  v_exp_f32 v153, v153
  v_exp_f32 v154, v154
  v_exp_f32 v155, v155
  v_mfma_f32_16x16x32_bf16 v[144:147], v[128:131], v[46:49], 0
  buffer_load_dwordx4 v250, s[36:39], s45 offen offset:0 sc1 lds
  v_exp_f32 v156, v156
  v_exp_f32 v157, v157
  v_exp_f32 v158, v158
  v_mfma_f32_16x16x32_bf16 v[148:151], v[132:135], v[48:51], v[12:15]
  v_exp_f32 v159, v159
  buffer_load_dwordx4 v251, s[36:39], s45 offen offset:1024 sc1 lds
  v_cvt_pk_bf16_f32 v176, v152, v153
  v_cvt_pk_bf16_f32 v177, v154, v155
  v_mfma_f32_16x16x32_bf16 v[192:195], v[184:187], v[168:171], v[192:195]
  v_cvt_pk_bf16_f32 v178, v156, v157
  v_cvt_pk_bf16_f32 v179, v158, v159
  v_exp_f32 v160, v160
  v_exp_f32 v161, v161
  v_mfma_f32_16x16x32_bf16 v[200:203], a[24:27], v[168:171], v[200:203]
  v_exp_f32 v162, v162
  v_exp_f32 v163, v163
  buffer_load_dwordx4 v252, s[36:39], s45 offen offset:2048 sc1 lds
  v_exp_f32 v164, v164
  v_mfma_f32_16x16x32_bf16 v[196:199], v[184:187], v[172:175], v[196:199]
  v_exp_f32 v165, v165
  v_exp_f32 v166, v166
  v_exp_f32 v167, v167
  v_cvt_pk_bf16_f32 v180, v160, v161
  v_mfma_f32_16x16x32_bf16 v[204:207], a[24:27], v[172:175], v[204:207]
  v_cvt_pk_bf16_f32 v181, v162, v163
  v_cvt_pk_bf16_f32 v182, v164, v165
  v_cvt_pk_bf16_f32 v183, v166, v167
  ds_read_b128 v[184:187], v22 offset:18432
  s_waitcnt lgkmcnt(1)
  v_mfma_f32_16x16x32_bf16 v[192:195], v[188:191], v[176:179], v[192:195]
  v_exp_f32 v136, v136
  v_exp_f32 v137, v137
  v_exp_f32 v138, v138
  v_exp_f32 v139, v139
  buffer_load_dwordx4 v[232:235], v7, s[32:35], s77 offen offset:0
  buffer_load_dwordx4 v[236:239], v7, s[32:35], s77 offen offset:64
  v_mfma_f32_16x16x32_bf16 v[200:203], a[28:31], v[176:179], v[200:203]
  v_cvt_pk_bf16_f32 v168, v136, v137
  v_cvt_pk_bf16_f32 v169, v138, v139
  v_mov_b32 v170, 0
  v_mov_b32 v171, 0
  v_exp_f32 v144, v144
  v_exp_f32 v145, v145
  v_mfma_f32_16x16x32_bf16 v[196:199], v[188:191], v[180:183], v[196:199]
  v_exp_f32 v146, v146
  v_exp_f32 v147, v147
  buffer_load_dwordx4 v[240:243], v7, s[32:35], s77 offen offset:128
  v_exp_f32 v148, v148
  v_exp_f32 v149, v149
  v_exp_f32 v150, v150
  v_mfma_f32_16x16x32_bf16 v[204:207], a[28:31], v[180:183], v[204:207]
  v_exp_f32 v151, v151
  v_cvt_pk_bf16_f32 v172, v144, v145
  v_cvt_pk_bf16_f32 v173, v146, v147
  v_cvt_pk_bf16_f32 v174, v148, v149
  v_cvt_pk_bf16_f32 v175, v150, v151
  s_waitcnt lgkmcnt(0)
  v_mfma_f32_16x16x32_bf16 v[192:195], v[184:187], v[168:171], v[192:195]
  v_mfma_f32_16x16x32_bf16 v[200:203], a[32:35], v[168:171], v[200:203]
  v_mfma_f32_16x16x32_bf16 v[196:199], v[184:187], v[172:175], v[196:199]
  v_mfma_f32_16x16x32_bf16 v[204:207], a[32:35], v[172:175], v[204:207]
  s_nop 5
  v_rcp_f32 v30, v203
  s_nop 0
  v_rcp_f32 v31, v207
  v_mul_f32 v192, v192, v30
  v_mul_f32 v193, v193, v30
  v_mul_f32 v194, v194, v30
  v_mul_f32 v195, v195, v30
  v_mul_f32 v200, v200, v30
  v_mul_f32 v201, v201, v30
  v_mul_f32 v196, v196, v31
  v_mul_f32 v197, v197, v31
  v_mul_f32 v198, v198, v31
  v_mul_f32 v199, v199, v31
  v_mul_f32 v204, v204, v31
  v_mul_f32 v205, v205, v31
  v_cvt_pk_bf16_f32 v208, v192, v193
  v_cvt_pk_bf16_f32 v209, v194, v195
  v_cvt_pk_bf16_f32 v32, v200, v201
  v_cvt_pk_bf16_f32 v212, v196, v197
  v_cvt_pk_bf16_f32 v213, v198, v199
  v_cvt_pk_bf16_f32 v34, v204, v205
  s_cmp_lg_u32 s40, 0
  s_cbranch_scc1 Lmk_29_x
  s_mov_b32 s47, 100000
  s_waitcnt vmcnt(28)
Lmk_29:
  v_cmp_ne_u32 vcc, s43, v224
  s_cbranch_vccz Lmk_29_x
  s_sleep 2
  s_mov_b32 s46, 520192
  buffer_load_dword v224, v225, s[28:31], s46 offen sc1
  s_waitcnt vmcnt(0)
  s_sub_u32 s47, s47, 1
  s_cbranch_scc0 Lmk_29
Lmk_29_x:
  s_waitcnt vmcnt(20)
  s_barrier
  s_cmp_lg_u32 s40, 0
  s_cbranch_scc1 Lmp_30
  s_lshl_b32 s46, s2, 2
  s_add_u32 s46, s46, 521216
  v_mov_b32 v224, s43
  v_mov_b32 v225, 0
  s_mov_b64 exec, 1
  buffer_store_dword v224, v225, s[28:31], s46 offen sc1
  s_mov_b64 exec, -1
Lmp_30:
  ds_read_b128 v[66:69], v20 offset:1024
  ds_read_b128 v[74:77], v20 offset:3328
  s_waitcnt lgkmcnt(1)
  v_mfma_f32_16x16x32_bf16 v[136:139], v[64:67], v[52:55], v[8:11]
  v_mfma_f32_16x16x32_bf16 v[140:143], v[68:71], v[54:57], 0
  v_mfma_f32_16x16x32_bf16 v[148:151], v[68:71], v[60:63], v[8:11]
  s_waitcnt lgkmcnt(0)
  v_mfma_f32_16x16x32_bf16 v[152:155], v[72:75], v[52:55], 0
  ds_read_b128 v[82:85], v20 offset:5632
  s_nop 2
  v_exp_f32 v136, v136
  v_exp_f32 v137, v137
  v_exp_f32 v138, v138
  v_exp_f32 v139, v139
  s_add_u32 s59, s71, 0
  buffer_load_dwordx4 a[40:43], v4, s[28:31], s59 offen offset:0 sc1
  v_mfma_f32_16x16x32_bf16 v[156:159], v[76:79], v[54:57], 0
  v_exp_f32 v140, v140
  v_exp_f32 v141, v141
  v_exp_f32 v142, v142
  v_exp_f32 v143, v143
  buffer_load_dwordx4 a[44:47], v4, s[28:31], s59 offen offset:1024 sc1
  v_cvt_pk_bf16_f32 v168, v136, v137
  v_mfma_f32_16x16x32_bf16 v[160:163], v[72:75], v[58:61], 0
  v_cvt_pk_bf16_f32 v169, v138, v139
  v_cvt_pk_bf16_f32 v170, v140, v141
  v_cvt_pk_bf16_f32 v171, v142, v143
  buffer_load_dwordx4 a[48:51], v4, s[28:31], s59 offen offset:2048 sc1
  v_exp_f32 v148, v148
  v_exp_f32 v149, v149
  v_mfma_f32_16x16x32_bf16 v[164:167], v[76:79], v[60:63], 0
  v_exp_f32 v150, v150
  v_exp_f32 v151, v151
  v_mov_b32 v172, 0
  v_mov_b32 v173, 0
  v_cvt_pk_bf16_f32 v174, v148, v149
  v_cvt_pk_bf16_f32 v175, v150, v151
  s_mov_b32 exec_lo, 0x00030003
  s_mov_b32 exec_hi, 0x00030003
  ds_read_b128 a[0:3], v23 offset:128
  ds_read_b128 a[4:7], v23 offset:2432
  ds_read_b128 a[8:11], v23 offset:4736
  ds_read_b128 a[12:15], v23 offset:7040
  ds_read_b128 a[16:19], v23 offset:9344
  ds_read_b128 a[20:23], v23 offset:11648
  ds_read_b128 a[24:27], v23 offset:13952
  ds_read_b128 a[28:31], v23 offset:16256
  ds_read_b128 a[32:35], v23 offset:18560
  s_mov_b64 exec, -1
  ds_read_b128 v[184:187], v22 offset:1024
  ds_read_b128 v[188:191], v22 offset:3328
  s_waitcnt lgkmcnt(11)
  v_mfma_f32_16x16x32_bf16 v[136:139], v[80:83], v[52:55], 0
  ds_read_b128 v[90:93], v20 offset:7936
  v_exp_f32 v152, v152
  v_exp_f32 v153, v153
  v_exp_f32 v154, v154
  v_mfma_f32_16x16x32_bf16 v[140:143], v[84:87], v[54:57], 0
  v_exp_f32 v155, v155
  buffer_load_dwordx4 a[52:55], v4, s[28:31], s59 offen offset:3072 sc1
  v_exp_f32 v156, v156
  v_mfma_f32_16x16x32_bf16 v[144:147], v[80:83], v[58:61], 0
  v_exp_f32 v157, v157
  v_exp_f32 v158, v158
  v_exp_f32 v159, v159
  s_add_u32 s59, s71, 4096
  buffer_load_dwordx4 a[56:59], v4, s[28:31], s59 offen offset:0 sc1
  v_mfma_f32_16x16x32_bf16 v[148:151], v[84:87], v[60:63], 0
  v_cvt_pk_bf16_f32 v176, v152, v153
  v_cvt_pk_bf16_f32 v177, v154, v155
  v_cvt_pk_bf16_f32 v178, v156, v157
  s_waitcnt lgkmcnt(2)
  v_mfma_f32_16x16x32_bf16 v[192:195], v[184:187], v[168:171], 0
  v_cvt_pk_bf16_f32 v179, v158, v159
  v_exp_f32 v160, v160
  v_exp_f32 v161, v161
  v_exp_f32 v162, v162
  v_mfma_f32_16x16x32_bf16 v[200:203], a[0:3], v[168:171], 0
  v_exp_f32 v163, v163
  buffer_load_dwordx4 a[60:63], v4, s[28:31], s59 offen offset:1024 sc1
  v_exp_f32 v164, v164
  v_mfma_f32_16x16x32_bf16 v[196:199], v[184:187], v[172:175], 0
  v_exp_f32 v165, v165
  v_exp_f32 v166, v166
  v_exp_f32 v167, v167
  v_cvt_pk_bf16_f32 v180, v160, v161
  v_mfma_f32_16x16x32_bf16 v[204:207], a[0:3], v[172:175], 0
  v_cvt_pk_bf16_f32 v181, v162, v163
  v_cvt_pk_bf16_f32 v182, v164, v165
  v_cvt_pk_bf16_f32 v183, v166, v167
  ds_read_b128 v[184:187], v22 offset:5632
  s_waitcnt lgkmcnt(1)
  v_mfma_f32_16x16x32_bf16 v[152:155], v[88:91], v[52:55], 0
  ds_read_b128 v[98:101], v20 offset:10240
  v_exp_f32 v136, v136
  v_exp_f32 v137, v137
  v_exp_f32 v138, v138
  v_mfma_f32_16x16x32_bf16 v[156:159], v[92:95], v[54:57], 0
  v_exp_f32 v139, v139
  buffer_load_dwordx4 a[64:67], v4, s[28:31], s59 offen offset:2048 sc1
  v_exp_f32 v140, v140
  v_mfma_f32_16x16x32_bf16 v[160:163], v[88:91], v[58:61], 0
  v_exp_f32 v141, v141
  v_exp_f32 v142, v142
  v_exp_f32 v143, v143
  buffer_load_dwordx4 a[68:71], v4, s[28:31], s59 offen offset:3072 sc1
  v_mfma_f32_16x16x32_bf16 v[164:167], v[92:95], v[60:63], 0
  v_cvt_pk_bf16_f32 v168, v136, v137
  v_cvt_pk_bf16_f32 v169, v138, v139
  v_cvt_pk_bf16_f32 v170, v140, v141
  v_mfma_f32_16x16x32_bf16 v[192:195], v[188:191], v[176:179], v[192:195]
  v_cvt_pk_bf16_f32 v171, v142, v143
  v_exp_f32 v144, v144
  v_exp_f32 v145, v145
  v_exp_f32 v146, v146
  v_mfma_f32_16x16x32_bf16 v[200:203], a[4:7], v[176:179], v[200:203]
  v_exp_f32 v147, v147
  s_add_u32 s59, s71, 8192
  buffer_load_dwordx4 a[72:75], v4, s[28:31], s59 offen offset:0 sc1
  v_exp_f32 v148, v148
  v_mfma_f32_16x16x32_bf16 v[196:199], v[188:191], v[180:183], v[196:199]
  v_exp_f32 v149, v149
  v_exp_f32 v150, v150
  v_exp_f32 v151, v151
  v_cvt_pk_bf16_f32 v172, v144, v145
  v_mfma_f32_16x16x32_bf16 v[204:207], a[4:7], v[180:183], v[204:207]
  v_cvt_pk_bf16_f32 v173, v146, v147
  v_cvt_pk_bf16_f32 v174, v148, v149
  v_cvt_pk_bf16_f32 v175, v150, v151
  ds_read_b128 v[188:191], v22 offset:7936
  s_waitcnt lgkmcnt(1)
  v_mfma_f32_16x16x32_bf16 v[136:139], v[96:99], v[52:55], 0
  ds_read_b128 v[106:109], v20 offset:12544
  v_exp_f32 v152, v152
  v_exp_f32 v153, v153
  v_exp_f32 v154, v154
  v_mfma_f32_16x16x32_bf16 v[140:143], v[100:103], v[54:57], 0
  v_exp_f32 v155, v155
  buffer_load_dwordx4 a[76:79], v4, s[28:31], s59 offen offset:1024 sc1
  v_exp_f32 v156, v156
  v_mfma_f32_16x16x32_bf16 v[144:147], v[96:99], v[58:61], 0
  v_exp_f32 v157, v157
  v_exp_f32 v158, v158
  v_exp_f32 v159, v159
  buffer_load_dwordx4 a[80:83], v4, s[28:31], s59 offen offset:2048 sc1
  v_mfma_f32_16x16x32_bf16 v[148:151], v[100:103], v[60:63], 0
  v_cvt_pk_bf16_f32 v176, v152, v153
  v_cvt_pk_bf16_f32 v177, v154, v155
  v_cvt_pk_bf16_f32 v178, v156, v157
  v_mfma_f32_16x16x32_bf16 v[192:195], v[184:187], v[168:171], v[192:195]
  v_cvt_pk_bf16_f32 v179, v158, v159
  v_exp_f32 v160, v160
  v_exp_f32 v161, v161
  v_exp_f32 v162, v162
  v_mfma_f32_16x16x32_bf16 v[200:203], a[8:11], v[168:171], v[200:203]
  v_exp_f32 v163, v163
  buffer_load_dwordx4 a[84:87], v4, s[28:31], s59 offen offset:3072 sc1
  v_exp_f32 v164, v164
  v_mfma_f32_16x16x32_bf16 v[196:199], v[184:187], v[172:175], v[196:199]
  v_exp_f32 v165, v165
  v_exp_f32 v166, v166
  v_exp_f32 v167, v167
  v_cvt_pk_bf16_f32 v180, v160, v161
  v_mfma_f32_16x16x32_bf16 v[204:207], a[8:11], v[172:175], v[204:207]
  v_cvt_pk_bf16_f32 v181, v162, v163
  v_cvt_pk_bf16_f32 v182, v164, v165
  v_cvt_pk_bf16_f32 v183, v166, v167
  ds_read_b128 v[184:187], v22 offset:10240
  s_waitcnt lgkmcnt(1)
  v_mfma_f32_16x16x32_bf16 v[152:155], v[104:107], v[52:55], 0
  ds_read_b128 v[114:117], v20 offset:14848
  v_exp_f32 v136, v136
  v_exp_f32 v137, v137
  v_exp_f32 v138, v138
  v_mfma_f32_16x16x32_bf16 v[156:159], v[108:111], v[54:57], 0
  v_exp_f32 v139, v139
  s_add_u32 s59, s71, 12288
  buffer_load_dwordx4 a[88:91], v4, s[28:31], s59 offen offset:0 sc1
  v_exp_f32 v140, v140
  v_mfma_f32_16x16x32_bf16 v[160:163], v[104:107], v[58:61], 0
  v_exp_f32 v141, v141
  v_exp_f32 v142, v142
  v_exp_f32 v143, v143
  buffer_load_dwordx4 a[92:95], v4, s[28:31], s59 offen offset:1024 sc1
  v_mfma_f32_16x16x32_bf16 v[164:167], v[108:111], v[60:63], 0
  v_cvt_pk_bf16_f32 v168, v136, v137
  v_cvt_pk_bf16_f32 v169, v138, v139
  v_cvt_pk_bf16_f32 v170, v140, v141
  v_mfma_f32_16x16x32_bf16 v[192:195], v[188:191], v[176:179], v[192:195]
  v_cvt_pk_bf16_f32 v171, v142, v143
  v_exp_f32 v144, v144
  v_exp_f32 v145, v145
  v_exp_f32 v146, v146
  v_mfma_f32_16x16x32_bf16 v[200:203], a[12:15], v[176:179], v[200:203]
  v_exp_f32 v147, v147
  buffer_load_dwordx4 a[96:99], v4, s[28:31], s59 offen offset:2048 sc1
  v_exp_f32 v148, v148
  v_mfma_f32_16x16x32_bf16 v[196:199], v[188:191], v[180:183], v[196:199]
  v_exp_f32 v149, v149
  v_exp_f32 v150, v150
  v_exp_f32 v151, v151
  v_cvt_pk_bf16_f32 v172, v144, v145
  v_mfma_f32_16x16x32_bf16 v[204:207], a[12:15], v[180:183], v[204:207]
  v_cvt_pk_bf16_f32 v173, v146, v147
  v_cvt_pk_bf16_f32 v174, v148, v149
  v_cvt_pk_bf16_f32 v175, v150, v151
  ds_read_b128 v[188:191], v22 offset:12544
  s_waitcnt lgkmcnt(1)
  v_mfma_f32_16x16x32_bf16 v[136:139], v[112:115], v[52:55], 0
  ds_read_b128 v[122:125], v20 offset:17152
  v_exp_f32 v152, v152
  v_exp_f32 v153, v153
  v_exp_f32 v154, v154
  v_mfma_f32_16x16x32_bf16 v[140:143], v[116:119], v[54:57], 0
  v_exp_f32 v155, v155
  buffer_load_dwordx4 a[100:103], v4, s[28:31], s59 offen offset:3072 sc1
  v_exp_f32 v156, v156
  v_mfma_f32_16x16x32_bf16 v[144:147], v[112:115], v[58:61], 0
  v_exp_f32 v157, v157
  v_exp_f32 v158, v158
  v_exp_f32 v159, v159
  s_add_u32 s59, s71, 16384
  buffer_load_dwordx4 a[104:107], v4, s[28:31], s59 offen offset:0 sc1
  v_mfma_f32_16x16x32_bf16 v[148:151], v[116:119], v[60:63], 0
  v_cvt_pk_bf16_f32 v176, v152, v153
  v_cvt_pk_bf16_f32 v177, v154, v155
  v_cvt_pk_bf16_f32 v178, v156, v157
  v_mfma_f32_16x16x32_bf16 v[192:195], v[184:187], v[168:171], v[192:195]
  v_cvt_pk_bf16_f32 v179, v158, v159
  v_exp_f32 v160, v160
  v_exp_f32 v161, v161
  v_exp_f32 v162, v162
  v_mfma_f32_16x16x32_bf16 v[200:203], a[16:19], v[168:171], v[200:203]
  v_exp_f32 v163, v163
  buffer_load_dwordx4 a[108:111], v4, s[28:31], s59 offen offset:1024 sc1
  v_exp_f32 v164, v164
  v_mfma_f32_16x16x32_bf16 v[196:199], v[184:187], v[172:175], v[196:199]
  v_exp_f32 v165, v165
  v_exp_f32 v166, v166
  v_exp_f32 v167, v167
  v_cvt_pk_bf16_f32 v180, v160, v161
  v_mfma_f32_16x16x32_bf16 v[204:207], a[16:19], v[172:175], v[204:207]
  v_cvt_pk_bf16_f32 v181, v162, v163
  v_cvt_pk_bf16_f32 v182, v164, v165
  v_cvt_pk_bf16_f32 v183, v166, v167
  ds_read_b128 v[184:187], v22 offset:14848
  s_waitcnt lgkmcnt(1)
  v_mfma_f32_16x16x32_bf16 v[152:155], v[120:123], v[52:55], 0
  ds_read_b128 v[130:133], v20 offset:19456
  v_exp_f32 v136, v136
  v_exp_f32 v137, v137
  v_exp_f32 v138, v138
  v_mfma_f32_16x16x32_bf16 v[156:159], v[124:127], v[54:57], 0
  v_exp_f32 v139, v139
  buffer_load_dwordx4 a[112:115], v4, s[28:31], s59 offen offset:2048 sc1
  v_exp_f32 v140, v140
  v_mfma_f32_16x16x32_bf16 v[160:163], v[120:123], v[58:61], 0
  v_exp_f32 v141, v141
  v_exp_f32 v142, v142
  v_exp_f32 v143, v143
  buffer_load_dwordx4 a[116:119], v4, s[28:31], s59 offen offset:3072 sc1
  v_mfma_f32_16x16x32_bf16 v[164:167], v[124:127], v[60:63], 0
  v_cvt_pk_bf16_f32 v168, v136, v137
  v_cvt_pk_bf16_f32 v169, v138, v139
  v_cvt_pk_bf16_f32 v170, v140, v141
  v_mfma_f32_16x16x32_bf16 v[192:195], v[188:191], v[176:179], v[192:195]
  v_cvt_pk_bf16_f32 v171, v142, v143
  v_exp_f32 v144, v144
  v_exp_f32 v145, v145
  v_exp_f32 v146, v146
  v_mfma_f32_16x16x32_bf16 v[200:203], a[20:23], v[176:179], v[200:203]
  v_exp_f32 v147, v147
  s_add_u32 s59, s71, 20480
  buffer_load_dwordx4 a[120:123], v4, s[28:31], s59 offen offset:0 sc1
  v_exp_f32 v148, v148
  v_mfma_f32_16x16x32_bf16 v[196:199], v[188:191], v[180:183], v[196:199]
  v_exp_f32 v149, v149
  v_exp_f32 v150, v150
  v_exp_f32 v151, v151
  v_cvt_pk_bf16_f32 v172, v144, v145
  v_mfma_f32_16x16x32_bf16 v[204:207], a[20:23], v[180:183], v[204:207]
  v_cvt_pk_bf16_f32 v173, v146, v147
  v_cvt_pk_bf16_f32 v174, v148, v149
  v_cvt_pk_bf16_f32 v175, v150, v151
  ds_read_b128 v[188:191], v22 offset:17152
  s_waitcnt lgkmcnt(1)
  v_mfma_f32_16x16x32_bf16 v[136:139], v[128:131], v[52:55], v[12:15]
  v_exp_f32 v152, v152
  v_exp_f32 v153, v153
  v_exp_f32 v154, v154
  v_exp_f32 v155, v155
  v_mfma_f32_16x16x32_bf16 v[144:147], v[128:131], v[58:61], 0
  buffer_load_dwordx4 a[124:127], v4, s[28:31], s59 offen offset:1024 sc1
  v_exp_f32 v156, v156
  v_exp_f32 v157, v157
  v_exp_f32 v158, v158
  v_mfma_f32_16x16x32_bf16 v[148:151], v[132:135], v[60:63], v[12:15]
  v_exp_f32 v159, v159
  buffer_load_dwordx4 a[128:131], v4, s[28:31], s59 offen offset:2048 sc1
  v_cvt_pk_bf16_f32 v176, v152, v153
  v_cvt_pk_bf16_f32 v177, v154, v155
  v_mfma_f32_16x16x32_bf16 v[192:195], v[184:187], v[168:171], v[192:195]
  v_cvt_pk_bf16_f32 v178, v156, v157
  v_cvt_pk_bf16_f32 v179, v158, v159
  v_exp_f32 v160, v160
  v_exp_f32 v161, v161
  v_mfma_f32_16x16x32_bf16 v[200:203], a[24:27], v[168:171], v[200:203]
  v_exp_f32 v162, v162
  v_exp_f32 v163, v163
  buffer_load_dwordx4 a[132:135], v4, s[28:31], s59 offen offset:3072 sc1
  v_exp_f32 v164, v164
  v_mfma_f32_16x16x32_bf16 v[196:199], v[184:187], v[172:175], v[196:199]
  v_exp_f32 v165, v165
  v_exp_f32 v166, v166
  v_exp_f32 v167, v167
  v_cvt_pk_bf16_f32 v180, v160, v161
  v_mfma_f32_16x16x32_bf16 v[204:207], a[24:27], v[172:175], v[204:207]
  v_cvt_pk_bf16_f32 v181, v162, v163
  v_cvt_pk_bf16_f32 v182, v164, v165
  v_cvt_pk_bf16_f32 v183, v166, v167
  ds_read_b128 v[184:187], v22 offset:19456
  s_waitcnt lgkmcnt(1)
  v_mfma_f32_16x16x32_bf16 v[192:195], v[188:191], v[176:179], v[192:195]
  v_exp_f32 v136, v136
  v_exp_f32 v137, v137
  v_exp_f32 v138, v138
  v_exp_f32 v139, v139
  s_add_u32 s59, s71, 24576
  buffer_load_dwordx4 a[136:139], v4, s[28:31], s59 offen offset:0 sc1
  buffer_load_dwordx4 a[140:143], v4, s[28:31], s59 offen offset:1024 sc1
  v_mfma_f32_16x16x32_bf16 v[200:203], a[28:31], v[176:179], v[200:203]
  v_cvt_pk_bf16_f32 v168, v136, v137
  v_cvt_pk_bf16_f32 v169, v138, v139
  v_mov_b32 v170, 0
  v_mov_b32 v171, 0
  v_exp_f32 v144, v144
  v_exp_f32 v145, v145
  v_mfma_f32_16x16x32_bf16 v[196:199], v[188:191], v[180:183], v[196:199]
  v_exp_f32 v146, v146
  v_exp_f32 v147, v147
  buffer_load_dwordx4 a[144:147], v4, s[28:31], s59 offen offset:2048 sc1
  v_exp_f32 v148, v148
  v_exp_f32 v149, v149
  v_exp_f32 v150, v150
  v_mfma_f32_16x16x32_bf16 v[204:207], a[28:31], v[180:183], v[204:207]
  v_exp_f32 v151, v151
  v_cvt_pk_bf16_f32 v172, v144, v145
  v_cvt_pk_bf16_f32 v173, v146, v147
  v_cvt_pk_bf16_f32 v174, v148, v149
  v_cvt_pk_bf16_f32 v175, v150, v151
  s_waitcnt lgkmcnt(0)
  v_mfma_f32_16x16x32_bf16 v[192:195], v[184:187], v[168:171], v[192:195]
  v_mfma_f32_16x16x32_bf16 v[200:203], a[32:35], v[168:171], v[200:203]
  v_mfma_f32_16x16x32_bf16 v[196:199], v[184:187], v[172:175], v[196:199]
  v_mfma_f32_16x16x32_bf16 v[204:207], a[32:35], v[172:175], v[204:207]
  s_mul_i32 s54, s53, 18432
  s_add_u32 s54, s54, 7667712
  s_lshl_b32 s46, s51, 10
  s_add_u32 s58, s46, s54
  s_add_u32 s59, s58, 18432
  s_lshr_b32 s46, s51, 3
  s_add_u32 s46, s46, 16
  s_lshl_b32 s46, s46, 10
  s_add_u32 s54, s54, s46
  s_and_b32 s46, s51, 7
  s_lshr_b32 s46, s46, 1
  s_lshl_b32 s46, s46, 8
  s_add_u32 s54, s54, s46
  s_and_b32 s46, s51, 1
  s_lshl_b32 s46, s46, 3
  s_add_u32 s54, s54, s46
  s_add_u32 s47, s54, 18432
  v_rcp_f32 v30, v203
  v_rcp_f32 v31, v207
  v_mul_f32 v192, v192, v30
  v_mul_f32 v193, v193, v30
  v_mul_f32 v194, v194, v30
  v_mul_f32 v195, v195, v30
  v_mul_f32 v200, v200, v30
  v_mul_f32 v201, v201, v30
  v_mul_f32 v196, v196, v31
  v_mul_f32 v197, v197, v31
  v_mul_f32 v198, v198, v31
  v_mul_f32 v199, v199, v31
  v_mul_f32 v204, v204, v31
  v_mul_f32 v205, v205, v31
  v_cvt_pk_bf16_f32 v210, v192, v193
  v_cvt_pk_bf16_f32 v211, v194, v195
  v_cvt_pk_bf16_f32 v33, v200, v201
  v_cvt_pk_bf16_f32 v214, v196, v197
  v_cvt_pk_bf16_f32 v215, v198, v199
  v_cvt_pk_bf16_f32 v35, v204, v205
  s_branch L_p2_out
L_p2_edge:
  ds_read_b128 v[66:69], v20 offset:0
  ds_read_b64 v[64:65], v21 offset:0
  ds_read_b64 v[70:71], v21 offset:8
  ds_read_b128 v[74:77], v20 offset:2304
  ds_read_b64 v[72:73], v21 offset:2304
  ds_read_b64 v[78:79], v21 offset:2312
  v_mov_b32 v216, v25
  v_mov_b32 v217, v25
  v_mov_b32 v218, v25
  v_mov_b32 v219, v25
  s_waitcnt lgkmcnt(3)
  s_nop 0
  v_mfma_f32_16x16x32_bf16 v[136:139], v[64:67], v[40:43], v[216:219]
  v_mfma_f32_16x16x32_bf16 v[140:143], v[68:71], v[42:45], v[216:219]
  v_mfma_f32_16x16x32_bf16 v[148:151], v[68:71], v[48:51], v[216:219]
  s_cmp_eq_u32 s55, 2
  s_cbranch_scc0 Lsw_31
  s_nop 0
  v_mov_b32 v216, 0
  v_mov_b32 v217, 0
  v_mov_b32 v218, 0
  v_mov_b32 v219, 0
Lsw_31:
  s_waitcnt lgkmcnt(0)
  s_nop 0
  v_mfma_f32_16x16x32_bf16 v[152:155], v[72:75], v[40:43], v[216:219]
  ds_read_b128 v[82:85], v20 offset:4608
  ds_read_b64 v[80:81], v21 offset:4608
  ds_read_b64 v[86:87], v21 offset:4616
  v_cndmask_b32 v136, v25, v136, s[60:61]
  v_cndmask_b32 v137, v25, v137, s[62:63]
  v_cndmask_b32 v138, v25, v138, s[64:65]
  v_cndmask_b32 v139, v25, v139, s[66:67]
  v_exp_f32 v136, v136
  v_mfma_f32_16x16x32_bf16 v[156:159], v[76:79], v[42:45], v[216:219]
  v_exp_f32 v137, v137
  v_exp_f32 v138, v138
  v_exp_f32 v139, v139
  v_exp_f32 v140, v140
  v_exp_f32 v141, v141
  v_exp_f32 v142, v142
  v_exp_f32 v143, v143
  v_cvt_pk_bf16_f32 v168, v136, v137
  v_mfma_f32_16x16x32_bf16 v[160:163], v[72:75], v[46:49], v[216:219]
  v_cvt_pk_bf16_f32 v169, v138, v139
  v_cvt_pk_bf16_f32 v170, v140, v141
  v_cvt_pk_bf16_f32 v171, v142, v143
  v_cndmask_b32 v148, v25, v148, s[60:61]
  v_cndmask_b32 v149, v25, v149, s[62:63]
  v_cndmask_b32 v150, v25, v150, s[64:65]
  v_cndmask_b32 v151, v25, v151, s[66:67]
  v_exp_f32 v148, v148
  v_mfma_f32_16x16x32_bf16 v[164:167], v[76:79], v[48:51], v[216:219]
  v_exp_f32 v149, v149
  v_exp_f32 v150, v150
  v_exp_f32 v151, v151
  v_mov_b32 v172, 0
  v_mov_b32 v173, 0
  v_cvt_pk_bf16_f32 v174, v148, v149
  v_cvt_pk_bf16_f32 v175, v150, v151
  s_waitcnt vmcnt(0)
  s_barrier
  buffer_store_dwordx4 v[228:231], v4, s[28:31], s56 offen offset:0 sc1
  buffer_store_dwordx4 v[228:231], v4, s[28:31], s56 offen offset:1024 sc1
  buffer_store_dwordx4 v[228:231], v4, s[28:31], s56 offen offset:2048 sc1
  buffer_store_dwordx4 v[228:231], v4, s[28:31], s56 offen offset:3072 sc1
  s_add_u32 s56, s56, 4096
  buffer_store_dwordx4 v[228:231], v4, s[28:31], s56 offen offset:0 sc1
  s_mov_b32 s46, 520192
  buffer_load_dword v224, v225, s[28:31], s46 offen sc1
  s_mov_b32 exec_lo, 0x00030003
  s_mov_b32 exec_hi, 0x00030003
  ds_read_b128 a[0:3], v23 offset:0
  ds_read_b128 a[4:7], v23 offset:2304
  ds_read_b128 a[8:11], v23 offset:4608
  ds_read_b128 a[12:15], v23 offset:6912
  ds_read_b128 a[16:19], v23 offset:9216
  ds_read_b128 a[20:23], v23 offset:11520
  ds_read_b128 a[24:27], v23 offset:13824
  ds_read_b128 a[28:31], v23 offset:16128
  ds_read_b128 a[32:35], v23 offset:18432
  s_mov_b64 exec, -1
  ds_read_b128 v[184:187], v22 offset:0
  ds_read_b128 v[188:191], v22 offset:2304
  s_cmp_eq_u32 s55, 4
  s_cbranch_scc0 Lsw_32
  v_mov_b32 v216, 0
  v_mov_b32 v217, 0
  v_mov_b32 v218, 0
  v_mov_b32 v219, 0
Lsw_32:
  s_waitcnt lgkmcnt(11)
  s_nop 0
  v_mfma_f32_16x16x32_bf16 v[136:139], v[80:83], v[40:43], v[216:219]
  ds_read_b128 v[90:93], v20 offset:6912
  ds_read_b64 v[88:89], v21 offset:6912
  ds_read_b64 v[94:95], v21 offset:6920
  v_exp_f32 v152, v152
  v_mfma_f32_16x16x32_bf16 v[140:143], v[84:87], v[42:45], v[216:219]
  v_exp_f32 v153, v153
  v_exp_f32 v154, v154
  v_exp_f32 v155, v155
  s_mul_i32 s58, s79, 0
  s_add_u32 s58, s58, s73
  s_mov_b32 m0, s58
  s_nop 0
  buffer_load_dwordx4 v246, s[36:39], s3 offen offset:2048 sc1 lds
  s_add_u32 m0, m0, 3072
  v_mfma_f32_16x16x32_bf16 v[144:147], v[80:83], v[46:49], v[216:219]
  v_exp_f32 v156, v156
  v_exp_f32 v157, v157
  v_exp_f32 v158, v158
  v_exp_f32 v159, v159
  v_mfma_f32_16x16x32_bf16 v[148:151], v[84:87], v[48:51], v[216:219]
  buffer_load_dwordx4 v247, s[36:39], s3 offen offset:0 sc1 lds
  v_cvt_pk_bf16_f32 v176, v152, v153
  v_cvt_pk_bf16_f32 v177, v154, v155
  s_waitcnt lgkmcnt(4)
  v_mfma_f32_16x16x32_bf16 v[192:195], v[184:187], v[168:171], 0
  v_cvt_pk_bf16_f32 v178, v156, v157
  v_cvt_pk_bf16_f32 v179, v158, v159
  v_exp_f32 v160, v160
  v_exp_f32 v161, v161
  v_mfma_f32_16x16x32_bf16 v[200:203], a[0:3], v[168:171], 0
  v_exp_f32 v162, v162
  v_exp_f32 v163, v163
  buffer_load_dwordx4 v248, s[36:39], s3 offen offset:1024 sc1 lds
  v_exp_f32 v164, v164
  v_mfma_f32_16x16x32_bf16 v[196:199], v[184:187], v[172:175], 0
  v_exp_f32 v165, v165
  v_exp_f32 v166, v166
  v_exp_f32 v167, v167
  buffer_load_dwordx4 v249, s[36:39], s3 offen offset:2048 sc1 lds
  s_add_u32 m0, m0, 3072
  v_mfma_f32_16x16x32_bf16 v[204:207], a[0:3], v[172:175], 0
  v_cvt_pk_bf16_f32 v180, v160, v161
  v_cvt_pk_bf16_f32 v181, v162, v163
  v_cvt_pk_bf16_f32 v182, v164, v165
  v_cvt_pk_bf16_f32 v183, v166, v167
  ds_read_b128 v[184:187], v22 offset:4608
  s_cmp_eq_u32 s55, 6
  s_cbranch_scc0 Lsw_33
  v_mov_b32 v216, 0
  v_mov_b32 v217, 0
  v_mov_b32 v218, 0
  v_mov_b32 v219, 0
Lsw_33:
  s_waitcnt lgkmcnt(1)
  s_nop 0
  v_mfma_f32_16x16x32_bf16 v[152:155], v[88:91], v[40:43], v[216:219]
  ds_read_b128 v[98:101], v20 offset:9216
  ds_read_b64 v[96:97], v21 offset:9216
  ds_read_b64 v[102:103], v21 offset:9224
  v_exp_f32 v136, v136
  v_mfma_f32_16x16x32_bf16 v[156:159], v[92:95], v[42:45], v[216:219]
  v_exp_f32 v137, v137
  v_exp_f32 v138, v138
  v_exp_f32 v139, v139
  buffer_load_dwordx4 v250, s[36:39], s3 offen offset:0 sc1 lds
  v_mfma_f32_16x16x32_bf16 v[160:163], v[88:91], v[46:49], v[216:219]
  v_exp_f32 v140, v140
  v_exp_f32 v141, v141
  v_exp_f32 v142, v142
  v_exp_f32 v143, v143
  v_mfma_f32_16x16x32_bf16 v[164:167], v[92:95], v[48:51], v[216:219]
  buffer_load_dwordx4 v251, s[36:39], s3 offen offset:1024 sc1 lds
  v_cvt_pk_bf16_f32 v168, v136, v137
  v_cvt_pk_bf16_f32 v169, v138, v139
  v_cvt_pk_bf16_f32 v170, v140, v141
  v_mfma_f32_16x16x32_bf16 v[192:195], v[188:191], v[176:179], v[192:195]
  v_cvt_pk_bf16_f32 v171, v142, v143
  v_exp_f32 v144, v144
  v_exp_f32 v145, v145
  v_exp_f32 v146, v146
  v_mfma_f32_16x16x32_bf16 v[200:203], a[4:7], v[176:179], v[200:203]
  v_exp_f32 v147, v147
  buffer_load_dwordx4 v252, s[36:39], s3 offen offset:2048 sc1 lds
  v_exp_f32 v148, v148
  v_exp_f32 v149, v149
  v_mfma_f32_16x16x32_bf16 v[196:199], v[188:191], v[180:183], v[196:199]
  v_exp_f32 v150, v150
  v_exp_f32 v151, v151
  s_mul_i32 s58, s79, 1
  s_add_u32 s58, s58, s73
  s_mov_b32 m0, s58
  s_nop 0
  buffer_load_dwordx4 v244, s[36:39], s27 offen offset:0 sc1 lds
  v_cvt_pk_bf16_f32 v172, v144, v145
  v_mfma_f32_16x16x32_bf16 v[204:207], a[4:7], v[180:183], v[204:207]
  v_cvt_pk_bf16_f32 v173, v146, v147
  v_cvt_pk_bf16_f32 v174, v148, v149
  v_cvt_pk_bf16_f32 v175, v150, v151
  ds_read_b128 v[188:191], v22 offset:6912
  s_cmp_eq_u32 s55, 8
  s_cbranch_scc0 Lsw_34
  v_mov_b32 v216, 0
  v_mov_b32 v217, 0
  v_mov_b32 v218, 0
  v_mov_b32 v219, 0
Lsw_34:
  s_waitcnt lgkmcnt(1)
  s_nop 0
  v_mfma_f32_16x16x32_bf16 v[136:139], v[96:99], v[40:43], v[216:219]
  ds_read_b128 v[106:109], v20 offset:11520
  ds_read_b64 v[104:105], v21 offset:11520
  ds_read_b64 v[110:111], v21 offset:11528
  v_exp_f32 v152, v152
  v_mfma_f32_16x16x32_bf16 v[140:143], v[100:103], v[42:45], v[216:219]
  v_exp_f32 v153, v153
  v_exp_f32 v154, v154
  v_exp_f32 v155, v155
  buffer_load_dwordx4 v245, s[36:39], s27 offen offset:1024 sc1 lds
  v_mfma_f32_16x16x32_bf16 v[144:147], v[96:99], v[46:49], v[216:219]
  v_exp_f32 v156, v156
  v_exp_f32 v157, v157
  v_exp_f32 v158, v158
  v_exp_f32 v159, v159
  v_mfma_f32_16x16x32_bf16 v[148:151], v[100:103], v[48:51], v[216:219]
  buffer_load_dwordx4 v246, s[36:39], s27 offen offset:2048 sc1 lds
  s_add_u32 m0, m0, 3072
  v_cvt_pk_bf16_f32 v176, v152, v153
  v_cvt_pk_bf16_f32 v177, v154, v155
  v_cvt_pk_bf16_f32 v178, v156, v157
  v_mfma_f32_16x16x32_bf16 v[192:195], v[184:187], v[168:171], v[192:195]
  v_cvt_pk_bf16_f32 v179, v158, v159
  v_exp_f32 v160, v160
  v_exp_f32 v161, v161
  v_exp_f32 v162, v162
  v_mfma_f32_16x16x32_bf16 v[200:203], a[8:11], v[168:171], v[200:203]
  v_exp_f32 v163, v163
  buffer_load_dwordx4 v247, s[36:39], s27 offen offset:0 sc1 lds
  v_exp_f32 v164, v164
  v_exp_f32 v165, v165
  v_mfma_f32_16x16x32_bf16 v[196:199], v[184:187], v[172:175], v[196:199]
  v_exp_f32 v166, v166
  v_exp_f32 v167, v167
  buffer_load_dwordx4 v248, s[36:39], s27 offen offset:1024 sc1 lds
  v_cvt_pk_bf16_f32 v180, v160, v161
  v_mfma_f32_16x16x32_bf16 v[204:207], a[8:11], v[172:175], v[204:207]
  v_cvt_pk_bf16_f32 v181, v162, v163
  v_cvt_pk_bf16_f32 v182, v164, v165
  v_cvt_pk_bf16_f32 v183, v166, v167
  ds_read_b128 v[184:187], v22 offset:9216
  s_cmp_eq_u32 s55, 10
  s_cbranch_scc0 Lsw_35
  v_mov_b32 v216, 0
  v_mov_b32 v217, 0
  v_mov_b32 v218, 0
  v_mov_b32 v219, 0
Lsw_35:
  s_waitcnt lgkmcnt(1)
  s_nop 0
  v_mfma_f32_16x16x32_bf16 v[152:155], v[104:107], v[40:43], v[216:219]
  ds_read_b128 v[114:117], v20 offset:13824
  ds_read_b64 v[112:113], v21 offset:13824
  ds_read_b64 v[118:119], v21 offset:13832
  v_exp_f32 v136, v136
  v_mfma_f32_16x16x32_bf16 v[156:159], v[108:111], v[42:45], v[216:219]
  v_exp_f32 v137, v137
  v_exp_f32 v138, v138
  v_exp_f32 v139, v139
  buffer_load_dwordx4 v249, s[36:39], s27 offen offset:2048 sc1 lds
  s_add_u32 m0, m0, 3072
  v_mfma_f32_16x16x32_bf16 v[160:163], v[104:107], v[46:49], v[216:219]
  v_exp_f32 v140, v140
  v_exp_f32 v141, v141
  v_exp_f32 v142, v142
  v_exp_f32 v143, v143
  v_mfma_f32_16x16x32_bf16 v[164:167], v[108:111], v[48:51], v[216:219]
  buffer_load_dwordx4 v250, s[36:39], s27 offen offset:0 sc1 lds
  v_cvt_pk_bf16_f32 v168, v136, v137
  v_cvt_pk_bf16_f32 v169, v138, v139
  v_cvt_pk_bf16_f32 v170, v140, v141
  v_mfma_f32_16x16x32_bf16 v[192:195], v[188:191], v[176:179], v[192:195]
  v_cvt_pk_bf16_f32 v171, v142, v143
  v_exp_f32 v144, v144
  v_exp_f32 v145, v145
  v_exp_f32 v146, v146
  v_mfma_f32_16x16x32_bf16 v[200:203], a[12:15], v[176:179], v[200:203]
  v_exp_f32 v147, v147
  buffer_load_dwordx4 v251, s[36:39], s27 offen offset:1024 sc1 lds
  v_exp_f32 v148, v148
  v_exp_f32 v149, v149
  v_mfma_f32_16x16x32_bf16 v[196:199], v[188:191], v[180:183], v[196:199]
  v_exp_f32 v150, v150
  v_exp_f32 v151, v151
  buffer_load_dwordx4 v252, s[36:39], s27 offen offset:2048 sc1 lds
  v_cvt_pk_bf16_f32 v172, v144, v145
  v_mfma_f32_16x16x32_bf16 v[204:207], a[12:15], v[180:183], v[204:207]
  v_cvt_pk_bf16_f32 v173, v146, v147
  v_cvt_pk_bf16_f32 v174, v148, v149
  v_cvt_pk_bf16_f32 v175, v150, v151
  ds_read_b128 v[188:191], v22 offset:11520
  s_cmp_eq_u32 s55, 12
  s_cbranch_scc0 Lsw_36
  v_mov_b32 v216, 0
  v_mov_b32 v217, 0
  v_mov_b32 v218, 0
  v_mov_b32 v219, 0
Lsw_36:
  s_waitcnt lgkmcnt(1)
  s_nop 0
  v_mfma_f32_16x16x32_bf16 v[136:139], v[112:115], v[40:43], v[216:219]
  ds_read_b128 v[122:125], v20 offset:16128
  ds_read_b64 v[120:121], v21 offset:16128
  ds_read_b64 v[126:127], v21 offset:16136
  v_exp_f32 v152, v152
  v_mfma_f32_16x16x32_bf16 v[140:143], v[116:119], v[42:45], v[216:219]
  v_exp_f32 v153, v153
  v_exp_f32 v154, v154
  v_exp_f32 v155, v155
  s_mul_i32 s58, s79, 2
  s_add_u32 s58, s58, s73
  s_mov_b32 m0, s58
  s_nop 0
  buffer_load_dwordx4 v244, s[36:39], s45 offen offset:0 sc1 lds
  v_mfma_f32_16x16x32_bf16 v[144:147], v[112:115], v[46:49], v[216:219]
  v_exp_f32 v156, v156
  v_exp_f32 v157, v157
  v_exp_f32 v158, v158
  v_exp_f32 v159, v159
  v_mfma_f32_16x16x32_bf16 v[148:151], v[116:119], v[48:51], v[216:219]
  buffer_load_dwordx4 v245, s[36:39], s45 offen offset:1024 sc1 lds
  v_cvt_pk_bf16_f32 v176, v152, v153
  v_cvt_pk_bf16_f32 v177, v154, v155
  v_mfma_f32_16x16x32_bf16 v[192:195], v[184:187], v[168:171], v[192:195]
  v_cvt_pk_bf16_f32 v178, v156, v157
  v_cvt_pk_bf16_f32 v179, v158, v159
  v_exp_f32 v160, v160
  v_exp_f32 v161, v161
  v_mfma_f32_16x16x32_bf16 v[200:203], a[16:19], v[168:171], v[200:203]
  v_exp_f32 v162, v162
  v_exp_f32 v163, v163
  buffer_load_dwordx4 v246, s[36:39], s45 offen offset:2048 sc1 lds
  s_add_u32 m0, m0, 3072
  v_exp_f32 v164, v164
  v_mfma_f32_16x16x32_bf16 v[196:199], v[184:187], v[172:175], v[196:199]
  v_exp_f32 v165, v165
  v_exp_f32 v166, v166
  v_exp_f32 v167, v167
  v_cvt_pk_bf16_f32 v180, v160, v161
  v_mfma_f32_16x16x32_bf16 v[204:207], a[16:19], v[172:175], v[204:207]
  v_cvt_pk_bf16_f32 v181, v162, v163
  v_cvt_pk_bf16_f32 v182, v164, v165
  v_cvt_pk_bf16_f32 v183, v166, v167
  ds_read_b128 v[184:187], v22 offset:13824
  s_cmp_eq_u32 s55, 14
  s_cbranch_scc0 Lsw_37
  v_mov_b32 v216, 0
  v_mov_b32 v217, 0
  v_mov_b32 v218, 0
  v_mov_b32 v219, 0
Lsw_37:
  s_waitcnt lgkmcnt(1)
  s_nop 0
  v_mfma_f32_16x16x32_bf16 v[152:155], v[120:123], v[40:43], v[216:219]
  ds_read_b128 v[130:133], v20 offset:18432
  ds_read_b64 v[128:129], v21 offset:18432
  ds_read_b64 v[134:135], v21 offset:18440
  v_exp_f32 v136, v136
  v_mfma_f32_16x16x32_bf16 v[156:159], v[124:127], v[42:45], v[216:219]
  v_exp_f32 v137, v137
  v_exp_f32 v138, v138
  v_exp_f32 v139, v139
  buffer_load_dwordx4 v247, s[36:39], s45 offen offset:0 sc1 lds
  v_mfma_f32_16x16x32_bf16 v[160:163], v[120:123], v[46:49], v[216:219]
  v_exp_f32 v140, v140
  v_exp_f32 v141, v141
  v_exp_f32 v142, v142
  v_exp_f32 v143, v143
  v_mfma_f32_16x16x32_bf16 v[164:167], v[124:127], v[48:51], v[216:219]
  buffer_load_dwordx4 v248, s[36:39], s45 offen offset:1024 sc1 lds
  v_cvt_pk_bf16_f32 v168, v136, v137
  v_cvt_pk_bf16_f32 v169, v138, v139
  v_mfma_f32_16x16x32_bf16 v[192:195], v[188:191], v[176:179], v[192:195]
  v_cvt_pk_bf16_f32 v170, v140, v141
  v_cvt_pk_bf16_f32 v171, v142, v143
  v_exp_f32 v144, v144
  v_exp_f32 v145, v145
  v_mfma_f32_16x16x32_bf16 v[200:203], a[20:23], v[176:179], v[200:203]
  v_exp_f32 v146, v146
  v_exp_f32 v147, v147
  buffer_load_dwordx4 v249, s[36:39], s45 offen offset:2048 sc1 lds
  s_add_u32 m0, m0, 3072
  v_exp_f32 v148, v148
  v_mfma_f32_16x16x32_bf16 v[196:199], v[188:191], v[180:183], v[196:199]
  v_exp_f32 v149, v149
  v_exp_f32 v150, v150
  v_exp_f32 v151, v151
  v_cvt_pk_bf16_f32 v172, v144, v145
  v_mfma_f32_16x16x32_bf16 v[204:207], a[20:23], v[180:183], v[204:207]
  v_cvt_pk_bf16_f32 v173, v146, v147
  v_cvt_pk_bf16_f32 v174, v148, v149
  v_cvt_pk_bf16_f32 v175, v150, v151
  ds_read_b128 v[188:191], v22 offset:16128
  s_cmp_eq_u32 s55, 16
  s_cbranch_scc0 Lsw_38
  v_mov_b32 v216, 0
  v_mov_b32 v217, 0
  v_mov_b32 v218, 0
  v_mov_b32 v219, 0
Lsw_38:
  s_waitcnt lgkmcnt(1)
  s_nop 0
  v_mfma_f32_16x16x32_bf16 v[136:139], v[128:131], v[40:43], v[216:219]
  v_exp_f32 v152, v152
  v_exp_f32 v153, v153
  v_exp_f32 v154, v154
  v_exp_f32 v155, v155
  v_mfma_f32_16x16x32_bf16 v[144:147], v[128:131], v[46:49], v[216:219]
  buffer_load_dwordx4 v250, s[36:39], s45 offen offset:0 sc1 lds
  v_exp_f32 v156, v156
  v_exp_f32 v157, v157
  v_exp_f32 v158, v158
  v_mfma_f32_16x16x32_bf16 v[148:151], v[132:135], v[48:51], v[216:219]
  v_exp_f32 v159, v159
  buffer_load_dwordx4 v251, s[36:39], s45 offen offset:1024 sc1 lds
  v_cvt_pk_bf16_f32 v176, v152, v153
  v_cvt_pk_bf16_f32 v177, v154, v155
  v_mfma_f32_16x16x32_bf16 v[192:195], v[184:187], v[168:171], v[192:195]
  v_cvt_pk_bf16_f32 v178, v156, v157
  v_cvt_pk_bf16_f32 v179, v158, v159
  v_exp_f32 v160, v160
  v_exp_f32 v161, v161
  v_mfma_f32_16x16x32_bf16 v[200:203], a[24:27], v[168:171], v[200:203]
  v_exp_f32 v162, v162
  v_exp_f32 v163, v163
  buffer_load_dwordx4 v252, s[36:39], s45 offen offset:2048 sc1 lds
  v_exp_f32 v164, v164
  v_mfma_f32_16x16x32_bf16 v[196:199], v[184:187], v[172:175], v[196:199]
  v_exp_f32 v165, v165
  v_exp_f32 v166, v166
  v_exp_f32 v167, v167
  v_cvt_pk_bf16_f32 v180, v160, v161
  v_mfma_f32_16x16x32_bf16 v[204:207], a[24:27], v[172:175], v[204:207]
  v_cvt_pk_bf16_f32 v181, v162, v163
  v_cvt_pk_bf16_f32 v182, v164, v165
  v_cvt_pk_bf16_f32 v183, v166, v167
  ds_read_b128 v[184:187], v22 offset:18432
  s_waitcnt lgkmcnt(1)
  v_mfma_f32_16x16x32_bf16 v[192:195], v[188:191], v[176:179], v[192:195]
  v_cndmask_b32 v136, v136, v25, s[60:61]
  v_cndmask_b32 v137, v137, v25, s[62:63]
  v_cndmask_b32 v138, v138, v25, s[64:65]
  v_cndmask_b32 v139, v139, v25, s[66:67]
  v_exp_f32 v136, v136
  v_exp_f32 v137, v137
  v_exp_f32 v138, v138
  v_exp_f32 v139, v139
  v_mfma_f32_16x16x32_bf16 v[200:203], a[28:31], v[176:179], v[200:203]
  buffer_load_dwordx4 v[232:235], v7, s[32:35], s77 offen offset:0
  buffer_load_dwordx4 v[236:239], v7, s[32:35], s77 offen offset:64
  v_cvt_pk_bf16_f32 v168, v136, v137
  v_cvt_pk_bf16_f32 v169, v138, v139
  v_mov_b32 v170, 0
  v_mov_b32 v171, 0
  v_exp_f32 v144, v144
  v_exp_f32 v145, v145
  v_mfma_f32_16x16x32_bf16 v[196:199], v[188:191], v[180:183], v[196:199]
  v_exp_f32 v146, v146
  v_exp_f32 v147, v147
  buffer_load_dwordx4 v[240:243], v7, s[32:35], s77 offen offset:128
  v_cndmask_b32 v148, v148, v25, s[60:61]
  v_cndmask_b32 v149, v149, v25, s[62:63]
  v_cndmask_b32 v150, v150, v25, s[64:65]
  v_cndmask_b32 v151, v151, v25, s[66:67]
  v_exp_f32 v148, v148
  v_mfma_f32_16x16x32_bf16 v[204:207], a[28:31], v[180:183], v[204:207]
  v_exp_f32 v149, v149
  v_exp_f32 v150, v150
  v_exp_f32 v151, v151
  v_cvt_pk_bf16_f32 v172, v144, v145
  v_cvt_pk_bf16_f32 v173, v146, v147
  v_cvt_pk_bf16_f32 v174, v148, v149
  v_cvt_pk_bf16_f32 v175, v150, v151
  s_waitcnt lgkmcnt(0)
  v_mfma_f32_16x16x32_bf16 v[192:195], v[184:187], v[168:171], v[192:195]
  v_mfma_f32_16x16x32_bf16 v[200:203], a[32:35], v[168:171], v[200:203]
  v_mfma_f32_16x16x32_bf16 v[196:199], v[184:187], v[172:175], v[196:199]
  v_mfma_f32_16x16x32_bf16 v[204:207], a[32:35], v[172:175], v[204:207]
  s_nop 5
  v_rcp_f32 v30, v203
  s_nop 0
  v_rcp_f32 v31, v207
  v_mul_f32 v192, v192, v30
  v_mul_f32 v193, v193, v30
  v_mul_f32 v194, v194, v30
  v_mul_f32 v195, v195, v30
  v_mul_f32 v200, v200, v30
  v_mul_f32 v201, v201, v30
  v_mul_f32 v196, v196, v31
  v_mul_f32 v197, v197, v31
  v_mul_f32 v198, v198, v31
  v_mul_f32 v199, v199, v31
  v_mul_f32 v204, v204, v31
  v_mul_f32 v205, v205, v31
  v_cvt_pk_bf16_f32 v208, v192, v193
  v_cvt_pk_bf16_f32 v209, v194, v195
  v_cvt_pk_bf16_f32 v32, v200, v201
  v_cvt_pk_bf16_f32 v212, v196, v197
  v_cvt_pk_bf16_f32 v213, v198, v199
  v_cvt_pk_bf16_f32 v34, v204, v205
  s_cmp_lg_u32 s40, 0
  s_cbranch_scc1 Lmk_39_x
  s_mov_b32 s47, 100000
  s_waitcnt vmcnt(28)
Lmk_39:
  v_cmp_ne_u32 vcc, s43, v224
  s_cbranch_vccz Lmk_39_x
  s_sleep 2
  s_mov_b32 s46, 520192
  buffer_load_dword v224, v225, s[28:31], s46 offen sc1
  s_waitcnt vmcnt(0)
  s_sub_u32 s47, s47, 1
  s_cbranch_scc0 Lmk_39
Lmk_39_x:
  s_waitcnt vmcnt(20)
  s_barrier
  s_cmp_lg_u32 s40, 0
  s_cbranch_scc1 Lmp_40
  s_lshl_b32 s46, s2, 2
  s_add_u32 s46, s46, 521216
  v_mov_b32 v224, s43
  v_mov_b32 v225, 0
  s_mov_b64 exec, 1
  buffer_store_dword v224, v225, s[28:31], s46 offen sc1
  s_mov_b64 exec, -1
Lmp_40:
  ds_read_b128 v[66:69], v20 offset:1024
  ds_read_b128 v[74:77], v20 offset:3328
  v_mov_b32 v216, v25
  v_mov_b32 v217, v25
  v_mov_b32 v218, v25
  v_mov_b32 v219, v25
  s_waitcnt lgkmcnt(1)
  s_nop 0
  v_mfma_f32_16x16x32_bf16 v[136:139], v[64:67], v[52:55], v[216:219]
  v_mfma_f32_16x16x32_bf16 v[140:143], v[68:71], v[54:57], v[216:219]
  v_mfma_f32_16x16x32_bf16 v[148:151], v[68:71], v[60:63], v[216:219]
  s_cmp_eq_u32 s55, 2
  s_nop 0
  s_cbranch_scc0 Lsw_41
  v_mov_b32 v216, 0
  v_mov_b32 v217, 0
  v_mov_b32 v218, 0
  v_mov_b32 v219, 0
Lsw_41:
  s_waitcnt lgkmcnt(0)
  s_nop 0
  v_mfma_f32_16x16x32_bf16 v[152:155], v[72:75], v[52:55], v[216:219]
  ds_read_b128 v[82:85], v20 offset:5632
  v_cndmask_b32 v136, v25, v136, s[60:61]
  v_cndmask_b32 v137, v25, v137, s[62:63]
  v_cndmask_b32 v138, v25, v138, s[64:65]
  v_cndmask_b32 v139, v25, v139, s[66:67]
  v_exp_f32 v136, v136
  v_exp_f32 v137, v137
  v_exp_f32 v138, v138
  v_mfma_f32_16x16x32_bf16 v[156:159], v[76:79], v[54:57], v[216:219]
  v_exp_f32 v139, v139
  s_add_u32 s59, s71, 0
  buffer_load_dwordx4 a[40:43], v4, s[28:31], s59 offen offset:0 sc1
  v_exp_f32 v140, v140
  v_exp_f32 v141, v141
  v_exp_f32 v142, v142
  v_exp_f32 v143, v143
  buffer_load_dwordx4 a[44:47], v4, s[28:31], s59 offen offset:1024 sc1
  v_cvt_pk_bf16_f32 v168, v136, v137
  v_mfma_f32_16x16x32_bf16 v[160:163], v[72:75], v[58:61], v[216:219]
  v_cvt_pk_bf16_f32 v169, v138, v139
  v_cvt_pk_bf16_f32 v170, v140, v141
  v_cvt_pk_bf16_f32 v171, v142, v143
  buffer_load_dwordx4 a[48:51], v4, s[28:31], s59 offen offset:2048 sc1
  v_cndmask_b32 v148, v25, v148, s[60:61]
  v_cndmask_b32 v149, v25, v149, s[62:63]
  v_cndmask_b32 v150, v25, v150, s[64:65]
  v_cndmask_b32 v151, v25, v151, s[66:67]
  v_mfma_f32_16x16x32_bf16 v[164:167], v[76:79], v[60:63], v[216:219]
  v_exp_f32 v148, v148
  v_exp_f32 v149, v149
  v_exp_f32 v150, v150
  v_exp_f32 v151, v151
  v_mov_b32 v172, 0
  v_mov_b32 v173, 0
  v_cvt_pk_bf16_f32 v174, v148, v149
  v_cvt_pk_bf16_f32 v175, v150, v151
  s_mov_b32 exec_lo, 0x00030003
  s_mov_b32 exec_hi, 0x00030003
  ds_read_b128 a[0:3], v23 offset:128
  ds_read_b128 a[4:7], v23 offset:2432
  ds_read_b128 a[8:11], v23 offset:4736
  ds_read_b128 a[12:15], v23 offset:7040
  ds_read_b128 a[16:19], v23 offset:9344
  ds_read_b128 a[20:23], v23 offset:11648
  ds_read_b128 a[24:27], v23 offset:13952
  ds_read_b128 a[28:31], v23 offset:16256
  ds_read_b128 a[32:35], v23 offset:18560
  s_mov_b64 exec, -1
  ds_read_b128 v[184:187], v22 offset:1024
  ds_read_b128 v[188:191], v22 offset:3328
  s_cmp_eq_u32 s55, 4
  s_cbranch_scc0 Lsw_42
  v_mov_b32 v216, 0
  v_mov_b32 v217, 0
  v_mov_b32 v218, 0
  v_mov_b32 v219, 0
Lsw_42:
  s_waitcnt lgkmcnt(11)
  s_nop 0
  v_mfma_f32_16x16x32_bf16 v[136:139], v[80:83], v[52:55], v[216:219]
  ds_read_b128 v[90:93], v20 offset:7936
  v_exp_f32 v152, v152
  v_exp_f32 v153, v153
  v_exp_f32 v154, v154
  v_mfma_f32_16x16x32_bf16 v[140:143], v[84:87], v[54:57], v[216:219]
  v_exp_f32 v155, v155
  buffer_load_dwordx4 a[52:55], v4, s[28:31], s59 offen offset:3072 sc1
  v_exp_f32 v156, v156
  v_mfma_f32_16x16x32_bf16 v[144:147], v[80:83], v[58:61], v[216:219]
  v_exp_f32 v157, v157
  v_exp_f32 v158, v158
  v_exp_f32 v159, v159
  s_add_u32 s59, s71, 4096
  buffer_load_dwordx4 a[56:59], v4, s[28:31], s59 offen offset:0 sc1
  v_mfma_f32_16x16x32_bf16 v[148:151], v[84:87], v[60:63], v[216:219]
  v_cvt_pk_bf16_f32 v176, v152, v153
  v_cvt_pk_bf16_f32 v177, v154, v155
  v_cvt_pk_bf16_f32 v178, v156, v157
  s_waitcnt lgkmcnt(2)
  v_mfma_f32_16x16x32_bf16 v[192:195], v[184:187], v[168:171], 0
  v_cvt_pk_bf16_f32 v179, v158, v159
  v_exp_f32 v160, v160
  v_exp_f32 v161, v161
  v_exp_f32 v162, v162
  v_mfma_f32_16x16x32_bf16 v[200:203], a[0:3], v[168:171], 0
  v_exp_f32 v163, v163
  buffer_load_dwordx4 a[60:63], v4, s[28:31], s59 offen offset:1024 sc1
  v_exp_f32 v164, v164
  v_mfma_f32_16x16x32_bf16 v[196:199], v[184:187], v[172:175], 0
  v_exp_f32 v165, v165
  v_exp_f32 v166, v166
  v_exp_f32 v167, v167
  v_cvt_pk_bf16_f32 v180, v160, v161
  v_mfma_f32_16x16x32_bf16 v[204:207], a[0:3], v[172:175], 0
  v_cvt_pk_bf16_f32 v181, v162, v163
  v_cvt_pk_bf16_f32 v182, v164, v165
  v_cvt_pk_bf16_f32 v183, v166, v167
  ds_read_b128 v[184:187], v22 offset:5632
  s_cmp_eq_u32 s55, 6
  s_cbranch_scc0 Lsw_43
  v_mov_b32 v216, 0
  v_mov_b32 v217, 0
  v_mov_b32 v218, 0
  v_mov_b32 v219, 0
Lsw_43:
  s_waitcnt lgkmcnt(1)
  s_nop 0
  v_mfma_f32_16x16x32_bf16 v[152:155], v[88:91], v[52:55], v[216:219]
  ds_read_b128 v[98:101], v20 offset:10240
  v_exp_f32 v136, v136
  v_exp_f32 v137, v137
  v_exp_f32 v138, v138
  v_mfma_f32_16x16x32_bf16 v[156:159], v[92:95], v[54:57], v[216:219]
  v_exp_f32 v139, v139
  buffer_load_dwordx4 a[64:67], v4, s[28:31], s59 offen offset:2048 sc1
  v_exp_f32 v140, v140
  v_mfma_f32_16x16x32_bf16 v[160:163], v[88:91], v[58:61], v[216:219]
  v_exp_f32 v141, v141
  v_exp_f32 v142, v142
  v_exp_f32 v143, v143
  buffer_load_dwordx4 a[68:71], v4, s[28:31], s59 offen offset:3072 sc1
  v_mfma_f32_16x16x32_bf16 v[164:167], v[92:95], v[60:63], v[216:219]
  v_cvt_pk_bf16_f32 v168, v136, v137
  v_cvt_pk_bf16_f32 v169, v138, v139
  v_cvt_pk_bf16_f32 v170, v140, v141
  v_mfma_f32_16x16x32_bf16 v[192:195], v[188:191], v[176:179], v[192:195]
  v_cvt_pk_bf16_f32 v171, v142, v143
  v_exp_f32 v144, v144
  v_exp_f32 v145, v145
  v_exp_f32 v146, v146
  v_mfma_f32_16x16x32_bf16 v[200:203], a[4:7], v[176:179], v[200:203]
  v_exp_f32 v147, v147
  s_add_u32 s59, s71, 8192
  buffer_load_dwordx4 a[72:75], v4, s[28:31], s59 offen offset:0 sc1
  v_exp_f32 v148, v148
  v_mfma_f32_16x16x32_bf16 v[196:199], v[188:191], v[180:183], v[196:199]
  v_exp_f32 v149, v149
  v_exp_f32 v150, v150
  v_exp_f32 v151, v151
  v_cvt_pk_bf16_f32 v172, v144, v145
  v_mfma_f32_16x16x32_bf16 v[204:207], a[4:7], v[180:183], v[204:207]
  v_cvt_pk_bf16_f32 v173, v146, v147
  v_cvt_pk_bf16_f32 v174, v148, v149
  v_cvt_pk_bf16_f32 v175, v150, v151
  ds_read_b128 v[188:191], v22 offset:7936
  s_cmp_eq_u32 s55, 8
  s_cbranch_scc0 Lsw_44
  v_mov_b32 v216, 0
  v_mov_b32 v217, 0
  v_mov_b32 v218, 0
  v_mov_b32 v219, 0
Lsw_44:
  s_waitcnt lgkmcnt(1)
  s_nop 0
  v_mfma_f32_16x16x32_bf16 v[136:139], v[96:99], v[52:55], v[216:219]
  ds_read_b128 v[106:109], v20 offset:12544
  v_exp_f32 v152, v152
  v_exp_f32 v153, v153
  v_exp_f32 v154, v154
  v_mfma_f32_16x16x32_bf16 v[140:143], v[100:103], v[54:57], v[216:219]
  v_exp_f32 v155, v155
  buffer_load_dwordx4 a[76:79], v4, s[28:31], s59 offen offset:1024 sc1
  v_exp_f32 v156, v156
  v_mfma_f32_16x16x32_bf16 v[144:147], v[96:99], v[58:61], v[216:219]
  v_exp_f32 v157, v157
  v_exp_f32 v158, v158
  v_exp_f32 v159, v159
  buffer_load_dwordx4 a[80:83], v4, s[28:31], s59 offen offset:2048 sc1
  v_mfma_f32_16x16x32_bf16 v[148:151], v[100:103], v[60:63], v[216:219]
  v_cvt_pk_bf16_f32 v176, v152, v153
  v_cvt_pk_bf16_f32 v177, v154, v155
  v_cvt_pk_bf16_f32 v178, v156, v157
  v_mfma_f32_16x16x32_bf16 v[192:195], v[184:187], v[168:171], v[192:195]
  v_cvt_pk_bf16_f32 v179, v158, v159
  v_exp_f32 v160, v160
  v_exp_f32 v161, v161
  v_exp_f32 v162, v162
  v_mfma_f32_16x16x32_bf16 v[200:203], a[8:11], v[168:171], v[200:203]
  v_exp_f32 v163, v163
  buffer_load_dwordx4 a[84:87], v4, s[28:31], s59 offen offset:3072 sc1
  v_exp_f32 v164, v164
  v_mfma_f32_16x16x32_bf16 v[196:199], v[184:187], v[172:175], v[196:199]
  v_exp_f32 v165, v165
  v_exp_f32 v166, v166
  v_exp_f32 v167, v167
  v_cvt_pk_bf16_f32 v180, v160, v161
  v_mfma_f32_16x16x32_bf16 v[204:207], a[8:11], v[172:175], v[204:207]
  v_cvt_pk_bf16_f32 v181, v162, v163
  v_cvt_pk_bf16_f32 v182, v164, v165
  v_cvt_pk_bf16_f32 v183, v166, v167
  ds_read_b128 v[184:187], v22 offset:10240
  s_cmp_eq_u32 s55, 10
  s_cbranch_scc0 Lsw_45
  v_mov_b32 v216, 0
  v_mov_b32 v217, 0
  v_mov_b32 v218, 0
  v_mov_b32 v219, 0
Lsw_45:
  s_waitcnt lgkmcnt(1)
  s_nop 0
  v_mfma_f32_16x16x32_bf16 v[152:155], v[104:107], v[52:55], v[216:219]
  ds_read_b128 v[114:117], v20 offset:14848
  v_exp_f32 v136, v136
  v_exp_f32 v137, v137
  v_exp_f32 v138, v138
  v_mfma_f32_16x16x32_bf16 v[156:159], v[108:111], v[54:57], v[216:219]
  v_exp_f32 v139, v139
  s_add_u32 s59, s71, 12288
  buffer_load_dwordx4 a[88:91], v4, s[28:31], s59 offen offset:0 sc1
  v_exp_f32 v140, v140
  v_mfma_f32_16x16x32_bf16 v[160:163], v[104:107], v[58:61], v[216:219]
  v_exp_f32 v141, v141
  v_exp_f32 v142, v142
  v_exp_f32 v143, v143
  buffer_load_dwordx4 a[92:95], v4, s[28:31], s59 offen offset:1024 sc1
  v_mfma_f32_16x16x32_bf16 v[164:167], v[108:111], v[60:63], v[216:219]
  v_cvt_pk_bf16_f32 v168, v136, v137
  v_cvt_pk_bf16_f32 v169, v138, v139
  v_cvt_pk_bf16_f32 v170, v140, v141
  v_mfma_f32_16x16x32_bf16 v[192:195], v[188:191], v[176:179], v[192:195]
  v_cvt_pk_bf16_f32 v171, v142, v143
  v_exp_f32 v144, v144
  v_exp_f32 v145, v145
  v_exp_f32 v146, v146
  v_mfma_f32_16x16x32_bf16 v[200:203], a[12:15], v[176:179], v[200:203]
  v_exp_f32 v147, v147
  buffer_load_dwordx4 a[96:99], v4, s[28:31], s59 offen offset:2048 sc1
  v_exp_f32 v148, v148
  v_mfma_f32_16x16x32_bf16 v[196:199], v[188:191], v[180:183], v[196:199]
  v_exp_f32 v149, v149
  v_exp_f32 v150, v150
  v_exp_f32 v151, v151
  v_cvt_pk_bf16_f32 v172, v144, v145
  v_mfma_f32_16x16x32_bf16 v[204:207], a[12:15], v[180:183], v[204:207]
  v_cvt_pk_bf16_f32 v173, v146, v147
  v_cvt_pk_bf16_f32 v174, v148, v149
  v_cvt_pk_bf16_f32 v175, v150, v151
  ds_read_b128 v[188:191], v22 offset:12544
  s_cmp_eq_u32 s55, 12
  s_cbranch_scc0 Lsw_46
  v_mov_b32 v216, 0
  v_mov_b32 v217, 0
  v_mov_b32 v218, 0
  v_mov_b32 v219, 0
Lsw_46:
  s_waitcnt lgkmcnt(1)
  s_nop 0
  v_mfma_f32_16x16x32_bf16 v[136:139], v[112:115], v[52:55], v[216:219]
  ds_read_b128 v[122:125], v20 offset:17152
  v_exp_f32 v152, v152
  v_exp_f32 v153, v153
  v_exp_f32 v154, v154
  v_mfma_f32_16x16x32_bf16 v[140:143], v[116:119], v[54:57], v[216:219]
  v_exp_f32 v155, v155
  buffer_load_dwordx4 a[100:103], v4, s[28:31], s59 offen offset:3072 sc1
  v_exp_f32 v156, v156
  v_mfma_f32_16x16x32_bf16 v[144:147], v[112:115], v[58:61], v[216:219]
  v_exp_f32 v157, v157
  v_exp_f32 v158, v158
  v_exp_f32 v159, v159
  s_add_u32 s59, s71, 16384
  buffer_load_dwordx4 a[104:107], v4, s[28:31], s59 offen offset:0 sc1
  v_mfma_f32_16x16x32_bf16 v[148:151], v[116:119], v[60:63], v[216:219]
  v_cvt_pk_bf16_f32 v176, v152, v153
  v_cvt_pk_bf16_f32 v177, v154, v155
  v_cvt_pk_bf16_f32 v178, v156, v157
  v_mfma_f32_16x16x32_bf16 v[192:195], v[184:187], v[168:171], v[192:195]
  v_cvt_pk_bf16_f32 v179, v158, v159
  v_exp_f32 v160, v160
  v_exp_f32 v161, v161
  v_exp_f32 v162, v162
  v_mfma_f32_16x16x32_bf16 v[200:203], a[16:19], v[168:171], v[200:203]
  v_exp_f32 v163, v163
  buffer_load_dwordx4 a[108:111], v4, s[28:31], s59 offen offset:1024 sc1
  v_exp_f32 v164, v164
  v_mfma_f32_16x16x32_bf16 v[196:199], v[184:187], v[172:175], v[196:199]
  v_exp_f32 v165, v165
  v_exp_f32 v166, v166
  v_exp_f32 v167, v167
  v_cvt_pk_bf16_f32 v180, v160, v161
  v_mfma_f32_16x16x32_bf16 v[204:207], a[16:19], v[172:175], v[204:207]
  v_cvt_pk_bf16_f32 v181, v162, v163
  v_cvt_pk_bf16_f32 v182, v164, v165
  v_cvt_pk_bf16_f32 v183, v166, v167
  ds_read_b128 v[184:187], v22 offset:14848
  s_cmp_eq_u32 s55, 14
  s_cbranch_scc0 Lsw_47
  v_mov_b32 v216, 0
  v_mov_b32 v217, 0
  v_mov_b32 v218, 0
  v_mov_b32 v219, 0
Lsw_47:
  s_waitcnt lgkmcnt(1)
  s_nop 0
  v_mfma_f32_16x16x32_bf16 v[152:155], v[120:123], v[52:55], v[216:219]
  ds_read_b128 v[130:133], v20 offset:19456
  v_exp_f32 v136, v136
  v_exp_f32 v137, v137
  v_exp_f32 v138, v138
  v_mfma_f32_16x16x32_bf16 v[156:159], v[124:127], v[54:57], v[216:219]
  v_exp_f32 v139, v139
  buffer_load_dwordx4 a[112:115], v4, s[28:31], s59 offen offset:2048 sc1
  v_exp_f32 v140, v140
  v_mfma_f32_16x16x32_bf16 v[160:163], v[120:123], v[58:61], v[216:219]
  v_exp_f32 v141, v141
  v_exp_f32 v142, v142
  v_exp_f32 v143, v143
  buffer_load_dwordx4 a[116:119], v4, s[28:31], s59 offen offset:3072 sc1
  v_mfma_f32_16x16x32_bf16 v[164:167], v[124:127], v[60:63], v[216:219]
  v_cvt_pk_bf16_f32 v168, v136, v137
  v_cvt_pk_bf16_f32 v169, v138, v139
  v_cvt_pk_bf16_f32 v170, v140, v141
  v_mfma_f32_16x16x32_bf16 v[192:195], v[188:191], v[176:179], v[192:195]
  v_cvt_pk_bf16_f32 v171, v142, v143
  v_exp_f32 v144, v144
  v_exp_f32 v145, v145
  v_exp_f32 v146, v146
  v_mfma_f32_16x16x32_bf16 v[200:203], a[20:23], v[176:179], v[200:203]
  v_exp_f32 v147, v147
  s_add_u32 s59, s71, 20480
  buffer_load_dwordx4 a[120:123], v4, s[28:31], s59 offen offset:0 sc1
  v_exp_f32 v148, v148
  v_mfma_f32_16x16x32_bf16 v[196:199], v[188:191], v[180:183], v[196:199]
  v_exp_f32 v149, v149
  v_exp_f32 v150, v150
  v_exp_f32 v151, v151
  v_cvt_pk_bf16_f32 v172, v144, v145
  v_mfma_f32_16x16x32_bf16 v[204:207], a[20:23], v[180:183], v[204:207]
  v_cvt_pk_bf16_f32 v173, v146, v147
  v_cvt_pk_bf16_f32 v174, v148, v149
  v_cvt_pk_bf16_f32 v175, v150, v151
  ds_read_b128 v[188:191], v22 offset:17152
  s_cmp_eq_u32 s55, 16
  s_cbranch_scc0 Lsw_48
  v_mov_b32 v216, 0
  v_mov_b32 v217, 0
  v_mov_b32 v218, 0
  v_mov_b32 v219, 0
Lsw_48:
  s_waitcnt lgkmcnt(1)
  s_nop 0
  v_mfma_f32_16x16x32_bf16 v[136:139], v[128:131], v[52:55], v[216:219]
  v_exp_f32 v152, v152
  v_exp_f32 v153, v153
  v_exp_f32 v154, v154
  v_exp_f32 v155, v155
  v_mfma_f32_16x16x32_bf16 v[144:147], v[128:131], v[58:61], v[216:219]
  buffer_load_dwordx4 a[124:127], v4, s[28:31], s59 offen offset:1024 sc1
  v_exp_f32 v156, v156
  v_exp_f32 v157, v157
  v_exp_f32 v158, v158
  v_mfma_f32_16x16x32_bf16 v[148:151], v[132:135], v[60:63], v[216:219]
  v_exp_f32 v159, v159
  buffer_load_dwordx4 a[128:131], v4, s[28:31], s59 offen offset:2048 sc1
  v_cvt_pk_bf16_f32 v176, v152, v153
  v_cvt_pk_bf16_f32 v177, v154, v155
  v_mfma_f32_16x16x32_bf16 v[192:195], v[184:187], v[168:171], v[192:195]
  v_cvt_pk_bf16_f32 v178, v156, v157
  v_cvt_pk_bf16_f32 v179, v158, v159
  v_exp_f32 v160, v160
  v_exp_f32 v161, v161
  v_mfma_f32_16x16x32_bf16 v[200:203], a[24:27], v[168:171], v[200:203]
  v_exp_f32 v162, v162
  v_exp_f32 v163, v163
  buffer_load_dwordx4 a[132:135], v4, s[28:31], s59 offen offset:3072 sc1
  v_exp_f32 v164, v164
  v_mfma_f32_16x16x32_bf16 v[196:199], v[184:187], v[172:175], v[196:199]
  v_exp_f32 v165, v165
  v_exp_f32 v166, v166
  v_exp_f32 v167, v167
  v_cvt_pk_bf16_f32 v180, v160, v161
  v_mfma_f32_16x16x32_bf16 v[204:207], a[24:27], v[172:175], v[204:207]
  v_cvt_pk_bf16_f32 v181, v162, v163
  v_cvt_pk_bf16_f32 v182, v164, v165
  v_cvt_pk_bf16_f32 v183, v166, v167
  ds_read_b128 v[184:187], v22 offset:19456
  s_waitcnt lgkmcnt(1)
  v_mfma_f32_16x16x32_bf16 v[192:195], v[188:191], v[176:179], v[192:195]
  v_cndmask_b32 v136, v136, v25, s[60:61]
  v_cndmask_b32 v137, v137, v25, s[62:63]
  v_cndmask_b32 v138, v138, v25, s[64:65]
  v_cndmask_b32 v139, v139, v25, s[66:67]
  v_exp_f32 v136, v136
  v_exp_f32 v137, v137
  v_exp_f32 v138, v138
  v_exp_f32 v139, v139
  v_mfma_f32_16x16x32_bf16 v[200:203], a[28:31], v[176:179], v[200:203]
  s_add_u32 s59, s71, 24576
  buffer_load_dwordx4 a[136:139], v4, s[28:31], s59 offen offset:0 sc1
  buffer_load_dwordx4 a[140:143], v4, s[28:31], s59 offen offset:1024 sc1
  v_cvt_pk_bf16_f32 v168, v136, v137
  v_cvt_pk_bf16_f32 v169, v138, v139
  v_mov_b32 v170, 0
  v_mov_b32 v171, 0
  v_exp_f32 v144, v144
  v_exp_f32 v145, v145
  v_mfma_f32_16x16x32_bf16 v[196:199], v[188:191], v[180:183], v[196:199]
  v_exp_f32 v146, v146
  v_exp_f32 v147, v147
  buffer_load_dwordx4 a[144:147], v4, s[28:31], s59 offen offset:2048 sc1
  v_cndmask_b32 v148, v148, v25, s[60:61]
  v_cndmask_b32 v149, v149, v25, s[62:63]
  v_cndmask_b32 v150, v150, v25, s[64:65]
  v_cndmask_b32 v151, v151, v25, s[66:67]
  v_exp_f32 v148, v148
  v_mfma_f32_16x16x32_bf16 v[204:207], a[28:31], v[180:183], v[204:207]
  v_exp_f32 v149, v149
  v_exp_f32 v150, v150
  v_exp_f32 v151, v151
  v_cvt_pk_bf16_f32 v172, v144, v145
  v_cvt_pk_bf16_f32 v173, v146, v147
  v_cvt_pk_bf16_f32 v174, v148, v149
  v_cvt_pk_bf16_f32 v175, v150, v151
  s_waitcnt lgkmcnt(0)
  v_mfma_f32_16x16x32_bf16 v[192:195], v[184:187], v[168:171], v[192:195]
  v_mfma_f32_16x16x32_bf16 v[200:203], a[32:35], v[168:171], v[200:203]
  v_mfma_f32_16x16x32_bf16 v[196:199], v[184:187], v[172:175], v[196:199]
  v_mfma_f32_16x16x32_bf16 v[204:207], a[32:35], v[172:175], v[204:207]
  s_mul_i32 s54, s53, 18432
  s_add_u32 s54, s54, 7667712
  s_lshl_b32 s46, s51, 10
  s_add_u32 s58, s46, s54
  s_add_u32 s59, s58, 18432
  s_lshr_b32 s46, s51, 3
  s_add_u32 s46, s46, 16
  s_lshl_b32 s46, s46, 10
  s_add_u32 s54, s54, s46
  s_and_b32 s46, s51, 7
  s_lshr_b32 s46, s46, 1
  s_lshl_b32 s46, s46, 8
  s_add_u32 s54, s54, s46
  s_and_b32 s46, s51, 1
  s_lshl_b32 s46, s46, 3
  s_add_u32 s54, s54, s46
  s_add_u32 s47, s54, 18432
  v_rcp_f32 v30, v203
  v_rcp_f32 v31, v207
  v_mul_f32 v192, v192, v30
  v_mul_f32 v193, v193, v30
  v_mul_f32 v194, v194, v30
  v_mul_f32 v195, v195, v30
  v_mul_f32 v200, v200, v30
  v_mul_f32 v201, v201, v30
  v_mul_f32 v196, v196, v31
  v_mul_f32 v197, v197, v31
  v_mul_f32 v198, v198, v31
  v_mul_f32 v199, v199, v31
  v_mul_f32 v204, v204, v31
  v_mul_f32 v205, v205, v31
  v_cvt_pk_bf16_f32 v210, v192, v193
  v_cvt_pk_bf16_f32 v211, v194, v195
  v_cvt_pk_bf16_f32 v33, v200, v201
  v_cvt_pk_bf16_f32 v214, v196, v197
  v_cvt_pk_bf16_f32 v215, v198, v199
  v_cvt_pk_bf16_f32 v35, v204, v205
  s_branch L_p2_out
L_p2_slow:
  ds_read_b128 v[66:69], v20 offset:0
  ds_read_b64 v[64:65], v21 offset:0
  ds_read_b64 v[70:71], v21 offset:8
  ds_read_b128 v[74:77], v20 offset:2304
  ds_read_b64 v[72:73], v21 offset:2304
  ds_read_b64 v[78:79], v21 offset:2312
  ds_read_b128 v[82:85], v20 offset:4608
  ds_read_b64 v[80:81], v21 offset:4608
  ds_read_b64 v[86:87], v21 offset:4616
  v_mov_b32 v16, v25
  v_mov_b32 v17, v25
  v_mov_b32 v26, v25
  v_mov_b32 v27, v25
  v_mov_b32 v28, v25
  v_mov_b32 v29, v25
  s_cmp_eq_u32 s55, 0
  s_cbranch_scc0 Lsw_49
  v_mov_b32 v26, 0
  v_mov_b32 v27, 0
  v_mov_b32 v28, 0
  v_mov_b32 v29, 0
Lsw_49:
  s_waitcnt lgkmcnt(6)
  s_nop 0
  v_mfma_f32_16x16x32_bf16 v[136:139], v[64:67], v[40:43], v[26:29]
  ds_read_b128 v[90:93], v20 offset:6912
  ds_read_b64 v[88:89], v21 offset:6912
  ds_read_b64 v[94:95], v21 offset:6920
  v_mfma_f32_16x16x32_bf16 v[144:147], v[68:71], v[42:45], v[26:29]
  v_mfma_f32_16x16x32_bf16 v[148:151], v[68:71], v[48:51], v[26:29]
  s_cmp_eq_u32 s55, 2
  s_cbranch_scc0 Lsw_50
  s_nop 0
  v_mov_b32 v26, 0
  v_mov_b32 v27, 0
  v_mov_b32 v28, 0
  v_mov_b32 v29, 0
Lsw_50:
  s_waitcnt lgkmcnt(6)
  s_nop 0
  v_mfma_f32_16x16x32_bf16 v[152:155], v[72:75], v[40:43], v[26:29]
  ds_read_b128 v[98:101], v20 offset:9216
  ds_read_b64 v[96:97], v21 offset:9216
  ds_read_b64 v[102:103], v21 offset:9224
  v_cndmask_b32 v136, v25, v136, s[60:61]
  v_cndmask_b32 v137, v25, v137, s[62:63]
  v_mfma_f32_16x16x32_bf16 v[156:159], v[72:75], v[46:49], v[26:29]
  v_cndmask_b32 v138, v25, v138, s[64:65]
  v_cndmask_b32 v139, v25, v139, s[66:67]
  v_max3_f32 v16, v136, v137, v16
  v_max3_f32 v16, v138, v139, v16
  v_mfma_f32_16x16x32_bf16 v[136:139], v[76:79], v[42:45], v[26:29]
  v_max3_f32 v16, v144, v145, v16
  v_cndmask_b32 v148, v25, v148, s[60:61]
  v_cndmask_b32 v149, v25, v149, s[62:63]
  v_cndmask_b32 v150, v25, v150, s[64:65]
  v_mfma_f32_16x16x32_bf16 v[140:143], v[76:79], v[48:51], v[26:29]
  v_cndmask_b32 v151, v25, v151, s[66:67]
  v_max3_f32 v17, v148, v149, v17
  v_max3_f32 v16, v146, v147, v16
  v_max3_f32 v17, v150, v151, v17
  s_cmp_eq_u32 s55, 4
  s_cbranch_scc0 Lsw_51
  v_mov_b32 v26, 0
  v_mov_b32 v27, 0
  v_mov_b32 v28, 0
  v_mov_b32 v29, 0
Lsw_51:
  s_waitcnt lgkmcnt(6)
  s_nop 0
  v_mfma_f32_16x16x32_bf16 v[144:147], v[80:83], v[40:43], v[26:29]
  ds_read_b128 v[106:109], v20 offset:11520
  ds_read_b64 v[104:105], v21 offset:11520
  ds_read_b64 v[110:111], v21 offset:11528
  v_max3_f32 v16, v152, v153, v16
  v_mfma_f32_16x16x32_bf16 v[148:151], v[80:83], v[46:49], v[26:29]
  v_max3_f32 v17, v156, v157, v17
  v_max3_f32 v16, v154, v155, v16
  v_max3_f32 v17, v158, v159, v17
  v_mfma_f32_16x16x32_bf16 v[152:155], v[84:87], v[42:45], v[26:29]
  v_max3_f32 v16, v136, v137, v16
  v_max3_f32 v17, v140, v141, v17
  v_mfma_f32_16x16x32_bf16 v[156:159], v[84:87], v[48:51], v[26:29]
  v_max3_f32 v16, v138, v139, v16
  v_max3_f32 v17, v142, v143, v17
  s_cmp_eq_u32 s55, 6
  s_cbranch_scc0 Lsw_52
  v_mov_b32 v26, 0
  v_mov_b32 v27, 0
  v_mov_b32 v28, 0
  v_mov_b32 v29, 0
Lsw_52:
  s_waitcnt lgkmcnt(6)
  s_nop 0
  v_mfma_f32_16x16x32_bf16 v[136:139], v[88:91], v[40:43], v[26:29]
  ds_read_b128 v[114:117], v20 offset:13824
  ds_read_b64 v[112:113], v21 offset:13824
  ds_read_b64 v[118:119], v21 offset:13832
  v_max3_f32 v16, v144, v145, v16
  v_mfma_f32_16x16x32_bf16 v[140:143], v[88:91], v[46:49], v[26:29]
  v_max3_f32 v17, v148, v149, v17
  v_max3_f32 v16, v146, v147, v16
  v_max3_f32 v17, v150, v151, v17
  v_mfma_f32_16x16x32_bf16 v[144:147], v[92:95], v[42:45], v[26:29]
  v_max3_f32 v16, v152, v153, v16
  v_max3_f32 v17, v156, v157, v17
  v_mfma_f32_16x16x32_bf16 v[148:151], v[92:95], v[48:51], v[26:29]
  v_max3_f32 v16, v154, v155, v16
  v_max3_f32 v17, v158, v159, v17
  s_cmp_eq_u32 s55, 8
  s_cbranch_scc0 Lsw_53
  v_mov_b32 v26, 0
  v_mov_b32 v27, 0
  v_mov_b32 v28, 0
  v_mov_b32 v29, 0
Lsw_53:
  s_waitcnt lgkmcnt(6)
  s_nop 0
  v_mfma_f32_16x16x32_bf16 v[152:155], v[96:99], v[40:43], v[26:29]
  ds_read_b128 v[122:125], v20 offset:16128
  ds_read_b64 v[120:121], v21 offset:16128
  ds_read_b64 v[126:127], v21 offset:16136
  v_max3_f32 v16, v136, v137, v16
  v_mfma_f32_16x16x32_bf16 v[156:159], v[96:99], v[46:49], v[26:29]
  v_max3_f32 v17, v140, v141, v17
  v_max3_f32 v16, v138, v139, v16
  v_max3_f32 v17, v142, v143, v17
  v_mfma_f32_16x16x32_bf16 v[136:139], v[100:103], v[42:45], v[26:29]
  v_max3_f32 v16, v144, v145, v16
  v_max3_f32 v17, v148, v149, v17
  v_mfma_f32_16x16x32_bf16 v[140:143], v[100:103], v[48:51], v[26:29]
  v_max3_f32 v16, v146, v147, v16
  v_max3_f32 v17, v150, v151, v17
  s_cmp_eq_u32 s55, 10
  s_cbranch_scc0 Lsw_54
  v_mov_b32 v26, 0
  v_mov_b32 v27, 0
  v_mov_b32 v28, 0
  v_mov_b32 v29, 0
Lsw_54:
  s_waitcnt lgkmcnt(6)
  s_nop 0
  v_mfma_f32_16x16x32_bf16 v[144:147], v[104:107], v[40:43], v[26:29]
  ds_read_b128 v[130:133], v20 offset:18432
  ds_read_b64 v[128:129], v21 offset:18432
  ds_read_b64 v[134:135], v21 offset:18440
  v_max3_f32 v16, v152, v153, v16
  v_mfma_f32_16x16x32_bf16 v[148:151], v[104:107], v[46:49], v[26:29]
  v_max3_f32 v17, v156, v157, v17
  v_max3_f32 v16, v154, v155, v16
  v_max3_f32 v17, v158, v159, v17
  v_mfma_f32_16x16x32_bf16 v[152:155], v[108:111], v[42:45], v[26:29]
  v_max3_f32 v16, v136, v137, v16
  v_max3_f32 v17, v140, v141, v17
  v_mfma_f32_16x16x32_bf16 v[156:159], v[108:111], v[48:51], v[26:29]
  v_max3_f32 v16, v138, v139, v16
  v_max3_f32 v17, v142, v143, v17
  s_cmp_eq_u32 s55, 12
  s_cbranch_scc0 Lsw_55
  v_mov_b32 v26, 0
  v_mov_b32 v27, 0
  v_mov_b32 v28, 0
  v_mov_b32 v29, 0
Lsw_55:
  s_waitcnt lgkmcnt(6)
  s_nop 0
  v_mfma_f32_16x16x32_bf16 v[136:139], v[112:115], v[40:43], v[26:29]
  v_max3_f32 v16, v144, v145, v16
  v_max3_f32 v17, v148, v149, v17
  v_mfma_f32_16x16x32_bf16 v[140:143], v[112:115], v[46:49], v[26:29]
  v_max3_f32 v16, v146, v147, v16
  v_max3_f32 v17, v150, v151, v17
  v_mfma_f32_16x16x32_bf16 v[144:147], v[116:119], v[42:45], v[26:29]
  v_max3_f32 v16, v152, v153, v16
  v_max3_f32 v17, v156, v157, v17
  v_mfma_f32_16x16x32_bf16 v[148:151], v[116:119], v[48:51], v[26:29]
  v_max3_f32 v16, v154, v155, v16
  v_max3_f32 v17, v158, v159, v17
  s_cmp_eq_u32 s55, 14
  s_cbranch_scc0 Lsw_56
  v_mov_b32 v26, 0
  v_mov_b32 v27, 0
  v_mov_b32 v28, 0
  v_mov_b32 v29, 0
Lsw_56:
  s_waitcnt lgkmcnt(3)
  s_nop 0
  v_mfma_f32_16x16x32_bf16 v[152:155], v[120:123], v[40:43], v[26:29]
  v_max3_f32 v16, v136, v137, v16
  v_max3_f32 v17, v140, v141, v17
  v_mfma_f32_16x16x32_bf16 v[156:159], v[120:123], v[46:49], v[26:29]
  v_max3_f32 v16, v138, v139, v16
  v_max3_f32 v17, v142, v143, v17
  v_mfma_f32_16x16x32_bf16 v[136:139], v[124:127], v[42:45], v[26:29]
  v_max3_f32 v16, v144, v145, v16
  v_max3_f32 v17, v148, v149, v17
  v_mfma_f32_16x16x32_bf16 v[140:143], v[124:127], v[48:51], v[26:29]
  v_max3_f32 v16, v146, v147, v16
  v_max3_f32 v17, v150, v151, v17
  s_cmp_eq_u32 s55, 16
  s_cbranch_scc0 Lsw_57
  v_mov_b32 v26, 0
  v_mov_b32 v27, 0
  v_mov_b32 v28, 0
  v_mov_b32 v29, 0
Lsw_57:
  s_waitcnt lgkmcnt(0)
  s_nop 0
  v_mfma_f32_16x16x32_bf16 v[144:147], v[128:131], v[40:43], v[26:29]
  v_max3_f32 v16, v152, v153, v16
  v_max3_f32 v17, v156, v157, v17
  v_mfma_f32_16x16x32_bf16 v[148:151], v[128:131], v[46:49], v[26:29]
  v_max3_f32 v16, v154, v155, v16
  v_max3_f32 v17, v158, v159, v17
  v_mfma_f32_16x16x32_bf16 v[156:159], v[132:135], v[48:51], v[26:29]
  v_max3_f32 v16, v136, v137, v16
  v_max3_f32 v17, v140, v141, v17
  v_max3_f32 v16, v138, v139, v16
  v_max3_f32 v17, v142, v143, v17
  s_waitcnt vmcnt(0)
  s_barrier
  buffer_store_dwordx4 v[228:231], v4, s[28:31], s56 offen offset:0 sc1
  buffer_store_dwordx4 v[228:231], v4, s[28:31], s56 offen offset:1024 sc1
  buffer_store_dwordx4 v[228:231], v4, s[28:31], s56 offen offset:2048 sc1
  buffer_store_dwordx4 v[228:231], v4, s[28:31], s56 offen offset:3072 sc1
  s_add_u32 s56, s56, 4096
  buffer_store_dwordx4 v[228:231], v4, s[28:31], s56 offen offset:0 sc1
  s_mov_b32 s46, 520192
  buffer_load_dword v224, v225, s[28:31], s46 offen sc1
  s_mov_b32 exec_lo, 0x00030003
  s_mov_b32 exec_hi, 0x00030003
  ds_read_b128 a[0:3], v23 offset:0
  ds_read_b128 a[4:7], v23 offset:2304
  ds_read_b128 a[8:11], v23 offset:4608
  ds_read_b128 a[12:15], v23 offset:6912
  ds_read_b128 a[16:19], v23 offset:9216
  ds_read_b128 a[20:23], v23 offset:11520
  ds_read_b128 a[24:27], v23 offset:13824
  ds_read_b128 a[28:31], v23 offset:16128
  ds_read_b128 a[32:35], v23 offset:18432
  s_mov_b64 exec, -1
  ds_read_b128 v[184:187], v22 offset:0
  v_cndmask_b32 v144, v144, v25, s[60:61]
  v_cndmask_b32 v145, v145, v25, s[62:63]
  v_cndmask_b32 v146, v146, v25, s[64:65]
  v_cndmask_b32 v147, v147, v25, s[66:67]
  v_max3_f32 v16, v144, v145, v16
  v_max3_f32 v17, v148, v149, v17
  v_max3_f32 v16, v146, v147, v16
  v_max3_f32 v17, v150, v151, v17
  v_cndmask_b32 v156, v156, v25, s[60:61]
  v_cndmask_b32 v157, v157, v25, s[62:63]
  v_cndmask_b32 v158, v158, v25, s[64:65]
  v_cndmask_b32 v159, v159, v25, s[66:67]
  v_max3_f32 v17, v156, v157, v17
  v_max3_f32 v17, v158, v159, v17
  v_mov_b32 v30, v16
  v_mov_b32 v31, v17
  s_nop 0
  v_permlane32_swap_b32 v16, v30
  v_permlane32_swap_b32 v17, v31
  v_max_f32 v16, v16, v30
  v_max_f32 v17, v17, v31
  v_mov_b32 v30, v16
  v_mov_b32 v31, v17
  s_nop 0
  v_permlane16_swap_b32 v16, v30
  v_permlane16_swap_b32 v17, v31
  v_max_f32 v16, v16, v30
  v_max_f32 v17, v17, v31
  v_mov_b32 v216, v25
  v_mov_b32 v217, v25
  v_mov_b32 v218, v25
  v_mov_b32 v219, v25
  v_mov_b32 v220, v25
  v_mov_b32 v221, v25
  v_mov_b32 v222, v25
  v_mov_b32 v223, v25
  s_cmp_eq_u32 s55, 0
  s_cbranch_scc0 Lsw_58
  v_sub_f32 v216, 0, v16
  v_sub_f32 v217, 0, v16
  v_sub_f32 v218, 0, v16
  v_sub_f32 v219, 0, v16
  v_sub_f32 v220, 0, v17
  v_sub_f32 v221, 0, v17
  v_sub_f32 v222, 0, v17
  v_sub_f32 v223, 0, v17
Lsw_58:
  v_mfma_f32_16x16x32_bf16 v[136:139], v[64:67], v[40:43], v[216:219]
  v_mfma_f32_16x16x32_bf16 v[140:143], v[68:71], v[42:45], v[216:219]
  v_mfma_f32_16x16x32_bf16 v[148:151], v[68:71], v[48:51], v[220:223]
  s_cmp_eq_u32 s55, 2
  s_nop 2
  s_cbranch_scc0 Lsw_59
  v_sub_f32 v216, 0, v16
  v_sub_f32 v217, 0, v16
  v_sub_f32 v218, 0, v16
  v_sub_f32 v219, 0, v16
  v_sub_f32 v220, 0, v17
  v_sub_f32 v221, 0, v17
  v_sub_f32 v222, 0, v17
  v_sub_f32 v223, 0, v17
Lsw_59:
  v_mfma_f32_16x16x32_bf16 v[152:155], v[72:75], v[40:43], v[216:219]
  v_cndmask_b32 v136, v25, v136, s[60:61]
  v_cndmask_b32 v137, v25, v137, s[62:63]
  v_cndmask_b32 v138, v25, v138, s[64:65]
  v_cndmask_b32 v139, v25, v139, s[66:67]
  v_exp_f32 v136, v136
  v_exp_f32 v137, v137
  v_exp_f32 v138, v138
  v_exp_f32 v139, v139
  v_mfma_f32_16x16x32_bf16 v[156:159], v[76:79], v[42:45], v[216:219]
  s_mul_i32 s58, s79, 0
  s_add_u32 s58, s58, s73
  s_mov_b32 m0, s58
  s_nop 0
  buffer_load_dwordx4 v246, s[36:39], s3 offen offset:2048 sc1 lds
  s_add_u32 m0, m0, 3072
  v_exp_f32 v140, v140
  v_exp_f32 v141, v141
  v_exp_f32 v142, v142
  v_exp_f32 v143, v143
  buffer_load_dwordx4 v247, s[36:39], s3 offen offset:0 sc1 lds
  v_cvt_pk_bf16_f32 v168, v136, v137
  v_cvt_pk_bf16_f32 v169, v138, v139
  v_mfma_f32_16x16x32_bf16 v[160:163], v[72:75], v[46:49], v[220:223]
  v_cvt_pk_bf16_f32 v170, v140, v141
  v_cvt_pk_bf16_f32 v171, v142, v143
  buffer_load_dwordx4 v248, s[36:39], s3 offen offset:1024 sc1 lds
  v_cndmask_b32 v148, v25, v148, s[60:61]
  v_cndmask_b32 v149, v25, v149, s[62:63]
  v_cndmask_b32 v150, v25, v150, s[64:65]
  v_cndmask_b32 v151, v25, v151, s[66:67]
  v_exp_f32 v148, v148
  v_mfma_f32_16x16x32_bf16 v[164:167], v[76:79], v[48:51], v[220:223]
  v_exp_f32 v149, v149
  v_exp_f32 v150, v150
  v_exp_f32 v151, v151
  v_mov_b32 v172, 0
  v_mov_b32 v173, 0
  v_cvt_pk_bf16_f32 v174, v148, v149
  v_cvt_pk_bf16_f32 v175, v150, v151
  ds_read_b128 v[188:191], v22 offset:2304
  s_cmp_eq_u32 s55, 4
  s_cbranch_scc0 Lsw_60
  v_sub_f32 v216, 0, v16
  v_sub_f32 v217, 0, v16
  v_sub_f32 v218, 0, v16
  v_sub_f32 v219, 0, v16
  v_sub_f32 v220, 0, v17
  v_sub_f32 v221, 0, v17
  v_sub_f32 v222, 0, v17
  v_sub_f32 v223, 0, v17
Lsw_60:
  s_waitcnt lgkmcnt(1)
  v_mfma_f32_16x16x32_bf16 v[136:139], v[80:83], v[40:43], v[216:219]
  v_exp_f32 v152, v152
  v_exp_f32 v153, v153
  v_exp_f32 v154, v154
  v_exp_f32 v155, v155
  v_mfma_f32_16x16x32_bf16 v[140:143], v[84:87], v[42:45], v[216:219]
  buffer_load_dwordx4 v249, s[36:39], s3 offen offset:2048 sc1 lds
  s_add_u32 m0, m0, 3072
  v_exp_f32 v156, v156
  v_exp_f32 v157, v157
  v_mfma_f32_16x16x32_bf16 v[144:147], v[80:83], v[46:49], v[220:223]
  v_exp_f32 v158, v158
  v_exp_f32 v159, v159
  buffer_load_dwordx4 v250, s[36:39], s3 offen offset:0 sc1 lds
  v_cvt_pk_bf16_f32 v176, v152, v153
  v_mfma_f32_16x16x32_bf16 v[148:151], v[84:87], v[48:51], v[220:223]
  v_cvt_pk_bf16_f32 v177, v154, v155
  v_cvt_pk_bf16_f32 v178, v156, v157
  v_cvt_pk_bf16_f32 v179, v158, v159
  v_mfma_f32_16x16x32_bf16 v[192:195], v[184:187], v[168:171], 0
  v_exp_f32 v160, v160
  v_exp_f32 v161, v161
  v_exp_f32 v162, v162
  v_mfma_f32_16x16x32_bf16 v[200:203], a[0:3], v[168:171], 0
  v_exp_f32 v163, v163
  buffer_load_dwordx4 v251, s[36:39], s3 offen offset:1024 sc1 lds
  v_exp_f32 v164, v164
  v_exp_f32 v165, v165
  v_mfma_f32_16x16x32_bf16 v[196:199], v[184:187], v[172:175], 0
  v_exp_f32 v166, v166
  v_exp_f32 v167, v167
  v_cvt_pk_bf16_f32 v180, v160, v161
  v_mfma_f32_16x16x32_bf16 v[204:207], a[0:3], v[172:175], 0
  v_cvt_pk_bf16_f32 v181, v162, v163
  v_cvt_pk_bf16_f32 v182, v164, v165
  v_cvt_pk_bf16_f32 v183, v166, v167
  ds_read_b128 v[184:187], v22 offset:4608
  s_cmp_eq_u32 s55, 6
  s_cbranch_scc0 Lsw_61
  v_sub_f32 v216, 0, v16
  v_sub_f32 v217, 0, v16
  v_sub_f32 v218, 0, v16
  v_sub_f32 v219, 0, v16
  v_sub_f32 v220, 0, v17
  v_sub_f32 v221, 0, v17
  v_sub_f32 v222, 0, v17
  v_sub_f32 v223, 0, v17
Lsw_61:
  s_waitcnt lgkmcnt(1)
  v_mfma_f32_16x16x32_bf16 v[152:155], v[88:91], v[40:43], v[216:219]
  v_exp_f32 v136, v136
  v_exp_f32 v137, v137
  v_exp_f32 v138, v138
  v_exp_f32 v139, v139
  v_mfma_f32_16x16x32_bf16 v[156:159], v[92:95], v[42:45], v[216:219]
  buffer_load_dwordx4 v252, s[36:39], s3 offen offset:2048 sc1 lds
  v_exp_f32 v140, v140
  v_exp_f32 v141, v141
  v_mfma_f32_16x16x32_bf16 v[160:163], v[88:91], v[46:49], v[220:223]
  v_exp_f32 v142, v142
  v_exp_f32 v143, v143
  s_mul_i32 s58, s79, 1
  s_add_u32 s58, s58, s73
  s_mov_b32 m0, s58
  s_nop 0
  buffer_load_dwordx4 v244, s[36:39], s27 offen offset:0 sc1 lds
  v_cvt_pk_bf16_f32 v168, v136, v137
  v_mfma_f32_16x16x32_bf16 v[164:167], v[92:95], v[48:51], v[220:223]
  v_cvt_pk_bf16_f32 v169, v138, v139
  v_cvt_pk_bf16_f32 v170, v140, v141
  v_cvt_pk_bf16_f32 v171, v142, v143
  v_mfma_f32_16x16x32_bf16 v[192:195], v[188:191], v[176:179], v[192:195]
  v_exp_f32 v144, v144
  v_exp_f32 v145, v145
  v_exp_f32 v146, v146
  v_mfma_f32_16x16x32_bf16 v[200:203], a[4:7], v[176:179], v[200:203]
  v_exp_f32 v147, v147
  buffer_load_dwordx4 v245, s[36:39], s27 offen offset:1024 sc1 lds
  v_exp_f32 v148, v148
  v_exp_f32 v149, v149
  v_mfma_f32_16x16x32_bf16 v[196:199], v[188:191], v[180:183], v[196:199]
  v_exp_f32 v150, v150
  v_exp_f32 v151, v151
  v_cvt_pk_bf16_f32 v172, v144, v145
  v_mfma_f32_16x16x32_bf16 v[204:207], a[4:7], v[180:183], v[204:207]
  v_cvt_pk_bf16_f32 v173, v146, v147
  v_cvt_pk_bf16_f32 v174, v148, v149
  v_cvt_pk_bf16_f32 v175, v150, v151
  ds_read_b128 v[188:191], v22 offset:6912
  s_cmp_eq_u32 s55, 8
  s_cbranch_scc0 Lsw_62
  v_sub_f32 v216, 0, v16
  v_sub_f32 v217, 0, v16
  v_sub_f32 v218, 0, v16
  v_sub_f32 v219, 0, v16
  v_sub_f32 v220, 0, v17
  v_sub_f32 v221, 0, v17
  v_sub_f32 v222, 0, v17
  v_sub_f32 v223, 0, v17
Lsw_62:
  s_waitcnt lgkmcnt(1)
  v_mfma_f32_16x16x32_bf16 v[136:139], v[96:99], v[40:43], v[216:219]
  v_exp_f32 v152, v152
  v_exp_f32 v153, v153
  v_exp_f32 v154, v154
  v_exp_f32 v155, v155
  v_mfma_f32_16x16x32_bf16 v[140:143], v[100:103], v[42:45], v[216:219]
  buffer_load_dwordx4 v246, s[36:39], s27 offen offset:2048 sc1 lds
  s_add_u32 m0, m0, 3072
  v_exp_f32 v156, v156
  v_exp_f32 v157, v157
  v_mfma_f32_16x16x32_bf16 v[144:147], v[96:99], v[46:49], v[220:223]
  v_exp_f32 v158, v158
  v_exp_f32 v159, v159
  buffer_load_dwordx4 v247, s[36:39], s27 offen offset:0 sc1 lds
  v_cvt_pk_bf16_f32 v176, v152, v153
  v_mfma_f32_16x16x32_bf16 v[148:151], v[100:103], v[48:51], v[220:223]
  v_cvt_pk_bf16_f32 v177, v154, v155
  v_cvt_pk_bf16_f32 v178, v156, v157
  v_cvt_pk_bf16_f32 v179, v158, v159
  v_mfma_f32_16x16x32_bf16 v[192:195], v[184:187], v[168:171], v[192:195]
  v_exp_f32 v160, v160
  v_exp_f32 v161, v161
  v_exp_f32 v162, v162
  v_mfma_f32_16x16x32_bf16 v[200:203], a[8:11], v[168:171], v[200:203]
  v_exp_f32 v163, v163
  buffer_load_dwordx4 v248, s[36:39], s27 offen offset:1024 sc1 lds
  v_exp_f32 v164, v164
  v_exp_f32 v165, v165
  v_mfma_f32_16x16x32_bf16 v[196:199], v[184:187], v[172:175], v[196:199]
  v_exp_f32 v166, v166
  v_exp_f32 v167, v167
  v_cvt_pk_bf16_f32 v180, v160, v161
  v_mfma_f32_16x16x32_bf16 v[204:207], a[8:11], v[172:175], v[204:207]
  v_cvt_pk_bf16_f32 v181, v162, v163
  v_cvt_pk_bf16_f32 v182, v164, v165
  v_cvt_pk_bf16_f32 v183, v166, v167
  ds_read_b128 v[184:187], v22 offset:9216
  s_cmp_eq_u32 s55, 10
  s_cbranch_scc0 Lsw_63
  v_sub_f32 v216, 0, v16
  v_sub_f32 v217, 0, v16
  v_sub_f32 v218, 0, v16
  v_sub_f32 v219, 0, v16
  v_sub_f32 v220, 0, v17
  v_sub_f32 v221, 0, v17
  v_sub_f32 v222, 0, v17
  v_sub_f32 v223, 0, v17
Lsw_63:
  s_waitcnt lgkmcnt(1)
  v_mfma_f32_16x16x32_bf16 v[152:155], v[104:107], v[40:43], v[216:219]
  v_exp_f32 v136, v136
  v_exp_f32 v137, v137
  v_exp_f32 v138, v138
  v_exp_f32 v139, v139
  v_mfma_f32_16x16x32_bf16 v[156:159], v[108:111], v[42:45], v[216:219]
  buffer_load_dwordx4 v249, s[36:39], s27 offen offset:2048 sc1 lds
  s_add_u32 m0, m0, 3072
  v_exp_f32 v140, v140
  v_exp_f32 v141, v141
  v_mfma_f32_16x16x32_bf16 v[160:163], v[104:107], v[46:49], v[220:223]
  v_exp_f32 v142, v142
  v_exp_f32 v143, v143
  buffer_load_dwordx4 v250, s[36:39], s27 offen offset:0 sc1 lds
  v_cvt_pk_bf16_f32 v168, v136, v137
  v_mfma_f32_16x16x32_bf16 v[164:167], v[108:111], v[48:51], v[220:223]
  v_cvt_pk_bf16_f32 v169, v138, v139
  v_cvt_pk_bf16_f32 v170, v140, v141
  v_cvt_pk_bf16_f32 v171, v142, v143
  v_mfma_f32_16x16x32_bf16 v[192:195], v[188:191], v[176:179], v[192:195]
  v_exp_f32 v144, v144
  v_exp_f32 v145, v145
  v_exp_f32 v146, v146
  v_mfma_f32_16x16x32_bf16 v[200:203], a[12:15], v[176:179], v[200:203]
  v_exp_f32 v147, v147
  buffer_load_dwordx4 v251, s[36:39], s27 offen offset:1024 sc1 lds
  v_exp_f32 v148, v148
  v_exp_f32 v149, v149
  v_mfma_f32_16x16x32_bf16 v[196:199], v[188:191], v[180:183], v[196:199]
  v_exp_f32 v150, v150
  v_exp_f32 v151, v151
  v_cvt_pk_bf16_f32 v172, v144, v145
  v_mfma_f32_16x16x32_bf16 v[204:207], a[12:15], v[180:183], v[204:207]
  v_cvt_pk_bf16_f32 v173, v146, v147
  v_cvt_pk_bf16_f32 v174, v148, v149
  v_cvt_pk_bf16_f32 v175, v150, v151
  ds_read_b128 v[188:191], v22 offset:11520
  s_cmp_eq_u32 s55, 12
  s_cbranch_scc0 Lsw_64
  v_sub_f32 v216, 0, v16
  v_sub_f32 v217, 0, v16
  v_sub_f32 v218, 0, v16
  v_sub_f32 v219, 0, v16
  v_sub_f32 v220, 0, v17
  v_sub_f32 v221, 0, v17
  v_sub_f32 v222, 0, v17
  v_sub_f32 v223, 0, v17
Lsw_64:
  s_waitcnt lgkmcnt(1)
  v_mfma_f32_16x16x32_bf16 v[136:139], v[112:115], v[40:43], v[216:219]
  v_exp_f32 v152, v152
  v_exp_f32 v153, v153
  v_exp_f32 v154, v154
  v_exp_f32 v155, v155
  v_mfma_f32_16x16x32_bf16 v[140:143], v[116:119], v[42:45], v[216:219]
  buffer_load_dwordx4 v252, s[36:39], s27 offen offset:2048 sc1 lds
  v_exp_f32 v156, v156
  v_exp_f32 v157, v157
  v_mfma_f32_16x16x32_bf16 v[144:147], v[112:115], v[46:49], v[220:223]
  v_exp_f32 v158, v158
  v_exp_f32 v159, v159
  s_mul_i32 s58, s79, 2
  s_add_u32 s58, s58, s73
  s_mov_b32 m0, s58
  s_nop 0
  buffer_load_dwordx4 v244, s[36:39], s45 offen offset:0 sc1 lds
  v_cvt_pk_bf16_f32 v176, v152, v153
  v_mfma_f32_16x16x32_bf16 v[148:151], v[116:119], v[48:51], v[220:223]
  v_cvt_pk_bf16_f32 v177, v154, v155
  v_cvt_pk_bf16_f32 v178, v156, v157
  v_cvt_pk_bf16_f32 v179, v158, v159
  v_mfma_f32_16x16x32_bf16 v[192:195], v[184:187], v[168:171], v[192:195]
  v_exp_f32 v160, v160
  v_exp_f32 v161, v161
  v_exp_f32 v162, v162
  v_mfma_f32_16x16x32_bf16 v[200:203], a[16:19], v[168:171], v[200:203]
  v_exp_f32 v163, v163
  buffer_load_dwordx4 v245, s[36:39], s45 offen offset:1024 sc1 lds
  v_exp_f32 v164, v164
  v_exp_f32 v165, v165
  v_mfma_f32_16x16x32_bf16 v[196:199], v[184:187], v[172:175], v[196:199]
  v_exp_f32 v166, v166
  v_exp_f32 v167, v167
  v_cvt_pk_bf16_f32 v180, v160, v161
  v_mfma_f32_16x16x32_bf16 v[204:207], a[16:19], v[172:175], v[204:207]
  v_cvt_pk_bf16_f32 v181, v162, v163
  v_cvt_pk_bf16_f32 v182, v164, v165
  v_cvt_pk_bf16_f32 v183, v166, v167
  ds_read_b128 v[184:187], v22 offset:13824
  s_cmp_eq_u32 s55, 14
  s_cbranch_scc0 Lsw_65
  v_sub_f32 v216, 0, v16
  v_sub_f32 v217, 0, v16
  v_sub_f32 v218, 0, v16
  v_sub_f32 v219, 0, v16
  v_sub_f32 v220, 0, v17
  v_sub_f32 v221, 0, v17
  v_sub_f32 v222, 0, v17
  v_sub_f32 v223, 0, v17
Lsw_65:
  s_waitcnt lgkmcnt(1)
  v_mfma_f32_16x16x32_bf16 v[152:155], v[120:123], v[40:43], v[216:219]
  v_exp_f32 v136, v136
  v_exp_f32 v137, v137
  v_exp_f32 v138, v138
  v_exp_f32 v139, v139
  v_mfma_f32_16x16x32_bf16 v[156:159], v[124:127], v[42:45], v[216:219]
  buffer_load_dwordx4 v246, s[36:39], s45 offen offset:2048 sc1 lds
  s_add_u32 m0, m0, 3072
  v_exp_f32 v140, v140
  v_exp_f32 v141, v141
  v_mfma_f32_16x16x32_bf16 v[160:163], v[120:123], v[46:49], v[220:223]
  v_exp_f32 v142, v142
  v_exp_f32 v143, v143
  buffer_load_dwordx4 v247, s[36:39], s45 offen offset:0 sc1 lds
  v_cvt_pk_bf16_f32 v168, v136, v137
  v_mfma_f32_16x16x32_bf16 v[164:167], v[124:127], v[48:51], v[220:223]
  v_cvt_pk_bf16_f32 v169, v138, v139
  v_cvt_pk_bf16_f32 v170, v140, v141
  v_cvt_pk_bf16_f32 v171, v142, v143
  v_mfma_f32_16x16x32_bf16 v[192:195], v[188:191], v[176:179], v[192:195]
  v_exp_f32 v144, v144
  v_exp_f32 v145, v145
  v_exp_f32 v146, v146
  v_mfma_f32_16x16x32_bf16 v[200:203], a[20:23], v[176:179], v[200:203]
  v_exp_f32 v147, v147
  buffer_load_dwordx4 v248, s[36:39], s45 offen offset:1024 sc1 lds
  v_exp_f32 v148, v148
  v_exp_f32 v149, v149
  v_mfma_f32_16x16x32_bf16 v[196:199], v[188:191], v[180:183], v[196:199]
  v_exp_f32 v150, v150
  v_exp_f32 v151, v151
  v_cvt_pk_bf16_f32 v172, v144, v145
  v_mfma_f32_16x16x32_bf16 v[204:207], a[20:23], v[180:183], v[204:207]
  v_cvt_pk_bf16_f32 v173, v146, v147
  v_cvt_pk_bf16_f32 v174, v148, v149
  v_cvt_pk_bf16_f32 v175, v150, v151
  ds_read_b128 v[188:191], v22 offset:16128
  s_cmp_eq_u32 s55, 16
  s_cbranch_scc0 Lsw_66
  v_sub_f32 v216, 0, v16
  v_sub_f32 v217, 0, v16
  v_sub_f32 v218, 0, v16
  v_sub_f32 v219, 0, v16
  v_sub_f32 v220, 0, v17
  v_sub_f32 v221, 0, v17
  v_sub_f32 v222, 0, v17
  v_sub_f32 v223, 0, v17
Lsw_66:
  s_waitcnt lgkmcnt(1)
  v_mfma_f32_16x16x32_bf16 v[136:139], v[128:131], v[40:43], v[216:219]
  v_exp_f32 v152, v152
  v_exp_f32 v153, v153
  v_exp_f32 v154, v154
  v_exp_f32 v155, v155
  v_mfma_f32_16x16x32_bf16 v[144:147], v[128:131], v[46:49], v[220:223]
  buffer_load_dwordx4 v249, s[36:39], s45 offen offset:2048 sc1 lds
  s_add_u32 m0, m0, 3072
  v_exp_f32 v156, v156
  v_exp_f32 v157, v157
  v_exp_f32 v158, v158
  v_mfma_f32_16x16x32_bf16 v[148:151], v[132:135], v[48:51], v[220:223]
  v_exp_f32 v159, v159
  buffer_load_dwordx4 v250, s[36:39], s45 offen offset:0 sc1 lds
  v_cvt_pk_bf16_f32 v176, v152, v153
  v_cvt_pk_bf16_f32 v177, v154, v155
  v_mfma_f32_16x16x32_bf16 v[192:195], v[184:187], v[168:171], v[192:195]
  v_cvt_pk_bf16_f32 v178, v156, v157
  v_cvt_pk_bf16_f32 v179, v158, v159
  v_exp_f32 v160, v160
  v_exp_f32 v161, v161
  v_mfma_f32_16x16x32_bf16 v[200:203], a[24:27], v[168:171], v[200:203]
  v_exp_f32 v162, v162
  v_exp_f32 v163, v163
  buffer_load_dwordx4 v251, s[36:39], s45 offen offset:1024 sc1 lds
  v_exp_f32 v164, v164
  v_mfma_f32_16x16x32_bf16 v[196:199], v[184:187], v[172:175], v[196:199]
  v_exp_f32 v165, v165
  v_exp_f32 v166, v166
  v_exp_f32 v167, v167
  v_cvt_pk_bf16_f32 v180, v160, v161
  v_mfma_f32_16x16x32_bf16 v[204:207], a[24:27], v[172:175], v[204:207]
  v_cvt_pk_bf16_f32 v181, v162, v163
  v_cvt_pk_bf16_f32 v182, v164, v165
  v_cvt_pk_bf16_f32 v183, v166, v167
  ds_read_b128 v[184:187], v22 offset:18432
  s_waitcnt lgkmcnt(1)
  v_mfma_f32_16x16x32_bf16 v[192:195], v[188:191], v[176:179], v[192:195]
  v_cndmask_b32 v136, v136, v25, s[60:61]
  v_cndmask_b32 v137, v137, v25, s[62:63]
  v_cndmask_b32 v138, v138, v25, s[64:65]
  v_cndmask_b32 v139, v139, v25, s[66:67]
  v_exp_f32 v136, v136
  v_exp_f32 v137, v137
  v_exp_f32 v138, v138
  v_exp_f32 v139, v139
  v_mfma_f32_16x16x32_bf16 v[200:203], a[28:31], v[176:179], v[200:203]
  buffer_load_dwordx4 v252, s[36:39], s45 offen offset:2048 sc1 lds
  buffer_load_dwordx4 v[232:235], v7, s[32:35], s77 offen offset:0
  v_cvt_pk_bf16_f32 v168, v136, v137
  v_cvt_pk_bf16_f32 v169, v138, v139
  v_mov_b32 v170, 0
  v_mov_b32 v171, 0
  v_exp_f32 v144, v144
  v_exp_f32 v145, v145
  v_mfma_f32_16x16x32_bf16 v[196:199], v[188:191], v[180:183], v[196:199]
  v_exp_f32 v146, v146
  v_exp_f32 v147, v147
  buffer_load_dwordx4 v[236:239], v7, s[32:35], s77 offen offset:64
  v_cndmask_b32 v148, v148, v25, s[60:61]
  v_cndmask_b32 v149, v149, v25, s[62:63]
  v_cndmask_b32 v150, v150, v25, s[64:65]
  v_cndmask_b32 v151, v151, v25, s[66:67]
  v_exp_f32 v148, v148
  v_mfma_f32_16x16x32_bf16 v[204:207], a[28:31], v[180:183], v[204:207]
  v_exp_f32 v149, v149
  v_exp_f32 v150, v150
  v_exp_f32 v151, v151
  v_cvt_pk_bf16_f32 v172, v144, v145
  v_cvt_pk_bf16_f32 v173, v146, v147
  v_cvt_pk_bf16_f32 v174, v148, v149
  v_cvt_pk_bf16_f32 v175, v150, v151
  s_waitcnt lgkmcnt(0)
  v_mfma_f32_16x16x32_bf16 v[192:195], v[184:187], v[168:171], v[192:195]
  v_mfma_f32_16x16x32_bf16 v[200:203], a[32:35], v[168:171], v[200:203]
  v_mfma_f32_16x16x32_bf16 v[196:199], v[184:187], v[172:175], v[196:199]
  v_mfma_f32_16x16x32_bf16 v[204:207], a[32:35], v[172:175], v[204:207]
  s_nop 5
  v_rcp_f32 v30, v203
  s_nop 0
  v_rcp_f32 v31, v207
  v_mul_f32 v192, v192, v30
  v_mul_f32 v193, v193, v30
  v_mul_f32 v194, v194, v30
  v_mul_f32 v195, v195, v30
  v_mul_f32 v200, v200, v30
  v_mul_f32 v201, v201, v30
  v_mul_f32 v196, v196, v31
  v_mul_f32 v197, v197, v31
  v_mul_f32 v198, v198, v31
  v_mul_f32 v199, v199, v31
  v_mul_f32 v204, v204, v31
  v_mul_f32 v205, v205, v31
  v_cvt_pk_bf16_f32 v208, v192, v193
  v_cvt_pk_bf16_f32 v209, v194, v195
  v_cvt_pk_bf16_f32 v32, v200, v201
  v_cvt_pk_bf16_f32 v212, v196, v197
  v_cvt_pk_bf16_f32 v213, v198, v199
  v_cvt_pk_bf16_f32 v34, v204, v205
  s_cmp_lg_u32 s40, 0
  s_cbranch_scc1 Lmk_67_x
  s_mov_b32 s47, 100000
  s_waitcnt vmcnt(27)
Lmk_67:
  v_cmp_ne_u32 vcc, s43, v224
  s_cbranch_vccz Lmk_67_x
  s_sleep 2
  s_mov_b32 s46, 520192
  buffer_load_dword v224, v225, s[28:31], s46 offen sc1
  s_waitcnt vmcnt(0)
  s_sub_u32 s47, s47, 1
  s_cbranch_scc0 Lmk_67
Lmk_67_x:
  s_waitcnt vmcnt(20)
  s_barrier
  s_cmp_lg_u32 s40, 0
  s_cbranch_scc1 Lmp_68
  s_lshl_b32 s46, s2, 2
  s_add_u32 s46, s46, 521216
  v_mov_b32 v224, s43
  v_mov_b32 v225, 0
  s_mov_b64 exec, 1
  buffer_store_dword v224, v225, s[28:31], s46 offen sc1
  s_mov_b64 exec, -1
Lmp_68:
  ds_read_b128 v[66:69], v20 offset:1024
  ds_read_b128 v[74:77], v20 offset:3328
  ds_read_b128 v[82:85], v20 offset:5632
  v_mov_b32 v16, v25
  v_mov_b32 v17, v25
  v_mov_b32 v26, v25
  v_mov_b32 v27, v25
  v_mov_b32 v28, v25
  v_mov_b32 v29, v25
  s_cmp_eq_u32 s55, 0
  s_cbranch_scc0 Lsw_69
  v_mov_b32 v26, 0
  v_mov_b32 v27, 0
  v_mov_b32 v28, 0
  v_mov_b32 v29, 0
Lsw_69:
  s_waitcnt lgkmcnt(2)
  s_nop 0
  v_mfma_f32_16x16x32_bf16 v[136:139], v[64:67], v[52:55], v[26:29]
  ds_read_b128 v[90:93], v20 offset:7936
  v_mfma_f32_16x16x32_bf16 v[144:147], v[68:71], v[54:57], v[26:29]
  buffer_load_dwordx4 v[240:243], v7, s[32:35], s77 offen offset:128
  v_mfma_f32_16x16x32_bf16 v[148:151], v[68:71], v[60:63], v[26:29]
  s_cmp_eq_u32 s55, 2
  s_cbranch_scc0 Lsw_70
  s_nop 0
  v_mov_b32 v26, 0
  v_mov_b32 v27, 0
  v_mov_b32 v28, 0
  v_mov_b32 v29, 0
Lsw_70:
  s_waitcnt lgkmcnt(2)
  s_nop 0
  v_mfma_f32_16x16x32_bf16 v[152:155], v[72:75], v[52:55], v[26:29]
  ds_read_b128 v[98:101], v20 offset:10240
  v_cndmask_b32 v136, v25, v136, s[60:61]
  v_cndmask_b32 v137, v25, v137, s[62:63]
  v_cndmask_b32 v138, v25, v138, s[64:65]
  v_mfma_f32_16x16x32_bf16 v[156:159], v[72:75], v[58:61], v[26:29]
  v_cndmask_b32 v139, v25, v139, s[66:67]
  v_max3_f32 v16, v136, v137, v16
  v_max3_f32 v16, v138, v139, v16
  v_mfma_f32_16x16x32_bf16 v[136:139], v[76:79], v[54:57], v[26:29]
  v_max3_f32 v16, v144, v145, v16
  v_cndmask_b32 v148, v25, v148, s[60:61]
  v_cndmask_b32 v149, v25, v149, s[62:63]
  v_cndmask_b32 v150, v25, v150, s[64:65]
  v_mfma_f32_16x16x32_bf16 v[140:143], v[76:79], v[60:63], v[26:29]
  v_cndmask_b32 v151, v25, v151, s[66:67]
  v_max3_f32 v17, v148, v149, v17
  v_max3_f32 v16, v146, v147, v16
  v_max3_f32 v17, v150, v151, v17
  s_cmp_eq_u32 s55, 4
  s_cbranch_scc0 Lsw_71
  v_mov_b32 v26, 0
  v_mov_b32 v27, 0
  v_mov_b32 v28, 0
  v_mov_b32 v29, 0
Lsw_71:
  s_waitcnt lgkmcnt(2)
  s_nop 0
  v_mfma_f32_16x16x32_bf16 v[144:147], v[80:83], v[52:55], v[26:29]
  ds_read_b128 v[106:109], v20 offset:12544
  v_max3_f32 v16, v152, v153, v16
  v_max3_f32 v17, v156, v157, v17
  v_mfma_f32_16x16x32_bf16 v[148:151], v[80:83], v[58:61], v[26:29]
  v_max3_f32 v16, v154, v155, v16
  v_max3_f32 v17, v158, v159, v17
  s_add_u32 s59, s71, 0
  buffer_load_dwordx4 a[40:43], v4, s[28:31], s59 offen offset:0 sc1
  v_mfma_f32_16x16x32_bf16 v[152:155], v[84:87], v[54:57], v[26:29]
  v_max3_f32 v16, v136, v137, v16
  v_max3_f32 v17, v140, v141, v17
  v_mfma_f32_16x16x32_bf16 v[156:159], v[84:87], v[60:63], v[26:29]
  v_max3_f32 v16, v138, v139, v16
  v_max3_f32 v17, v142, v143, v17
  s_cmp_eq_u32 s55, 6
  s_cbranch_scc0 Lsw_72
  v_mov_b32 v26, 0
  v_mov_b32 v27, 0
  v_mov_b32 v28, 0
  v_mov_b32 v29, 0
Lsw_72:
  s_waitcnt lgkmcnt(2)
  s_nop 0
  v_mfma_f32_16x16x32_bf16 v[136:139], v[88:91], v[52:55], v[26:29]
  ds_read_b128 v[114:117], v20 offset:14848
  v_max3_f32 v16, v144, v145, v16
  v_max3_f32 v17, v148, v149, v17
  v_mfma_f32_16x16x32_bf16 v[140:143], v[88:91], v[58:61], v[26:29]
  v_max3_f32 v16, v146, v147, v16
  v_max3_f32 v17, v150, v151, v17
  v_mfma_f32_16x16x32_bf16 v[144:147], v[92:95], v[54:57], v[26:29]
  v_max3_f32 v16, v152, v153, v16
  v_max3_f32 v17, v156, v157, v17
  v_max3_f32 v16, v154, v155, v16
  v_mfma_f32_16x16x32_bf16 v[148:151], v[92:95], v[60:63], v[26:29]
  v_max3_f32 v17, v158, v159, v17
  buffer_load_dwordx4 a[44:47], v4, s[28:31], s59 offen offset:1024 sc1
  s_cmp_eq_u32 s55, 8
  s_cbranch_scc0 Lsw_73
  v_mov_b32 v26, 0
  v_mov_b32 v27, 0
  v_mov_b32 v28, 0
  v_mov_b32 v29, 0
Lsw_73:
  s_waitcnt lgkmcnt(2)
  s_nop 0
  v_mfma_f32_16x16x32_bf16 v[152:155], v[96:99], v[52:55], v[26:29]
  ds_read_b128 v[122:125], v20 offset:17152
  v_max3_f32 v16, v136, v137, v16
  v_max3_f32 v17, v140, v141, v17
  v_mfma_f32_16x16x32_bf16 v[156:159], v[96:99], v[58:61], v[26:29]
  v_max3_f32 v16, v138, v139, v16
  v_max3_f32 v17, v142, v143, v17
  v_mfma_f32_16x16x32_bf16 v[136:139], v[100:103], v[54:57], v[26:29]
  v_max3_f32 v16, v144, v145, v16
  v_max3_f32 v17, v148, v149, v17
  v_mfma_f32_16x16x32_bf16 v[140:143], v[100:103], v[60:63], v[26:29]
  v_max3_f32 v16, v146, v147, v16
  v_max3_f32 v17, v150, v151, v17
  s_cmp_eq_u32 s55, 10
  s_cbranch_scc0 Lsw_74
  v_mov_b32 v26, 0
  v_mov_b32 v27, 0
  v_mov_b32 v28, 0
  v_mov_b32 v29, 0
Lsw_74:
  s_waitcnt lgkmcnt(2)
  s_nop 0
  v_mfma_f32_16x16x32_bf16 v[144:147], v[104:107], v[52:55], v[26:29]
  ds_read_b128 v[130:133], v20 offset:19456
  v_max3_f32 v16, v152, v153, v16
  v_max3_f32 v17, v156, v157, v17
  v_mfma_f32_16x16x32_bf16 v[148:151], v[104:107], v[58:61], v[26:29]
  v_max3_f32 v16, v154, v155, v16
  v_max3_f32 v17, v158, v159, v17
  buffer_load_dwordx4 a[48:51], v4, s[28:31], s59 offen offset:2048 sc1
  v_mfma_f32_16x16x32_bf16 v[152:155], v[108:111], v[54:57], v[26:29]
  v_max3_f32 v16, v136, v137, v16
  v_max3_f32 v17, v140, v141, v17
  v_mfma_f32_16x16x32_bf16 v[156:159], v[108:111], v[60:63], v[26:29]
  v_max3_f32 v16, v138, v139, v16
  v_max3_f32 v17, v142, v143, v17
  s_cmp_eq_u32 s55, 12
  s_cbranch_scc0 Lsw_75
  v_mov_b32 v26, 0
  v_mov_b32 v27, 0
  v_mov_b32 v28, 0
  v_mov_b32 v29, 0
Lsw_75:
  s_waitcnt lgkmcnt(2)
  s_nop 0
  v_mfma_f32_16x16x32_bf16 v[136:139], v[112:115], v[52:55], v[26:29]
  v_max3_f32 v16, v144, v145, v16
  v_max3_f32 v17, v148, v149, v17
  v_mfma_f32_16x16x32_bf16 v[140:143], v[112:115], v[58:61], v[26:29]
  v_max3_f32 v16, v146, v147, v16
  v_max3_f32 v17, v150, v151, v17
  v_mfma_f32_16x16x32_bf16 v[144:147], v[116:119], v[54:57], v[26:29]
  v_max3_f32 v16, v152, v153, v16
  v_max3_f32 v17, v156, v157, v17
  v_max3_f32 v16, v154, v155, v16
  v_mfma_f32_16x16x32_bf16 v[148:151], v[116:119], v[60:63], v[26:29]
  v_max3_f32 v17, v158, v159, v17
  buffer_load_dwordx4 a[52:55], v4, s[28:31], s59 offen offset:3072 sc1
  s_cmp_eq_u32 s55, 14
  s_cbranch_scc0 Lsw_76
  v_mov_b32 v26, 0
  v_mov_b32 v27, 0
  v_mov_b32 v28, 0
  v_mov_b32 v29, 0
Lsw_76:
  s_waitcnt lgkmcnt(1)
  s_nop 0
  v_mfma_f32_16x16x32_bf16 v[152:155], v[120:123], v[52:55], v[26:29]
  v_max3_f32 v16, v136, v137, v16
  v_max3_f32 v17, v140, v141, v17
  v_mfma_f32_16x16x32_bf16 v[156:159], v[120:123], v[58:61], v[26:29]
  v_max3_f32 v16, v138, v139, v16
  v_max3_f32 v17, v142, v143, v17
  v_mfma_f32_16x16x32_bf16 v[136:139], v[124:127], v[54:57], v[26:29]
  v_max3_f32 v16, v144, v145, v16
  v_max3_f32 v17, v148, v149, v17
  v_mfma_f32_16x16x32_bf16 v[140:143], v[124:127], v[60:63], v[26:29]
  v_max3_f32 v16, v146, v147, v16
  v_max3_f32 v17, v150, v151, v17
  s_cmp_eq_u32 s55, 16
  s_cbranch_scc0 Lsw_77
  v_mov_b32 v26, 0
  v_mov_b32 v27, 0
  v_mov_b32 v28, 0
  v_mov_b32 v29, 0
Lsw_77:
  s_waitcnt lgkmcnt(0)
  s_nop 0
  v_mfma_f32_16x16x32_bf16 v[144:147], v[128:131], v[52:55], v[26:29]
  v_max3_f32 v16, v152, v153, v16
  v_max3_f32 v17, v156, v157, v17
  v_max3_f32 v16, v154, v155, v16
  v_mfma_f32_16x16x32_bf16 v[148:151], v[128:131], v[58:61], v[26:29]
  v_max3_f32 v17, v158, v159, v17
  s_add_u32 s59, s71, 4096
  buffer_load_dwordx4 a[56:59], v4, s[28:31], s59 offen offset:0 sc1
  v_mfma_f32_16x16x32_bf16 v[156:159], v[132:135], v[60:63], v[26:29]
  v_max3_f32 v16, v136, v137, v16
  v_max3_f32 v17, v140, v141, v17
  v_max3_f32 v16, v138, v139, v16
  v_max3_f32 v17, v142, v143, v17
  s_mov_b32 exec_lo, 0x00030003
  s_mov_b32 exec_hi, 0x00030003
  ds_read_b128 a[0:3], v23 offset:128
  ds_read_b128 a[4:7], v23 offset:2432
  ds_read_b128 a[8:11], v23 offset:4736
  ds_read_b128 a[12:15], v23 offset:7040
  ds_read_b128 a[16:19], v23 offset:9344
  ds_read_b128 a[20:23], v23 offset:11648
  ds_read_b128 a[24:27], v23 offset:13952
  ds_read_b128 a[28:31], v23 offset:16256
  ds_read_b128 a[32:35], v23 offset:18560
  s_mov_b64 exec, -1
  ds_read_b128 v[184:187], v22 offset:1024
  v_cndmask_b32 v144, v144, v25, s[60:61]
  v_cndmask_b32 v145, v145, v25, s[62:63]
  v_cndmask_b32 v146, v146, v25, s[64:65]
  v_cndmask_b32 v147, v147, v25, s[66:67]
  v_max3_f32 v16, v144, v145, v16
  v_max3_f32 v17, v148, v149, v17
  v_max3_f32 v16, v146, v147, v16
  v_max3_f32 v17, v150, v151, v17
  v_cndmask_b32 v156, v156, v25, s[60:61]
  v_cndmask_b32 v157, v157, v25, s[62:63]
  v_cndmask_b32 v158, v158, v25, s[64:65]
  v_cndmask_b32 v159, v159, v25, s[66:67]
  v_max3_f32 v17, v156, v157, v17
  v_max3_f32 v17, v158, v159, v17
  v_mov_b32 v30, v16
  v_mov_b32 v31, v17
  s_nop 0
  v_permlane32_swap_b32 v16, v30
  v_permlane32_swap_b32 v17, v31
  v_max_f32 v16, v16, v30
  v_max_f32 v17, v17, v31
  v_mov_b32 v30, v16
  v_mov_b32 v31, v17
  s_nop 0
  v_permlane16_swap_b32 v16, v30
  v_permlane16_swap_b32 v17, v31
  v_max_f32 v16, v16, v30
  v_max_f32 v17, v17, v31
  v_mov_b32 v216, v25
  v_mov_b32 v217, v25
  v_mov_b32 v218, v25
  v_mov_b32 v219, v25
  v_mov_b32 v220, v25
  v_mov_b32 v221, v25
  v_mov_b32 v222, v25
  v_mov_b32 v223, v25
  s_cmp_eq_u32 s55, 0
  s_cbranch_scc0 Lsw_78
  v_sub_f32 v216, 0, v16
  v_sub_f32 v217, 0, v16
  v_sub_f32 v218, 0, v16
  v_sub_f32 v219, 0, v16
  v_sub_f32 v220, 0, v17
  v_sub_f32 v221, 0, v17
  v_sub_f32 v222, 0, v17
  v_sub_f32 v223, 0, v17
Lsw_78:
  v_mfma_f32_16x16x32_bf16 v[136:139], v[64:67], v[52:55], v[216:219]
  v_mfma_f32_16x16x32_bf16 v[140:143], v[68:71], v[54:57], v[216:219]
  v_mfma_f32_16x16x32_bf16 v[148:151], v[68:71], v[60:63], v[220:223]
  s_cmp_eq_u32 s55, 2
  s_nop 2
  s_cbranch_scc0 Lsw_79
  v_sub_f32 v216, 0, v16
  v_sub_f32 v217, 0, v16
  v_sub_f32 v218, 0, v16
  v_sub_f32 v219, 0, v16
  v_sub_f32 v220, 0, v17
  v_sub_f32 v221, 0, v17
  v_sub_f32 v222, 0, v17
  v_sub_f32 v223, 0, v17
Lsw_79:
  v_mfma_f32_16x16x32_bf16 v[152:155], v[72:75], v[52:55], v[216:219]
  v_cndmask_b32 v136, v25, v136, s[60:61]
  v_cndmask_b32 v137, v25, v137, s[62:63]
  v_cndmask_b32 v138, v25, v138, s[64:65]
  v_cndmask_b32 v139, v25, v139, s[66:67]
  v_exp_f32 v136, v136
  v_exp_f32 v137, v137
  v_exp_f32 v138, v138
  v_exp_f32 v139, v139
  v_mfma_f32_16x16x32_bf16 v[156:159], v[76:79], v[54:57], v[216:219]
  buffer_load_dwordx4 a[60:63], v4, s[28:31], s59 offen offset:1024 sc1
  v_exp_f32 v140, v140
  v_exp_f32 v141, v141
  v_exp_f32 v142, v142
  v_exp_f32 v143, v143
  buffer_load_dwordx4 a[64:67], v4, s[28:31], s59 offen offset:2048 sc1
  v_cvt_pk_bf16_f32 v168, v136, v137
  v_mfma_f32_16x16x32_bf16 v[160:163], v[72:75], v[58:61], v[220:223]
  v_cvt_pk_bf16_f32 v169, v138, v139
  v_cvt_pk_bf16_f32 v170, v140, v141
  v_cvt_pk_bf16_f32 v171, v142, v143
  v_cndmask_b32 v148, v25, v148, s[60:61]
  v_cndmask_b32 v149, v25, v149, s[62:63]
  v_cndmask_b32 v150, v25, v150, s[64:65]
  v_cndmask_b32 v151, v25, v151, s[66:67]
  v_exp_f32 v148, v148
  v_mfma_f32_16x16x32_bf16 v[164:167], v[76:79], v[60:63], v[220:223]
  v_exp_f32 v149, v149
  v_exp_f32 v150, v150
  v_exp_f32 v151, v151
  v_mov_b32 v172, 0
  v_mov_b32 v173, 0
  v_cvt_pk_bf16_f32 v174, v148, v149
  v_cvt_pk_bf16_f32 v175, v150, v151
  ds_read_b128 v[188:191], v22 offset:3328
  s_cmp_eq_u32 s55, 4
  s_cbranch_scc0 Lsw_80
  v_sub_f32 v216, 0, v16
  v_sub_f32 v217, 0, v16
  v_sub_f32 v218, 0, v16
  v_sub_f32 v219, 0, v16
  v_sub_f32 v220, 0, v17
  v_sub_f32 v221, 0, v17
  v_sub_f32 v222, 0, v17
  v_sub_f32 v223, 0, v17
Lsw_80:
  s_waitcnt lgkmcnt(1)
  v_mfma_f32_16x16x32_bf16 v[136:139], v[80:83], v[52:55], v[216:219]
  v_exp_f32 v152, v152
  v_exp_f32 v153, v153
  v_exp_f32 v154, v154
  v_exp_f32 v155, v155
  v_mfma_f32_16x16x32_bf16 v[140:143], v[84:87], v[54:57], v[216:219]
  buffer_load_dwordx4 a[68:71], v4, s[28:31], s59 offen offset:3072 sc1
  v_exp_f32 v156, v156
  v_exp_f32 v157, v157
  v_mfma_f32_16x16x32_bf16 v[144:147], v[80:83], v[58:61], v[220:223]
  v_exp_f32 v158, v158
  v_exp_f32 v159, v159
  s_add_u32 s59, s71, 8192
  buffer_load_dwordx4 a[72:75], v4, s[28:31], s59 offen offset:0 sc1
  v_cvt_pk_bf16_f32 v176, v152, v153
  v_mfma_f32_16x16x32_bf16 v[148:151], v[84:87], v[60:63], v[220:223]
  v_cvt_pk_bf16_f32 v177, v154, v155
  v_cvt_pk_bf16_f32 v178, v156, v157
  v_cvt_pk_bf16_f32 v179, v158, v159
  v_mfma_f32_16x16x32_bf16 v[192:195], v[184:187], v[168:171], 0
  v_exp_f32 v160, v160
  v_exp_f32 v161, v161
  v_exp_f32 v162, v162
  v_mfma_f32_16x16x32_bf16 v[200:203], a[0:3], v[168:171], 0
  v_exp_f32 v163, v163
  buffer_load_dwordx4 a[76:79], v4, s[28:31], s59 offen offset:1024 sc1
  v_exp_f32 v164, v164
  v_exp_f32 v165, v165
  v_mfma_f32_16x16x32_bf16 v[196:199], v[184:187], v[172:175], 0
  v_exp_f32 v166, v166
  v_exp_f32 v167, v167
  v_cvt_pk_bf16_f32 v180, v160, v161
  v_mfma_f32_16x16x32_bf16 v[204:207], a[0:3], v[172:175], 0
  v_cvt_pk_bf16_f32 v181, v162, v163
  v_cvt_pk_bf16_f32 v182, v164, v165
  v_cvt_pk_bf16_f32 v183, v166, v167
  ds_read_b128 v[184:187], v22 offset:5632
  s_cmp_eq_u32 s55, 6
  s_cbranch_scc0 Lsw_81
  v_sub_f32 v216, 0, v16
  v_sub_f32 v217, 0, v16
  v_sub_f32 v218, 0, v16
  v_sub_f32 v219, 0, v16
  v_sub_f32 v220, 0, v17
  v_sub_f32 v221, 0, v17
  v_sub_f32 v222, 0, v17
  v_sub_f32 v223, 0, v17
Lsw_81:
  s_waitcnt lgkmcnt(1)
  v_mfma_f32_16x16x32_bf16 v[152:155], v[88:91], v[52:55], v[216:219]
  v_exp_f32 v136, v136
  v_exp_f32 v137, v137
  v_exp_f32 v138, v138
  v_exp_f32 v139, v139
  v_mfma_f32_16x16x32_bf16 v[156:159], v[92:95], v[54:57], v[216:219]
  buffer_load_dwordx4 a[80:83], v4, s[28:31], s59 offen offset:2048 sc1
  v_exp_f32 v140, v140
  v_exp_f32 v141, v141
  v_mfma_f32_16x16x32_bf16 v[160:163], v[88:91], v[58:61], v[220:223]
  v_exp_f32 v142, v142
  v_exp_f32 v143, v143
  buffer_load_dwordx4 a[84:87], v4, s[28:31], s59 offen offset:3072 sc1
  v_cvt_pk_bf16_f32 v168, v136, v137
  v_mfma_f32_16x16x32_bf16 v[164:167], v[92:95], v[60:63], v[220:223]
  v_cvt_pk_bf16_f32 v169, v138, v139
  v_cvt_pk_bf16_f32 v170, v140, v141
  v_cvt_pk_bf16_f32 v171, v142, v143
  v_mfma_f32_16x16x32_bf16 v[192:195], v[188:191], v[176:179], v[192:195]
  v_exp_f32 v144, v144
  v_exp_f32 v145, v145
  v_exp_f32 v146, v146
  v_mfma_f32_16x16x32_bf16 v[200:203], a[4:7], v[176:179], v[200:203]
  v_exp_f32 v147, v147
  s_add_u32 s59, s71, 12288
  buffer_load_dwordx4 a[88:91], v4, s[28:31], s59 offen offset:0 sc1
  v_exp_f32 v148, v148
  v_exp_f32 v149, v149
  v_mfma_f32_16x16x32_bf16 v[196:199], v[188:191], v[180:183], v[196:199]
  v_exp_f32 v150, v150
  v_exp_f32 v151, v151
  v_cvt_pk_bf16_f32 v172, v144, v145
  v_mfma_f32_16x16x32_bf16 v[204:207], a[4:7], v[180:183], v[204:207]
  v_cvt_pk_bf16_f32 v173, v146, v147
  v_cvt_pk_bf16_f32 v174, v148, v149
  v_cvt_pk_bf16_f32 v175, v150, v151
  ds_read_b128 v[188:191], v22 offset:7936
  s_cmp_eq_u32 s55, 8
  s_cbranch_scc0 Lsw_82
  v_sub_f32 v216, 0, v16
  v_sub_f32 v217, 0, v16
  v_sub_f32 v218, 0, v16
  v_sub_f32 v219, 0, v16
  v_sub_f32 v220, 0, v17
  v_sub_f32 v221, 0, v17
  v_sub_f32 v222, 0, v17
  v_sub_f32 v223, 0, v17
Lsw_82:
  s_waitcnt lgkmcnt(1)
  v_mfma_f32_16x16x32_bf16 v[136:139], v[96:99], v[52:55], v[216:219]
  v_exp_f32 v152, v152
  v_exp_f32 v153, v153
  v_exp_f32 v154, v154
  v_exp_f32 v155, v155
  v_mfma_f32_16x16x32_bf16 v[140:143], v[100:103], v[54:57], v[216:219]
  buffer_load_dwordx4 a[92:95], v4, s[28:31], s59 offen offset:1024 sc1
  v_exp_f32 v156, v156
  v_exp_f32 v157, v157
  v_mfma_f32_16x16x32_bf16 v[144:147], v[96:99], v[58:61], v[220:223]
  v_exp_f32 v158, v158
  v_exp_f32 v159, v159
  buffer_load_dwordx4 a[96:99], v4, s[28:31], s59 offen offset:2048 sc1
  v_mfma_f32_16x16x32_bf16 v[148:151], v[100:103], v[60:63], v[220:223]
  v_cvt_pk_bf16_f32 v176, v152, v153
  v_cvt_pk_bf16_f32 v177, v154, v155
  v_cvt_pk_bf16_f32 v178, v156, v157
  v_mfma_f32_16x16x32_bf16 v[192:195], v[184:187], v[168:171], v[192:195]
  v_cvt_pk_bf16_f32 v179, v158, v159
  v_exp_f32 v160, v160
  v_exp_f32 v161, v161
  v_exp_f32 v162, v162
  v_mfma_f32_16x16x32_bf16 v[200:203], a[8:11], v[168:171], v[200:203]
  v_exp_f32 v163, v163
  v_exp_f32 v164, v164
  v_exp_f32 v165, v165
  v_mfma_f32_16x16x32_bf16 v[196:199], v[184:187], v[172:175], v[196:199]
  v_exp_f32 v166, v166
  v_exp_f32 v167, v167
  v_cvt_pk_bf16_f32 v180, v160, v161
  v_mfma_f32_16x16x32_bf16 v[204:207], a[8:11], v[172:175], v[204:207]
  v_cvt_pk_bf16_f32 v181, v162, v163
  v_cvt_pk_bf16_f32 v182, v164, v165
  v_cvt_pk_bf16_f32 v183, v166, v167
  ds_read_b128 v[184:187], v22 offset:10240
  s_cmp_eq_u32 s55, 10
  s_cbranch_scc0 Lsw_83
  v_sub_f32 v216, 0, v16
  v_sub_f32 v217, 0, v16
  v_sub_f32 v218, 0, v16
  v_sub_f32 v219, 0, v16
  v_sub_f32 v220, 0, v17
  v_sub_f32 v221, 0, v17
  v_sub_f32 v222, 0, v17
  v_sub_f32 v223, 0, v17
Lsw_83:
  s_waitcnt lgkmcnt(1)
  v_mfma_f32_16x16x32_bf16 v[152:155], v[104:107], v[52:55], v[216:219]
  v_exp_f32 v136, v136
  v_exp_f32 v137, v137
  v_exp_f32 v138, v138
  v_exp_f32 v139, v139
  v_mfma_f32_16x16x32_bf16 v[156:159], v[108:111], v[54:57], v[216:219]
  buffer_load_dwordx4 a[100:103], v4, s[28:31], s59 offen offset:3072 sc1
  v_exp_f32 v140, v140
  v_exp_f32 v141, v141
  v_mfma_f32_16x16x32_bf16 v[160:163], v[104:107], v[58:61], v[220:223]
  v_exp_f32 v142, v142
  v_exp_f32 v143, v143
  s_add_u32 s59, s71, 16384
  buffer_load_dwordx4 a[104:107], v4, s[28:31], s59 offen offset:0 sc1
  v_cvt_pk_bf16_f32 v168, v136, v137
  v_mfma_f32_16x16x32_bf16 v[164:167], v[108:111], v[60:63], v[220:223]
  v_cvt_pk_bf16_f32 v169, v138, v139
  v_cvt_pk_bf16_f32 v170, v140, v141
  v_cvt_pk_bf16_f32 v171, v142, v143
  v_mfma_f32_16x16x32_bf16 v[192:195], v[188:191], v[176:179], v[192:195]
  v_exp_f32 v144, v144
  v_exp_f32 v145, v145
  v_exp_f32 v146, v146
  v_mfma_f32_16x16x32_bf16 v[200:203], a[12:15], v[176:179], v[200:203]
  v_exp_f32 v147, v147
  buffer_load_dwordx4 a[108:111], v4, s[28:31], s59 offen offset:1024 sc1
  v_exp_f32 v148, v148
  v_exp_f32 v149, v149
  v_mfma_f32_16x16x32_bf16 v[196:199], v[188:191], v[180:183], v[196:199]
  v_exp_f32 v150, v150
  v_exp_f32 v151, v151
  v_cvt_pk_bf16_f32 v172, v144, v145
  v_mfma_f32_16x16x32_bf16 v[204:207], a[12:15], v[180:183], v[204:207]
  v_cvt_pk_bf16_f32 v173, v146, v147
  v_cvt_pk_bf16_f32 v174, v148, v149
  v_cvt_pk_bf16_f32 v175, v150, v151
  ds_read_b128 v[188:191], v22 offset:12544
  s_cmp_eq_u32 s55, 12
  s_cbranch_scc0 Lsw_84
  v_sub_f32 v216, 0, v16
  v_sub_f32 v217, 0, v16
  v_sub_f32 v218, 0, v16
  v_sub_f32 v219, 0, v16
  v_sub_f32 v220, 0, v17
  v_sub_f32 v221, 0, v17
  v_sub_f32 v222, 0, v17
  v_sub_f32 v223, 0, v17
Lsw_84:
  s_waitcnt lgkmcnt(1)
  v_mfma_f32_16x16x32_bf16 v[136:139], v[112:115], v[52:55], v[216:219]
  v_exp_f32 v152, v152
  v_exp_f32 v153, v153
  v_exp_f32 v154, v154
  v_exp_f32 v155, v155
  v_mfma_f32_16x16x32_bf16 v[140:143], v[116:119], v[54:57], v[216:219]
  buffer_load_dwordx4 a[112:115], v4, s[28:31], s59 offen offset:2048 sc1
  v_exp_f32 v156, v156
  v_exp_f32 v157, v157
  v_mfma_f32_16x16x32_bf16 v[144:147], v[112:115], v[58:61], v[220:223]
  v_exp_f32 v158, v158
  v_exp_f32 v159, v159
  buffer_load_dwordx4 a[116:119], v4, s[28:31], s59 offen offset:3072 sc1
  v_cvt_pk_bf16_f32 v176, v152, v153
  v_mfma_f32_16x16x32_bf16 v[148:151], v[116:119], v[60:63], v[220:223]
  v_cvt_pk_bf16_f32 v177, v154, v155
  v_cvt_pk_bf16_f32 v178, v156, v157
  v_cvt_pk_bf16_f32 v179, v158, v159
  v_mfma_f32_16x16x32_bf16 v[192:195], v[184:187], v[168:171], v[192:195]
  v_exp_f32 v160, v160
  v_exp_f32 v161, v161
  v_exp_f32 v162, v162
  v_mfma_f32_16x16x32_bf16 v[200:203], a[16:19], v[168:171], v[200:203]
  v_exp_f32 v163, v163
  s_add_u32 s59, s71, 20480
  buffer_load_dwordx4 a[120:123], v4, s[28:31], s59 offen offset:0 sc1
  v_exp_f32 v164, v164
  v_exp_f32 v165, v165
  v_mfma_f32_16x16x32_bf16 v[196:199], v[184:187], v[172:175], v[196:199]
  v_exp_f32 v166, v166
  v_exp_f32 v167, v167
  v_cvt_pk_bf16_f32 v180, v160, v161
  v_mfma_f32_16x16x32_bf16 v[204:207], a[16:19], v[172:175], v[204:207]
  v_cvt_pk_bf16_f32 v181, v162, v163
  v_cvt_pk_bf16_f32 v182, v164, v165
  v_cvt_pk_bf16_f32 v183, v166, v167
  ds_read_b128 v[184:187], v22 offset:14848
  s_cmp_eq_u32 s55, 14
  s_cbranch_scc0 Lsw_85
  v_sub_f32 v216, 0, v16
  v_sub_f32 v217, 0, v16
  v_sub_f32 v218, 0, v16
  v_sub_f32 v219, 0, v16
  v_sub_f32 v220, 0, v17
  v_sub_f32 v221, 0, v17
  v_sub_f32 v222, 0, v17
  v_sub_f32 v223, 0, v17
Lsw_85:
  s_waitcnt lgkmcnt(1)
  v_mfma_f32_16x16x32_bf16 v[152:155], v[120:123], v[52:55], v[216:219]
  v_exp_f32 v136, v136
  v_exp_f32 v137, v137
  v_exp_f32 v138, v138
  v_exp_f32 v139, v139
  v_mfma_f32_16x16x32_bf16 v[156:159], v[124:127], v[54:57], v[216:219]
  buffer_load_dwordx4 a[124:127], v4, s[28:31], s59 offen offset:1024 sc1
  v_exp_f32 v140, v140
  v_exp_f32 v141, v141
  v_mfma_f32_16x16x32_bf16 v[160:163], v[120:123], v[58:61], v[220:223]
  v_exp_f32 v142, v142
  v_exp_f32 v143, v143
  buffer_load_dwordx4 a[128:131], v4, s[28:31], s59 offen offset:2048 sc1
  v_mfma_f32_16x16x32_bf16 v[164:167], v[124:127], v[60:63], v[220:223]
  v_cvt_pk_bf16_f32 v168, v136, v137
  v_cvt_pk_bf16_f32 v169, v138, v139
  v_cvt_pk_bf16_f32 v170, v140, v141
  v_mfma_f32_16x16x32_bf16 v[192:195], v[188:191], v[176:179], v[192:195]
  v_cvt_pk_bf16_f32 v171, v142, v143
  v_exp_f32 v144, v144
  v_exp_f32 v145, v145
  v_exp_f32 v146, v146
  v_mfma_f32_16x16x32_bf16 v[200:203], a[20:23], v[176:179], v[200:203]
  v_exp_f32 v147, v147
  v_exp_f32 v148, v148
  v_exp_f32 v149, v149
  v_mfma_f32_16x16x32_bf16 v[196:199], v[188:191], v[180:183], v[196:199]
  v_exp_f32 v150, v150
  v_exp_f32 v151, v151
  v_cvt_pk_bf16_f32 v172, v144, v145
  v_mfma_f32_16x16x32_bf16 v[204:207], a[20:23], v[180:183], v[204:207]
  v_cvt_pk_bf16_f32 v173, v146, v147
  v_cvt_pk_bf16_f32 v174, v148, v149
  v_cvt_pk_bf16_f32 v175, v150, v151
  ds_read_b128 v[188:191], v22 offset:17152
  s_cmp_eq_u32 s55, 16
  s_cbranch_scc0 Lsw_86
  v_sub_f32 v216, 0, v16
  v_sub_f32 v217, 0, v16
  v_sub_f32 v218, 0, v16
  v_sub_f32 v219, 0, v16
  v_sub_f32 v220, 0, v17
  v_sub_f32 v221, 0, v17
  v_sub_f32 v222, 0, v17
  v_sub_f32 v223, 0, v17
Lsw_86:
  s_waitcnt lgkmcnt(1)
  v_mfma_f32_16x16x32_bf16 v[136:139], v[128:131], v[52:55], v[216:219]
  v_exp_f32 v152, v152
  v_exp_f32 v153, v153
  v_exp_f32 v154, v154
  v_exp_f32 v155, v155
  v_mfma_f32_16x16x32_bf16 v[144:147], v[128:131], v[58:61], v[220:223]
  buffer_load_dwordx4 a[132:135], v4, s[28:31], s59 offen offset:3072 sc1
  v_exp_f32 v156, v156
  v_exp_f32 v157, v157
  v_exp_f32 v158, v158
  v_mfma_f32_16x16x32_bf16 v[148:151], v[132:135], v[60:63], v[220:223]
  v_exp_f32 v159, v159
  s_add_u32 s59, s71, 24576
  buffer_load_dwordx4 a[136:139], v4, s[28:31], s59 offen offset:0 sc1
  v_cvt_pk_bf16_f32 v176, v152, v153
  v_cvt_pk_bf16_f32 v177, v154, v155
  v_mfma_f32_16x16x32_bf16 v[192:195], v[184:187], v[168:171], v[192:195]
  v_cvt_pk_bf16_f32 v178, v156, v157
  v_cvt_pk_bf16_f32 v179, v158, v159
  v_exp_f32 v160, v160
  v_exp_f32 v161, v161
  v_mfma_f32_16x16x32_bf16 v[200:203], a[24:27], v[168:171], v[200:203]
  v_exp_f32 v162, v162
  v_exp_f32 v163, v163
  buffer_load_dwordx4 a[140:143], v4, s[28:31], s59 offen offset:1024 sc1
  v_exp_f32 v164, v164
  v_mfma_f32_16x16x32_bf16 v[196:199], v[184:187], v[172:175], v[196:199]
  v_exp_f32 v165, v165
  v_exp_f32 v166, v166
  v_exp_f32 v167, v167
  v_cvt_pk_bf16_f32 v180, v160, v161
  v_mfma_f32_16x16x32_bf16 v[204:207], a[24:27], v[172:175], v[204:207]
  v_cvt_pk_bf16_f32 v181, v162, v163
  v_cvt_pk_bf16_f32 v182, v164, v165
  v_cvt_pk_bf16_f32 v183, v166, v167
  ds_read_b128 v[184:187], v22 offset:19456
  s_waitcnt lgkmcnt(1)
  v_mfma_f32_16x16x32_bf16 v[192:195], v[188:191], v[176:179], v[192:195]
  v_cndmask_b32 v136, v136, v25, s[60:61]
  v_cndmask_b32 v137, v137, v25, s[62:63]
  v_cndmask_b32 v138, v138, v25, s[64:65]
  v_cndmask_b32 v139, v139, v25, s[66:67]
  v_exp_f32 v136, v136
  v_exp_f32 v137, v137
  v_exp_f32 v138, v138
  v_exp_f32 v139, v139
  v_mfma_f32_16x16x32_bf16 v[200:203], a[28:31], v[176:179], v[200:203]
  buffer_load_dwordx4 a[144:147], v4, s[28:31], s59 offen offset:2048 sc1
  v_cvt_pk_bf16_f32 v168, v136, v137
  v_cvt_pk_bf16_f32 v169, v138, v139
  v_mov_b32 v170, 0
  v_mov_b32 v171, 0
  v_exp_f32 v144, v144
  v_exp_f32 v145, v145
  v_mfma_f32_16x16x32_bf16 v[196:199], v[188:191], v[180:183], v[196:199]
  v_exp_f32 v146, v146
  v_exp_f32 v147, v147
  v_cndmask_b32 v148, v148, v25, s[60:61]
  v_cndmask_b32 v149, v149, v25, s[62:63]
  v_cndmask_b32 v150, v150, v25, s[64:65]
  v_cndmask_b32 v151, v151, v25, s[66:67]
  v_exp_f32 v148, v148
  v_mfma_f32_16x16x32_bf16 v[204:207], a[28:31], v[180:183], v[204:207]
  v_exp_f32 v149, v149
  v_exp_f32 v150, v150
  v_exp_f32 v151, v151
  v_cvt_pk_bf16_f32 v172, v144, v145
  v_cvt_pk_bf16_f32 v173, v146, v147
  v_cvt_pk_bf16_f32 v174, v148, v149
  v_cvt_pk_bf16_f32 v175, v150, v151
  s_waitcnt lgkmcnt(0)
  v_mfma_f32_16x16x32_bf16 v[192:195], v[184:187], v[168:171], v[192:195]
  v_mfma_f32_16x16x32_bf16 v[200:203], a[32:35], v[168:171], v[200:203]
  v_mfma_f32_16x16x32_bf16 v[196:199], v[184:187], v[172:175], v[196:199]
  v_mfma_f32_16x16x32_bf16 v[204:207], a[32:35], v[172:175], v[204:207]
  s_mul_i32 s54, s53, 18432
  s_add_u32 s54, s54, 7667712
  s_lshl_b32 s46, s51, 10
  s_add_u32 s58, s46, s54
  s_add_u32 s59, s58, 18432
  s_lshr_b32 s46, s51, 3
  s_add_u32 s46, s46, 16
  s_lshl_b32 s46, s46, 10
  s_add_u32 s54, s54, s46
  s_and_b32 s46, s51, 7
  s_lshr_b32 s46, s46, 1
  s_lshl_b32 s46, s46, 8
  s_add_u32 s54, s54, s46
  s_and_b32 s46, s51, 1
  s_lshl_b32 s46, s46, 3
  s_add_u32 s54, s54, s46
  s_add_u32 s47, s54, 18432
  v_rcp_f32 v30, v203
  v_rcp_f32 v31, v207
  v_mul_f32 v192, v192, v30
  v_mul_f32 v193, v193, v30
  v_mul_f32 v194, v194, v30
  v_mul_f32 v195, v195, v30
  v_mul_f32 v200, v200, v30
  v_mul_f32 v201, v201, v30
  v_mul_f32 v196, v196, v31
  v_mul_f32 v197, v197, v31
  v_mul_f32 v198, v198, v31
  v_mul_f32 v199, v199, v31
  v_mul_f32 v204, v204, v31
  v_mul_f32 v205, v205, v31
  v_cvt_pk_bf16_f32 v210, v192, v193
  v_cvt_pk_bf16_f32 v211, v194, v195
  v_cvt_pk_bf16_f32 v33, v200, v201
  v_cvt_pk_bf16_f32 v214, v196, v197
  v_cvt_pk_bf16_f32 v215, v198, v199
  v_cvt_pk_bf16_f32 v35, v204, v205
L_p2_out:
  buffer_store_dwordx4 v[208:211], v4, s[28:31], s58 offen sc1
  buffer_store_dwordx4 v[212:215], v4, s[28:31], s59 offen sc1
  s_mov_b64 exec, 0xffff
  buffer_store_dwordx2 v[32:33], v4, s[28:31], s54 offen sc1
  buffer_store_dwordx2 v[34:35], v4, s[28:31], s47 offen sc1
  s_mov_b64 exec, -1
  s_mov_b32 s50, s74
  s_mov_b32 s51, s75
  s_mov_b32 s53, s76
  s_cmp_ge_u32 s51, 6
  s_cbranch_scc1 L_p3_helper
  v_add_u32 v5, 65536, v4
  v_add_u32 v6, 131072, v4
  s_mul_i32 s46, s40, 12288
  v_add_u32 v7, s46, v4
  s_mul_i32 s46, s40, 15360
  v_add_u32 v8, s46, v4
  v_add_u32 v62, 114688, v7
  v_add_u32 v63, 53248, v8
  s_mul_i32 s54, s53, 18432
  s_mul_i32 s55, s51, 3072
  s_add_u32 s55, s55, s54
  s_lshl_b32 s46, s51, 2
  s_add_u32 s46, s46, s40
  s_mul_i32 s46, s46, 3072
  s_mul_i32 s78, s50, 73728
  s_add_u32 s78, s78, s46
  v_and_b32 v19, 1, v2
  v_cmp_eq_u32 s[56:57], 1, v19
  v_and_b32 v19, 2, v2
  v_cmp_eq_u32 s[68:69], 2, v19
  v_lshrrev_b32 v19, 2, v2
  v_cmp_eq_u32 s[76:77], v19, v3
  v_lshlrev_b32 v9, 3, v2
  s_lshl_b32 s46, s53, 4
  v_add_u32 v20, s46, v2
  s_mov_b32 s47, 18432
  v_subrev_u32 v21, 1, v20
  v_ashrrev_i32 v22, 4, v21
  v_mul_lo_u32 v22, v22, s47
  v_and_b32 v21, 15, v21
  v_lshl_add_u32 v21, v3, 4, v21
  v_lshl_add_u32 v56, v21, 4, v22
  v_subrev_u32 v21, -1, v20
  v_ashrrev_i32 v22, 4, v21
  v_mul_lo_u32 v22, v22, s47
  v_and_b32 v21, 15, v21
  v_lshl_add_u32 v21, v3, 4, v21
  v_lshl_add_u32 v57, v21, 4, v22
  v_subrev_u32 v21, 2, v20
  v_ashrrev_i32 v22, 4, v21
  v_mul_lo_u32 v22, v22, s47
  v_and_b32 v21, 15, v21
  v_lshl_add_u32 v21, v3, 4, v21
  v_lshl_add_u32 v58, v21, 4, v22
  v_subrev_u32 v21, -2, v20
  v_ashrrev_i32 v22, 4, v21
  v_mul_lo_u32 v22, v22, s47
  v_and_b32 v21, 15, v21
  v_lshl_add_u32 v21, v3, 4, v21
  v_lshl_add_u32 v59, v21, 4, v22
  v_cmp_gt_u32 vcc, 32, v1
  s_nop 1
  v_cndmask_b32 v60, v57, v56, vcc
  v_cndmask_b32 v61, v59, v58, vcc
  v_mov_b32 v20, s44
  v_mov_b32 v21, s44
  v_mov_b32 v22, s44
  v_mov_b32 v23, s44
  s_add_u32 s60, s54, 7667712
  s_add_u32 s61, s54, 7671808
  s_add_u32 s62, s54, 7675904
  s_add_u32 s63, s54, 7680000
  s_add_u32 s64, s54, 7684096
  s_waitcnt vmcnt(20)
  s_barrier
  s_mul_i32 s58, s79, 0
  s_add_u32 s58, s58, s73
  s_mov_b32 m0, s58
  s_nop 0
  buffer_load_dwordx4 v244, s[36:39], s3 offen offset:0 sc1 lds
  buffer_load_dwordx4 v245, s[36:39], s3 offen offset:1024 sc1 lds
  s_mov_b32 s79, 50000
  buffer_load_dwordx4 v[64:67], v4, s[28:31], s60 offen offset:0 sc1
  buffer_load_dwordx4 v[68:71], v4, s[28:31], s60 offen offset:1024 sc1
  buffer_load_dwordx4 v[72:75], v4, s[28:31], s60 offen offset:2048 sc1
  buffer_load_dwordx4 v[76:79], v4, s[28:31], s60 offen offset:3072 sc1
  buffer_load_dwordx4 v[80:83], v4, s[28:31], s61 offen offset:0 sc1
  buffer_load_dwordx4 v[84:87], v4, s[28:31], s61 offen offset:1024 sc1
  buffer_load_dwordx4 v[88:91], v4, s[28:31], s61 offen offset:2048 sc1
  buffer_load_dwordx4 v[92:95], v4, s[28:31], s61 offen offset:3072 sc1
  s_waitcnt vmcnt(8) lgkmcnt(0)
  s_barrier
  ds_write_b128 v7, a[40:43] offset:0
  ds_write_b128 v7, a[44:47] offset:1024
  ds_write_b128 v7, a[48:51] offset:2048
  ds_write_b128 v7, a[52:55] offset:3072
  ds_write_b128 v7, a[56:59] offset:4096
  ds_write_b128 v7, a[60:63] offset:5120
  ds_write_b128 v7, a[64:67] offset:6144
  ds_write_b128 v7, a[68:71] offset:7168
  ds_write_b128 v7, a[72:75] offset:8192
  ds_write_b128 v7, a[76:79] offset:9216
  ds_write_b128 v7, a[80:83] offset:10240
  ds_write_b128 v7, a[84:87] offset:11264
  ds_read_b128 v[160:163], v4 offset:53248
  ds_read_b128 v[164:167], v5 offset:6144
  ds_read_b128 v[168:171], v5 offset:24576
  ds_read_b128 v[172:175], v5 offset:43008
  ds_read_b128 v[176:179], v5 offset:61440
  ds_read_b128 v[180:183], v6 offset:14336
  ds_read_b128 v[184:187], v4 offset:54272
  ds_read_b128 v[188:191], v5 offset:7168
  ds_read_b128 v[192:195], v5 offset:25600
  ds_read_b128 v[196:199], v5 offset:44032
  ds_read_b128 v[200:203], v5 offset:62464
  ds_read_b128 v[204:207], v6 offset:15360
  ds_read_b128 v[208:211], v4 offset:55296
  ds_read_b128 v[212:215], v5 offset:8192
  ds_read_b128 v[216:219], v5 offset:26624
  ds_read_b128 v[220:223], v5 offset:45056
  ds_read_b128 v[224:227], v5 offset:63488
  ds_read_b128 v[228:231], v6 offset:16384
  ds_read_b128 a[0:3], v4 offset:62464
  ds_read_b128 a[4:7], v5 offset:15360
  ds_read_b128 a[8:11], v5 offset:33792
  ds_read_b128 a[12:15], v5 offset:52224
  ds_read_b128 a[16:19], v6 offset:5120
  ds_read_b128 a[20:23], v6 offset:23552
  v_lshlrev_b32 v136, 16, v232
  v_and_b32 v137, 0xffff0000, v232
  v_lshlrev_b32 v138, 16, v233
  v_and_b32 v139, 0xffff0000, v233
  v_lshlrev_b32 v140, 16, v234
  v_and_b32 v141, 0xffff0000, v234
  v_lshlrev_b32 v142, 16, v235
  v_and_b32 v143, 0xffff0000, v235
  v_lshlrev_b32 v144, 16, v236
  v_and_b32 v145, 0xffff0000, v236
  v_lshlrev_b32 v146, 16, v237
  v_and_b32 v147, 0xffff0000, v237
  v_lshlrev_b32 v148, 16, v238
  v_and_b32 v149, 0xffff0000, v238
  v_lshlrev_b32 v150, 16, v239
  v_and_b32 v151, 0xffff0000, v239
  v_lshlrev_b32 v152, 16, v240
  v_and_b32 v153, 0xffff0000, v240
  v_lshlrev_b32 v154, 16, v241
  v_and_b32 v155, 0xffff0000, v241
  v_lshlrev_b32 v156, 16, v242
  v_and_b32 v157, 0xffff0000, v242
  v_lshlrev_b32 v158, 16, v243
  v_and_b32 v159, 0xffff0000, v243
  s_waitcnt vmcnt(6)
  v_max3_u32 v30, v64, v65, v66
  v_max3_u32 v30, v30, v67, v68
  v_max3_u32 v30, v30, v69, v70
  v_max_u32 v30, v30, v71
  v_cmp_eq_u32 vcc, -1, v30
  s_cbranch_vccnz Ltg_87
Ltg_87_b:
  s_waitcnt lgkmcnt(15)
  v_mfma_f32_16x16x32_bf16 v[136:139], v[160:163], v[64:67], v[136:139]
  buffer_load_dwordx4 v[96:99], v4, s[28:31], s62 offen offset:0 sc1
  v_mfma_f32_16x16x32_bf16 v[140:143], v[164:167], v[64:67], v[140:143]
  v_mfma_f32_16x16x32_bf16 v[144:147], v[168:171], v[64:67], v[144:147]
  v_mfma_f32_16x16x32_bf16 v[148:151], v[172:175], v[64:67], v[148:151]
  v_mfma_f32_16x16x32_bf16 v[152:155], v[176:179], v[64:67], v[152:155]
  v_mfma_f32_16x16x32_bf16 v[156:159], v[180:183], v[64:67], v[156:159]
  s_waitcnt vmcnt(5) lgkmcnt(12)
  v_mfma_f32_16x16x32_bf16 v[136:139], v[184:187], v[68:71], v[136:139]
  buffer_load_dwordx4 v[100:103], v4, s[28:31], s62 offen offset:1024 sc1
  v_max3_u32 v30, v72, v73, v74
  v_mfma_f32_16x16x32_bf16 v[140:143], v[188:191], v[68:71], v[140:143]
  v_max3_u32 v30, v30, v75, v76
  v_max3_u32 v30, v30, v77, v78
  v_mfma_f32_16x16x32_bf16 v[144:147], v[192:195], v[68:71], v[144:147]
  v_max_u32 v30, v30, v79
  v_cmp_eq_u32 vcc, -1, v30
  v_mfma_f32_16x16x32_bf16 v[148:151], v[196:199], v[68:71], v[148:151]
  ds_read_b128 v[160:163], v4 offset:56320
  ds_read_b128 v[164:167], v5 offset:9216
  v_mfma_f32_16x16x32_bf16 v[152:155], v[200:203], v[68:71], v[152:155]
  ds_read_b128 v[168:171], v5 offset:27648
  ds_read_b128 v[172:175], v5 offset:46080
  v_mfma_f32_16x16x32_bf16 v[156:159], v[204:207], v[68:71], v[156:159]
  ds_read_b128 v[176:179], v5 offset:64512
  ds_read_b128 v[180:183], v6 offset:17408
  s_cbranch_vccnz Ltg_88
Ltg_88_b:
  s_waitcnt lgkmcnt(12)
  v_mfma_f32_16x16x32_bf16 v[136:139], v[208:211], v[72:75], v[136:139]
  buffer_load_dwordx4 v[104:107], v4, s[28:31], s62 offen offset:2048 sc1
  ds_read_b128 v[184:187], v4 offset:57344
  v_mfma_f32_16x16x32_bf16 v[140:143], v[212:215], v[72:75], v[140:143]
  ds_read_b128 v[188:191], v5 offset:10240
  v_mfma_f32_16x16x32_bf16 v[144:147], v[216:219], v[72:75], v[144:147]
  ds_read_b128 v[192:195], v5 offset:28672
  v_mfma_f32_16x16x32_bf16 v[148:151], v[220:223], v[72:75], v[148:151]
  ds_read_b128 v[196:199], v5 offset:47104
  v_mfma_f32_16x16x32_bf16 v[152:155], v[224:227], v[72:75], v[152:155]
  ds_read_b128 v[200:203], v6 offset:0
  v_mfma_f32_16x16x32_bf16 v[156:159], v[228:231], v[72:75], v[156:159]
  ds_read_b128 v[204:207], v6 offset:18432
  s_waitcnt vmcnt(5) lgkmcnt(6)
  v_mfma_f32_16x16x32_bf16 v[136:139], v[160:163], v[76:79], v[136:139]
  buffer_load_dwordx4 v[108:111], v4, s[28:31], s62 offen offset:3072 sc1
  v_max3_u32 v30, v80, v81, v82
  v_mfma_f32_16x16x32_bf16 v[140:143], v[164:167], v[76:79], v[140:143]
  v_max3_u32 v30, v30, v83, v84
  v_max3_u32 v30, v30, v85, v86
  v_mfma_f32_16x16x32_bf16 v[144:147], v[168:171], v[76:79], v[144:147]
  v_max_u32 v30, v30, v87
  v_cmp_eq_u32 vcc, -1, v30
  v_mfma_f32_16x16x32_bf16 v[148:151], v[172:175], v[76:79], v[148:151]
  ds_read_b128 v[208:211], v4 offset:58368
  ds_read_b128 v[212:215], v5 offset:11264
  v_mfma_f32_16x16x32_bf16 v[152:155], v[176:179], v[76:79], v[152:155]
  ds_read_b128 v[216:219], v5 offset:29696
  ds_read_b128 v[220:223], v5 offset:48128
  v_mfma_f32_16x16x32_bf16 v[156:159], v[180:183], v[76:79], v[156:159]
  ds_read_b128 v[224:227], v6 offset:1024
  ds_read_b128 v[228:231], v6 offset:19456
  s_cbranch_vccnz Ltg_89
Ltg_89_b:
  s_waitcnt lgkmcnt(6)
  v_mfma_f32_16x16x32_bf16 v[136:139], v[184:187], v[80:83], v[136:139]
  buffer_load_dwordx4 v[112:115], v4, s[28:31], s63 offen offset:0 sc1
  ds_read_b128 v[160:163], v4 offset:59392
  v_mfma_f32_16x16x32_bf16 v[140:143], v[188:191], v[80:83], v[140:143]
  ds_read_b128 v[164:167], v5 offset:12288
  v_mfma_f32_16x16x32_bf16 v[144:147], v[192:195], v[80:83], v[144:147]
  ds_read_b128 v[168:171], v5 offset:30720
  v_mfma_f32_16x16x32_bf16 v[148:151], v[196:199], v[80:83], v[148:151]
  ds_read_b128 v[172:175], v5 offset:49152
  v_mfma_f32_16x16x32_bf16 v[152:155], v[200:203], v[80:83], v[152:155]
  ds_read_b128 v[176:179], v6 offset:2048
  v_mfma_f32_16x16x32_bf16 v[156:159], v[204:207], v[80:83], v[156:159]
  ds_read_b128 v[180:183], v6 offset:20480
  s_waitcnt vmcnt(5) lgkmcnt(6)
  v_mfma_f32_16x16x32_bf16 v[136:139], v[208:211], v[84:87], v[136:139]
  buffer_load_dwordx4 v[116:119], v4, s[28:31], s63 offen offset:1024 sc1
  v_max3_u32 v30, v88, v89, v90
  v_mfma_f32_16x16x32_bf16 v[140:143], v[212:215], v[84:87], v[140:143]
  v_max3_u32 v30, v30, v91, v92
  v_max3_u32 v30, v30, v93, v94
  v_mfma_f32_16x16x32_bf16 v[144:147], v[216:219], v[84:87], v[144:147]
  v_max_u32 v30, v30, v95
  v_cmp_eq_u32 vcc, -1, v30
  v_mfma_f32_16x16x32_bf16 v[148:151], v[220:223], v[84:87], v[148:151]
  ds_read_b128 v[184:187], v4 offset:60416
  ds_read_b128 v[188:191], v5 offset:13312
  v_mfma_f32_16x16x32_bf16 v[152:155], v[224:227], v[84:87], v[152:155]
  ds_read_b128 v[192:195], v5 offset:31744
  ds_read_b128 v[196:199], v5 offset:50176
  v_mfma_f32_16x16x32_bf16 v[156:159], v[228:231], v[84:87], v[156:159]
  ds_read_b128 v[200:203], v6 offset:3072
  ds_read_b128 v[204:207], v6 offset:21504
  s_cbranch_vccnz Ltg_90
Ltg_90_b:
  s_waitcnt lgkmcnt(6)
  v_mfma_f32_16x16x32_bf16 v[136:139], v[160:163], v[88:91], v[136:139]
  buffer_load_dwordx4 v[120:123], v4, s[28:31], s63 offen offset:2048 sc1
  ds_read_b128 v[208:211], v4 offset:61440
  v_mfma_f32_16x16x32_bf16 v[140:143], v[164:167], v[88:91], v[140:143]
  ds_read_b128 v[212:215], v5 offset:14336
  v_mfma_f32_16x16x32_bf16 v[144:147], v[168:171], v[88:91], v[144:147]
  ds_read_b128 v[216:219], v5 offset:32768
  v_mfma_f32_16x16x32_bf16 v[148:151], v[172:175], v[88:91], v[148:151]
  ds_read_b128 v[220:223], v5 offset:51200
  v_mfma_f32_16x16x32_bf16 v[152:155], v[176:179], v[88:91], v[152:155]
  ds_read_b128 v[224:227], v6 offset:4096
  v_mfma_f32_16x16x32_bf16 v[156:159], v[180:183], v[88:91], v[156:159]
  ds_read_b128 v[228:231], v6 offset:22528
  s_waitcnt vmcnt(5) lgkmcnt(6)
  v_mfma_f32_16x16x32_bf16 v[136:139], v[184:187], v[92:95], v[136:139]
  buffer_load_dwordx4 v[124:127], v4, s[28:31], s63 offen offset:3072 sc1
  v_max3_u32 v30, v96, v97, v98
  v_mfma_f32_16x16x32_bf16 v[140:143], v[188:191], v[92:95], v[140:143]
  v_max3_u32 v30, v30, v99, v100
  v_max3_u32 v30, v30, v101, v102
  v_mfma_f32_16x16x32_bf16 v[144:147], v[192:195], v[92:95], v[144:147]
  v_max_u32 v30, v30, v103
  v_cmp_eq_u32 vcc, -1, v30
  v_mfma_f32_16x16x32_bf16 v[148:151], v[196:199], v[92:95], v[148:151]
  ds_read_b128 v[160:163], v4 offset:63488
  ds_read_b128 v[164:167], v5 offset:16384
  v_mfma_f32_16x16x32_bf16 v[152:155], v[200:203], v[92:95], v[152:155]
  ds_read_b128 v[168:171], v5 offset:34816
  ds_read_b128 v[172:175], v5 offset:53248
  v_mfma_f32_16x16x32_bf16 v[156:159], v[204:207], v[92:95], v[156:159]
  ds_read_b128 v[176:179], v6 offset:6144
  ds_read_b128 v[180:183], v6 offset:24576
  s_cbranch_vccnz Ltg_91
Ltg_91_b:
  s_waitcnt lgkmcnt(6)
  v_mfma_f32_16x16x32_bf16 v[136:139], v[208:211], v[96:99], v[136:139]
  buffer_load_dwordx4 v[128:131], v4, s[28:31], s64 offen offset:0 sc1
  ds_read_b128 v[184:187], v4 offset:64512
  v_mfma_f32_16x16x32_bf16 v[140:143], v[212:215], v[96:99], v[140:143]
  ds_read_b128 v[188:191], v5 offset:17408
  v_mfma_f32_16x16x32_bf16 v[144:147], v[216:219], v[96:99], v[144:147]
  ds_read_b128 v[192:195], v5 offset:35840
  v_mfma_f32_16x16x32_bf16 v[148:151], v[220:223], v[96:99], v[148:151]
  ds_read_b128 v[196:199], v5 offset:54272
  v_mfma_f32_16x16x32_bf16 v[152:155], v[224:227], v[96:99], v[152:155]
  ds_read_b128 v[200:203], v6 offset:7168
  v_mfma_f32_16x16x32_bf16 v[156:159], v[228:231], v[96:99], v[156:159]
  ds_read_b128 v[204:207], v6 offset:25600
  s_waitcnt vmcnt(5)
  v_mfma_f32_16x16x32_bf16 v[136:139], a[0:3], v[100:103], v[136:139]
  buffer_load_dwordx4 v[132:135], v4, s[28:31], s64 offen offset:1024 sc1
  v_max3_u32 v30, v104, v105, v106
  v_max3_u32 v30, v30, v107, v108
  v_mfma_f32_16x16x32_bf16 v[140:143], a[4:7], v[100:103], v[140:143]
  v_max3_u32 v30, v30, v109, v110
  v_max_u32 v30, v30, v111
  v_mfma_f32_16x16x32_bf16 v[144:147], a[8:11], v[100:103], v[144:147]
  v_cmp_eq_u32 vcc, -1, v30
  ds_read_b128 v[208:211], v5 offset:0
  v_mfma_f32_16x16x32_bf16 v[148:151], a[12:15], v[100:103], v[148:151]
  ds_read_b128 v[212:215], v5 offset:18432
  ds_read_b128 v[216:219], v5 offset:36864
  v_mfma_f32_16x16x32_bf16 v[152:155], a[16:19], v[100:103], v[152:155]
  ds_read_b128 v[220:223], v5 offset:55296
  ds_read_b128 v[224:227], v6 offset:8192
  v_mfma_f32_16x16x32_bf16 v[156:159], a[20:23], v[100:103], v[156:159]
  ds_read_b128 v[228:231], v6 offset:26624
  s_add_u32 s59, s72, 0
  buffer_load_dwordx4 a[148:151], v4, s[28:31], s59 offen offset:0 sc1
  s_cbranch_vccnz Ltg_92
Ltg_92_b:
  s_waitcnt lgkmcnt(12)
  v_mfma_f32_16x16x32_bf16 v[136:139], v[160:163], v[104:107], v[136:139]
  buffer_load_dwordx4 a[152:155], v4, s[28:31], s59 offen offset:1024 sc1
  v_mfma_f32_16x16x32_bf16 v[140:143], v[164:167], v[104:107], v[140:143]
  v_mfma_f32_16x16x32_bf16 v[144:147], v[168:171], v[104:107], v[144:147]
  v_mfma_f32_16x16x32_bf16 v[148:151], v[172:175], v[104:107], v[148:151]
  buffer_load_dwordx4 a[156:159], v4, s[28:31], s59 offen offset:2048 sc1
  v_mfma_f32_16x16x32_bf16 v[152:155], v[176:179], v[104:107], v[152:155]
  v_mfma_f32_16x16x32_bf16 v[156:159], v[180:183], v[104:107], v[156:159]
  s_waitcnt vmcnt(7) lgkmcnt(6)
  v_mfma_f32_16x16x32_bf16 v[136:139], v[184:187], v[108:111], v[136:139]
  v_max3_u32 v30, v112, v113, v114
  v_max3_u32 v30, v30, v115, v116
  v_mfma_f32_16x16x32_bf16 v[140:143], v[188:191], v[108:111], v[140:143]
  v_max3_u32 v30, v30, v117, v118
  v_max_u32 v30, v30, v119
  v_mfma_f32_16x16x32_bf16 v[144:147], v[192:195], v[108:111], v[144:147]
  v_cmp_eq_u32 vcc, -1, v30
  ds_read_b128 v[160:163], v5 offset:1024
  v_mfma_f32_16x16x32_bf16 v[148:151], v[196:199], v[108:111], v[148:151]
  ds_read_b128 v[164:167], v5 offset:19456
  ds_read_b128 v[168:171], v5 offset:37888
  v_mfma_f32_16x16x32_bf16 v[152:155], v[200:203], v[108:111], v[152:155]
  ds_read_b128 v[172:175], v5 offset:56320
  ds_read_b128 v[176:179], v6 offset:9216
  v_mfma_f32_16x16x32_bf16 v[156:159], v[204:207], v[108:111], v[156:159]
  ds_read_b128 v[180:183], v6 offset:27648
  buffer_load_dwordx4 a[160:163], v4, s[28:31], s59 offen offset:3072 sc1
  s_cbranch_vccnz Ltg_93
Ltg_93_b:
  s_waitcnt lgkmcnt(6)
  v_mfma_f32_16x16x32_bf16 v[136:139], v[208:211], v[112:115], v[136:139]
  ds_read_b128 v[184:187], v5 offset:2048
  ds_read_b128 v[188:191], v5 offset:20480
  v_mfma_f32_16x16x32_bf16 v[140:143], v[212:215], v[112:115], v[140:143]
  ds_read_b128 v[192:195], v5 offset:38912
  v_mfma_f32_16x16x32_bf16 v[144:147], v[216:219], v[112:115], v[144:147]
  ds_read_b128 v[196:199], v5 offset:57344
  v_mfma_f32_16x16x32_bf16 v[148:151], v[220:223], v[112:115], v[148:151]
  ds_read_b128 v[200:203], v6 offset:10240
  ds_read_b128 v[204:207], v6 offset:28672
  v_mfma_f32_16x16x32_bf16 v[152:155], v[224:227], v[112:115], v[152:155]
  s_add_u32 s59, s72, 4096
  buffer_load_dwordx4 a[164:167], v4, s[28:31], s59 offen offset:0 sc1
  v_mfma_f32_16x16x32_bf16 v[156:159], v[228:231], v[112:115], v[156:159]
  buffer_load_dwordx4 a[168:171], v4, s[28:31], s59 offen offset:1024 sc1
  s_waitcnt vmcnt(8) lgkmcnt(6)
  v_mfma_f32_16x16x32_bf16 v[136:139], v[160:163], v[116:119], v[136:139]
  v_max3_u32 v30, v120, v121, v122
  v_max3_u32 v30, v30, v123, v124
  v_mfma_f32_16x16x32_bf16 v[140:143], v[164:167], v[116:119], v[140:143]
  v_max3_u32 v30, v30, v125, v126
  v_max_u32 v30, v30, v127
  v_mfma_f32_16x16x32_bf16 v[144:147], v[168:171], v[116:119], v[144:147]
  v_cmp_eq_u32 vcc, -1, v30
  ds_read_b128 v[208:211], v5 offset:3072
  v_mfma_f32_16x16x32_bf16 v[148:151], v[172:175], v[116:119], v[148:151]
  ds_read_b128 v[212:215], v5 offset:21504
  ds_read_b128 v[216:219], v5 offset:39936
  v_mfma_f32_16x16x32_bf16 v[152:155], v[176:179], v[116:119], v[152:155]
  ds_read_b128 v[220:223], v5 offset:58368
  ds_read_b128 v[224:227], v6 offset:11264
  v_mfma_f32_16x16x32_bf16 v[156:159], v[180:183], v[116:119], v[156:159]
  ds_read_b128 v[228:231], v6 offset:29696
  buffer_load_dwordx4 a[172:175], v4, s[28:31], s59 offen offset:2048 sc1
  s_cbranch_vccnz Ltg_94
Ltg_94_b:
  s_waitcnt lgkmcnt(6)
  v_mfma_f32_16x16x32_bf16 v[136:139], v[184:187], v[120:123], v[136:139]
  ds_read_b128 v[160:163], v5 offset:4096
  ds_read_b128 v[164:167], v5 offset:22528
  v_mfma_f32_16x16x32_bf16 v[140:143], v[188:191], v[120:123], v[140:143]
  ds_read_b128 v[168:171], v5 offset:40960
  v_mfma_f32_16x16x32_bf16 v[144:147], v[192:195], v[120:123], v[144:147]
  ds_read_b128 v[172:175], v5 offset:59392
  v_mfma_f32_16x16x32_bf16 v[148:151], v[196:199], v[120:123], v[148:151]
  ds_read_b128 v[176:179], v6 offset:12288
  ds_read_b128 v[180:183], v6 offset:30720
  v_mfma_f32_16x16x32_bf16 v[152:155], v[200:203], v[120:123], v[152:155]
  buffer_load_dwordx4 a[176:179], v4, s[28:31], s59 offen offset:3072 sc1
  v_mfma_f32_16x16x32_bf16 v[156:159], v[204:207], v[120:123], v[156:159]
  s_add_u32 s59, s72, 8192
  buffer_load_dwordx4 a[180:183], v4, s[28:31], s59 offen offset:0 sc1
  s_waitcnt vmcnt(9) lgkmcnt(6)
  v_mfma_f32_16x16x32_bf16 v[136:139], v[208:211], v[124:127], v[136:139]
  v_max3_u32 v30, v128, v129, v130
  v_max3_u32 v30, v30, v131, v132
  v_mfma_f32_16x16x32_bf16 v[140:143], v[212:215], v[124:127], v[140:143]
  v_max3_u32 v30, v30, v133, v134
  v_max_u32 v30, v30, v135
  v_mfma_f32_16x16x32_bf16 v[144:147], v[216:219], v[124:127], v[144:147]
  v_cmp_eq_u32 vcc, -1, v30
  ds_read_b128 v[184:187], v5 offset:5120
  v_mfma_f32_16x16x32_bf16 v[148:151], v[220:223], v[124:127], v[148:151]
  ds_read_b128 v[188:191], v5 offset:23552
  ds_read_b128 v[192:195], v5 offset:41984
  v_mfma_f32_16x16x32_bf16 v[152:155], v[224:227], v[124:127], v[152:155]
  ds_read_b128 v[196:199], v5 offset:60416
  ds_read_b128 v[200:203], v6 offset:13312
  v_mfma_f32_16x16x32_bf16 v[156:159], v[228:231], v[124:127], v[156:159]
  ds_read_b128 v[204:207], v6 offset:31744
  buffer_load_dwordx4 a[184:187], v4, s[28:31], s59 offen offset:1024 sc1
  s_cbranch_vccnz Ltg_95
Ltg_95_b:
  s_waitcnt lgkmcnt(6)
  v_mfma_f32_16x16x32_bf16 v[136:139], v[160:163], v[128:131], v[136:139]
  buffer_load_dwordx4 a[188:191], v4, s[28:31], s59 offen offset:2048 sc1
  v_mfma_f32_16x16x32_bf16 v[140:143], v[164:167], v[128:131], v[140:143]
  v_mfma_f32_16x16x32_bf16 v[144:147], v[168:171], v[128:131], v[144:147]
  v_mfma_f32_16x16x32_bf16 v[148:151], v[172:175], v[128:131], v[148:151]
  buffer_load_dwordx4 a[192:195], v4, s[28:31], s59 offen offset:3072 sc1
  v_mfma_f32_16x16x32_bf16 v[152:155], v[176:179], v[128:131], v[152:155]
  v_mfma_f32_16x16x32_bf16 v[156:159], v[180:183], v[128:131], v[156:159]
  s_waitcnt lgkmcnt(0)
  v_mfma_f32_16x16x32_bf16 v[136:139], v[184:187], v[132:135], v[136:139]
  v_mfma_f32_16x16x32_bf16 v[140:143], v[188:191], v[132:135], v[140:143]
  v_mfma_f32_16x16x32_bf16 v[144:147], v[192:195], v[132:135], v[144:147]
  v_mfma_f32_16x16x32_bf16 v[148:151], v[196:199], v[132:135], v[148:151]
  v_mfma_f32_16x16x32_bf16 v[152:155], v[200:203], v[132:135], v[152:155]
  v_mfma_f32_16x16x32_bf16 v[156:159], v[204:207], v[132:135], v[156:159]
  s_mov_b32 s46, 521216
  buffer_load_dwordx4 v[16:19], v4, s[28:31], s46 offen sc1
  s_nop 0
  v_cvt_pk_bf16_f32 v40, v136, v137
  v_cvt_pk_bf16_f32 v41, v138, v139
  v_cvt_pk_bf16_f32 v42, v140, v141
  v_cvt_pk_bf16_f32 v43, v142, v143
  v_cvt_pk_bf16_f32 v44, v144, v145
  v_cvt_pk_bf16_f32 v45, v146, v147
  v_cvt_pk_bf16_f32 v46, v148, v149
  v_cvt_pk_bf16_f32 v47, v150, v151
  v_cvt_pk_bf16_f32 v48, v152, v153
  v_cvt_pk_bf16_f32 v49, v154, v155
  v_cvt_pk_bf16_f32 v50, v156, v157
  v_cvt_pk_bf16_f32 v51, v158, v159
  v_mfma_f32_16x16x32_bf16 v[184:187], v[20:23], v[40:43], 0
  v_mfma_f32_16x16x32_bf16 v[188:191], v[40:43], v[40:43], 0
  v_mfma_f32_16x16x32_bf16 v[184:187], v[20:23], v[44:47], v[184:187]
  v_mfma_f32_16x16x32_bf16 v[188:191], v[44:47], v[44:47], v[188:191]
  v_mfma_f32_16x16x32_bf16 v[184:187], v[20:23], v[48:51], v[184:187]
  v_mfma_f32_16x16x32_bf16 v[188:191], v[48:51], v[48:51], v[188:191]
  s_add_u32 s46, s55, 10027008
  buffer_store_dwordx4 v[40:43], v4, s[28:31], s46 offen offset:0 sc1
  buffer_store_dwordx4 v[44:47], v4, s[28:31], s46 offen offset:1024 sc1
  buffer_store_dwordx4 v[48:51], v4, s[28:31], s46 offen offset:2048 sc1
  s_mul_i32 s46, s53, 6
  s_add_u32 s46, s46, s51
  s_lshl_b32 s46, s46, 7
  s_add_u32 s46, s46, 12386304
  v_cndmask_b32 v188, v188, v189, s[56:57]
  v_cndmask_b32 v190, v190, v191, s[56:57]
  v_cndmask_b32 v185, v188, v190, s[68:69]
  s_mov_b64 exec, s[76:77]
  buffer_store_dwordx2 v[184:185], v9, s[28:31], s46 offen sc1
  s_mov_b64 exec, -1
  s_mul_i32 s46, s40, 192
  s_add_u32 s46, s46, 49152
  v_lshl_add_u32 v24, v3, 4, s46
  v_lshlrev_b32 v14, 3, v1
  v_add_u32 v15, 512, v14
  v_cmp_gt_u32 vcc, 32, v1
  v_mov_b32 v10, 0x7fffffff
  s_nop 0
  v_cndmask_b32 v15, v10, v15, vcc
  s_mul_i32 s46, s53, 768
  s_add_u32 s46, s46, 12386304
  s_mov_b32 s65, s46
  s_add_u32 s60, s54, 10027008
  s_add_u32 s61, s54, 10031104
  s_add_u32 s62, s54, 10035200
  s_add_u32 s63, s54, 10039296
  s_add_u32 s64, s54, 10043392
  s_waitcnt vmcnt(20)
  s_barrier
  v_mfma_f32_16x16x32_bf16 v[160:163], a[40:43], v[20:23], 0
  ds_write_b128 v63, a[88:91] offset:0
  v_mfma_f32_16x16x32_bf16 v[164:167], a[76:79], v[20:23], 0
  ds_write_b128 v63, a[92:95] offset:1024
  v_mfma_f32_16x16x32_bf16 v[168:171], a[112:115], v[20:23], 0
  v_mfma_f32_16x16x32_bf16 v[160:163], a[44:47], v[20:23], v[160:163]
  ds_write_b128 v63, a[96:99] offset:2048
  v_mfma_f32_16x16x32_bf16 v[164:167], a[80:83], v[20:23], v[164:167]
  v_mfma_f32_16x16x32_bf16 v[168:171], a[116:119], v[20:23], v[168:171]
  ds_write_b128 v63, a[100:103] offset:3072
  v_mfma_f32_16x16x32_bf16 v[160:163], a[48:51], v[20:23], v[160:163]
  v_mfma_f32_16x16x32_bf16 v[164:167], a[84:87], v[20:23], v[164:167]
  ds_write_b128 v63, a[104:107] offset:4096
  v_mfma_f32_16x16x32_bf16 v[168:171], a[120:123], v[20:23], v[168:171]
  v_mfma_f32_16x16x32_bf16 v[160:163], a[52:55], v[20:23], v[160:163]
  s_mov_b32 s79, 50000
  buffer_load_dwordx2 v[10:11], v14, s[28:31], s65 offen sc1
  buffer_load_dwordx2 v[12:13], v15, s[28:31], s65 offen sc1
  buffer_load_dwordx4 v[64:67], v4, s[28:31], s60 offen offset:0 sc1
  ds_write_b128 v63, a[108:111] offset:5120
  v_mfma_f32_16x16x32_bf16 v[164:167], a[88:91], v[20:23], v[164:167]
  ds_write_b128 v63, a[112:115] offset:6144
  v_mfma_f32_16x16x32_bf16 v[168:171], a[124:127], v[20:23], v[168:171]
  buffer_load_dwordx4 v[68:71], v4, s[28:31], s60 offen offset:1024 sc1
  v_mfma_f32_16x16x32_bf16 v[160:163], a[56:59], v[20:23], v[160:163]
  ds_write_b128 v63, a[116:119] offset:7168
  v_mfma_f32_16x16x32_bf16 v[164:167], a[92:95], v[20:23], v[164:167]
  v_mfma_f32_16x16x32_bf16 v[168:171], a[128:131], v[20:23], v[168:171]
  buffer_load_dwordx4 v[72:75], v4, s[28:31], s60 offen offset:2048 sc1
  ds_write_b128 v63, a[120:123] offset:8192
  v_mfma_f32_16x16x32_bf16 v[160:163], a[60:63], v[20:23], v[160:163]
  v_mfma_f32_16x16x32_bf16 v[164:167], a[96:99], v[20:23], v[164:167]
  ds_write_b128 v63, a[124:127] offset:9216
  buffer_load_dwordx4 v[76:79], v4, s[28:31], s60 offen offset:3072 sc1
  v_mfma_f32_16x16x32_bf16 v[168:171], a[132:135], v[20:23], v[168:171]
  v_mfma_f32_16x16x32_bf16 v[160:163], a[64:67], v[20:23], v[160:163]
  ds_write_b128 v63, a[128:131] offset:10240
  v_mfma_f32_16x16x32_bf16 v[164:167], a[100:103], v[20:23], v[164:167]
  buffer_load_dwordx4 v[80:83], v4, s[28:31], s61 offen offset:0 sc1
  ds_write_b128 v63, a[132:135] offset:11264
  v_mfma_f32_16x16x32_bf16 v[168:171], a[136:139], v[20:23], v[168:171]
  v_mfma_f32_16x16x32_bf16 v[160:163], a[68:71], v[20:23], v[160:163]
  ds_write_b128 v63, a[136:139] offset:12288
  buffer_load_dwordx4 v[84:87], v4, s[28:31], s61 offen offset:1024 sc1
  v_mfma_f32_16x16x32_bf16 v[164:167], a[104:107], v[20:23], v[164:167]
  v_mfma_f32_16x16x32_bf16 v[168:171], a[140:143], v[20:23], v[168:171]
  ds_write_b128 v63, a[140:143] offset:13312
  v_mfma_f32_16x16x32_bf16 v[160:163], a[72:75], v[20:23], v[160:163]
  buffer_load_dwordx4 v[88:91], v4, s[28:31], s61 offen offset:2048 sc1
  v_mfma_f32_16x16x32_bf16 v[164:167], a[108:111], v[20:23], v[164:167]
  ds_write_b128 v63, a[144:147] offset:14336
  v_mfma_f32_16x16x32_bf16 v[168:171], a[144:147], v[20:23], v[168:171]
  s_nop 7
  buffer_load_dwordx4 v[92:95], v4, s[28:31], s61 offen offset:3072 sc1
  ds_write_b128 v24, v[160:163] offset:0
  ds_write_b128 v24, v[164:167] offset:64
  ds_write_b128 v24, v[168:171] offset:128
  s_waitcnt vmcnt(10) lgkmcnt(0)
  s_cmp_lg_u32 s40, 0
  s_cbranch_scc1 Lm2_96_x
  s_mov_b32 s47, 100000
Lm2_96:
  v_xor_b32 v16, s43, v16
  v_xor_b32 v17, s43, v17
  v_xor_b32 v18, s43, v18
  v_xor_b32 v19, s43, v19
  v_or3_b32 v16, v16, v17, v18
  v_or_b32 v16, v16, v19
  v_cmp_ne_u32 vcc, 0, v16
  s_cbranch_vccz Lm2_96_x
  s_mov_b32 s46, 521216
  buffer_load_dwordx4 v[16:19], v4, s[28:31], s46 offen sc1
  s_waitcnt vmcnt(0)
  s_sub_u32 s47, s47, 1
  s_cbranch_scc0 Lm2_96
Lm2_96_x:
  s_barrier
  v_lshlrev_b32 v24, 4, v3
  ds_read_b128 v[232:235], v24 offset:49152
  ds_read_b128 v[136:139], v24 offset:49216
  ds_read_b128 v[236:239], v24 offset:49280
  ds_read_b128 v[140:143], v24 offset:49344
  ds_read_b128 v[240:243], v24 offset:49408
  ds_read_b128 v[144:147], v24 offset:49472
  ds_read_b128 v[244:247], v24 offset:49536
  ds_read_b128 v[148:151], v24 offset:49600
  ds_read_b128 v[248:251], v24 offset:49664
  ds_read_b128 v[152:155], v24 offset:49728
  ds_read_b128 v[252:255], v24 offset:49792
  ds_read_b128 v[156:159], v24 offset:49856
  ds_read_b128 v[160:163], v4 offset:0
  ds_read_b128 v[164:167], v4 offset:59392
  ds_read_b128 v[168:171], v4 offset:21504
  ds_read_b128 v[172:175], v4 offset:24576
  ds_read_b128 v[176:179], v5 offset:24576
  ds_read_b128 v[180:183], v4 offset:46080
  ds_read_b128 v[184:187], v4 offset:1024
  ds_read_b128 v[188:191], v4 offset:60416
  ds_read_b128 v[192:195], v4 offset:22528
  ds_read_b128 v[196:199], v4 offset:25600
  ds_read_b128 v[200:203], v5 offset:25600
  ds_read_b128 v[204:207], v4 offset:47104
  ds_read_b128 v[208:211], v4 offset:2048
  ds_read_b128 v[212:215], v4 offset:61440
  ds_read_b128 v[216:219], v4 offset:23552
  ds_read_b128 v[220:223], v4 offset:26624
  ds_read_b128 v[224:227], v5 offset:26624
  ds_read_b128 v[228:231], v4 offset:48128
  ds_read_b128 a[40:43], v4 offset:4096
  ds_read_b128 a[44:47], v4 offset:63488
  ds_read_b128 a[48:51], v5 offset:4096
  ds_read_b128 a[52:55], v4 offset:28672
  ds_read_b128 a[56:59], v5 offset:28672
  ds_read_b128 a[60:63], v5 offset:34816
  ds_read_b128 a[64:67], v4 offset:9216
  ds_read_b128 a[68:71], v4 offset:12288
  ds_read_b128 a[72:75], v5 offset:9216
  ds_read_b128 a[76:79], v4 offset:33792
  ds_read_b128 a[80:83], v4 offset:36864
  ds_read_b128 a[84:87], v5 offset:39936
  ds_read_b128 a[88:91], v4 offset:54272
  ds_read_b128 a[92:95], v4 offset:16384
  ds_read_b128 a[96:99], v5 offset:13312
  ds_read_b128 a[100:103], v5 offset:19456
  ds_read_b128 a[104:107], v4 offset:40960
  ds_read_b128 a[108:111], v5 offset:44032
  s_waitcnt lgkmcnt(15)
  v_pk_add_f32 v[232:233], v[232:233], v[136:137]
  v_pk_add_f32 v[234:235], v[234:235], v[138:139]
  v_pk_add_f32 v[236:237], v[236:237], v[140:141]
  v_pk_add_f32 v[238:239], v[238:239], v[142:143]
  v_pk_add_f32 v[240:241], v[240:241], v[144:145]
  v_pk_add_f32 v[242:243], v[242:243], v[146:147]
  v_pk_add_f32 v[244:245], v[244:245], v[148:149]
  v_pk_add_f32 v[246:247], v[246:247], v[150:151]
  v_pk_add_f32 v[248:249], v[248:249], v[152:153]
  v_pk_add_f32 v[250:251], v[250:251], v[154:155]
  v_pk_add_f32 v[252:253], v[252:253], v[156:157]
  v_pk_add_f32 v[254:255], v[254:255], v[158:159]
  s_waitcnt vmcnt(8)
  v_max3_u32 v30, v10, v11, v12
  v_max_u32 v30, v30, v13
  v_cmp_eq_u32 vcc, -1, v30
  s_cbranch_vccnz Ltg_97
Ltg_97_b:
  s_waitcnt vmcnt(6)
  v_max3_u32 v30, v64, v65, v66
  v_max3_u32 v30, v30, v67, v68
  v_max3_u32 v30, v30, v69, v70
  v_max_u32 v30, v30, v71
  v_cmp_eq_u32 vcc, -1, v30
  s_cbranch_vccnz Ltg_98
Ltg_98_b:
  s_waitcnt lgkmcnt(15)
  v_mfma_f32_16x16x32_bf16 v[136:139], v[160:163], v[64:67], 0
  buffer_load_dwordx4 v[96:99], v4, s[28:31], s62 offen offset:0 sc1
  v_add_f32 v10, v10, v12
  v_mfma_f32_16x16x32_bf16 v[140:143], v[164:167], v[64:67], 0
  v_add_f32 v11, v11, v13
  v_mov_b32 v12, v10
  v_mfma_f32_16x16x32_bf16 v[144:147], v[168:171], v[64:67], 0
  v_mov_b32 v13, v11
  v_permlane32_swap_b32 v10, v12
  v_mfma_f32_16x16x32_bf16 v[148:151], v[172:175], v[64:67], 0
  v_permlane32_swap_b32 v11, v13
  v_add_f32 v10, v10, v12
  v_mfma_f32_16x16x32_bf16 v[152:155], v[176:179], v[64:67], 0
  v_add_f32 v11, v11, v13
  v_mov_b32 v12, v10
  v_mfma_f32_16x16x32_bf16 v[156:159], v[180:183], v[64:67], 0
  v_mov_b32 v13, v11
  v_permlane16_swap_b32 v10, v12
  s_waitcnt vmcnt(5) lgkmcnt(15)
  v_mfma_f32_16x16x32_bf16 v[136:139], v[184:187], v[68:71], v[136:139]
  buffer_load_dwordx4 v[100:103], v4, s[28:31], s62 offen offset:1024 sc1
  v_max3_u32 v30, v72, v73, v74
  v_mfma_f32_16x16x32_bf16 v[140:143], v[188:191], v[68:71], v[140:143]
  v_max3_u32 v30, v30, v75, v76
  v_max3_u32 v30, v30, v77, v78
  v_mfma_f32_16x16x32_bf16 v[144:147], v[192:195], v[68:71], v[144:147]
  v_max_u32 v30, v30, v79
  v_cmp_eq_u32 vcc, -1, v30
  v_mfma_f32_16x16x32_bf16 v[148:151], v[196:199], v[68:71], v[148:151]
  ds_read_b128 v[160:163], v4 offset:3072
  ds_read_b128 v[164:167], v4 offset:62464
  v_mfma_f32_16x16x32_bf16 v[152:155], v[200:203], v[68:71], v[152:155]
  ds_read_b128 v[168:171], v5 offset:3072
  ds_read_b128 v[172:175], v4 offset:27648
  v_mfma_f32_16x16x32_bf16 v[156:159], v[204:207], v[68:71], v[156:159]
  ds_read_b128 v[176:179], v5 offset:27648
  ds_read_b128 v[180:183], v5 offset:33792
  s_cbranch_vccnz Ltg_99
Ltg_99_b:
  s_waitcnt lgkmcnt(15)
  v_mfma_f32_16x16x32_bf16 v[136:139], v[208:211], v[72:75], v[136:139]
  buffer_load_dwordx4 v[104:107], v4, s[28:31], s62 offen offset:2048 sc1
  ds_read_b128 v[184:187], v4 offset:5120
  v_mfma_f32_16x16x32_bf16 v[140:143], v[212:215], v[72:75], v[140:143]
  ds_read_b128 v[188:191], v4 offset:64512
  ds_read_b128 v[192:195], v5 offset:5120
  v_mfma_f32_16x16x32_bf16 v[144:147], v[216:219], v[72:75], v[144:147]
  ds_read_b128 v[196:199], v4 offset:29696
  ds_read_b128 v[200:203], v5 offset:29696
  v_mfma_f32_16x16x32_bf16 v[148:151], v[220:223], v[72:75], v[148:151]
  ds_read_b128 v[204:207], v5 offset:35840
  v_permlane16_swap_b32 v11, v13
  v_mfma_f32_16x16x32_bf16 v[152:155], v[224:227], v[72:75], v[152:155]
  v_add_f32 v10, v10, v12
  v_add_f32 v11, v11, v13
  v_mfma_f32_16x16x32_bf16 v[156:159], v[228:231], v[72:75], v[156:159]
  s_mov_b32 s47, 987991609
  v_mul_f32 v52, s47, v10
  s_waitcnt vmcnt(5) lgkmcnt(6)
  v_mfma_f32_16x16x32_bf16 v[136:139], v[160:163], v[76:79], v[136:139]
  buffer_load_dwordx4 v[108:111], v4, s[28:31], s62 offen offset:3072 sc1
  v_max3_u32 v30, v80, v81, v82
  v_mfma_f32_16x16x32_bf16 v[140:143], v[164:167], v[76:79], v[140:143]
  v_max3_u32 v30, v30, v83, v84
  v_max3_u32 v30, v30, v85, v86
  v_mfma_f32_16x16x32_bf16 v[144:147], v[168:171], v[76:79], v[144:147]
  v_max_u32 v30, v30, v87
  v_cmp_eq_u32 vcc, -1, v30
  v_mfma_f32_16x16x32_bf16 v[148:151], v[172:175], v[76:79], v[148:151]
  ds_read_b128 v[208:211], v4 offset:6144
  ds_read_b128 v[212:215], v5 offset:0
  v_mfma_f32_16x16x32_bf16 v[152:155], v[176:179], v[76:79], v[152:155]
  ds_read_b128 v[216:219], v5 offset:6144
  ds_read_b128 v[220:223], v4 offset:30720
  v_mfma_f32_16x16x32_bf16 v[156:159], v[180:183], v[76:79], v[156:159]
  ds_read_b128 v[224:227], v5 offset:30720
  ds_read_b128 v[228:231], v5 offset:36864
  s_cbranch_vccnz Ltg_100
Ltg_100_b:
  v_mfma_f32_16x16x32_bf16 v[136:139], a[40:43], v[80:83], v[136:139]
  buffer_load_dwordx4 v[112:115], v4, s[28:31], s63 offen offset:0 sc1
  ds_read_b128 v[160:163], v4 offset:7168
  v_mfma_f32_16x16x32_bf16 v[140:143], a[44:47], v[80:83], v[140:143]
  ds_read_b128 v[164:167], v5 offset:1024
  ds_read_b128 v[168:171], v5 offset:7168
  v_mfma_f32_16x16x32_bf16 v[144:147], a[48:51], v[80:83], v[144:147]
  ds_read_b128 v[172:175], v4 offset:31744
  ds_read_b128 v[176:179], v5 offset:31744
  v_mfma_f32_16x16x32_bf16 v[148:151], a[52:55], v[80:83], v[148:151]
  ds_read_b128 v[180:183], v5 offset:37888
  v_mul_f32 v10, v52, v52
  v_mfma_f32_16x16x32_bf16 v[152:155], a[56:59], v[80:83], v[152:155]
  v_fma_f32 v11, v11, s47, -v10
  v_max_f32 v11, 0, v11
  v_mfma_f32_16x16x32_bf16 v[156:159], a[60:63], v[80:83], v[156:159]
  v_add_f32 v10, 925353388, v11
  v_rsq_f32 v53, v10
  s_waitcnt vmcnt(5) lgkmcnt(12)
  v_mfma_f32_16x16x32_bf16 v[136:139], v[184:187], v[84:87], v[136:139]
  buffer_load_dwordx4 v[116:119], v4, s[28:31], s63 offen offset:1024 sc1
  v_max3_u32 v30, v88, v89, v90
  v_mfma_f32_16x16x32_bf16 v[140:143], v[188:191], v[84:87], v[140:143]
  v_max3_u32 v30, v30, v91, v92
  v_max3_u32 v30, v30, v93, v94
  v_mfma_f32_16x16x32_bf16 v[144:147], v[192:195], v[84:87], v[144:147]
  v_max_u32 v30, v30, v95
  v_cmp_eq_u32 vcc, -1, v30
  v_mfma_f32_16x16x32_bf16 v[148:151], v[196:199], v[84:87], v[148:151]
  v_mul_f32 v12, v53, v53
  v_mul_f32 v12, v12, v11
  v_mfma_f32_16x16x32_bf16 v[152:155], v[200:203], v[84:87], v[152:155]
  v_add_f32 v12, 925353388, v12
  v_rsq_f32 v12, v12
  v_mfma_f32_16x16x32_bf16 v[156:159], v[204:207], v[84:87], v[156:159]
  v_mul_f32 v16, 1055913304, v53
  v_mul_f32 v16, v12, v16
  s_cbranch_vccnz Ltg_101
Ltg_101_b:
  s_waitcnt lgkmcnt(6)
  v_mfma_f32_16x16x32_bf16 v[136:139], v[208:211], v[88:91], v[136:139]
  buffer_load_dwordx4 v[120:123], v4, s[28:31], s63 offen offset:2048 sc1
  ds_read_b128 v[184:187], v4 offset:8192
  v_mfma_f32_16x16x32_bf16 v[140:143], v[212:215], v[88:91], v[140:143]
  ds_read_b128 v[188:191], v5 offset:2048
  ds_read_b128 v[192:195], v5 offset:8192
  v_mfma_f32_16x16x32_bf16 v[144:147], v[216:219], v[88:91], v[144:147]
  ds_read_b128 v[196:199], v4 offset:32768
  ds_read_b128 v[200:203], v5 offset:32768
  v_mfma_f32_16x16x32_bf16 v[148:151], v[220:223], v[88:91], v[148:151]
  ds_read_b128 v[204:207], v5 offset:38912
  v_mul_f32 v17, v16, -v52
  v_mfma_f32_16x16x32_bf16 v[152:155], v[224:227], v[88:91], v[152:155]
  v_mul_f32 v232, v17, v232
  v_mul_f32 v233, v17, v233
  v_mfma_f32_16x16x32_bf16 v[156:159], v[228:231], v[88:91], v[156:159]
  v_mul_f32 v234, v17, v234
  v_mul_f32 v235, v17, v235
  s_waitcnt vmcnt(5) lgkmcnt(6)
  v_mfma_f32_16x16x32_bf16 v[136:139], v[160:163], v[92:95], v[136:139]
  buffer_load_dwordx4 v[124:127], v4, s[28:31], s63 offen offset:3072 sc1
  v_max3_u32 v30, v96, v97, v98
  v_mfma_f32_16x16x32_bf16 v[140:143], v[164:167], v[92:95], v[140:143]
  v_max3_u32 v30, v30, v99, v100
  v_max3_u32 v30, v30, v101, v102
  v_mfma_f32_16x16x32_bf16 v[144:147], v[168:171], v[92:95], v[144:147]
  v_max_u32 v30, v30, v103
  v_cmp_eq_u32 vcc, -1, v30
  v_mfma_f32_16x16x32_bf16 v[148:151], v[172:175], v[92:95], v[148:151]
  ds_read_b128 v[208:211], v4 offset:10240
  ds_read_b128 v[212:215], v4 offset:13312
  v_mfma_f32_16x16x32_bf16 v[152:155], v[176:179], v[92:95], v[152:155]
  ds_read_b128 v[216:219], v5 offset:10240
  ds_read_b128 v[220:223], v4 offset:34816
  v_mfma_f32_16x16x32_bf16 v[156:159], v[180:183], v[92:95], v[156:159]
  ds_read_b128 v[224:227], v4 offset:37888
  ds_read_b128 v[228:231], v5 offset:40960
  s_cbranch_vccnz Ltg_102
Ltg_102_b:
  s_waitcnt lgkmcnt(6)
  v_mfma_f32_16x16x32_bf16 v[136:139], v[184:187], v[96:99], v[136:139]
  buffer_load_dwordx4 v[128:131], v4, s[28:31], s64 offen offset:0 sc1
  ds_read_b128 v[160:163], v4 offset:11264
  v_mfma_f32_16x16x32_bf16 v[140:143], v[188:191], v[96:99], v[140:143]
  ds_read_b128 v[164:167], v4 offset:14336
  ds_read_b128 v[168:171], v5 offset:11264
  v_mfma_f32_16x16x32_bf16 v[144:147], v[192:195], v[96:99], v[144:147]
  ds_read_b128 v[172:175], v4 offset:35840
  ds_read_b128 v[176:179], v4 offset:38912
  v_mfma_f32_16x16x32_bf16 v[148:151], v[196:199], v[96:99], v[148:151]
  ds_read_b128 v[180:183], v5 offset:41984
  v_mul_f32 v236, v17, v236
  v_mfma_f32_16x16x32_bf16 v[152:155], v[200:203], v[96:99], v[152:155]
  v_mul_f32 v237, v17, v237
  v_mul_f32 v238, v17, v238
  v_mfma_f32_16x16x32_bf16 v[156:159], v[204:207], v[96:99], v[156:159]
  v_mul_f32 v239, v17, v239
  v_mul_f32 v240, v17, v240
  s_waitcnt vmcnt(5)
  v_mfma_f32_16x16x32_bf16 v[136:139], a[64:67], v[100:103], v[136:139]
  buffer_load_dwordx4 v[132:135], v4, s[28:31], s64 offen offset:1024 sc1
  v_max3_u32 v30, v104, v105, v106
  v_max3_u32 v30, v30, v107, v108
  v_mfma_f32_16x16x32_bf16 v[140:143], a[68:71], v[100:103], v[140:143]
  v_max3_u32 v30, v30, v109, v110
  v_max_u32 v30, v30, v111
  v_mfma_f32_16x16x32_bf16 v[144:147], a[72:75], v[100:103], v[144:147]
  v_cmp_eq_u32 vcc, -1, v30
  ds_read_b128 v[184:187], v4 offset:53248
  ds_read_b128 v[188:191], v4 offset:15360
  v_mfma_f32_16x16x32_bf16 v[148:151], a[76:79], v[100:103], v[148:151]
  ds_read_b128 v[192:195], v5 offset:12288
  ds_read_b128 v[196:199], v5 offset:18432
  v_mfma_f32_16x16x32_bf16 v[152:155], a[80:83], v[100:103], v[152:155]
  ds_read_b128 v[200:203], v4 offset:39936
  ds_read_b128 v[204:207], v5 offset:43008
  s_add_u32 s59, s72, 12288
  buffer_load_dwordx4 a[196:199], v4, s[28:31], s59 offen offset:0 sc1
  v_mfma_f32_16x16x32_bf16 v[156:159], a[84:87], v[100:103], v[156:159]
  v_mul_f32 v241, v17, v241
  v_mul_f32 v242, v17, v242
  s_cbranch_vccnz Ltg_103
Ltg_103_b:
  s_waitcnt lgkmcnt(12)
  v_mfma_f32_16x16x32_bf16 v[136:139], v[208:211], v[104:107], v[136:139]
  buffer_load_dwordx4 a[200:203], v4, s[28:31], s59 offen offset:1024 sc1
  buffer_load_dwordx4 a[204:207], v4, s[28:31], s59 offen offset:2048 sc1
  v_mfma_f32_16x16x32_bf16 v[140:143], v[212:215], v[104:107], v[140:143]
  v_mul_f32 v243, v17, v243
  v_mul_f32 v244, v17, v244
  v_mfma_f32_16x16x32_bf16 v[144:147], v[216:219], v[104:107], v[144:147]
  v_mul_f32 v245, v17, v245
  v_mul_f32 v246, v17, v246
  v_mfma_f32_16x16x32_bf16 v[148:151], v[220:223], v[104:107], v[148:151]
  v_mul_f32 v247, v17, v247
  v_mul_f32 v248, v17, v248
  v_mfma_f32_16x16x32_bf16 v[152:155], v[224:227], v[104:107], v[152:155]
  v_mul_f32 v249, v17, v249
  v_mul_f32 v250, v17, v250
  v_mfma_f32_16x16x32_bf16 v[156:159], v[228:231], v[104:107], v[156:159]
  v_mul_f32 v251, v17, v251
  v_mul_f32 v252, v17, v252
  s_waitcnt vmcnt(7) lgkmcnt(6)
  v_mfma_f32_16x16x32_bf16 v[136:139], v[160:163], v[108:111], v[136:139]
  v_max3_u32 v30, v112, v113, v114
  v_max3_u32 v30, v30, v115, v116
  v_max3_u32 v30, v30, v117, v118
  v_mfma_f32_16x16x32_bf16 v[140:143], v[164:167], v[108:111], v[140:143]
  v_max_u32 v30, v30, v119
  v_cmp_eq_u32 vcc, -1, v30
  v_mfma_f32_16x16x32_bf16 v[144:147], v[168:171], v[108:111], v[144:147]
  ds_read_b128 v[208:211], v4 offset:55296
  ds_read_b128 v[212:215], v4 offset:17408
  v_mfma_f32_16x16x32_bf16 v[148:151], v[172:175], v[108:111], v[148:151]
  ds_read_b128 v[216:219], v5 offset:14336
  ds_read_b128 v[220:223], v5 offset:20480
  ds_read_b128 v[224:227], v4 offset:41984
  v_mfma_f32_16x16x32_bf16 v[152:155], v[176:179], v[108:111], v[152:155]
  ds_read_b128 v[228:231], v5 offset:45056
  buffer_load_dwordx4 a[208:211], v4, s[28:31], s59 offen offset:3072 sc1
  v_mfma_f32_16x16x32_bf16 v[156:159], v[180:183], v[108:111], v[156:159]
  s_add_u32 s59, s72, 16384
  buffer_load_dwordx4 a[212:215], v4, s[28:31], s59 offen offset:0 sc1
  v_mul_f32 v253, v17, v253
  s_cbranch_vccnz Ltg_104
Ltg_104_b:
  s_waitcnt lgkmcnt(6)
  v_mfma_f32_16x16x32_bf16 v[136:139], v[184:187], v[112:115], v[136:139]
  ds_read_b128 v[160:163], v4 offset:56320
  ds_read_b128 v[164:167], v4 offset:18432
  v_mfma_f32_16x16x32_bf16 v[140:143], v[188:191], v[112:115], v[140:143]
  ds_read_b128 v[168:171], v5 offset:15360
  ds_read_b128 v[172:175], v5 offset:21504
  v_mfma_f32_16x16x32_bf16 v[144:147], v[192:195], v[112:115], v[144:147]
  ds_read_b128 v[176:179], v4 offset:43008
  v_mfma_f32_16x16x32_bf16 v[148:151], v[196:199], v[112:115], v[148:151]
  ds_read_b128 v[180:183], v5 offset:46080
  buffer_load_dwordx4 a[216:219], v4, s[28:31], s59 offen offset:1024 sc1
  v_mfma_f32_16x16x32_bf16 v[152:155], v[200:203], v[112:115], v[152:155]
  buffer_load_dwordx4 a[220:223], v4, s[28:31], s59 offen offset:2048 sc1
  v_mul_f32 v254, v17, v254
  v_mfma_f32_16x16x32_bf16 v[156:159], v[204:207], v[112:115], v[156:159]
  v_mul_f32 v255, v17, v255
  s_waitcnt vmcnt(9)
  v_mfma_f32_16x16x32_bf16 v[136:139], a[88:91], v[116:119], v[136:139]
  v_max3_u32 v30, v120, v121, v122
  v_max3_u32 v30, v30, v123, v124
  v_max3_u32 v30, v30, v125, v126
  v_mfma_f32_16x16x32_bf16 v[140:143], a[92:95], v[116:119], v[140:143]
  v_max_u32 v30, v30, v127
  v_cmp_eq_u32 vcc, -1, v30
  v_mfma_f32_16x16x32_bf16 v[144:147], a[96:99], v[116:119], v[144:147]
  ds_read_b128 v[184:187], v4 offset:57344
  ds_read_b128 v[188:191], v4 offset:19456
  v_mfma_f32_16x16x32_bf16 v[148:151], a[100:103], v[116:119], v[148:151]
  ds_read_b128 v[192:195], v5 offset:16384
  ds_read_b128 v[196:199], v5 offset:22528
  v_mfma_f32_16x16x32_bf16 v[152:155], a[104:107], v[116:119], v[152:155]
  ds_read_b128 v[200:203], v4 offset:44032
  ds_read_b128 v[204:207], v5 offset:47104
  v_mfma_f32_16x16x32_bf16 v[156:159], a[108:111], v[116:119], v[156:159]
  buffer_load_dwordx4 a[224:227], v4, s[28:31], s59 offen offset:3072 sc1
  s_add_u32 s59, s72, 20480
  buffer_load_dwordx4 a[228:231], v4, s[28:31], s59 offen offset:0 sc1
  s_cbranch_vccnz Ltg_105
Ltg_105_b:
  s_waitcnt lgkmcnt(12)
  v_mfma_f32_16x16x32_bf16 v[136:139], v[208:211], v[120:123], v[136:139]
  buffer_load_dwordx4 a[232:235], v4, s[28:31], s59 offen offset:1024 sc1
  v_mfma_f32_16x16x32_bf16 v[140:143], v[212:215], v[120:123], v[140:143]
  v_mfma_f32_16x16x32_bf16 v[144:147], v[216:219], v[120:123], v[144:147]
  v_mfma_f32_16x16x32_bf16 v[148:151], v[220:223], v[120:123], v[148:151]
  buffer_load_dwordx4 a[236:239], v4, s[28:31], s59 offen offset:2048 sc1
  v_mfma_f32_16x16x32_bf16 v[152:155], v[224:227], v[120:123], v[152:155]
  v_mfma_f32_16x16x32_bf16 v[156:159], v[228:231], v[120:123], v[156:159]
  s_waitcnt vmcnt(11) lgkmcnt(6)
  v_mfma_f32_16x16x32_bf16 v[136:139], v[160:163], v[124:127], v[136:139]
  v_max3_u32 v30, v128, v129, v130
  v_max3_u32 v30, v30, v131, v132
  v_max3_u32 v30, v30, v133, v134
  v_mfma_f32_16x16x32_bf16 v[140:143], v[164:167], v[124:127], v[140:143]
  v_max_u32 v30, v30, v135
  v_cmp_eq_u32 vcc, -1, v30
  v_mfma_f32_16x16x32_bf16 v[144:147], v[168:171], v[124:127], v[144:147]
  ds_read_b128 v[208:211], v4 offset:58368
  ds_read_b128 v[212:215], v4 offset:20480
  v_mfma_f32_16x16x32_bf16 v[148:151], v[172:175], v[124:127], v[148:151]
  ds_read_b128 v[216:219], v5 offset:17408
  ds_read_b128 v[220:223], v5 offset:23552
  v_mfma_f32_16x16x32_bf16 v[152:155], v[176:179], v[124:127], v[152:155]
  ds_read_b128 v[224:227], v4 offset:45056
  ds_read_b128 v[228:231], v5 offset:48128
  v_mfma_f32_16x16x32_bf16 v[156:159], v[180:183], v[124:127], v[156:159]
  buffer_load_dwordx4 a[240:243], v4, s[28:31], s59 offen offset:3072 sc1
  s_add_u32 s59, s72, 24576
  buffer_load_dwordx4 a[244:247], v4, s[28:31], s59 offen offset:0 sc1
  s_cbranch_vccnz Ltg_106
Ltg_106_b:
  s_waitcnt lgkmcnt(6)
  v_mfma_f32_16x16x32_bf16 v[136:139], v[184:187], v[128:131], v[136:139]
  buffer_load_dwordx4 a[248:251], v4, s[28:31], s59 offen offset:1024 sc1
  v_mfma_f32_16x16x32_bf16 v[140:143], v[188:191], v[128:131], v[140:143]
  v_mfma_f32_16x16x32_bf16 v[144:147], v[192:195], v[128:131], v[144:147]
  v_mfma_f32_16x16x32_bf16 v[148:151], v[196:199], v[128:131], v[148:151]
  buffer_load_dwordx4 a[252:255], v4, s[28:31], s59 offen offset:2048 sc1
  v_mfma_f32_16x16x32_bf16 v[152:155], v[200:203], v[128:131], v[152:155]
  v_mfma_f32_16x16x32_bf16 v[156:159], v[204:207], v[128:131], v[156:159]
  s_waitcnt lgkmcnt(0)
  v_mfma_f32_16x16x32_bf16 v[136:139], v[208:211], v[132:135], v[136:139]
  v_mfma_f32_16x16x32_bf16 v[140:143], v[212:215], v[132:135], v[140:143]
  v_mfma_f32_16x16x32_bf16 v[144:147], v[216:219], v[132:135], v[144:147]
  v_mfma_f32_16x16x32_bf16 v[148:151], v[220:223], v[132:135], v[148:151]
  v_mfma_f32_16x16x32_bf16 v[152:155], v[224:227], v[132:135], v[152:155]
  v_mfma_f32_16x16x32_bf16 v[156:159], v[228:231], v[132:135], v[156:159]
  s_mov_b32 s48, 1055913304
  s_mov_b32 s49, 1084043516
  s_nop 0
  v_pk_fma_f32 v[136:137], v[136:137], v[16:17], v[232:233] op_sel_hi:[1,0,1]
  v_pk_fma_f32 v[138:139], v[138:139], v[16:17], v[234:235] op_sel_hi:[1,0,1]
  v_pk_fma_f32 v[140:141], v[140:141], v[16:17], v[236:237] op_sel_hi:[1,0,1]
  v_pk_fma_f32 v[142:143], v[142:143], v[16:17], v[238:239] op_sel_hi:[1,0,1]
  v_pk_fma_f32 v[144:145], v[144:145], v[16:17], v[240:241] op_sel_hi:[1,0,1]
  v_pk_fma_f32 v[146:147], v[146:147], v[16:17], v[242:243] op_sel_hi:[1,0,1]
  v_pk_fma_f32 v[148:149], v[148:149], v[16:17], v[244:245] op_sel_hi:[1,0,1]
  v_pk_fma_f32 v[150:151], v[150:151], v[16:17], v[246:247] op_sel_hi:[1,0,1]
  v_pk_fma_f32 v[152:153], v[152:153], v[16:17], v[248:249] op_sel_hi:[1,0,1]
  v_pk_fma_f32 v[154:155], v[154:155], v[16:17], v[250:251] op_sel_hi:[1,0,1]
  v_pk_fma_f32 v[156:157], v[156:157], v[16:17], v[252:253] op_sel_hi:[1,0,1]
  v_pk_fma_f32 v[158:159], v[158:159], v[16:17], v[254:255] op_sel_hi:[1,0,1]
  v_pk_fma_f32 v[64:65], v[136:137], v[136:137], s[48:49] op_sel:[0,0,1] op_sel_hi:[1,1,1]
  ds_write_b128 v62, a[148:151] offset:0
  v_pk_fma_f32 v[66:67], v[138:139], v[138:139], s[48:49] op_sel:[0,0,1] op_sel_hi:[1,1,1]
  v_pk_fma_f32 v[68:69], v[140:141], v[140:141], s[48:49] op_sel:[0,0,1] op_sel_hi:[1,1,1]
  v_pk_fma_f32 v[70:71], v[142:143], v[142:143], s[48:49] op_sel:[0,0,1] op_sel_hi:[1,1,1]
  v_pk_fma_f32 v[72:73], v[144:145], v[144:145], s[48:49] op_sel:[0,0,1] op_sel_hi:[1,1,1]
  v_pk_fma_f32 v[74:75], v[146:147], v[146:147], s[48:49] op_sel:[0,0,1] op_sel_hi:[1,1,1]
  v_pk_fma_f32 v[76:77], v[148:149], v[148:149], s[48:49] op_sel:[0,0,1] op_sel_hi:[1,1,1]
  v_pk_fma_f32 v[78:79], v[150:151], v[150:151], s[48:49] op_sel:[0,0,1] op_sel_hi:[1,1,1]
  v_pk_fma_f32 v[80:81], v[152:153], v[152:153], s[48:49] op_sel:[0,0,1] op_sel_hi:[1,1,1]
  ds_write_b128 v62, a[152:155] offset:1024
  v_pk_fma_f32 v[82:83], v[154:155], v[154:155], s[48:49] op_sel:[0,0,1] op_sel_hi:[1,1,1]
  v_pk_fma_f32 v[84:85], v[156:157], v[156:157], s[48:49] op_sel:[0,0,1] op_sel_hi:[1,1,1]
  v_pk_fma_f32 v[86:87], v[158:159], v[158:159], s[48:49] op_sel:[0,0,1] op_sel_hi:[1,1,1]
  v_pk_mul_f32 v[64:65], v[64:65], v[136:137]
  v_pk_mul_f32 v[66:67], v[66:67], v[138:139]
  v_pk_mul_f32 v[68:69], v[68:69], v[140:141]
  v_pk_mul_f32 v[70:71], v[70:71], v[142:143]
  v_pk_mul_f32 v[72:73], v[72:73], v[144:145]
  ds_write_b128 v62, a[156:159] offset:2048
  v_pk_mul_f32 v[74:75], v[74:75], v[146:147]
  v_pk_mul_f32 v[76:77], v[76:77], v[148:149]
  v_pk_mul_f32 v[78:79], v[78:79], v[150:151]
  v_pk_mul_f32 v[80:81], v[80:81], v[152:153]
  v_pk_mul_f32 v[82:83], v[82:83], v[154:155]
  v_pk_mul_f32 v[84:85], v[84:85], v[156:157]
  v_pk_mul_f32 v[86:87], v[86:87], v[158:159]
  v_exp_f32 v64, -v64
  ds_write_b128 v62, a[160:163] offset:3072
  v_exp_f32 v65, -v65
  v_exp_f32 v66, -v66
  v_exp_f32 v67, -v67
  v_exp_f32 v68, -v68
  v_exp_f32 v69, -v69
  v_exp_f32 v70, -v70
  v_exp_f32 v71, -v71
  v_exp_f32 v72, -v72
  ds_write_b128 v62, a[164:167] offset:4096
  v_exp_f32 v73, -v73
  v_exp_f32 v74, -v74
  v_exp_f32 v75, -v75
  v_exp_f32 v76, -v76
  v_exp_f32 v77, -v77
  v_exp_f32 v78, -v78
  v_exp_f32 v79, -v79
  v_exp_f32 v80, -v80
  ds_write_b128 v62, a[168:171] offset:5120
  v_exp_f32 v81, -v81
  v_exp_f32 v82, -v82
  v_exp_f32 v83, -v83
  v_exp_f32 v84, -v84
  v_exp_f32 v85, -v85
  v_exp_f32 v86, -v86
  v_exp_f32 v87, -v87
  v_pk_fma_f32 v[64:65], v[64:65], s[48:49], s[48:49] op_sel_hi:[1,0,0]
  ds_write_b128 v62, a[172:175] offset:6144
  v_pk_fma_f32 v[66:67], v[66:67], s[48:49], s[48:49] op_sel_hi:[1,0,0]
  v_pk_fma_f32 v[68:69], v[68:69], s[48:49], s[48:49] op_sel_hi:[1,0,0]
  v_pk_fma_f32 v[70:71], v[70:71], s[48:49], s[48:49] op_sel_hi:[1,0,0]
  v_pk_fma_f32 v[72:73], v[72:73], s[48:49], s[48:49] op_sel_hi:[1,0,0]
  v_pk_fma_f32 v[74:75], v[74:75], s[48:49], s[48:49] op_sel_hi:[1,0,0]
  v_pk_fma_f32 v[76:77], v[76:77], s[48:49], s[48:49] op_sel_hi:[1,0,0]
  v_pk_fma_f32 v[78:79], v[78:79], s[48:49], s[48:49] op_sel_hi:[1,0,0]
  v_pk_fma_f32 v[80:81], v[80:81], s[48:49], s[48:49] op_sel_hi:[1,0,0]
  ds_write_b128 v62, a[176:179] offset:7168
  v_pk_fma_f32 v[82:83], v[82:83], s[48:49], s[48:49] op_sel_hi:[1,0,0]
  v_pk_fma_f32 v[84:85], v[84:85], s[48:49], s[48:49] op_sel_hi:[1,0,0]
  v_pk_fma_f32 v[86:87], v[86:87], s[48:49], s[48:49] op_sel_hi:[1,0,0]
  v_rcp_f32 v64, v64
  v_rcp_f32 v65, v65
  v_rcp_f32 v66, v66
  v_rcp_f32 v67, v67
  v_rcp_f32 v68, v68
  ds_write_b128 v62, a[180:183] offset:8192
  v_rcp_f32 v69, v69
  v_rcp_f32 v70, v70
  v_rcp_f32 v71, v71
  v_rcp_f32 v72, v72
  v_rcp_f32 v73, v73
  v_rcp_f32 v74, v74
  v_rcp_f32 v75, v75
  v_rcp_f32 v76, v76
  ds_write_b128 v62, a[184:187] offset:9216
  v_rcp_f32 v77, v77
  v_rcp_f32 v78, v78
  v_rcp_f32 v79, v79
  v_rcp_f32 v80, v80
  v_rcp_f32 v81, v81
  v_rcp_f32 v82, v82
  v_rcp_f32 v83, v83
  v_rcp_f32 v84, v84
  ds_write_b128 v62, a[188:191] offset:10240
  v_rcp_f32 v85, v85
  v_rcp_f32 v86, v86
  v_rcp_f32 v87, v87
  v_pk_mul_f32 v[136:137], v[136:137], v[64:65]
  v_pk_mul_f32 v[138:139], v[138:139], v[66:67]
  v_pk_mul_f32 v[140:141], v[140:141], v[68:69]
  v_pk_mul_f32 v[142:143], v[142:143], v[70:71]
  v_pk_mul_f32 v[144:145], v[144:145], v[72:73]
  ds_write_b128 v62, a[192:195] offset:11264
  v_pk_mul_f32 v[146:147], v[146:147], v[74:75]
  v_pk_mul_f32 v[148:149], v[148:149], v[76:77]
  v_pk_mul_f32 v[150:151], v[150:151], v[78:79]
  v_pk_mul_f32 v[152:153], v[152:153], v[80:81]
  v_pk_mul_f32 v[154:155], v[154:155], v[82:83]
  v_pk_mul_f32 v[156:157], v[156:157], v[84:85]
  v_pk_mul_f32 v[158:159], v[158:159], v[86:87]
  v_cvt_pk_bf16_f32 v160, v136, v137
  v_cvt_pk_bf16_f32 v161, v138, v139
  v_cvt_pk_bf16_f32 v162, v140, v141
  v_cvt_pk_bf16_f32 v163, v142, v143
  v_cvt_pk_bf16_f32 v164, v144, v145
  v_cvt_pk_bf16_f32 v165, v146, v147
  v_cvt_pk_bf16_f32 v166, v148, v149
  v_cvt_pk_bf16_f32 v167, v150, v151
  v_cvt_pk_bf16_f32 v168, v152, v153
  v_cvt_pk_bf16_f32 v169, v154, v155
  v_cvt_pk_bf16_f32 v170, v156, v157
  v_cvt_pk_bf16_f32 v171, v158, v159
  s_add_u32 s46, s55, 12484608
  buffer_store_dwordx4 v[160:163], v4, s[28:31], s46 offen offset:0 sc1
  buffer_store_dwordx4 v[164:167], v4, s[28:31], s46 offen offset:1024 sc1
  buffer_store_dwordx4 v[168:171], v4, s[28:31], s46 offen offset:2048 sc1
  s_add_u32 s32, s24, 12484608
  s_addc_u32 s33, s25, 0
  s_mov_b32 s34, 2359296
  s_mov_b32 s35, 0x20000
  s_mov_b32 s70, 0
  s_mov_b32 s71, 4096
  s_mov_b32 s72, 8192
  s_mov_b32 s73, 12288
  s_mov_b32 s74, 16384
  s_lshr_b32 s46, s41, 2
  s_lshl_b32 s64, s46, 4
  s_lshr_b32 s67, s42, 1
  s_add_u32 s64, s64, s67
  s_and_b32 s67, s67, 7
  s_mov_b32 s67, 0
  s_and_b32 s46, s41, 3
  s_lshl_b32 s65, s46, 1
  s_and_b32 s46, s42, 1
  s_add_u32 s65, s65, s46
  s_lshl_b32 s46, s65, 2
  s_add_u32 s46, s46, s40
  s_mul_i32 s66, s46, 165888
  s_add_u32 s66, s66, 19292160
  s_mul_i32 s46, s65, 18
  s_add_u32 s46, s46, 310
  v_min_u32 v54, 17, v1
  v_add_u32 v54, s46, v54
  v_lshlrev_b32 v54, 7, v54
  buffer_load_dword v55, v54, s[28:31], 0 offen offset:128 sc1
  s_waitcnt vmcnt(4)
  s_waitcnt vmcnt(20)
  s_barrier
  ds_write_b128 v8, a[196:199] offset:0
  ds_write_b128 v8, a[200:203] offset:1024
  ds_write_b128 v8, a[204:207] offset:2048
  ds_write_b128 v8, a[208:211] offset:3072
  ds_write_b128 v8, a[212:215] offset:4096
  s_mov_b32 s79, 50000
  buffer_load_dwordx4 v[64:67], v56, s[32:35], s70 offen offset:0 sc1
  ds_write_b128 v8, a[216:219] offset:5120
  ds_write_b128 v8, a[220:223] offset:6144
  buffer_load_dwordx4 v[68:71], v56, s[32:35], s70 offen offset:1024 sc1
  ds_write_b128 v8, a[224:227] offset:7168
  buffer_load_dwordx4 v[72:75], v56, s[32:35], s70 offen offset:2048 sc1
  ds_write_b128 v8, a[228:231] offset:8192
  buffer_load_dwordx4 v[76:79], v56, s[32:35], s70 offen offset:3072 sc1
  ds_write_b128 v8, a[232:235] offset:9216
  buffer_load_dwordx4 v[80:83], v60, s[32:35], s71 offen offset:0 sc1
  ds_write_b128 v8, a[236:239] offset:10240
  ds_write_b128 v8, a[240:243] offset:11264
  buffer_load_dwordx4 v[84:87], v57, s[32:35], s71 offen offset:1024 sc1
  ds_write_b128 v8, a[244:247] offset:12288
  buffer_load_dwordx4 v[88:91], v57, s[32:35], s71 offen offset:2048 sc1
  ds_write_b128 v8, a[248:251] offset:13312
  buffer_load_dwordx4 v[92:95], v57, s[32:35], s71 offen offset:3072 sc1
  ds_write_b128 v8, a[252:255] offset:14336
  s_waitcnt vmcnt(8) lgkmcnt(0)
  s_barrier
  ds_read_b128 v[160:163], v5 offset:49152
  ds_read_b128 v[164:167], v4 offset:6144
  ds_read_b128 v[168:171], v6 offset:5120
  ds_read_b128 v[172:175], v6 offset:8192
  ds_read_b128 v[176:179], v4 offset:36864
  ds_read_b128 v[180:183], v6 offset:29696
  ds_read_b128 v[184:187], v5 offset:50176
  ds_read_b128 v[188:191], v4 offset:7168
  ds_read_b128 v[192:195], v6 offset:6144
  ds_read_b128 v[196:199], v6 offset:9216
  ds_read_b128 v[200:203], v4 offset:37888
  ds_read_b128 v[204:207], v6 offset:30720
  ds_read_b128 v[208:211], v5 offset:51200
  ds_read_b128 v[212:215], v4 offset:8192
  ds_read_b128 v[216:219], v6 offset:7168
  ds_read_b128 v[220:223], v6 offset:10240
  ds_read_b128 v[224:227], v4 offset:38912
  ds_read_b128 v[228:231], v6 offset:31744
  ds_read_b128 a[0:3], v5 offset:53248
  ds_read_b128 a[4:7], v4 offset:10240
  ds_read_b128 a[8:11], v4 offset:16384
  ds_read_b128 a[12:15], v6 offset:12288
  ds_read_b128 a[16:19], v4 offset:40960
  ds_read_b128 a[20:23], v4 offset:47104
  ds_read_b128 a[24:27], v5 offset:58368
  ds_read_b128 a[28:31], v5 offset:61440
  ds_read_b128 a[32:35], v4 offset:21504
  ds_read_b128 a[36:39], v6 offset:17408
  ds_read_b128 a[40:43], v6 offset:20480
  ds_read_b128 a[44:47], v4 offset:52224
  ds_read_b128 a[48:51], v4 offset:1024
  ds_read_b128 a[52:55], v6 offset:0
  ds_read_b128 a[56:59], v4 offset:25600
  ds_read_b128 a[60:63], v4 offset:31744
  ds_read_b128 a[64:67], v6 offset:24576
  ds_read_b128 a[68:71], v4 offset:56320
  v_mul_f32 v17, v53, -v52
  v_mov_b32 v16, v53
  v_lshlrev_b32 v136, 16, v40
  v_and_b32 v137, 0xffff0000, v40
  v_lshlrev_b32 v138, 16, v41
  v_and_b32 v139, 0xffff0000, v41
  v_lshlrev_b32 v140, 16, v42
  v_and_b32 v141, 0xffff0000, v42
  v_lshlrev_b32 v142, 16, v43
  v_and_b32 v143, 0xffff0000, v43
  v_lshlrev_b32 v144, 16, v44
  v_and_b32 v145, 0xffff0000, v44
  v_lshlrev_b32 v146, 16, v45
  v_and_b32 v147, 0xffff0000, v45
  v_lshlrev_b32 v148, 16, v46
  v_and_b32 v149, 0xffff0000, v46
  v_lshlrev_b32 v150, 16, v47
  v_and_b32 v151, 0xffff0000, v47
  v_lshlrev_b32 v152, 16, v48
  v_and_b32 v153, 0xffff0000, v48
  v_lshlrev_b32 v154, 16, v49
  v_and_b32 v155, 0xffff0000, v49
  v_lshlrev_b32 v156, 16, v50
  v_and_b32 v157, 0xffff0000, v50
  v_lshlrev_b32 v158, 16, v51
  v_and_b32 v159, 0xffff0000, v51
  v_pk_fma_f32 v[136:137], v[136:137], v[16:17], v[16:17] op_sel:[0,0,1] op_sel_hi:[1,0,1]
  v_pk_fma_f32 v[138:139], v[138:139], v[16:17], v[16:17] op_sel:[0,0,1] op_sel_hi:[1,0,1]
  v_pk_fma_f32 v[140:141], v[140:141], v[16:17], v[16:17] op_sel:[0,0,1] op_sel_hi:[1,0,1]
  v_pk_fma_f32 v[142:143], v[142:143], v[16:17], v[16:17] op_sel:[0,0,1] op_sel_hi:[1,0,1]
  v_pk_fma_f32 v[144:145], v[144:145], v[16:17], v[16:17] op_sel:[0,0,1] op_sel_hi:[1,0,1]
  v_pk_fma_f32 v[146:147], v[146:147], v[16:17], v[16:17] op_sel:[0,0,1] op_sel_hi:[1,0,1]
  v_pk_fma_f32 v[148:149], v[148:149], v[16:17], v[16:17] op_sel:[0,0,1] op_sel_hi:[1,0,1]
  v_pk_fma_f32 v[150:151], v[150:151], v[16:17], v[16:17] op_sel:[0,0,1] op_sel_hi:[1,0,1]
  v_pk_fma_f32 v[152:153], v[152:153], v[16:17], v[16:17] op_sel:[0,0,1] op_sel_hi:[1,0,1]
  v_pk_fma_f32 v[154:155], v[154:155], v[16:17], v[16:17] op_sel:[0,0,1] op_sel_hi:[1,0,1]
  v_pk_fma_f32 v[156:157], v[156:157], v[16:17], v[16:17] op_sel:[0,0,1] op_sel_hi:[1,0,1]
  v_pk_fma_f32 v[158:159], v[158:159], v[16:17], v[16:17] op_sel:[0,0,1] op_sel_hi:[1,0,1]
  s_waitcnt vmcnt(6)
  v_max3_u32 v30, v64, v65, v66
  v_max3_u32 v30, v30, v67, v68
  v_max3_u32 v30, v30, v69, v70
  v_max_u32 v30, v30, v71
  v_cmp_eq_u32 vcc, -1, v30
  s_cbranch_vccnz Ltg_107
Ltg_107_b:
  s_waitcnt lgkmcnt(15)
  v_mfma_f32_16x16x32_bf16 v[136:139], v[160:163], v[64:67], v[136:139]
  buffer_load_dwordx4 v[96:99], v57, s[32:35], s72 offen offset:0 sc1
  v_mfma_f32_16x16x32_bf16 v[140:143], v[164:167], v[64:67], v[140:143]
  v_mfma_f32_16x16x32_bf16 v[144:147], v[168:171], v[64:67], v[144:147]
  v_mfma_f32_16x16x32_bf16 v[148:151], v[172:175], v[64:67], v[148:151]
  v_mfma_f32_16x16x32_bf16 v[152:155], v[176:179], v[64:67], v[152:155]
  v_mfma_f32_16x16x32_bf16 v[156:159], v[180:183], v[64:67], v[156:159]
  s_waitcnt vmcnt(5) lgkmcnt(15)
  v_mfma_f32_16x16x32_bf16 v[136:139], v[184:187], v[68:71], v[136:139]
  buffer_load_dwordx4 v[100:103], v58, s[32:35], s72 offen offset:1024 sc1
  v_max3_u32 v30, v72, v73, v74
  v_mfma_f32_16x16x32_bf16 v[140:143], v[188:191], v[68:71], v[140:143]
  v_max3_u32 v30, v30, v75, v76
  v_max3_u32 v30, v30, v77, v78
  v_mfma_f32_16x16x32_bf16 v[144:147], v[192:195], v[68:71], v[144:147]
  v_max_u32 v30, v30, v79
  v_cmp_eq_u32 vcc, -1, v30
  v_mfma_f32_16x16x32_bf16 v[148:151], v[196:199], v[68:71], v[148:151]
  ds_read_b128 v[160:163], v5 offset:52224
  ds_read_b128 v[164:167], v4 offset:9216
  v_mfma_f32_16x16x32_bf16 v[152:155], v[200:203], v[68:71], v[152:155]
  ds_read_b128 v[168:171], v4 offset:15360
  ds_read_b128 v[172:175], v6 offset:11264
  v_mfma_f32_16x16x32_bf16 v[156:159], v[204:207], v[68:71], v[156:159]
  ds_read_b128 v[176:179], v4 offset:39936
  ds_read_b128 v[180:183], v4 offset:46080
  s_cbranch_vccnz Ltg_108
Ltg_108_b:
  s_waitcnt lgkmcnt(15)
  v_mfma_f32_16x16x32_bf16 v[136:139], v[208:211], v[72:75], v[136:139]
  buffer_load_dwordx4 v[104:107], v58, s[32:35], s72 offen offset:2048 sc1
  ds_read_b128 v[184:187], v5 offset:54272
  v_mfma_f32_16x16x32_bf16 v[140:143], v[212:215], v[72:75], v[140:143]
  ds_read_b128 v[188:191], v4 offset:11264
  v_mfma_f32_16x16x32_bf16 v[144:147], v[216:219], v[72:75], v[144:147]
  ds_read_b128 v[192:195], v4 offset:17408
  v_mfma_f32_16x16x32_bf16 v[148:151], v[220:223], v[72:75], v[148:151]
  ds_read_b128 v[196:199], v6 offset:13312
  v_mfma_f32_16x16x32_bf16 v[152:155], v[224:227], v[72:75], v[152:155]
  ds_read_b128 v[200:203], v4 offset:41984
  v_mfma_f32_16x16x32_bf16 v[156:159], v[228:231], v[72:75], v[156:159]
  ds_read_b128 v[204:207], v4 offset:48128
  s_waitcnt vmcnt(5) lgkmcnt(6)
  v_mfma_f32_16x16x32_bf16 v[136:139], v[160:163], v[76:79], v[136:139]
  buffer_load_dwordx4 v[108:111], v58, s[32:35], s72 offen offset:3072 sc1
  v_max3_u32 v30, v80, v81, v82
  v_mfma_f32_16x16x32_bf16 v[140:143], v[164:167], v[76:79], v[140:143]
  v_max3_u32 v30, v30, v83, v84
  v_max3_u32 v30, v30, v85, v86
  v_mfma_f32_16x16x32_bf16 v[144:147], v[168:171], v[76:79], v[144:147]
  v_max_u32 v30, v30, v87
  v_cmp_eq_u32 vcc, -1, v30
  v_mfma_f32_16x16x32_bf16 v[148:151], v[172:175], v[76:79], v[148:151]
  ds_read_b128 v[208:211], v5 offset:55296
  ds_read_b128 v[212:215], v4 offset:12288
  v_mfma_f32_16x16x32_bf16 v[152:155], v[176:179], v[76:79], v[152:155]
  ds_read_b128 v[216:219], v4 offset:18432
  ds_read_b128 v[220:223], v6 offset:14336
  v_mfma_f32_16x16x32_bf16 v[156:159], v[180:183], v[76:79], v[156:159]
  ds_read_b128 v[224:227], v4 offset:43008
  ds_read_b128 v[228:231], v4 offset:49152
  s_cbranch_vccnz Ltg_109
Ltg_109_b:
  v_mfma_f32_16x16x32_bf16 v[136:139], a[0:3], v[80:83], v[136:139]
  buffer_load_dwordx4 v[112:115], v58, s[32:35], s73 offen offset:0 sc1
  ds_read_b128 v[160:163], v5 offset:56320
  v_mfma_f32_16x16x32_bf16 v[140:143], a[4:7], v[80:83], v[140:143]
  ds_read_b128 v[164:167], v4 offset:13312
  v_mfma_f32_16x16x32_bf16 v[144:147], a[8:11], v[80:83], v[144:147]
  ds_read_b128 v[168:171], v4 offset:19456
  v_mfma_f32_16x16x32_bf16 v[148:151], a[12:15], v[80:83], v[148:151]
  ds_read_b128 v[172:175], v6 offset:15360
  v_mfma_f32_16x16x32_bf16 v[152:155], a[16:19], v[80:83], v[152:155]
  ds_read_b128 v[176:179], v4 offset:44032
  v_mfma_f32_16x16x32_bf16 v[156:159], a[20:23], v[80:83], v[156:159]
  ds_read_b128 v[180:183], v4 offset:50176
  s_waitcnt vmcnt(5) lgkmcnt(12)
  v_mfma_f32_16x16x32_bf16 v[136:139], v[184:187], v[84:87], v[136:139]
  buffer_load_dwordx4 v[116:119], v61, s[32:35], s73 offen offset:1024 sc1
  v_mfma_f32_16x16x32_bf16 v[140:143], v[188:191], v[84:87], v[140:143]
  v_max3_u32 v30, v88, v89, v90
  v_mfma_f32_16x16x32_bf16 v[144:147], v[192:195], v[84:87], v[144:147]
  v_max3_u32 v30, v30, v91, v92
  v_mfma_f32_16x16x32_bf16 v[148:151], v[196:199], v[84:87], v[148:151]
  v_max3_u32 v30, v30, v93, v94
  v_mfma_f32_16x16x32_bf16 v[152:155], v[200:203], v[84:87], v[152:155]
  v_max_u32 v30, v30, v95
  v_mfma_f32_16x16x32_bf16 v[156:159], v[204:207], v[84:87], v[156:159]
  v_cmp_eq_u32 vcc, -1, v30
  s_cbranch_vccnz Ltg_110
Ltg_110_b:
  s_waitcnt lgkmcnt(6)
  v_mfma_f32_16x16x32_bf16 v[136:139], v[208:211], v[88:91], v[136:139]
  buffer_load_dwordx4 v[120:123], v59, s[32:35], s73 offen offset:2048 sc1
  ds_read_b128 v[184:187], v5 offset:57344
  v_mfma_f32_16x16x32_bf16 v[140:143], v[212:215], v[88:91], v[140:143]
  ds_read_b128 v[188:191], v4 offset:14336
  v_mfma_f32_16x16x32_bf16 v[144:147], v[216:219], v[88:91], v[144:147]
  ds_read_b128 v[192:195], v4 offset:20480
  v_mfma_f32_16x16x32_bf16 v[148:151], v[220:223], v[88:91], v[148:151]
  ds_read_b128 v[196:199], v6 offset:16384
  v_mfma_f32_16x16x32_bf16 v[152:155], v[224:227], v[88:91], v[152:155]
  ds_read_b128 v[200:203], v4 offset:45056
  v_mfma_f32_16x16x32_bf16 v[156:159], v[228:231], v[88:91], v[156:159]
  ds_read_b128 v[204:207], v4 offset:51200
  s_waitcnt vmcnt(5) lgkmcnt(6)
  v_mfma_f32_16x16x32_bf16 v[136:139], v[160:163], v[92:95], v[136:139]
  buffer_load_dwordx4 v[124:127], v59, s[32:35], s73 offen offset:3072 sc1
  v_max3_u32 v30, v96, v97, v98
  v_mfma_f32_16x16x32_bf16 v[140:143], v[164:167], v[92:95], v[140:143]
  v_max3_u32 v30, v30, v99, v100
  v_max3_u32 v30, v30, v101, v102
  v_mfma_f32_16x16x32_bf16 v[144:147], v[168:171], v[92:95], v[144:147]
  v_max_u32 v30, v30, v103
  v_cmp_eq_u32 vcc, -1, v30
  v_mfma_f32_16x16x32_bf16 v[148:151], v[172:175], v[92:95], v[148:151]
  ds_read_b128 v[208:211], v5 offset:59392
  ds_read_b128 v[212:215], v5 offset:62464
  v_mfma_f32_16x16x32_bf16 v[152:155], v[176:179], v[92:95], v[152:155]
  ds_read_b128 v[216:219], v4 offset:22528
  ds_read_b128 v[220:223], v6 offset:18432
  v_mfma_f32_16x16x32_bf16 v[156:159], v[180:183], v[92:95], v[156:159]
  ds_read_b128 v[224:227], v6 offset:21504
  ds_read_b128 v[228:231], v4 offset:53248
  s_cbranch_vccnz Ltg_111
Ltg_111_b:
  s_waitcnt lgkmcnt(6)
  v_mfma_f32_16x16x32_bf16 v[136:139], v[184:187], v[96:99], v[136:139]
  buffer_load_dwordx4 v[128:131], v59, s[32:35], s74 offen offset:0 sc1
  ds_read_b128 v[160:163], v5 offset:60416
  v_mfma_f32_16x16x32_bf16 v[140:143], v[188:191], v[96:99], v[140:143]
  ds_read_b128 v[164:167], v5 offset:63488
  v_mfma_f32_16x16x32_bf16 v[144:147], v[192:195], v[96:99], v[144:147]
  ds_read_b128 v[168:171], v4 offset:23552
  v_mfma_f32_16x16x32_bf16 v[148:151], v[196:199], v[96:99], v[148:151]
  ds_read_b128 v[172:175], v6 offset:19456
  v_mfma_f32_16x16x32_bf16 v[152:155], v[200:203], v[96:99], v[152:155]
  ds_read_b128 v[176:179], v6 offset:22528
  v_mfma_f32_16x16x32_bf16 v[156:159], v[204:207], v[96:99], v[156:159]
  ds_read_b128 v[180:183], v4 offset:54272
  s_waitcnt vmcnt(5)
  v_mfma_f32_16x16x32_bf16 v[136:139], a[24:27], v[100:103], v[136:139]
  buffer_load_dwordx4 v[132:135], v59, s[32:35], s74 offen offset:1024 sc1
  v_max3_u32 v30, v104, v105, v106
  v_mfma_f32_16x16x32_bf16 v[140:143], a[28:31], v[100:103], v[140:143]
  v_max3_u32 v30, v30, v107, v108
  v_max3_u32 v30, v30, v109, v110
  v_mfma_f32_16x16x32_bf16 v[144:147], a[32:35], v[100:103], v[144:147]
  v_max_u32 v30, v30, v111
  v_cmp_eq_u32 vcc, -1, v30
  v_mfma_f32_16x16x32_bf16 v[148:151], a[36:39], v[100:103], v[148:151]
  ds_read_b128 v[184:187], v4 offset:0
  ds_read_b128 v[188:191], v5 offset:64512
  v_mfma_f32_16x16x32_bf16 v[152:155], a[40:43], v[100:103], v[152:155]
  ds_read_b128 v[192:195], v4 offset:24576
  ds_read_b128 v[196:199], v4 offset:30720
  v_mfma_f32_16x16x32_bf16 v[156:159], a[44:47], v[100:103], v[156:159]
  ds_read_b128 v[200:203], v6 offset:23552
  ds_read_b128 v[204:207], v4 offset:55296
  s_cbranch_vccnz Ltg_112
Ltg_112_b:
  s_waitcnt lgkmcnt(12)
  v_mfma_f32_16x16x32_bf16 v[136:139], v[208:211], v[104:107], v[136:139]
  v_mfma_f32_16x16x32_bf16 v[140:143], v[212:215], v[104:107], v[140:143]
  v_mfma_f32_16x16x32_bf16 v[144:147], v[216:219], v[104:107], v[144:147]
  v_mfma_f32_16x16x32_bf16 v[148:151], v[220:223], v[104:107], v[148:151]
  v_mfma_f32_16x16x32_bf16 v[152:155], v[224:227], v[104:107], v[152:155]
  v_mfma_f32_16x16x32_bf16 v[156:159], v[228:231], v[104:107], v[156:159]
  s_waitcnt vmcnt(4) lgkmcnt(6)
  v_mfma_f32_16x16x32_bf16 v[136:139], v[160:163], v[108:111], v[136:139]
  v_max3_u32 v30, v112, v113, v114
  v_max3_u32 v30, v30, v115, v116
  v_mfma_f32_16x16x32_bf16 v[140:143], v[164:167], v[108:111], v[140:143]
  v_max3_u32 v30, v30, v117, v118
  v_max_u32 v30, v30, v119
  v_mfma_f32_16x16x32_bf16 v[144:147], v[168:171], v[108:111], v[144:147]
  v_cmp_eq_u32 vcc, -1, v30
  ds_read_b128 v[208:211], v4 offset:2048
  v_mfma_f32_16x16x32_bf16 v[148:151], v[172:175], v[108:111], v[148:151]
  ds_read_b128 v[212:215], v6 offset:1024
  ds_read_b128 v[216:219], v4 offset:26624
  v_mfma_f32_16x16x32_bf16 v[152:155], v[176:179], v[108:111], v[152:155]
  ds_read_b128 v[220:223], v4 offset:32768
  ds_read_b128 v[224:227], v6 offset:25600
  v_mfma_f32_16x16x32_bf16 v[156:159], v[180:183], v[108:111], v[156:159]
  ds_read_b128 v[228:231], v4 offset:57344
  s_cbranch_vccnz Ltg_113
Ltg_113_b:
  s_waitcnt lgkmcnt(6)
  v_mfma_f32_16x16x32_bf16 v[136:139], v[184:187], v[112:115], v[136:139]
  ds_read_b128 v[160:163], v4 offset:3072
  v_mfma_f32_16x16x32_bf16 v[140:143], v[188:191], v[112:115], v[140:143]
  ds_read_b128 v[164:167], v6 offset:2048
  v_mfma_f32_16x16x32_bf16 v[144:147], v[192:195], v[112:115], v[144:147]
  ds_read_b128 v[168:171], v4 offset:27648
  v_mfma_f32_16x16x32_bf16 v[148:151], v[196:199], v[112:115], v[148:151]
  ds_read_b128 v[172:175], v4 offset:33792
  v_mfma_f32_16x16x32_bf16 v[152:155], v[200:203], v[112:115], v[152:155]
  ds_read_b128 v[176:179], v6 offset:26624
  v_mfma_f32_16x16x32_bf16 v[156:159], v[204:207], v[112:115], v[156:159]
  ds_read_b128 v[180:183], v4 offset:58368
  s_waitcnt vmcnt(2)
  v_mfma_f32_16x16x32_bf16 v[136:139], a[48:51], v[116:119], v[136:139]
  v_max3_u32 v30, v120, v121, v122
  v_max3_u32 v30, v30, v123, v124
  v_mfma_f32_16x16x32_bf16 v[140:143], a[52:55], v[116:119], v[140:143]
  v_max3_u32 v30, v30, v125, v126
  v_max_u32 v30, v30, v127
  v_mfma_f32_16x16x32_bf16 v[144:147], a[56:59], v[116:119], v[144:147]
  v_cmp_eq_u32 vcc, -1, v30
  ds_read_b128 v[184:187], v4 offset:4096
  v_mfma_f32_16x16x32_bf16 v[148:151], a[60:63], v[116:119], v[148:151]
  ds_read_b128 v[188:191], v6 offset:3072
  ds_read_b128 v[192:195], v4 offset:28672
  v_mfma_f32_16x16x32_bf16 v[152:155], a[64:67], v[116:119], v[152:155]
  ds_read_b128 v[196:199], v4 offset:34816
  ds_read_b128 v[200:203], v6 offset:27648
  v_mfma_f32_16x16x32_bf16 v[156:159], a[68:71], v[116:119], v[156:159]
  ds_read_b128 v[204:207], v4 offset:59392
  s_cbranch_vccnz Ltg_114
Ltg_114_b:
  s_waitcnt lgkmcnt(12)
  v_mfma_f32_16x16x32_bf16 v[136:139], v[208:211], v[120:123], v[136:139]
  v_mfma_f32_16x16x32_bf16 v[140:143], v[212:215], v[120:123], v[140:143]
  v_mfma_f32_16x16x32_bf16 v[144:147], v[216:219], v[120:123], v[144:147]
  v_mfma_f32_16x16x32_bf16 v[148:151], v[220:223], v[120:123], v[148:151]
  v_mfma_f32_16x16x32_bf16 v[152:155], v[224:227], v[120:123], v[152:155]
  v_mfma_f32_16x16x32_bf16 v[156:159], v[228:231], v[120:123], v[156:159]
  s_waitcnt vmcnt(0) lgkmcnt(6)
  v_mfma_f32_16x16x32_bf16 v[136:139], v[160:163], v[124:127], v[136:139]
  v_max3_u32 v30, v128, v129, v130
  v_max3_u32 v30, v30, v131, v132
  v_mfma_f32_16x16x32_bf16 v[140:143], v[164:167], v[124:127], v[140:143]
  v_max3_u32 v30, v30, v133, v134
  v_max_u32 v30, v30, v135
  v_mfma_f32_16x16x32_bf16 v[144:147], v[168:171], v[124:127], v[144:147]
  v_cmp_eq_u32 vcc, -1, v30
  ds_read_b128 v[208:211], v4 offset:5120
  v_mfma_f32_16x16x32_bf16 v[148:151], v[172:175], v[124:127], v[148:151]
  ds_read_b128 v[212:215], v6 offset:4096
  ds_read_b128 v[216:219], v4 offset:29696
  v_mfma_f32_16x16x32_bf16 v[152:155], v[176:179], v[124:127], v[152:155]
  ds_read_b128 v[220:223], v4 offset:35840
  ds_read_b128 v[224:227], v6 offset:28672
  v_mfma_f32_16x16x32_bf16 v[156:159], v[180:183], v[124:127], v[156:159]
  ds_read_b128 v[228:231], v4 offset:60416
  s_cbranch_vccnz Ltg_115
Ltg_115_b:
  s_waitcnt lgkmcnt(6)
  v_mfma_f32_16x16x32_bf16 v[136:139], v[184:187], v[128:131], v[136:139]
  v_mfma_f32_16x16x32_bf16 v[140:143], v[188:191], v[128:131], v[140:143]
  v_mfma_f32_16x16x32_bf16 v[144:147], v[192:195], v[128:131], v[144:147]
  v_mfma_f32_16x16x32_bf16 v[148:151], v[196:199], v[128:131], v[148:151]
  v_mfma_f32_16x16x32_bf16 v[152:155], v[200:203], v[128:131], v[152:155]
  v_mfma_f32_16x16x32_bf16 v[156:159], v[204:207], v[128:131], v[156:159]
  s_waitcnt lgkmcnt(0)
  v_mfma_f32_16x16x32_bf16 v[136:139], v[208:211], v[132:135], v[136:139]
  v_mfma_f32_16x16x32_bf16 v[140:143], v[212:215], v[132:135], v[140:143]
  v_mfma_f32_16x16x32_bf16 v[144:147], v[216:219], v[132:135], v[144:147]
  v_mfma_f32_16x16x32_bf16 v[148:151], v[220:223], v[132:135], v[148:151]
  v_mfma_f32_16x16x32_bf16 v[152:155], v[224:227], v[132:135], v[152:155]
  v_mfma_f32_16x16x32_bf16 v[156:159], v[228:231], v[132:135], v[156:159]
  s_nop 2
  v_cvt_pk_bf16_f32 v160, v136, v137
  v_cvt_pk_bf16_f32 v161, v138, v139
  v_cvt_pk_bf16_f32 v162, v140, v141
  v_cvt_pk_bf16_f32 v163, v142, v143
  v_cvt_pk_bf16_f32 v164, v144, v145
  v_cvt_pk_bf16_f32 v165, v146, v147
  v_cvt_pk_bf16_f32 v166, v148, v149
  v_cvt_pk_bf16_f32 v167, v150, v151
  v_cvt_pk_bf16_f32 v168, v152, v153
  v_cvt_pk_bf16_f32 v169, v154, v155
  v_cvt_pk_bf16_f32 v170, v156, v157
  v_cvt_pk_bf16_f32 v171, v158, v159
  v_mfma_f32_16x16x32_bf16 v[184:187], v[20:23], v[160:163], 0
  v_mfma_f32_16x16x32_bf16 v[188:191], v[160:163], v[160:163], 0
  v_mfma_f32_16x16x32_bf16 v[184:187], v[20:23], v[164:167], v[184:187]
  v_mfma_f32_16x16x32_bf16 v[188:191], v[164:167], v[164:167], v[188:191]
  v_mfma_f32_16x16x32_bf16 v[184:187], v[20:23], v[168:171], v[184:187]
  v_mfma_f32_16x16x32_bf16 v[188:191], v[168:171], v[168:171], v[188:191]
  s_add_u32 s46, s55, 14843904
  buffer_store_dwordx4 v[160:163], v4, s[28:31], s46 offen offset:0 sc1
  buffer_store_dwordx4 v[164:167], v4, s[28:31], s46 offen offset:1024 sc1
  buffer_store_dwordx4 v[168:171], v4, s[28:31], s46 offen offset:2048 sc1
  s_mul_i32 s46, s53, 6
  s_add_u32 s46, s46, s51
  s_lshl_b32 s46, s46, 7
  s_add_u32 s46, s46, 17203200
  v_cndmask_b32 v188, v188, v189, s[56:57]
  v_cndmask_b32 v190, v190, v191, s[56:57]
  v_cndmask_b32 v185, v188, v190, s[68:69]
  s_mov_b64 exec, s[76:77]
  buffer_store_dwordx2 v[184:185], v9, s[28:31], s46 offen sc1
  s_mov_b64 exec, -1
  s_branch L_p5_pre
L_p3_helper:
  s_cmp_ge_u32 s48, 144
  s_cbranch_scc1 L_p3_touch
  s_barrier
  s_mul_i32 s58, s79, 0
  s_add_u32 s58, s58, s73
  s_mov_b32 m0, s58
  s_nop 0
  buffer_load_dwordx4 v244, s[36:39], s3 offen offset:0 sc1 lds
  buffer_load_dwordx4 v245, s[36:39], s3 offen offset:1024 sc1 lds
  v_add_u32 v40, 0, v1
  v_mul_u32_u24 v10, 911, v40
  v_lshrrev_b32 v10, 16, v10
  v_mul_u32_u24 v41, 72, v10
  v_sub_u32 v41, v40, v41
  v_lshlrev_b32 v20, 4, v41
  v_add_u32 v40, 64, v1
  v_mul_u32_u24 v11, 911, v40
  v_lshrrev_b32 v11, 16, v11
  v_mul_u32_u24 v41, 72, v11
  v_sub_u32 v41, v40, v41
  v_lshlrev_b32 v21, 4, v41
  v_add_u32 v40, 128, v1
  v_mul_u32_u24 v12, 911, v40
  v_lshrrev_b32 v12, 16, v12
  v_mul_u32_u24 v41, 72, v12
  v_sub_u32 v41, v40, v41
  v_lshlrev_b32 v22, 4, v41
  v_add_u32 v40, 192, v1
  v_mul_u32_u24 v13, 911, v40
  v_lshrrev_b32 v13, 16, v13
  v_mul_u32_u24 v41, 72, v13
  v_sub_u32 v41, v40, v41
  v_lshlrev_b32 v23, 4, v41
  v_add_u32 v40, 256, v1
  v_mul_u32_u24 v14, 911, v40
  v_lshrrev_b32 v14, 16, v14
  v_mul_u32_u24 v41, 72, v14
  v_sub_u32 v41, v40, v41
  v_lshlrev_b32 v24, 4, v41
  v_add_u32 v40, 320, v1
  v_mul_u32_u24 v15, 911, v40
  v_lshrrev_b32 v15, 16, v15
  v_mul_u32_u24 v41, 72, v15
  v_sub_u32 v41, v40, v41
  v_lshlrev_b32 v25, 4, v41
  v_add_u32 v40, 384, v1
  v_mul_u32_u24 v16, 911, v40
  v_lshrrev_b32 v16, 16, v16
  v_mul_u32_u24 v41, 72, v16
  v_sub_u32 v41, v40, v41
  v_lshlrev_b32 v26, 4, v41
  v_add_u32 v40, 448, v1
  v_mul_u32_u24 v17, 911, v40
  v_lshrrev_b32 v17, 16, v17
  v_mul_u32_u24 v41, 72, v17
  v_sub_u32 v41, v40, v41
  v_lshlrev_b32 v27, 4, v41
  v_add_u32 v40, 512, v1
  v_mul_u32_u24 v18, 911, v40
  v_lshrrev_b32 v18, 16, v18
  v_mul_u32_u24 v41, 72, v18
  v_sub_u32 v41, v40, v41
  v_lshlrev_b32 v28, 4, v41
  v_lshrrev_b32 v40, 2, v2
  v_lshl_add_u32 v40, v3, 3, v40
  v_mul_u32_u24 v40, 1152, v40
  v_and_b32 v41, 3, v2
  v_lshl_add_u32 v30, v41, 4, v40
  s_lshr_b32 s46, s40, 1
  s_lshl_b32 s46, s46, 6
  s_and_b32 s47, s40, 1
  s_lshl_b32 s47, s47, 3
  s_add_u32 s46, s46, s47
  v_add_u32 v30, s46, v30
  s_add_u32 s48, s48, 54
  s_sub_u32 s53, s48, 54
  s_mul_hi_u32 s51, s53, 238609295
  s_mul_i32 s52, s51, 18
  s_sub_u32 s52, s53, s52
  s_mul_i32 s60, s51, 663552
  s_add_u32 s60, s60, 19292160
  s_mul_i32 s53, s40, 165888
  s_add_u32 s60, s60, s53
  s_mov_b32 s61, 18432
  s_lshl_b32 s53, s52, 10
  s_add_u32 s60, s60, s53
  s_add_u32 s62, s48, 256
  s_add_u32 s48, s48, 1
  s_sub_u32 s53, s48, 54
  s_mul_hi_u32 s51, s53, 238609295
  s_mul_i32 s52, s51, 18
  s_sub_u32 s52, s53, s52
  s_mul_i32 s63, s51, 663552
  s_add_u32 s63, s63, 19292160
  s_mul_i32 s53, s40, 165888
  s_add_u32 s63, s63, s53
  s_mov_b32 s64, 18432
  s_lshl_b32 s53, s52, 10
  s_add_u32 s63, s63, s53
  s_add_u32 s65, s48, 256
  s_add_u32 s48, s48, 1
  s_sub_u32 s53, s48, 54
  s_mul_hi_u32 s51, s53, 238609295
  s_mul_i32 s52, s51, 18
  s_sub_u32 s52, s53, s52
  s_mul_i32 s66, s51, 663552
  s_add_u32 s66, s66, 19292160
  s_mul_i32 s53, s40, 165888
  s_add_u32 s66, s66, s53
  s_mov_b32 s67, 18432
  s_lshl_b32 s53, s52, 10
  s_add_u32 s66, s66, s53
  s_add_u32 s68, s48, 256
  s_add_u32 s48, s48, 1
  s_waitcnt vmcnt(0)
  s_barrier
  v_add_u32 v31, 53248, v30
  ds_read_b64_tr_b16 v[44:45], v31 offset:0
  ds_read_b64_tr_b16 v[46:47], v31 offset:4608
  ds_read_b64_tr_b16 v[48:49], v31 offset:128
  ds_read_b64_tr_b16 v[50:51], v31 offset:4736
  ds_read_b64_tr_b16 v[52:53], v31 offset:256
  ds_read_b64_tr_b16 v[54:55], v31 offset:4864
  ds_read_b64_tr_b16 v[56:57], v31 offset:384
  ds_read_b64_tr_b16 v[58:59], v31 offset:4992
  ds_read_b64_tr_b16 v[60:61], v31 offset:512
  ds_read_b64_tr_b16 v[62:63], v31 offset:5120
  ds_read_b64_tr_b16 v[64:65], v31 offset:640
  ds_read_b64_tr_b16 v[66:67], v31 offset:5248
  ds_read_b64_tr_b16 v[68:69], v31 offset:768
  ds_read_b64_tr_b16 v[70:71], v31 offset:5376
  ds_read_b64_tr_b16 v[72:73], v31 offset:896
  ds_read_b64_tr_b16 v[74:75], v31 offset:5504
  ds_read_b64_tr_b16 v[76:77], v31 offset:1024
  ds_read_b64_tr_b16 v[78:79], v31 offset:5632
  s_mov_b32 s53, s60
  s_waitcnt lgkmcnt(15)
  buffer_store_dwordx4 v[44:47], v4, s[28:31], s53 offen sc1
  s_add_u32 s53, s53, s61
  s_waitcnt lgkmcnt(14)
  buffer_store_dwordx4 v[48:51], v4, s[28:31], s53 offen sc1
  s_add_u32 s53, s53, s61
  s_waitcnt lgkmcnt(12)
  buffer_store_dwordx4 v[52:55], v4, s[28:31], s53 offen sc1
  s_add_u32 s53, s53, s61
  s_waitcnt lgkmcnt(10)
  buffer_store_dwordx4 v[56:59], v4, s[28:31], s53 offen sc1
  s_add_u32 s53, s53, s61
  s_waitcnt lgkmcnt(8)
  buffer_store_dwordx4 v[60:63], v4, s[28:31], s53 offen sc1
  s_add_u32 s53, s53, s61
  s_waitcnt lgkmcnt(6)
  buffer_store_dwordx4 v[64:67], v4, s[28:31], s53 offen sc1
  s_add_u32 s53, s53, s61
  s_waitcnt lgkmcnt(4)
  buffer_store_dwordx4 v[68:71], v4, s[28:31], s53 offen sc1
  s_add_u32 s53, s53, s61
  s_waitcnt lgkmcnt(2)
  buffer_store_dwordx4 v[72:75], v4, s[28:31], s53 offen sc1
  s_add_u32 s53, s53, s61
  s_waitcnt lgkmcnt(0)
  buffer_store_dwordx4 v[76:79], v4, s[28:31], s53 offen sc1
  s_add_u32 s53, s53, s61
  v_add_u32 v31, 90112, v30
  ds_read_b64_tr_b16 v[44:45], v31 offset:0
  ds_read_b64_tr_b16 v[46:47], v31 offset:4608
  ds_read_b64_tr_b16 v[48:49], v31 offset:128
  ds_read_b64_tr_b16 v[50:51], v31 offset:4736
  ds_read_b64_tr_b16 v[52:53], v31 offset:256
  ds_read_b64_tr_b16 v[54:55], v31 offset:4864
  ds_read_b64_tr_b16 v[56:57], v31 offset:384
  ds_read_b64_tr_b16 v[58:59], v31 offset:4992
  ds_read_b64_tr_b16 v[60:61], v31 offset:512
  ds_read_b64_tr_b16 v[62:63], v31 offset:5120
  ds_read_b64_tr_b16 v[64:65], v31 offset:640
  ds_read_b64_tr_b16 v[66:67], v31 offset:5248
  ds_read_b64_tr_b16 v[68:69], v31 offset:768
  ds_read_b64_tr_b16 v[70:71], v31 offset:5376
  ds_read_b64_tr_b16 v[72:73], v31 offset:896
  ds_read_b64_tr_b16 v[74:75], v31 offset:5504
  ds_read_b64_tr_b16 v[76:77], v31 offset:1024
  ds_read_b64_tr_b16 v[78:79], v31 offset:5632
  s_mov_b32 s53, s63
  s_waitcnt lgkmcnt(15)
  buffer_store_dwordx4 v[44:47], v4, s[28:31], s53 offen sc1
  s_add_u32 s53, s53, s64
  s_waitcnt lgkmcnt(14)
  buffer_store_dwordx4 v[48:51], v4, s[28:31], s53 offen sc1
  s_add_u32 s53, s53, s64
  s_waitcnt lgkmcnt(12)
  buffer_store_dwordx4 v[52:55], v4, s[28:31], s53 offen sc1
  s_add_u32 s53, s53, s64
  s_waitcnt lgkmcnt(10)
  buffer_store_dwordx4 v[56:59], v4, s[28:31], s53 offen sc1
  s_add_u32 s53, s53, s64
  s_waitcnt lgkmcnt(8)
  buffer_store_dwordx4 v[60:63], v4, s[28:31], s53 offen sc1
  s_add_u32 s53, s53, s64
  s_waitcnt lgkmcnt(6)
  buffer_store_dwordx4 v[64:67], v4, s[28:31], s53 offen sc1
  s_add_u32 s53, s53, s64
  s_waitcnt lgkmcnt(4)
  buffer_store_dwordx4 v[68:71], v4, s[28:31], s53 offen sc1
  s_add_u32 s53, s53, s64
  s_waitcnt lgkmcnt(2)
  buffer_store_dwordx4 v[72:75], v4, s[28:31], s53 offen sc1
  s_add_u32 s53, s53, s64
  s_waitcnt lgkmcnt(0)
  buffer_store_dwordx4 v[76:79], v4, s[28:31], s53 offen sc1
  s_add_u32 s53, s53, s64
  v_add_u32 v31, 126976, v30
  ds_read_b64_tr_b16 v[44:45], v31 offset:0
  ds_read_b64_tr_b16 v[46:47], v31 offset:4608
  ds_read_b64_tr_b16 v[48:49], v31 offset:128
  ds_read_b64_tr_b16 v[50:51], v31 offset:4736
  ds_read_b64_tr_b16 v[52:53], v31 offset:256
  ds_read_b64_tr_b16 v[54:55], v31 offset:4864
  ds_read_b64_tr_b16 v[56:57], v31 offset:384
  ds_read_b64_tr_b16 v[58:59], v31 offset:4992
  ds_read_b64_tr_b16 v[60:61], v31 offset:512
  ds_read_b64_tr_b16 v[62:63], v31 offset:5120
  ds_read_b64_tr_b16 v[64:65], v31 offset:640
  ds_read_b64_tr_b16 v[66:67], v31 offset:5248
  ds_read_b64_tr_b16 v[68:69], v31 offset:768
  ds_read_b64_tr_b16 v[70:71], v31 offset:5376
  ds_read_b64_tr_b16 v[72:73], v31 offset:896
  ds_read_b64_tr_b16 v[74:75], v31 offset:5504
  ds_read_b64_tr_b16 v[76:77], v31 offset:1024
  ds_read_b64_tr_b16 v[78:79], v31 offset:5632
  s_mov_b32 s53, s66
  s_waitcnt lgkmcnt(15)
  buffer_store_dwordx4 v[44:47], v4, s[28:31], s53 offen sc1
  s_add_u32 s53, s53, s67
  s_waitcnt lgkmcnt(14)
  buffer_store_dwordx4 v[48:51], v4, s[28:31], s53 offen sc1
  s_add_u32 s53, s53, s67
  s_waitcnt lgkmcnt(12)
  buffer_store_dwordx4 v[52:55], v4, s[28:31], s53 offen sc1
  s_add_u32 s53, s53, s67
  s_waitcnt lgkmcnt(10)
  buffer_store_dwordx4 v[56:59], v4, s[28:31], s53 offen sc1
  s_add_u32 s53, s53, s67
  s_waitcnt lgkmcnt(8)
  buffer_store_dwordx4 v[60:63], v4, s[28:31], s53 offen sc1
  s_add_u32 s53, s53, s67
  s_waitcnt lgkmcnt(6)
  buffer_store_dwordx4 v[64:67], v4, s[28:31], s53 offen sc1
  s_add_u32 s53, s53, s67
  s_waitcnt lgkmcnt(4)
  buffer_store_dwordx4 v[68:71], v4, s[28:31], s53 offen sc1
  s_add_u32 s53, s53, s67
  s_waitcnt lgkmcnt(2)
  buffer_store_dwordx4 v[72:75], v4, s[28:31], s53 offen sc1
  s_add_u32 s53, s53, s67
  s_waitcnt lgkmcnt(0)
  buffer_store_dwordx4 v[76:79], v4, s[28:31], s53 offen sc1
  s_add_u32 s53, s53, s67
  s_waitcnt vmcnt(0)
  s_barrier
  s_cmp_lg_u32 s40, 0
  s_cbranch_scc1 Lswf_116
  s_lshl_b32 s62, s62, 7
  s_add_u32 s62, s62, 128
  v_mov_b32 v40, s43
  v_mov_b32 v41, 0
  s_mov_b64 exec, 1
  buffer_store_dword v40, v41, s[28:31], s62 offen sc1
  s_mov_b64 exec, -1
  s_lshl_b32 s65, s65, 7
  s_add_u32 s65, s65, 128
  v_mov_b32 v40, s43
  v_mov_b32 v41, 0
  s_mov_b64 exec, 1
  buffer_store_dword v40, v41, s[28:31], s65 offen sc1
  s_mov_b64 exec, -1
  s_lshl_b32 s68, s68, 7
  s_add_u32 s68, s68, 128
  v_mov_b32 v40, s43
  v_mov_b32 v41, 0
  s_mov_b64 exec, 1
  buffer_store_dword v40, v41, s[28:31], s68 offen sc1
  s_mov_b64 exec, -1
Lswf_116:
L_p3_touch:
  s_lshr_b32 s46, s41, 2
  s_lshl_b32 s64, s46, 4
  s_lshr_b32 s67, s42, 1
  s_add_u32 s64, s64, s67
  s_and_b32 s67, s67, 7
  s_mov_b32 s67, 0
  s_and_b32 s46, s41, 3
  s_lshl_b32 s65, s46, 1
  s_and_b32 s46, s42, 1
  s_add_u32 s65, s65, s46
  s_lshl_b32 s46, s65, 2
  s_add_u32 s46, s46, s40
  s_mul_i32 s66, s46, 165888
  s_add_u32 s66, s66, 19292160
  s_lshr_b32 s46, s65, 1
  s_mul_i32 s46, s46, 1327104
  s_and_b32 s47, s74, 3
  s_lshl_b32 s47, s47, 1
  s_add_u32 s47, s47, s75
  s_sub_u32 s47, s47, 6
  s_mov_b32 s46, 0
  s_lshl_b32 s47, s74, 1
  s_add_u32 s47, s47, s75
  s_sub_u32 s47, s47, 6
  s_lshl_b32 s47, s47, 2
  s_add_u32 s47, s47, s40
  s_mul_i32 s47, s47, 20736
  s_add_u32 s46, s46, s47
  s_add_u32 s32, s18, 0
  s_addc_u32 s33, s19, 0
  s_mov_b32 s34, 5308416
  s_mov_b32 s35, 0x20000
  v_lshlrev_b32 v10, 7, v1
  buffer_load_dword v11, v10, s[32:35], s46 offen
  s_add_u32 s46, s46, 8192
  buffer_load_dword v11, v10, s[32:35], s46 offen
  s_add_u32 s46, s46, 8192
  s_bfm_b64 exec, 34, 0
  buffer_load_dword v11, v10, s[32:35], s46 offen
  s_add_u32 s46, s46, 8192
  s_mov_b64 exec, -1
  s_mul_i32 s46, s65, 18
  s_add_u32 s46, s46, 310
  v_min_u32 v54, 17, v1
  v_add_u32 v54, s46, v54
  v_lshlrev_b32 v54, 7, v54
  buffer_load_dword v55, v54, s[28:31], 0 offen offset:128 sc1
  s_mov_b32 s46, 521216
  buffer_load_dwordx4 v[16:19], v4, s[28:31], s46 offen sc1
  s_waitcnt vmcnt(0)
  s_cmp_lg_u32 s40, 0
  s_cbranch_scc1 Lm2_117_x
  s_mov_b32 s47, 100000
Lm2_117:
  v_xor_b32 v16, s43, v16
  v_xor_b32 v17, s43, v17
  v_xor_b32 v18, s43, v18
  v_xor_b32 v19, s43, v19
  v_or3_b32 v16, v16, v17, v18
  v_or_b32 v16, v16, v19
  v_cmp_ne_u32 vcc, 0, v16
  s_cbranch_vccz Lm2_117_x
  s_mov_b32 s46, 521216
  buffer_load_dwordx4 v[16:19], v4, s[28:31], s46 offen sc1
  s_waitcnt vmcnt(0)
  s_sub_u32 s47, s47, 1
  s_cbranch_scc0 Lm2_117
Lm2_117_x:
L_p5_pre:
L_p5_done:
  s_mov_b32 s50, s64
  s_mov_b32 s51, s65
  s_mov_b32 s54, s66
  s_mov_b32 s52, s67
  s_lshl_b32 s53, s50, 2
  s_add_u32 s53, s53, s40
  s_mul_i32 s56, s50, 72
  s_add_u32 s56, s56, s51
  s_lshl_b32 s56, s56, 2
  s_add_u32 s56, s56, s40
  s_lshl_b32 s56, s56, 11
  s_add_u32 s56, s56, 29908992
  s_mul_i32 s46, s53, 18432
  s_add_u32 s70, s46, 14843904
  s_add_u32 s71, s46, 14848000
  s_add_u32 s72, s46, 14852096
  s_add_u32 s73, s46, 14856192
  s_add_u32 s74, s46, 14860288
  s_mul_i32 s46, s40, 18432
  v_add_u32 v5, s46, v4
  v_lshlrev_b32 v14, 3, v1
  v_add_u32 v15, 512, v14
  v_cmp_gt_u32 vcc, 32, v1
  v_mov_b32 v10, 0x7fffffff
  s_nop 0
  v_cndmask_b32 v15, v10, v15, vcc
  s_mul_i32 s46, s53, 768
  s_add_u32 s46, s46, 17203200
  s_mov_b32 s60, s46
  v_mov_b32 v28, 0
  global_load_dword v29, v28, s[22:23] sc1
  s_cmp_lg_u32 s40, 0
  s_cbranch_scc1 Lh_118
  v_cmp_ne_u32 vcc, s43, v55
  s_cbranch_vccz Lh_118
  v_lshrrev_b32 v54, 7, v54
  v_lshlrev_b32 v54, 7, v54
  s_mov_b32 s46, 100000
Lpoll_119:
  buffer_load_dword v55, v54, s[28:31], 0 offen offset:128 sc1
  s_waitcnt vmcnt(0)
  v_cmp_ne_u32 vcc, s43, v55
  s_cbranch_vccz Lpoll_119_x
  s_sleep 2
  s_sub_u32 s46, s46, 1
  s_cbranch_scc0 Lpoll_119
Lpoll_119_x:
Lh_118:
  s_barrier
  s_mul_i32 s59, s67, 18432
  s_add_u32 s59, s59, s66
  buffer_load_dwordx4 a[184:187], v4, s[28:31], s59 offen offset:0 sc1
  buffer_load_dwordx4 a[188:191], v4, s[28:31], s59 offen offset:1024 sc1
  buffer_load_dwordx4 a[192:195], v4, s[28:31], s59 offen offset:2048 sc1
  buffer_load_dwordx4 a[196:199], v4, s[28:31], s59 offen offset:3072 sc1
  s_add_u32 s59, s59, 4096
  buffer_load_dwordx4 a[200:203], v4, s[28:31], s59 offen offset:0 sc1
  buffer_load_dwordx4 a[204:207], v4, s[28:31], s59 offen offset:1024 sc1
  buffer_load_dwordx4 a[208:211], v4, s[28:31], s59 offen offset:2048 sc1
  buffer_load_dwordx4 a[212:215], v4, s[28:31], s59 offen offset:3072 sc1
  s_add_u32 s59, s59, 4096
  buffer_load_dwordx4 a[216:219], v4, s[28:31], s59 offen offset:0 sc1
  buffer_load_dwordx4 a[220:223], v4, s[28:31], s59 offen offset:1024 sc1
  buffer_load_dwordx4 a[224:227], v4, s[28:31], s59 offen offset:2048 sc1
  buffer_load_dwordx4 a[228:231], v4, s[28:31], s59 offen offset:3072 sc1
  s_add_u32 s59, s59, 4096
  buffer_load_dwordx4 a[232:235], v4, s[28:31], s59 offen offset:0 sc1
  buffer_load_dwordx4 a[236:239], v4, s[28:31], s59 offen offset:1024 sc1
  buffer_load_dwordx4 a[240:243], v4, s[28:31], s59 offen offset:2048 sc1
  buffer_load_dwordx4 a[244:247], v4, s[28:31], s59 offen offset:3072 sc1
  s_add_u32 s59, s59, 4096
  buffer_load_dwordx4 a[248:251], v4, s[28:31], s59 offen offset:0 sc1
  buffer_load_dwordx4 a[252:255], v4, s[28:31], s59 offen offset:1024 sc1
  s_mov_b32 s79, 50000
  buffer_load_dwordx2 v[10:11], v14, s[28:31], s60 offen sc1
  buffer_load_dwordx2 v[12:13], v15, s[28:31], s60 offen sc1
  buffer_load_dwordx4 v[64:67], v4, s[28:31], s70 offen offset:0 sc1
  buffer_load_dwordx4 v[68:71], v4, s[28:31], s70 offen offset:1024 sc1
  buffer_load_dwordx4 v[72:75], v4, s[28:31], s70 offen offset:2048 sc1
  buffer_load_dwordx4 v[76:79], v4, s[28:31], s70 offen offset:3072 sc1
  buffer_load_dwordx4 v[80:83], v4, s[28:31], s71 offen offset:0 sc1
  buffer_load_dwordx4 v[84:87], v4, s[28:31], s71 offen offset:1024 sc1
  buffer_load_dwordx4 v[88:91], v4, s[28:31], s71 offen offset:2048 sc1
  buffer_load_dwordx4 v[92:95], v4, s[28:31], s71 offen offset:3072 sc1
  v_add_u32 v32, 36864, v4
  v_add_u32 v33, 73728, v4
  v_add_u32 v34, 110592, v4
  s_lshr_b32 s46, s40, 1
  s_lshl_b32 s46, s46, 12
  s_and_b32 s47, s40, 1
  s_lshl_b32 s47, s47, 3
  s_add_u32 s46, s46, s47
  v_add_u32 v35, s46, v33
  s_mov_b32 s48, 1055913304
  s_mov_b32 s49, 1084043516
  v_lshrrev_b32 v26, 2, v2
  v_cmp_eq_u32 s[64:65], v26, v3
  v_and_b32 v26, 1, v2
  v_lshlrev_b32 v26, 4, v26
  v_mov_b32 v27, 0x3f80
  v_lshlrev_b32 v27, v26, v27
  v_cndmask_b32 v27, 0, v27, s[64:65]
  v_and_b32 v26, 2, v2
  v_cmp_eq_u32 vcc, 0, v26
  s_nop 1
  v_cndmask_b32 v8, 0, v27, vcc
  v_cndmask_b32 v9, v27, 0, vcc
  v_mov_b32 v6, 0
  v_mov_b32 v7, 0
  s_bfe_u32 s66, s40, 65536
  s_lshl_b32 s66, s66, 1
  v_lshrrev_b32 v26, 3, v2
  v_add_u32 v26, s66, v26
  v_cmp_eq_u32 s[66:67], v26, v3
  v_and_b32 v26, 1, v2
  v_lshlrev_b32 v26, 4, v26
  v_mov_b32 v27, 0x3f80
  v_lshlrev_b32 v27, v26, v27
  v_cndmask_b32 v27, 0, v27, s[66:67]
  v_bfe_u32 v26, v2, 1, 2
  v_cmp_eq_u32 s[66:67], 0, v26
  s_nop 1
  v_cndmask_b32 v36, 0, v27, s[66:67]
  v_cmp_eq_u32 s[66:67], 1, v26
  s_nop 1
  v_cndmask_b32 v37, 0, v27, s[66:67]
  v_cmp_eq_u32 s[66:67], 2, v26
  s_nop 1
  v_cndmask_b32 v38, 0, v27, s[66:67]
  v_cmp_eq_u32 s[66:67], 3, v26
  s_nop 1
  v_cndmask_b32 v39, 0, v27, s[66:67]
  s_waitcnt vmcnt(8)
  v_max3_u32 v30, v10, v11, v12
  v_max_u32 v30, v30, v13
  v_cmp_eq_u32 vcc, -1, v30
  s_cbranch_vccnz Ltg_120
Ltg_120_b:
  v_add_f32 v10, v10, v12
  v_add_f32 v11, v11, v13
  v_mov_b32 v12, v10
  v_mov_b32 v13, v11
  s_nop 0
  v_permlane32_swap_b32 v10, v12
  v_permlane32_swap_b32 v11, v13
  v_add_f32 v10, v10, v12
  v_add_f32 v11, v11, v13
  v_mov_b32 v12, v10
  v_mov_b32 v13, v11
  s_nop 0
  v_permlane16_swap_b32 v10, v12
  v_permlane16_swap_b32 v11, v13
  v_add_f32 v10, v10, v12
  v_add_f32 v11, v11, v13
  s_mov_b32 s47, 987991609
  v_mul_f32 v17, s47, v10
  v_mul_f32 v10, v17, v17
  v_fma_f32 v11, v11, s47, -v10
  v_max_f32 v11, 0, v11
  v_add_f32 v10, 925353388, v11
  v_rsq_f32 v16, v10
  s_nop 0
  v_mul_f32 v16, s48, v16
  v_cvt_pk_bf16_f32 v16, v16, 0
  v_lshlrev_b32 v18, 16, v16
  v_mul_f32 v17, v18, -v17
  s_mul_i32 s60, s50, 73728
  s_lshl_b32 s46, s51, 1
  s_lshr_b32 s47, s40, 1
  s_add_u32 s46, s46, s47
  s_lshl_b32 s46, s46, 10
  s_add_u32 s78, s46, s60
  s_waitcnt vmcnt(6)
  v_max3_u32 v30, v64, v65, v66
  v_max3_u32 v30, v30, v67, v68
  v_max3_u32 v30, v30, v69, v70
  v_max_u32 v30, v30, v71
  v_cmp_eq_u32 vcc, -1, v30
  buffer_load_dwordx4 v[96:99], v4, s[28:31], s72 offen offset:0 sc1
  buffer_load_dwordx4 v[100:103], v4, s[28:31], s72 offen offset:1024 sc1
  s_cbranch_vccnz Ltg_121
Ltg_121_b:
  v_dot2_f32_bf16 v20, v64, v16, v17
  v_dot2_f32_bf16 v21, v64, v18, v17
  v_dot2_f32_bf16 v22, v65, v16, v17
  v_dot2_f32_bf16 v23, v65, v18, v17
  v_dot2_f32_bf16 v24, v66, v16, v17
  v_dot2_f32_bf16 v25, v66, v18, v17
  v_dot2_f32_bf16 v26, v67, v16, v17
  v_dot2_f32_bf16 v27, v67, v18, v17
  v_dot2_f32_bf16 v40, v68, v16, v17
  v_dot2_f32_bf16 v41, v68, v18, v17
  v_dot2_f32_bf16 v42, v69, v16, v17
  v_dot2_f32_bf16 v43, v69, v18, v17
  v_dot2_f32_bf16 v44, v70, v16, v17
  v_dot2_f32_bf16 v45, v70, v18, v17
  v_dot2_f32_bf16 v46, v71, v16, v17
  v_dot2_f32_bf16 v47, v71, v18, v17
  v_cvt_pk_bf16_f32 v64, v20, v21
  v_cvt_pk_bf16_f32 v65, v22, v23
  v_cvt_pk_bf16_f32 v66, v24, v25
  v_cvt_pk_bf16_f32 v67, v26, v27
  ds_write_b128 v5, v[64:67] offset:0
  v_cvt_pk_bf16_f32 v68, v40, v41
  v_cvt_pk_bf16_f32 v69, v42, v43
  v_cvt_pk_bf16_f32 v70, v44, v45
  v_cvt_pk_bf16_f32 v71, v46, v47
  ds_write_b128 v5, v[68:71] offset:1024
  s_waitcnt vmcnt(6)
  v_max3_u32 v30, v72, v73, v74
  v_max3_u32 v30, v30, v75, v76
  v_max3_u32 v30, v30, v77, v78
  v_max_u32 v30, v30, v79
  v_cmp_eq_u32 vcc, -1, v30
  buffer_load_dwordx4 v[104:107], v4, s[28:31], s72 offen offset:2048 sc1
  buffer_load_dwordx4 v[108:111], v4, s[28:31], s72 offen offset:3072 sc1
  s_cbranch_vccnz Ltg_122
Ltg_122_b:
  v_dot2_f32_bf16 v20, v72, v16, v17
  v_dot2_f32_bf16 v21, v72, v18, v17
  v_dot2_f32_bf16 v22, v73, v16, v17
  v_dot2_f32_bf16 v23, v73, v18, v17
  v_dot2_f32_bf16 v24, v74, v16, v17
  v_dot2_f32_bf16 v25, v74, v18, v17
  v_dot2_f32_bf16 v26, v75, v16, v17
  v_dot2_f32_bf16 v27, v75, v18, v17
  v_dot2_f32_bf16 v40, v76, v16, v17
  v_dot2_f32_bf16 v41, v76, v18, v17
  v_dot2_f32_bf16 v42, v77, v16, v17
  v_dot2_f32_bf16 v43, v77, v18, v17
  v_dot2_f32_bf16 v44, v78, v16, v17
  v_dot2_f32_bf16 v45, v78, v18, v17
  v_dot2_f32_bf16 v46, v79, v16, v17
  v_dot2_f32_bf16 v47, v79, v18, v17
  v_cvt_pk_bf16_f32 v72, v20, v21
  v_cvt_pk_bf16_f32 v73, v22, v23
  v_cvt_pk_bf16_f32 v74, v24, v25
  v_cvt_pk_bf16_f32 v75, v26, v27
  ds_write_b128 v5, v[72:75] offset:2048
  v_cvt_pk_bf16_f32 v76, v40, v41
  v_cvt_pk_bf16_f32 v77, v42, v43
  v_cvt_pk_bf16_f32 v78, v44, v45
  v_cvt_pk_bf16_f32 v79, v46, v47
  ds_write_b128 v5, v[76:79] offset:3072
  s_waitcnt vmcnt(6)
  v_max3_u32 v30, v80, v81, v82
  v_max3_u32 v30, v30, v83, v84
  v_max3_u32 v30, v30, v85, v86
  v_max_u32 v30, v30, v87
  v_cmp_eq_u32 vcc, -1, v30
  buffer_load_dwordx4 v[112:115], v4, s[28:31], s73 offen offset:0 sc1
  buffer_load_dwordx4 v[116:119], v4, s[28:31], s73 offen offset:1024 sc1
  s_cbranch_vccnz Ltg_123
Ltg_123_b:
  v_dot2_f32_bf16 v20, v80, v16, v17
  v_dot2_f32_bf16 v21, v80, v18, v17
  v_dot2_f32_bf16 v22, v81, v16, v17
  v_dot2_f32_bf16 v23, v81, v18, v17
  v_dot2_f32_bf16 v24, v82, v16, v17
  v_dot2_f32_bf16 v25, v82, v18, v17
  v_dot2_f32_bf16 v26, v83, v16, v17
  v_dot2_f32_bf16 v27, v83, v18, v17
  v_dot2_f32_bf16 v40, v84, v16, v17
  v_dot2_f32_bf16 v41, v84, v18, v17
  v_dot2_f32_bf16 v42, v85, v16, v17
  v_dot2_f32_bf16 v43, v85, v18, v17
  v_dot2_f32_bf16 v44, v86, v16, v17
  v_dot2_f32_bf16 v45, v86, v18, v17
  v_dot2_f32_bf16 v46, v87, v16, v17
  v_dot2_f32_bf16 v47, v87, v18, v17
  v_cvt_pk_bf16_f32 v80, v20, v21
  v_cvt_pk_bf16_f32 v81, v22, v23
  v_cvt_pk_bf16_f32 v82, v24, v25
  v_cvt_pk_bf16_f32 v83, v26, v27
  ds_write_b128 v5, v[80:83] offset:4096
  v_cvt_pk_bf16_f32 v84, v40, v41
  v_cvt_pk_bf16_f32 v85, v42, v43
  v_cvt_pk_bf16_f32 v86, v44, v45
  v_cvt_pk_bf16_f32 v87, v46, v47
  ds_write_b128 v5, v[84:87] offset:5120
  s_waitcnt vmcnt(6)
  v_max3_u32 v30, v88, v89, v90
  v_max3_u32 v30, v30, v91, v92
  v_max3_u32 v30, v30, v93, v94
  v_max_u32 v30, v30, v95
  v_cmp_eq_u32 vcc, -1, v30
  buffer_load_dwordx4 v[120:123], v4, s[28:31], s73 offen offset:2048 sc1
  buffer_load_dwordx4 v[124:127], v4, s[28:31], s73 offen offset:3072 sc1
  s_cbranch_vccnz Ltg_124
Ltg_124_b:
  v_dot2_f32_bf16 v20, v88, v16, v17
  v_dot2_f32_bf16 v21, v88, v18, v17
  v_dot2_f32_bf16 v22, v89, v16, v17
  v_dot2_f32_bf16 v23, v89, v18, v17
  v_dot2_f32_bf16 v24, v90, v16, v17
  v_dot2_f32_bf16 v25, v90, v18, v17
  v_dot2_f32_bf16 v26, v91, v16, v17
  v_dot2_f32_bf16 v27, v91, v18, v17
  v_dot2_f32_bf16 v40, v92, v16, v17
  v_dot2_f32_bf16 v41, v92, v18, v17
  v_dot2_f32_bf16 v42, v93, v16, v17
  v_dot2_f32_bf16 v43, v93, v18, v17
  v_dot2_f32_bf16 v44, v94, v16, v17
  v_dot2_f32_bf16 v45, v94, v18, v17
  v_dot2_f32_bf16 v46, v95, v16, v17
  v_dot2_f32_bf16 v47, v95, v18, v17
  v_cvt_pk_bf16_f32 v88, v20, v21
  v_cvt_pk_bf16_f32 v89, v22, v23
  v_cvt_pk_bf16_f32 v90, v24, v25
  v_cvt_pk_bf16_f32 v91, v26, v27
  ds_write_b128 v5, v[88:91] offset:6144
  v_cvt_pk_bf16_f32 v92, v40, v41
  v_cvt_pk_bf16_f32 v93, v42, v43
  v_cvt_pk_bf16_f32 v94, v44, v45
  v_cvt_pk_bf16_f32 v95, v46, v47
  ds_write_b128 v5, v[92:95] offset:7168
  s_waitcnt vmcnt(6)
  v_max3_u32 v30, v96, v97, v98
  v_max3_u32 v30, v30, v99, v100
  v_max3_u32 v30, v30, v101, v102
  v_max_u32 v30, v30, v103
  v_cmp_eq_u32 vcc, -1, v30
  buffer_load_dwordx4 v[128:131], v4, s[28:31], s74 offen offset:0 sc1
  buffer_load_dwordx4 v[132:135], v4, s[28:31], s74 offen offset:1024 sc1
  s_cbranch_vccnz Ltg_125
Ltg_125_b:
  v_dot2_f32_bf16 v20, v96, v16, v17
  v_dot2_f32_bf16 v21, v96, v18, v17
  v_dot2_f32_bf16 v22, v97, v16, v17
  v_dot2_f32_bf16 v23, v97, v18, v17
  v_dot2_f32_bf16 v24, v98, v16, v17
  v_dot2_f32_bf16 v25, v98, v18, v17
  v_dot2_f32_bf16 v26, v99, v16, v17
  v_dot2_f32_bf16 v27, v99, v18, v17
  v_dot2_f32_bf16 v40, v100, v16, v17
  v_dot2_f32_bf16 v41, v100, v18, v17
  v_dot2_f32_bf16 v42, v101, v16, v17
  v_dot2_f32_bf16 v43, v101, v18, v17
  v_dot2_f32_bf16 v44, v102, v16, v17
  v_dot2_f32_bf16 v45, v102, v18, v17
  v_dot2_f32_bf16 v46, v103, v16, v17
  v_dot2_f32_bf16 v47, v103, v18, v17
  v_cvt_pk_bf16_f32 v96, v20, v21
  v_cvt_pk_bf16_f32 v97, v22, v23
  v_cvt_pk_bf16_f32 v98, v24, v25
  v_cvt_pk_bf16_f32 v99, v26, v27
  ds_write_b128 v5, v[96:99] offset:8192
  v_cvt_pk_bf16_f32 v100, v40, v41
  v_cvt_pk_bf16_f32 v101, v42, v43
  v_cvt_pk_bf16_f32 v102, v44, v45
  v_cvt_pk_bf16_f32 v103, v46, v47
  ds_write_b128 v5, v[100:103] offset:9216
  s_waitcnt vmcnt(6)
  v_max3_u32 v30, v104, v105, v106
  v_max3_u32 v30, v30, v107, v108
  v_max3_u32 v30, v30, v109, v110
  v_max_u32 v30, v30, v111
  v_cmp_eq_u32 vcc, -1, v30
  s_cbranch_vccnz Ltg_126
Ltg_126_b:
  v_dot2_f32_bf16 v20, v104, v16, v17
  v_dot2_f32_bf16 v21, v104, v18, v17
  v_dot2_f32_bf16 v22, v105, v16, v17
  v_dot2_f32_bf16 v23, v105, v18, v17
  v_dot2_f32_bf16 v24, v106, v16, v17
  v_dot2_f32_bf16 v25, v106, v18, v17
  v_dot2_f32_bf16 v26, v107, v16, v17
  v_dot2_f32_bf16 v27, v107, v18, v17
  v_dot2_f32_bf16 v40, v108, v16, v17
  v_dot2_f32_bf16 v41, v108, v18, v17
  v_dot2_f32_bf16 v42, v109, v16, v17
  v_dot2_f32_bf16 v43, v109, v18, v17
  v_dot2_f32_bf16 v44, v110, v16, v17
  v_dot2_f32_bf16 v45, v110, v18, v17
  v_dot2_f32_bf16 v46, v111, v16, v17
  v_dot2_f32_bf16 v47, v111, v18, v17
  v_cvt_pk_bf16_f32 v104, v20, v21
  v_cvt_pk_bf16_f32 v105, v22, v23
  v_cvt_pk_bf16_f32 v106, v24, v25
  v_cvt_pk_bf16_f32 v107, v26, v27
  ds_write_b128 v5, v[104:107] offset:10240
  v_cvt_pk_bf16_f32 v108, v40, v41
  v_cvt_pk_bf16_f32 v109, v42, v43
  v_cvt_pk_bf16_f32 v110, v44, v45
  v_cvt_pk_bf16_f32 v111, v46, v47
  ds_write_b128 v5, v[108:111] offset:11264
  s_waitcnt vmcnt(4)
  v_max3_u32 v30, v112, v113, v114
  v_max3_u32 v30, v30, v115, v116
  v_max3_u32 v30, v30, v117, v118
  v_max_u32 v30, v30, v119
  v_cmp_eq_u32 vcc, -1, v30
  s_cbranch_vccnz Ltg_127
Ltg_127_b:
  v_dot2_f32_bf16 v20, v112, v16, v17
  v_dot2_f32_bf16 v21, v112, v18, v17
  v_dot2_f32_bf16 v22, v113, v16, v17
  v_dot2_f32_bf16 v23, v113, v18, v17
  v_dot2_f32_bf16 v24, v114, v16, v17
  v_dot2_f32_bf16 v25, v114, v18, v17
  v_dot2_f32_bf16 v26, v115, v16, v17
  v_dot2_f32_bf16 v27, v115, v18, v17
  v_dot2_f32_bf16 v40, v116, v16, v17
  v_dot2_f32_bf16 v41, v116, v18, v17
  v_dot2_f32_bf16 v42, v117, v16, v17
  v_dot2_f32_bf16 v43, v117, v18, v17
  v_dot2_f32_bf16 v44, v118, v16, v17
  v_dot2_f32_bf16 v45, v118, v18, v17
  v_dot2_f32_bf16 v46, v119, v16, v17
  v_dot2_f32_bf16 v47, v119, v18, v17
  v_cvt_pk_bf16_f32 v112, v20, v21
  v_cvt_pk_bf16_f32 v113, v22, v23
  v_cvt_pk_bf16_f32 v114, v24, v25
  v_cvt_pk_bf16_f32 v115, v26, v27
  ds_write_b128 v5, v[112:115] offset:12288
  v_cvt_pk_bf16_f32 v116, v40, v41
  v_cvt_pk_bf16_f32 v117, v42, v43
  v_cvt_pk_bf16_f32 v118, v44, v45
  v_cvt_pk_bf16_f32 v119, v46, v47
  ds_write_b128 v5, v[116:119] offset:13312
  s_waitcnt vmcnt(2)
  v_max3_u32 v30, v120, v121, v122
  v_max3_u32 v30, v30, v123, v124
  v_max3_u32 v30, v30, v125, v126
  v_max_u32 v30, v30, v127
  v_cmp_eq_u32 vcc, -1, v30
  s_cbranch_vccnz Ltg_128
Ltg_128_b:
  v_dot2_f32_bf16 v20, v120, v16, v17
  v_dot2_f32_bf16 v21, v120, v18, v17
  v_dot2_f32_bf16 v22, v121, v16, v17
  v_dot2_f32_bf16 v23, v121, v18, v17
  v_dot2_f32_bf16 v24, v122, v16, v17
  v_dot2_f32_bf16 v25, v122, v18, v17
  v_dot2_f32_bf16 v26, v123, v16, v17
  v_dot2_f32_bf16 v27, v123, v18, v17
  v_dot2_f32_bf16 v40, v124, v16, v17
  v_dot2_f32_bf16 v41, v124, v18, v17
  v_dot2_f32_bf16 v42, v125, v16, v17
  v_dot2_f32_bf16 v43, v125, v18, v17
  v_dot2_f32_bf16 v44, v126, v16, v17
  v_dot2_f32_bf16 v45, v126, v18, v17
  v_dot2_f32_bf16 v46, v127, v16, v17
  v_dot2_f32_bf16 v47, v127, v18, v17
  v_cvt_pk_bf16_f32 v120, v20, v21
  v_cvt_pk_bf16_f32 v121, v22, v23
  v_cvt_pk_bf16_f32 v122, v24, v25
  v_cvt_pk_bf16_f32 v123, v26, v27
  ds_write_b128 v5, v[120:123] offset:14336
  v_cvt_pk_bf16_f32 v124, v40, v41
  v_cvt_pk_bf16_f32 v125, v42, v43
  v_cvt_pk_bf16_f32 v126, v44, v45
  v_cvt_pk_bf16_f32 v127, v46, v47
  ds_write_b128 v5, v[124:127] offset:15360
  s_waitcnt vmcnt(0)
  v_max3_u32 v30, v128, v129, v130
  v_max3_u32 v30, v30, v131, v132
  v_max3_u32 v30, v30, v133, v134
  v_max_u32 v30, v30, v135
  v_cmp_eq_u32 vcc, -1, v30
  s_cbranch_vccnz Ltg_129
Ltg_129_b:
  v_dot2_f32_bf16 v20, v128, v16, v17
  v_dot2_f32_bf16 v21, v128, v18, v17
  v_dot2_f32_bf16 v22, v129, v16, v17
  v_dot2_f32_bf16 v23, v129, v18, v17
  v_dot2_f32_bf16 v24, v130, v16, v17
  v_dot2_f32_bf16 v25, v130, v18, v17
  v_dot2_f32_bf16 v26, v131, v16, v17
  v_dot2_f32_bf16 v27, v131, v18, v17
  v_dot2_f32_bf16 v40, v132, v16, v17
  v_dot2_f32_bf16 v41, v132, v18, v17
  v_dot2_f32_bf16 v42, v133, v16, v17
  v_dot2_f32_bf16 v43, v133, v18, v17
  v_dot2_f32_bf16 v44, v134, v16, v17
  v_dot2_f32_bf16 v45, v134, v18, v17
  v_dot2_f32_bf16 v46, v135, v16, v17
  v_dot2_f32_bf16 v47, v135, v18, v17
  v_cvt_pk_bf16_f32 v128, v20, v21
  v_cvt_pk_bf16_f32 v129, v22, v23
  v_cvt_pk_bf16_f32 v130, v24, v25
  v_cvt_pk_bf16_f32 v131, v26, v27
  ds_write_b128 v5, v[128:131] offset:16384
  v_cvt_pk_bf16_f32 v132, v40, v41
  v_cvt_pk_bf16_f32 v133, v42, v43
  v_cvt_pk_bf16_f32 v134, v44, v45
  v_cvt_pk_bf16_f32 v135, v46, v47
  ds_write_b128 v5, v[132:135] offset:17408
  v_readfirstlane_b32 s43, v29
  v_mov_b32 v10, 0
  v_mov_b32 v11, 0
  s_waitcnt lgkmcnt(0)
  s_barrier
  s_add_u32 s58, s54, 18432
  v_add_u32 v84, 4096, v4
  v_add_u32 v85, 8192, v4
  v_add_u32 v86, 12288, v4
  v_add_u32 v87, 16384, v4
  ds_read_b128 a[0:3], v4 offset:0
  ds_read_b128 a[16:19], v4 offset:1024
  ds_read_b128 a[4:7], v4 offset:18432
  ds_read_b128 a[20:23], v4 offset:19456
  ds_read_b128 a[8:11], v32 offset:0
  ds_read_b128 a[24:27], v32 offset:1024
  ds_read_b128 a[12:15], v32 offset:18432
  ds_read_b128 a[28:31], v32 offset:19456
  ds_read_b128 a[32:35], v4 offset:2048
  ds_read_b128 a[48:51], v4 offset:3072
  ds_read_b128 a[36:39], v4 offset:20480
  ds_read_b128 a[52:55], v4 offset:21504
  s_waitcnt vmcnt(16) lgkmcnt(10)
  v_mfma_f32_16x16x32_bf16 v[40:43], a[184:187], a[0:3], 0
  ds_read_b128 a[40:43], v32 offset:2048
  v_mfma_f32_16x16x32_bf16 v[40:43], a[188:191], a[16:19], v[40:43]
  ds_read_b128 a[56:59], v32 offset:3072
  s_waitcnt lgkmcnt(10)
  v_mfma_f32_16x16x32_bf16 v[44:47], a[184:187], a[4:7], 0
  ds_read_b128 a[44:47], v32 offset:20480
  v_mfma_f32_16x16x32_bf16 v[44:47], a[188:191], a[20:23], v[44:47]
  ds_read_b128 a[60:63], v32 offset:21504
  s_waitcnt lgkmcnt(10)
  s_add_u32 s62, s78, 14843904
  buffer_load_dwordx4 v[104:107], v4, s[28:31], s62 offen offset:0 sc1
  v_mfma_f32_16x16x32_bf16 v[48:51], a[184:187], a[8:11], 0
  ds_read_b128 a[64:67], v4 offset:4096
  v_mfma_f32_16x16x32_bf16 v[48:51], a[188:191], a[24:27], v[48:51]
  ds_read_b128 a[80:83], v4 offset:5120
  s_waitcnt lgkmcnt(10)
  v_mfma_f32_16x16x32_bf16 v[52:55], a[184:187], a[12:15], 0
  ds_read_b128 a[68:71], v4 offset:22528
  buffer_load_dwordx4 a[184:187], v4, s[28:31], s58 offen offset:0 sc1
  v_mfma_f32_16x16x32_bf16 v[52:55], a[188:191], a[28:31], v[52:55]
  ds_read_b128 a[84:87], v4 offset:23552
  buffer_load_dwordx4 a[188:191], v4, s[28:31], s58 offen offset:1024 sc1
  s_waitcnt vmcnt(17) lgkmcnt(10)
  v_mfma_f32_16x16x32_bf16 v[40:43], a[192:195], a[32:35], v[40:43]
  ds_read_b128 a[72:75], v32 offset:4096
  v_mfma_f32_16x16x32_bf16 v[40:43], a[196:199], a[48:51], v[40:43]
  ds_read_b128 a[88:91], v32 offset:5120
  s_waitcnt lgkmcnt(10)
  v_mfma_f32_16x16x32_bf16 v[44:47], a[192:195], a[36:39], v[44:47]
  ds_read_b128 a[76:79], v32 offset:22528
  v_mfma_f32_16x16x32_bf16 v[44:47], a[196:199], a[52:55], v[44:47]
  ds_read_b128 a[92:95], v32 offset:23552
  s_waitcnt lgkmcnt(10)
  s_add_u32 s62, s78, 14862336
  buffer_load_dwordx4 v[108:111], v4, s[28:31], s62 offen offset:0 sc1
  v_mfma_f32_16x16x32_bf16 v[48:51], a[192:195], a[40:43], v[48:51]
  ds_read_b128 a[96:99], v4 offset:6144
  v_mfma_f32_16x16x32_bf16 v[48:51], a[196:199], a[56:59], v[48:51]
  ds_read_b128 a[112:115], v4 offset:7168
  s_waitcnt lgkmcnt(10)
  v_mfma_f32_16x16x32_bf16 v[52:55], a[192:195], a[44:47], v[52:55]
  ds_read_b128 a[100:103], v4 offset:24576
  buffer_load_dwordx4 a[192:195], v4, s[28:31], s58 offen offset:2048 sc1
  v_mfma_f32_16x16x32_bf16 v[52:55], a[196:199], a[60:63], v[52:55]
  ds_read_b128 a[116:119], v4 offset:25600
  buffer_load_dwordx4 a[196:199], v4, s[28:31], s58 offen offset:3072 sc1
  s_waitcnt vmcnt(18) lgkmcnt(10)
  v_mfma_f32_16x16x32_bf16 v[40:43], a[200:203], a[64:67], v[40:43]
  ds_read_b128 a[104:107], v32 offset:6144
  v_mfma_f32_16x16x32_bf16 v[40:43], a[204:207], a[80:83], v[40:43]
  ds_read_b128 a[120:123], v32 offset:7168
  s_waitcnt lgkmcnt(10)
  v_mfma_f32_16x16x32_bf16 v[44:47], a[200:203], a[68:71], v[44:47]
  ds_read_b128 a[108:111], v32 offset:24576
  v_mfma_f32_16x16x32_bf16 v[44:47], a[204:207], a[84:87], v[44:47]
  ds_read_b128 a[124:127], v32 offset:25600
  s_waitcnt lgkmcnt(10)
  s_add_u32 s62, s78, 14880768
  buffer_load_dwordx4 v[112:115], v4, s[28:31], s62 offen offset:0 sc1
  v_mfma_f32_16x16x32_bf16 v[48:51], a[200:203], a[72:75], v[48:51]
  ds_read_b128 a[128:131], v4 offset:8192
  v_mfma_f32_16x16x32_bf16 v[48:51], a[204:207], a[88:91], v[48:51]
  ds_read_b128 a[144:147], v4 offset:9216
  s_waitcnt lgkmcnt(10)
  v_mfma_f32_16x16x32_bf16 v[52:55], a[200:203], a[76:79], v[52:55]
  ds_read_b128 a[132:135], v4 offset:26624
  buffer_load_dwordx4 a[200:203], v84, s[28:31], s58 offen offset:0 sc1
  v_mfma_f32_16x16x32_bf16 v[52:55], a[204:207], a[92:95], v[52:55]
  ds_read_b128 a[148:151], v4 offset:27648
  buffer_load_dwordx4 a[204:207], v84, s[28:31], s58 offen offset:1024 sc1
  s_waitcnt vmcnt(19) lgkmcnt(10)
  v_mfma_f32_16x16x32_bf16 v[40:43], a[208:211], a[96:99], v[40:43]
  ds_read_b128 a[136:139], v32 offset:8192
  v_mfma_f32_16x16x32_bf16 v[40:43], a[212:215], a[112:115], v[40:43]
  ds_read_b128 a[152:155], v32 offset:9216
  s_waitcnt lgkmcnt(10)
  v_mfma_f32_16x16x32_bf16 v[44:47], a[208:211], a[100:103], v[44:47]
  ds_read_b128 a[140:143], v32 offset:26624
  v_mfma_f32_16x16x32_bf16 v[44:47], a[212:215], a[116:119], v[44:47]
  ds_read_b128 a[156:159], v32 offset:27648
  s_waitcnt lgkmcnt(10)
  s_add_u32 s62, s78, 14899200
  buffer_load_dwordx4 v[116:119], v4, s[28:31], s62 offen offset:0 sc1
  v_mfma_f32_16x16x32_bf16 v[48:51], a[208:211], a[104:107], v[48:51]
  ds_read_b128 a[160:163], v4 offset:10240
  v_mfma_f32_16x16x32_bf16 v[48:51], a[212:215], a[120:123], v[48:51]
  ds_read_b128 a[176:179], v4 offset:11264
  s_waitcnt lgkmcnt(10)
  v_mfma_f32_16x16x32_bf16 v[52:55], a[208:211], a[108:111], v[52:55]
  ds_read_b128 a[164:167], v4 offset:28672
  buffer_load_dwordx4 a[208:211], v84, s[28:31], s58 offen offset:2048 sc1
  v_mfma_f32_16x16x32_bf16 v[52:55], a[212:215], a[124:127], v[52:55]
  ds_read_b128 a[180:183], v4 offset:29696
  buffer_load_dwordx4 a[212:215], v84, s[28:31], s58 offen offset:3072 sc1
  s_waitcnt vmcnt(20) lgkmcnt(10)
  v_mfma_f32_16x16x32_bf16 v[40:43], a[216:219], a[128:131], v[40:43]
  ds_read_b128 a[168:171], v32 offset:10240
  v_mfma_f32_16x16x32_bf16 v[40:43], a[220:223], a[144:147], v[40:43]
  ds_read_b128 v[152:155], v32 offset:11264
  s_waitcnt lgkmcnt(10)
  v_mfma_f32_16x16x32_bf16 v[44:47], a[216:219], a[132:135], v[44:47]
  ds_read_b128 a[172:175], v32 offset:28672
  v_mfma_f32_16x16x32_bf16 v[44:47], a[220:223], a[148:151], v[44:47]
  ds_read_b128 v[156:159], v32 offset:29696
  s_waitcnt lgkmcnt(10)
  s_add_u32 s62, s78, 10027008
  buffer_load_dwordx4 v[120:123], v4, s[28:31], s62 offen offset:0 sc1
  v_mfma_f32_16x16x32_bf16 v[48:51], a[216:219], a[136:139], v[48:51]
  ds_read_b128 v[160:163], v4 offset:12288
  v_mfma_f32_16x16x32_bf16 v[48:51], a[220:223], a[152:155], v[48:51]
  ds_read_b128 v[176:179], v4 offset:13312
  s_waitcnt lgkmcnt(10)
  v_mfma_f32_16x16x32_bf16 v[52:55], a[216:219], a[140:143], v[52:55]
  ds_read_b128 v[164:167], v4 offset:30720
  buffer_load_dwordx4 a[216:219], v85, s[28:31], s58 offen offset:0 sc1
  v_mfma_f32_16x16x32_bf16 v[52:55], a[220:223], a[156:159], v[52:55]
  ds_read_b128 v[180:183], v4 offset:31744
  buffer_load_dwordx4 a[220:223], v85, s[28:31], s58 offen offset:1024 sc1
  s_waitcnt vmcnt(21) lgkmcnt(10)
  v_mfma_f32_16x16x32_bf16 v[40:43], a[224:227], a[160:163], v[40:43]
  ds_read_b128 v[168:171], v32 offset:12288
  v_mfma_f32_16x16x32_bf16 v[40:43], a[228:231], a[176:179], v[40:43]
  ds_read_b128 v[184:187], v32 offset:13312
  s_waitcnt lgkmcnt(10)
  v_mfma_f32_16x16x32_bf16 v[44:47], a[224:227], a[164:167], v[44:47]
  ds_read_b128 v[172:175], v32 offset:30720
  v_mfma_f32_16x16x32_bf16 v[44:47], a[228:231], a[180:183], v[44:47]
  ds_read_b128 v[188:191], v32 offset:31744
  s_waitcnt lgkmcnt(10)
  s_add_u32 s62, s78, 10045440
  buffer_load_dwordx4 v[124:127], v4, s[28:31], s62 offen offset:0 sc1
  v_mfma_f32_16x16x32_bf16 v[48:51], a[224:227], a[168:171], v[48:51]
  ds_read_b128 v[192:195], v4 offset:14336
  v_mfma_f32_16x16x32_bf16 v[48:51], a[228:231], v[152:155], v[48:51]
  ds_read_b128 v[208:211], v4 offset:15360
  s_waitcnt lgkmcnt(10)
  v_mfma_f32_16x16x32_bf16 v[52:55], a[224:227], a[172:175], v[52:55]
  ds_read_b128 v[196:199], v4 offset:32768
  buffer_load_dwordx4 a[224:227], v85, s[28:31], s58 offen offset:2048 sc1
  v_mfma_f32_16x16x32_bf16 v[52:55], a[228:231], v[156:159], v[52:55]
  ds_read_b128 v[212:215], v4 offset:33792
  buffer_load_dwordx4 a[228:231], v85, s[28:31], s58 offen offset:3072 sc1
  s_waitcnt vmcnt(22) lgkmcnt(10)
  v_mfma_f32_16x16x32_bf16 v[40:43], a[232:235], v[160:163], v[40:43]
  ds_read_b128 v[200:203], v32 offset:14336
  v_mfma_f32_16x16x32_bf16 v[40:43], a[236:239], v[176:179], v[40:43]
  ds_read_b128 v[216:219], v32 offset:15360
  s_waitcnt lgkmcnt(10)
  v_mfma_f32_16x16x32_bf16 v[44:47], a[232:235], v[164:167], v[44:47]
  ds_read_b128 v[204:207], v32 offset:32768
  v_mfma_f32_16x16x32_bf16 v[44:47], a[236:239], v[180:183], v[44:47]
  ds_read_b128 v[220:223], v32 offset:33792
  s_waitcnt lgkmcnt(10)
  s_add_u32 s62, s78, 10063872
  buffer_load_dwordx4 v[128:131], v4, s[28:31], s62 offen offset:0 sc1
  v_mfma_f32_16x16x32_bf16 v[48:51], a[232:235], v[168:171], v[48:51]
  ds_read_b128 v[224:227], v4 offset:16384
  v_mfma_f32_16x16x32_bf16 v[48:51], a[236:239], v[184:187], v[48:51]
  ds_read_b128 v[240:243], v4 offset:17408
  s_waitcnt lgkmcnt(10)
  v_mfma_f32_16x16x32_bf16 v[52:55], a[232:235], v[172:175], v[52:55]
  ds_read_b128 v[228:231], v4 offset:34816
  buffer_load_dwordx4 a[232:235], v86, s[28:31], s58 offen offset:0 sc1
  v_mfma_f32_16x16x32_bf16 v[52:55], a[236:239], v[188:191], v[52:55]
  ds_read_b128 v[244:247], v4 offset:35840
  buffer_load_dwordx4 a[236:239], v86, s[28:31], s58 offen offset:1024 sc1
  s_waitcnt vmcnt(23) lgkmcnt(10)
  v_mfma_f32_16x16x32_bf16 v[40:43], a[240:243], v[192:195], v[40:43]
  ds_read_b128 v[232:235], v32 offset:16384
  v_mfma_f32_16x16x32_bf16 v[40:43], a[244:247], v[208:211], v[40:43]
  ds_read_b128 v[248:251], v32 offset:17408
  s_waitcnt lgkmcnt(10)
  v_mfma_f32_16x16x32_bf16 v[44:47], a[240:243], v[196:199], v[44:47]
  ds_read_b128 v[236:239], v32 offset:34816
  v_mfma_f32_16x16x32_bf16 v[44:47], a[244:247], v[212:215], v[44:47]
  ds_read_b128 v[252:255], v32 offset:35840
  s_waitcnt lgkmcnt(10)
  s_add_u32 s62, s78, 10082304
  buffer_load_dwordx4 v[132:135], v4, s[28:31], s62 offen offset:0 sc1
  v_mfma_f32_16x16x32_bf16 v[48:51], a[240:243], v[200:203], v[48:51]
  v_mfma_f32_16x16x32_bf16 v[48:51], a[244:247], v[216:219], v[48:51]
  s_waitcnt lgkmcnt(8)
  v_mfma_f32_16x16x32_bf16 v[52:55], a[240:243], v[204:207], v[52:55]
  buffer_load_dwordx4 a[240:243], v86, s[28:31], s58 offen offset:2048 sc1
  v_mfma_f32_16x16x32_bf16 v[52:55], a[244:247], v[220:223], v[52:55]
  buffer_load_dwordx4 a[244:247], v86, s[28:31], s58 offen offset:3072 sc1
  s_waitcnt vmcnt(24) lgkmcnt(6)
  v_mfma_f32_16x16x32_bf16 v[40:43], a[248:251], v[224:227], v[40:43]
  v_mfma_f32_16x16x32_bf16 v[40:43], a[252:255], v[240:243], v[40:43]
  s_waitcnt lgkmcnt(4)
  v_mfma_f32_16x16x32_bf16 v[44:47], a[248:251], v[228:231], v[44:47]
  v_mfma_f32_16x16x32_bf16 v[44:47], a[252:255], v[244:247], v[44:47]
  s_waitcnt lgkmcnt(2)
  v_mfma_f32_16x16x32_bf16 v[48:51], a[248:251], v[232:235], v[48:51]
  v_mfma_f32_16x16x32_bf16 v[48:51], a[252:255], v[248:251], v[48:51]
  s_waitcnt lgkmcnt(0)
  v_mfma_f32_16x16x32_bf16 v[52:55], a[248:251], v[236:239], v[52:55]
  buffer_load_dwordx4 a[248:251], v87, s[28:31], s58 offen offset:0 sc1
  v_mfma_f32_16x16x32_bf16 v[52:55], a[252:255], v[252:255], v[52:55]
  buffer_load_dwordx4 a[252:255], v87, s[28:31], s58 offen offset:1024 sc1
  s_sub_u32 s36, s18, 4096
  s_subb_u32 s37, s19, 0
  s_mov_b32 s38, 5312512
  s_mov_b32 s39, 0x20000
  v_lshrrev_b32 v30, 3, v1
  v_bfe_u32 v31, v1, 4, 1
  v_lshlrev_b32 v31, 1, v31
  v_and_b32 v102, 7, v1
  v_xor_b32 v31, v31, v102
  v_mul_u32_u24 v30, 1152, v30
  v_lshl_add_u32 v96, v31, 4, v30
  v_xor_b32 v31, 4, v31
  v_lshl_add_u32 v97, v31, 4, v30
  v_add_u32 v101, 48128, v97
  v_add_u32 v100, 39936, v96
  v_add_u32 v99, 31744, v97
  v_add_u32 v98, 20480, v96
  v_add_u32 v97, 12288, v97
  v_add_u32 v96, 4096, v96
  v_lshrrev_b32 v30, 2, v2
  v_lshl_add_u32 v31, v3, 3, v30
  v_lshlrev_b32 v31, 7, v31
  v_lshrrev_b32 v30, 1, v30
  v_and_b32 v102, 1, v3
  v_lshl_add_u32 v30, v102, 1, v30
  v_xor_b32 v30, s40, v30
  v_lshl_add_u32 v31, v30, 5, v31
  v_and_b32 v30, 3, v2
  v_lshl_add_u32 v102, v30, 3, v31
  s_mul_i32 s55, s51, 12
  s_add_u32 s55, s55, s40
  s_mul_i32 s55, s55, 55296
  s_mul_i32 s63, s40, 6144
  v_subrev_u32 v5, 8192, v35
  s_barrier
  v_mov_b32 v80, -1
  v_mov_b32 v81, -1
  v_mov_b32 v82, -1
  v_mov_b32 v83, -1
  s_mov_b32 s59, 0
L_p6_a:
  s_waitcnt vmcnt(16)
  v_mfma_f32_16x16x32_bf16 v[56:59], a[184:187], a[0:3], 0
  s_add_u32 s58, s58, 18432
  v_add_u32 v5, 8192, v5
  v_mfma_f32_16x16x32_bf16 v[56:59], a[188:191], a[16:19], v[56:59]
  v_pk_fma_f32 v[136:137], v[40:41], v[40:41], s[48:49] op_sel:[0,0,1] op_sel_hi:[1,1,1]
  v_pk_fma_f32 v[138:139], v[42:43], v[42:43], s[48:49] op_sel:[0,0,1] op_sel_hi:[1,1,1]
  v_pk_fma_f32 v[140:141], v[44:45], v[44:45], s[48:49] op_sel:[0,0,1] op_sel_hi:[1,1,1]
  v_pk_fma_f32 v[142:143], v[46:47], v[46:47], s[48:49] op_sel:[0,0,1] op_sel_hi:[1,1,1]
  v_pk_fma_f32 v[144:145], v[48:49], v[48:49], s[48:49] op_sel:[0,0,1] op_sel_hi:[1,1,1]
  v_pk_fma_f32 v[146:147], v[50:51], v[50:51], s[48:49] op_sel:[0,0,1] op_sel_hi:[1,1,1]
  v_pk_fma_f32 v[148:149], v[52:53], v[52:53], s[48:49] op_sel:[0,0,1] op_sel_hi:[1,1,1]
  v_pk_fma_f32 v[150:151], v[54:55], v[54:55], s[48:49] op_sel:[0,0,1] op_sel_hi:[1,1,1]
  v_pk_mul_f32 v[136:137], v[136:137], v[40:41]
  v_pk_mul_f32 v[138:139], v[138:139], v[42:43]
  v_pk_mul_f32 v[140:141], v[140:141], v[44:45]
  v_pk_mul_f32 v[142:143], v[142:143], v[46:47]
  v_pk_mul_f32 v[144:145], v[144:145], v[48:49]
  v_pk_mul_f32 v[146:147], v[146:147], v[50:51]
  v_pk_mul_f32 v[148:149], v[148:149], v[52:53]
  v_pk_mul_f32 v[150:151], v[150:151], v[54:55]
  v_mfma_f32_16x16x32_bf16 v[60:63], a[184:187], a[4:7], 0
  v_exp_f32 v136, -v136
  v_mfma_f32_16x16x32_bf16 v[60:63], a[188:191], a[20:23], v[60:63]
  v_exp_f32 v137, -v137
  v_mfma_f32_16x16x32_bf16 v[64:67], a[184:187], a[8:11], 0
  v_exp_f32 v138, -v138
  v_mfma_f32_16x16x32_bf16 v[64:67], a[188:191], a[24:27], v[64:67]
  v_exp_f32 v139, -v139
  v_mfma_f32_16x16x32_bf16 v[68:71], a[184:187], a[12:15], 0
  buffer_load_dwordx4 a[184:187], v4, s[28:31], s58 offen offset:0 sc1
  v_fma_f32 v136, v136, s48, s48
  v_mfma_f32_16x16x32_bf16 v[68:71], a[188:191], a[28:31], v[68:71]
  buffer_load_dwordx4 a[188:191], v4, s[28:31], s58 offen offset:1024 sc1
  s_waitcnt vmcnt(16)
  v_mfma_f32_16x16x32_bf16 v[56:59], a[192:195], a[32:35], v[56:59]
  v_fma_f32 v137, v137, s48, s48
  v_fma_f32 v138, v138, s48, s48
  v_mfma_f32_16x16x32_bf16 v[56:59], a[196:199], a[48:51], v[56:59]
  v_fma_f32 v139, v139, s48, s48
  v_mfma_f32_16x16x32_bf16 v[60:63], a[192:195], a[36:39], v[60:63]
  v_rcp_f32 v136, v136
  v_mfma_f32_16x16x32_bf16 v[60:63], a[196:199], a[52:55], v[60:63]
  v_rcp_f32 v137, v137
  v_mfma_f32_16x16x32_bf16 v[64:67], a[192:195], a[40:43], v[64:67]
  v_rcp_f32 v138, v138
  v_mfma_f32_16x16x32_bf16 v[64:67], a[196:199], a[56:59], v[64:67]
  v_rcp_f32 v139, v139
  v_mfma_f32_16x16x32_bf16 v[68:71], a[192:195], a[44:47], v[68:71]
  buffer_load_dwordx4 a[192:195], v4, s[28:31], s58 offen offset:2048 sc1
  v_mul_f32 v136, v136, v40
  v_mfma_f32_16x16x32_bf16 v[68:71], a[196:199], a[60:63], v[68:71]
  buffer_load_dwordx4 a[196:199], v4, s[28:31], s58 offen offset:3072 sc1
  s_waitcnt vmcnt(16)
  v_mfma_f32_16x16x32_bf16 v[56:59], a[200:203], a[64:67], v[56:59]
  v_mul_f32 v137, v137, v41
  v_mul_f32 v138, v138, v42
  v_mfma_f32_16x16x32_bf16 v[56:59], a[204:207], a[80:83], v[56:59]
  v_mul_f32 v139, v139, v43
  v_cvt_pk_bf16_f32 v72, v136, v137
  v_mfma_f32_16x16x32_bf16 v[60:63], a[200:203], a[68:71], v[60:63]
  v_cvt_pk_bf16_f32 v73, v138, v139
  ds_write_b64 v5, v[72:73] offset:0
  v_mfma_f32_16x16x32_bf16 v[60:63], a[204:207], a[84:87], v[60:63]
  v_exp_f32 v140, -v140
  v_mfma_f32_16x16x32_bf16 v[64:67], a[200:203], a[72:75], v[64:67]
  v_exp_f32 v141, -v141
  v_mfma_f32_16x16x32_bf16 v[64:67], a[204:207], a[88:91], v[64:67]
  v_exp_f32 v142, -v142
  v_mfma_f32_16x16x32_bf16 v[68:71], a[200:203], a[76:79], v[68:71]
  buffer_load_dwordx4 a[200:203], v84, s[28:31], s58 offen offset:0 sc1
  v_mfma_f32_16x16x32_bf16 v[68:71], a[204:207], a[92:95], v[68:71]
  buffer_load_dwordx4 a[204:207], v84, s[28:31], s58 offen offset:1024 sc1
  s_waitcnt vmcnt(16)
  v_mfma_f32_16x16x32_bf16 v[56:59], a[208:211], a[96:99], v[56:59]
  v_exp_f32 v143, -v143
  v_mfma_f32_16x16x32_bf16 v[56:59], a[212:215], a[112:115], v[56:59]
  v_fma_f32 v140, v140, s48, s48
  v_fma_f32 v141, v141, s48, s48
  v_mfma_f32_16x16x32_bf16 v[60:63], a[208:211], a[100:103], v[60:63]
  v_fma_f32 v142, v142, s48, s48
  v_fma_f32 v143, v143, s48, s48
  v_mfma_f32_16x16x32_bf16 v[60:63], a[212:215], a[116:119], v[60:63]
  v_rcp_f32 v140, v140
  v_mfma_f32_16x16x32_bf16 v[64:67], a[208:211], a[104:107], v[64:67]
  v_rcp_f32 v141, v141
  v_mfma_f32_16x16x32_bf16 v[64:67], a[212:215], a[120:123], v[64:67]
  v_rcp_f32 v142, v142
  v_mfma_f32_16x16x32_bf16 v[68:71], a[208:211], a[108:111], v[68:71]
  buffer_load_dwordx4 a[208:211], v84, s[28:31], s58 offen offset:2048 sc1
  v_mfma_f32_16x16x32_bf16 v[68:71], a[212:215], a[124:127], v[68:71]
  buffer_load_dwordx4 a[212:215], v84, s[28:31], s58 offen offset:3072 sc1
  s_waitcnt vmcnt(16)
  s_cmp_lt_u32 s59, 2
  s_cbranch_scc0 Lmk_130
  s_add_u32 s46, s51, s59
  s_add_u32 s46, s46, 6
  s_and_b32 s46, s46, 7
  s_lshl_b32 s46, s46, 16
  s_add_u32 s77, s46, s56
  buffer_store_dwordx4 v[80:83], v4, s[28:31], s77 offen offset:0 sc1
Lmk_130:
  v_mfma_f32_16x16x32_bf16 v[56:59], a[216:219], a[128:131], v[56:59]
  v_rcp_f32 v143, v143
  v_mfma_f32_16x16x32_bf16 v[56:59], a[220:223], a[144:147], v[56:59]
  v_mul_f32 v140, v140, v44
  v_mul_f32 v141, v141, v45
  v_mfma_f32_16x16x32_bf16 v[60:63], a[216:219], a[132:135], v[60:63]
  v_mul_f32 v142, v142, v46
  v_mul_f32 v143, v143, v47
  v_mfma_f32_16x16x32_bf16 v[60:63], a[220:223], a[148:151], v[60:63]
  v_cvt_pk_bf16_f32 v74, v140, v141
  v_cvt_pk_bf16_f32 v75, v142, v143
  v_mfma_f32_16x16x32_bf16 v[64:67], a[216:219], a[136:139], v[64:67]
  ds_write_b64 v5, v[74:75] offset:1024
  v_mfma_f32_16x16x32_bf16 v[64:67], a[220:223], a[152:155], v[64:67]
  v_exp_f32 v144, -v144
  v_mfma_f32_16x16x32_bf16 v[68:71], a[216:219], a[140:143], v[68:71]
  buffer_load_dwordx4 a[216:219], v85, s[28:31], s58 offen offset:0 sc1
  v_mfma_f32_16x16x32_bf16 v[68:71], a[220:223], a[156:159], v[68:71]
  buffer_load_dwordx4 a[220:223], v85, s[28:31], s58 offen offset:1024 sc1
  s_waitcnt vmcnt(16)
  v_mfma_f32_16x16x32_bf16 v[56:59], a[224:227], a[160:163], v[56:59]
  v_exp_f32 v145, -v145
  v_mfma_f32_16x16x32_bf16 v[56:59], a[228:231], a[176:179], v[56:59]
  v_exp_f32 v146, -v146
  v_mfma_f32_16x16x32_bf16 v[60:63], a[224:227], a[164:167], v[60:63]
  v_exp_f32 v147, -v147
  v_mfma_f32_16x16x32_bf16 v[60:63], a[228:231], a[180:183], v[60:63]
  v_fma_f32 v144, v144, s48, s48
  v_fma_f32 v145, v145, s48, s48
  v_mfma_f32_16x16x32_bf16 v[64:67], a[224:227], a[168:171], v[64:67]
  v_fma_f32 v146, v146, s48, s48
  v_fma_f32 v147, v147, s48, s48
  v_mfma_f32_16x16x32_bf16 v[64:67], a[228:231], v[152:155], v[64:67]
  v_rcp_f32 v144, v144
  v_mfma_f32_16x16x32_bf16 v[68:71], a[224:227], a[172:175], v[68:71]
  buffer_load_dwordx4 a[224:227], v85, s[28:31], s58 offen offset:2048 sc1
  v_mfma_f32_16x16x32_bf16 v[68:71], a[228:231], v[156:159], v[68:71]
  buffer_load_dwordx4 a[228:231], v85, s[28:31], s58 offen offset:3072 sc1
  s_waitcnt vmcnt(16)
  v_mfma_f32_16x16x32_bf16 v[56:59], a[232:235], v[160:163], v[56:59]
  v_rcp_f32 v145, v145
  v_mfma_f32_16x16x32_bf16 v[56:59], a[236:239], v[176:179], v[56:59]
  v_rcp_f32 v146, v146
  v_mfma_f32_16x16x32_bf16 v[60:63], a[232:235], v[164:167], v[60:63]
  v_rcp_f32 v147, v147
  v_mfma_f32_16x16x32_bf16 v[60:63], a[236:239], v[180:183], v[60:63]
  v_mul_f32 v144, v144, v48
  v_mul_f32 v145, v145, v49
  v_mfma_f32_16x16x32_bf16 v[64:67], a[232:235], v[168:171], v[64:67]
  v_mul_f32 v146, v146, v50
  v_mul_f32 v147, v147, v51
  v_mfma_f32_16x16x32_bf16 v[64:67], a[236:239], v[184:187], v[64:67]
  v_cvt_pk_bf16_f32 v76, v144, v145
  v_cvt_pk_bf16_f32 v77, v146, v147
  v_mfma_f32_16x16x32_bf16 v[68:71], a[232:235], v[172:175], v[68:71]
  buffer_load_dwordx4 a[232:235], v86, s[28:31], s58 offen offset:0 sc1
  ds_write_b64 v5, v[76:77] offset:2048
  v_mfma_f32_16x16x32_bf16 v[68:71], a[236:239], v[188:191], v[68:71]
  buffer_load_dwordx4 a[236:239], v86, s[28:31], s58 offen offset:1024 sc1
  s_waitcnt vmcnt(16)
  v_mfma_f32_16x16x32_bf16 v[56:59], a[240:243], v[192:195], v[56:59]
  v_exp_f32 v148, -v148
  v_mfma_f32_16x16x32_bf16 v[56:59], a[244:247], v[208:211], v[56:59]
  v_exp_f32 v149, -v149
  v_mfma_f32_16x16x32_bf16 v[60:63], a[240:243], v[196:199], v[60:63]
  v_exp_f32 v150, -v150
  v_mfma_f32_16x16x32_bf16 v[60:63], a[244:247], v[212:215], v[60:63]
  v_exp_f32 v151, -v151
  v_mfma_f32_16x16x32_bf16 v[64:67], a[240:243], v[200:203], v[64:67]
  v_fma_f32 v148, v148, s48, s48
  v_fma_f32 v149, v149, s48, s48
  v_mfma_f32_16x16x32_bf16 v[64:67], a[244:247], v[216:219], v[64:67]
  v_fma_f32 v150, v150, s48, s48
  v_fma_f32 v151, v151, s48, s48
  v_mfma_f32_16x16x32_bf16 v[68:71], a[240:243], v[204:207], v[68:71]
  buffer_load_dwordx4 a[240:243], v86, s[28:31], s58 offen offset:2048 sc1
  v_rcp_f32 v148, v148
  v_mfma_f32_16x16x32_bf16 v[68:71], a[244:247], v[220:223], v[68:71]
  buffer_load_dwordx4 a[244:247], v86, s[28:31], s58 offen offset:3072 sc1
  s_waitcnt vmcnt(16)
  v_mfma_f32_16x16x32_bf16 v[56:59], a[248:251], v[224:227], v[56:59]
  v_rcp_f32 v149, v149
  v_mfma_f32_16x16x32_bf16 v[56:59], a[252:255], v[240:243], v[56:59]
  v_rcp_f32 v150, v150
  v_mfma_f32_16x16x32_bf16 v[60:63], a[248:251], v[228:231], v[60:63]
  v_rcp_f32 v151, v151
  v_mfma_f32_16x16x32_bf16 v[60:63], a[252:255], v[244:247], v[60:63]
  v_mul_f32 v148, v148, v52
  v_mul_f32 v149, v149, v53
  v_mfma_f32_16x16x32_bf16 v[64:67], a[248:251], v[232:235], v[64:67]
  v_mul_f32 v150, v150, v54
  v_mul_f32 v151, v151, v55
  v_mfma_f32_16x16x32_bf16 v[64:67], a[252:255], v[248:251], v[64:67]
  v_cvt_pk_bf16_f32 v78, v148, v149
  v_cvt_pk_bf16_f32 v79, v150, v151
  v_mfma_f32_16x16x32_bf16 v[68:71], a[248:251], v[236:239], v[68:71]
  buffer_load_dwordx4 a[248:251], v87, s[28:31], s58 offen offset:0 sc1
  ds_write_b64 v5, v[78:79] offset:3072
  v_mfma_f32_16x16x32_bf16 v[68:71], a[252:255], v[252:255], v[68:71]
  buffer_load_dwordx4 a[252:255], v87, s[28:31], s58 offen offset:1024 sc1
  s_waitcnt vmcnt(16)
  v_mfma_f32_16x16x32_bf16 v[40:43], a[184:187], a[0:3], 0
  s_add_u32 s58, s58, 18432
  v_add_u32 v5, 8192, v5
  v_mfma_f32_16x16x32_bf16 v[40:43], a[188:191], a[16:19], v[40:43]
  v_pk_fma_f32 v[136:137], v[56:57], v[56:57], s[48:49] op_sel:[0,0,1] op_sel_hi:[1,1,1]
  v_pk_fma_f32 v[138:139], v[58:59], v[58:59], s[48:49] op_sel:[0,0,1] op_sel_hi:[1,1,1]
  v_pk_fma_f32 v[140:141], v[60:61], v[60:61], s[48:49] op_sel:[0,0,1] op_sel_hi:[1,1,1]
  v_pk_fma_f32 v[142:143], v[62:63], v[62:63], s[48:49] op_sel:[0,0,1] op_sel_hi:[1,1,1]
  v_pk_fma_f32 v[144:145], v[64:65], v[64:65], s[48:49] op_sel:[0,0,1] op_sel_hi:[1,1,1]
  v_pk_fma_f32 v[146:147], v[66:67], v[66:67], s[48:49] op_sel:[0,0,1] op_sel_hi:[1,1,1]
  v_pk_fma_f32 v[148:149], v[68:69], v[68:69], s[48:49] op_sel:[0,0,1] op_sel_hi:[1,1,1]
  v_pk_fma_f32 v[150:151], v[70:71], v[70:71], s[48:49] op_sel:[0,0,1] op_sel_hi:[1,1,1]
  v_pk_mul_f32 v[136:137], v[136:137], v[56:57]
  v_pk_mul_f32 v[138:139], v[138:139], v[58:59]
  v_pk_mul_f32 v[140:141], v[140:141], v[60:61]
  v_pk_mul_f32 v[142:143], v[142:143], v[62:63]
  v_pk_mul_f32 v[144:145], v[144:145], v[64:65]
  v_pk_mul_f32 v[146:147], v[146:147], v[66:67]
  v_pk_mul_f32 v[148:149], v[148:149], v[68:69]
  v_pk_mul_f32 v[150:151], v[150:151], v[70:71]
  v_mfma_f32_16x16x32_bf16 v[44:47], a[184:187], a[4:7], 0
  v_exp_f32 v136, -v136
  v_mfma_f32_16x16x32_bf16 v[44:47], a[188:191], a[20:23], v[44:47]
  v_exp_f32 v137, -v137
  v_mfma_f32_16x16x32_bf16 v[48:51], a[184:187], a[8:11], 0
  v_exp_f32 v138, -v138
  v_mfma_f32_16x16x32_bf16 v[48:51], a[188:191], a[24:27], v[48:51]
  v_exp_f32 v139, -v139
  v_mfma_f32_16x16x32_bf16 v[52:55], a[184:187], a[12:15], 0
  buffer_load_dwordx4 a[184:187], v4, s[28:31], s58 offen offset:0 sc1
  v_fma_f32 v136, v136, s48, s48
  v_mfma_f32_16x16x32_bf16 v[52:55], a[188:191], a[28:31], v[52:55]
  buffer_load_dwordx4 a[188:191], v4, s[28:31], s58 offen offset:1024 sc1
  s_waitcnt vmcnt(16)
  v_mfma_f32_16x16x32_bf16 v[40:43], a[192:195], a[32:35], v[40:43]
  v_fma_f32 v137, v137, s48, s48
  v_fma_f32 v138, v138, s48, s48
  v_mfma_f32_16x16x32_bf16 v[40:43], a[196:199], a[48:51], v[40:43]
  v_fma_f32 v139, v139, s48, s48
  v_mfma_f32_16x16x32_bf16 v[44:47], a[192:195], a[36:39], v[44:47]
  v_rcp_f32 v136, v136
  v_mfma_f32_16x16x32_bf16 v[44:47], a[196:199], a[52:55], v[44:47]
  v_rcp_f32 v137, v137
  v_mfma_f32_16x16x32_bf16 v[48:51], a[192:195], a[40:43], v[48:51]
  v_rcp_f32 v138, v138
  v_mfma_f32_16x16x32_bf16 v[48:51], a[196:199], a[56:59], v[48:51]
  v_rcp_f32 v139, v139
  v_mfma_f32_16x16x32_bf16 v[52:55], a[192:195], a[44:47], v[52:55]
  buffer_load_dwordx4 a[192:195], v4, s[28:31], s58 offen offset:2048 sc1
  v_mul_f32 v136, v136, v56
  v_mfma_f32_16x16x32_bf16 v[52:55], a[196:199], a[60:63], v[52:55]
  buffer_load_dwordx4 a[196:199], v4, s[28:31], s58 offen offset:3072 sc1
  s_waitcnt vmcnt(16)
  v_mfma_f32_16x16x32_bf16 v[40:43], a[200:203], a[64:67], v[40:43]
  v_mul_f32 v137, v137, v57
  v_mul_f32 v138, v138, v58
  v_mfma_f32_16x16x32_bf16 v[40:43], a[204:207], a[80:83], v[40:43]
  v_mul_f32 v139, v139, v59
  v_cvt_pk_bf16_f32 v72, v136, v137
  v_mfma_f32_16x16x32_bf16 v[44:47], a[200:203], a[68:71], v[44:47]
  v_cvt_pk_bf16_f32 v73, v138, v139
  ds_write_b64 v5, v[72:73] offset:0
  v_mfma_f32_16x16x32_bf16 v[44:47], a[204:207], a[84:87], v[44:47]
  v_exp_f32 v140, -v140
  v_mfma_f32_16x16x32_bf16 v[48:51], a[200:203], a[72:75], v[48:51]
  v_exp_f32 v141, -v141
  v_mfma_f32_16x16x32_bf16 v[48:51], a[204:207], a[88:91], v[48:51]
  v_exp_f32 v142, -v142
  v_mfma_f32_16x16x32_bf16 v[52:55], a[200:203], a[76:79], v[52:55]
  buffer_load_dwordx4 a[200:203], v84, s[28:31], s58 offen offset:0 sc1
  v_mfma_f32_16x16x32_bf16 v[52:55], a[204:207], a[92:95], v[52:55]
  buffer_load_dwordx4 a[204:207], v84, s[28:31], s58 offen offset:1024 sc1
  s_waitcnt vmcnt(16)
  v_mfma_f32_16x16x32_bf16 v[40:43], a[208:211], a[96:99], v[40:43]
  v_exp_f32 v143, -v143
  v_mfma_f32_16x16x32_bf16 v[40:43], a[212:215], a[112:115], v[40:43]
  v_fma_f32 v140, v140, s48, s48
  v_fma_f32 v141, v141, s48, s48
  v_mfma_f32_16x16x32_bf16 v[44:47], a[208:211], a[100:103], v[44:47]
  v_fma_f32 v142, v142, s48, s48
  v_fma_f32 v143, v143, s48, s48
  v_mfma_f32_16x16x32_bf16 v[44:47], a[212:215], a[116:119], v[44:47]
  v_rcp_f32 v140, v140
  v_mfma_f32_16x16x32_bf16 v[48:51], a[208:211], a[104:107], v[48:51]
  v_rcp_f32 v141, v141
  v_mfma_f32_16x16x32_bf16 v[48:51], a[212:215], a[120:123], v[48:51]
  v_rcp_f32 v142, v142
  v_mfma_f32_16x16x32_bf16 v[52:55], a[208:211], a[108:111], v[52:55]
  buffer_load_dwordx4 a[208:211], v84, s[28:31], s58 offen offset:2048 sc1
  v_mfma_f32_16x16x32_bf16 v[52:55], a[212:215], a[124:127], v[52:55]
  buffer_load_dwordx4 a[212:215], v84, s[28:31], s58 offen offset:3072 sc1
  s_waitcnt vmcnt(16)
  s_cmp_lt_u32 s59, 2
  s_cbranch_scc0 Lmk_131
  buffer_store_dwordx4 v[80:83], v4, s[28:31], s77 offen offset:1024 sc1
Lmk_131:
  v_mfma_f32_16x16x32_bf16 v[40:43], a[216:219], a[128:131], v[40:43]
  v_rcp_f32 v143, v143
  v_mfma_f32_16x16x32_bf16 v[40:43], a[220:223], a[144:147], v[40:43]
  v_mul_f32 v140, v140, v60
  v_mul_f32 v141, v141, v61
  v_mfma_f32_16x16x32_bf16 v[44:47], a[216:219], a[132:135], v[44:47]
  v_mul_f32 v142, v142, v62
  v_mul_f32 v143, v143, v63
  v_mfma_f32_16x16x32_bf16 v[44:47], a[220:223], a[148:151], v[44:47]
  v_cvt_pk_bf16_f32 v74, v140, v141
  v_cvt_pk_bf16_f32 v75, v142, v143
  v_mfma_f32_16x16x32_bf16 v[48:51], a[216:219], a[136:139], v[48:51]
  ds_write_b64 v5, v[74:75] offset:1024
  v_mfma_f32_16x16x32_bf16 v[48:51], a[220:223], a[152:155], v[48:51]
  v_exp_f32 v144, -v144
  v_mfma_f32_16x16x32_bf16 v[52:55], a[216:219], a[140:143], v[52:55]
  buffer_load_dwordx4 a[216:219], v85, s[28:31], s58 offen offset:0 sc1
  v_mfma_f32_16x16x32_bf16 v[52:55], a[220:223], a[156:159], v[52:55]
  buffer_load_dwordx4 a[220:223], v85, s[28:31], s58 offen offset:1024 sc1
  s_waitcnt vmcnt(16)
  v_mfma_f32_16x16x32_bf16 v[40:43], a[224:227], a[160:163], v[40:43]
  v_exp_f32 v145, -v145
  v_mfma_f32_16x16x32_bf16 v[40:43], a[228:231], a[176:179], v[40:43]
  v_exp_f32 v146, -v146
  v_mfma_f32_16x16x32_bf16 v[44:47], a[224:227], a[164:167], v[44:47]
  v_exp_f32 v147, -v147
  v_mfma_f32_16x16x32_bf16 v[44:47], a[228:231], a[180:183], v[44:47]
  v_fma_f32 v144, v144, s48, s48
  v_fma_f32 v145, v145, s48, s48
  v_mfma_f32_16x16x32_bf16 v[48:51], a[224:227], a[168:171], v[48:51]
  v_fma_f32 v146, v146, s48, s48
  v_fma_f32 v147, v147, s48, s48
  v_mfma_f32_16x16x32_bf16 v[48:51], a[228:231], v[152:155], v[48:51]
  v_rcp_f32 v144, v144
  v_mfma_f32_16x16x32_bf16 v[52:55], a[224:227], a[172:175], v[52:55]
  buffer_load_dwordx4 a[224:227], v85, s[28:31], s58 offen offset:2048 sc1
  v_mfma_f32_16x16x32_bf16 v[52:55], a[228:231], v[156:159], v[52:55]
  buffer_load_dwordx4 a[228:231], v85, s[28:31], s58 offen offset:3072 sc1
  s_waitcnt vmcnt(16)
  v_mfma_f32_16x16x32_bf16 v[40:43], a[232:235], v[160:163], v[40:43]
  v_rcp_f32 v145, v145
  v_mfma_f32_16x16x32_bf16 v[40:43], a[236:239], v[176:179], v[40:43]
  v_rcp_f32 v146, v146
  v_mfma_f32_16x16x32_bf16 v[44:47], a[232:235], v[164:167], v[44:47]
  v_rcp_f32 v147, v147
  v_mfma_f32_16x16x32_bf16 v[44:47], a[236:239], v[180:183], v[44:47]
  v_mul_f32 v144, v144, v64
  v_mul_f32 v145, v145, v65
  v_mfma_f32_16x16x32_bf16 v[48:51], a[232:235], v[168:171], v[48:51]
  v_mul_f32 v146, v146, v66
  v_mul_f32 v147, v147, v67
  v_mfma_f32_16x16x32_bf16 v[48:51], a[236:239], v[184:187], v[48:51]
  v_cvt_pk_bf16_f32 v76, v144, v145
  v_cvt_pk_bf16_f32 v77, v146, v147
  v_mfma_f32_16x16x32_bf16 v[52:55], a[232:235], v[172:175], v[52:55]
  buffer_load_dwordx4 a[232:235], v86, s[28:31], s58 offen offset:0 sc1
  ds_write_b64 v5, v[76:77] offset:2048
  v_mfma_f32_16x16x32_bf16 v[52:55], a[236:239], v[188:191], v[52:55]
  buffer_load_dwordx4 a[236:239], v86, s[28:31], s58 offen offset:1024 sc1
  s_waitcnt vmcnt(16)
  v_mfma_f32_16x16x32_bf16 v[40:43], a[240:243], v[192:195], v[40:43]
  v_exp_f32 v148, -v148
  v_mfma_f32_16x16x32_bf16 v[40:43], a[244:247], v[208:211], v[40:43]
  v_exp_f32 v149, -v149
  v_mfma_f32_16x16x32_bf16 v[44:47], a[240:243], v[196:199], v[44:47]
  v_exp_f32 v150, -v150
  v_mfma_f32_16x16x32_bf16 v[44:47], a[244:247], v[212:215], v[44:47]
  v_exp_f32 v151, -v151
  v_mfma_f32_16x16x32_bf16 v[48:51], a[240:243], v[200:203], v[48:51]
  v_fma_f32 v148, v148, s48, s48
  v_fma_f32 v149, v149, s48, s48
  v_mfma_f32_16x16x32_bf16 v[48:51], a[244:247], v[216:219], v[48:51]
  v_fma_f32 v150, v150, s48, s48
  v_fma_f32 v151, v151, s48, s48
  v_mfma_f32_16x16x32_bf16 v[52:55], a[240:243], v[204:207], v[52:55]
  buffer_load_dwordx4 a[240:243], v86, s[28:31], s58 offen offset:2048 sc1
  v_rcp_f32 v148, v148
  v_mfma_f32_16x16x32_bf16 v[52:55], a[244:247], v[220:223], v[52:55]
  buffer_load_dwordx4 a[244:247], v86, s[28:31], s58 offen offset:3072 sc1
  s_waitcnt vmcnt(16)
  v_mfma_f32_16x16x32_bf16 v[40:43], a[248:251], v[224:227], v[40:43]
  v_rcp_f32 v149, v149
  v_mfma_f32_16x16x32_bf16 v[40:43], a[252:255], v[240:243], v[40:43]
  v_rcp_f32 v150, v150
  v_mfma_f32_16x16x32_bf16 v[44:47], a[248:251], v[228:231], v[44:47]
  v_rcp_f32 v151, v151
  v_mfma_f32_16x16x32_bf16 v[44:47], a[252:255], v[244:247], v[44:47]
  v_mul_f32 v148, v148, v68
  v_mul_f32 v149, v149, v69
  v_mfma_f32_16x16x32_bf16 v[48:51], a[248:251], v[232:235], v[48:51]
  v_mul_f32 v150, v150, v70
  v_mul_f32 v151, v151, v71
  v_mfma_f32_16x16x32_bf16 v[48:51], a[252:255], v[248:251], v[48:51]
  v_cvt_pk_bf16_f32 v78, v148, v149
  v_cvt_pk_bf16_f32 v79, v150, v151
  v_mfma_f32_16x16x32_bf16 v[52:55], a[248:251], v[236:239], v[52:55]
  buffer_load_dwordx4 a[248:251], v87, s[28:31], s58 offen offset:0 sc1
  ds_write_b64 v5, v[78:79] offset:3072
  v_mfma_f32_16x16x32_bf16 v[52:55], a[252:255], v[252:255], v[52:55]
  buffer_load_dwordx4 a[252:255], v87, s[28:31], s58 offen offset:1024 sc1
  s_add_u32 s59, s59, 1
  s_cmp_lt_u32 s59, 3
  s_cbranch_scc1 L_p6_a
  s_waitcnt vmcnt(16)
  v_mfma_f32_16x16x32_bf16 v[56:59], a[184:187], a[0:3], 0
  s_add_u32 s58, s58, 18432
  v_add_u32 v5, 8192, v5
  v_mfma_f32_16x16x32_bf16 v[56:59], a[188:191], a[16:19], v[56:59]
  v_pk_fma_f32 v[136:137], v[40:41], v[40:41], s[48:49] op_sel:[0,0,1] op_sel_hi:[1,1,1]
  v_pk_fma_f32 v[138:139], v[42:43], v[42:43], s[48:49] op_sel:[0,0,1] op_sel_hi:[1,1,1]
  v_pk_fma_f32 v[140:141], v[44:45], v[44:45], s[48:49] op_sel:[0,0,1] op_sel_hi:[1,1,1]
  v_pk_fma_f32 v[142:143], v[46:47], v[46:47], s[48:49] op_sel:[0,0,1] op_sel_hi:[1,1,1]
  v_pk_fma_f32 v[144:145], v[48:49], v[48:49], s[48:49] op_sel:[0,0,1] op_sel_hi:[1,1,1]
  v_pk_fma_f32 v[146:147], v[50:51], v[50:51], s[48:49] op_sel:[0,0,1] op_sel_hi:[1,1,1]
  v_pk_fma_f32 v[148:149], v[52:53], v[52:53], s[48:49] op_sel:[0,0,1] op_sel_hi:[1,1,1]
  v_pk_fma_f32 v[150:151], v[54:55], v[54:55], s[48:49] op_sel:[0,0,1] op_sel_hi:[1,1,1]
  v_pk_mul_f32 v[136:137], v[136:137], v[40:41]
  v_pk_mul_f32 v[138:139], v[138:139], v[42:43]
  v_pk_mul_f32 v[140:141], v[140:141], v[44:45]
  v_pk_mul_f32 v[142:143], v[142:143], v[46:47]
  v_pk_mul_f32 v[144:145], v[144:145], v[48:49]
  v_pk_mul_f32 v[146:147], v[146:147], v[50:51]
  v_pk_mul_f32 v[148:149], v[148:149], v[52:53]
  v_pk_mul_f32 v[150:151], v[150:151], v[54:55]
  v_mfma_f32_16x16x32_bf16 v[60:63], a[184:187], a[4:7], 0
  v_exp_f32 v136, -v136
  v_mfma_f32_16x16x32_bf16 v[60:63], a[188:191], a[20:23], v[60:63]
  v_exp_f32 v137, -v137
  v_mfma_f32_16x16x32_bf16 v[64:67], a[184:187], a[8:11], 0
  v_exp_f32 v138, -v138
  v_mfma_f32_16x16x32_bf16 v[64:67], a[188:191], a[24:27], v[64:67]
  v_exp_f32 v139, -v139
  v_mfma_f32_16x16x32_bf16 v[68:71], a[184:187], a[12:15], 0
  buffer_load_dwordx4 a[184:187], v4, s[28:31], s58 offen offset:0 sc1
  v_fma_f32 v136, v136, s48, s48
  v_mfma_f32_16x16x32_bf16 v[68:71], a[188:191], a[28:31], v[68:71]
  buffer_load_dwordx4 a[188:191], v4, s[28:31], s58 offen offset:1024 sc1
  s_waitcnt vmcnt(16)
  v_mfma_f32_16x16x32_bf16 v[56:59], a[192:195], a[32:35], v[56:59]
  v_fma_f32 v137, v137, s48, s48
  v_fma_f32 v138, v138, s48, s48
  v_mfma_f32_16x16x32_bf16 v[56:59], a[196:199], a[48:51], v[56:59]
  v_fma_f32 v139, v139, s48, s48
  v_mfma_f32_16x16x32_bf16 v[60:63], a[192:195], a[36:39], v[60:63]
  v_rcp_f32 v136, v136
  v_mfma_f32_16x16x32_bf16 v[60:63], a[196:199], a[52:55], v[60:63]
  v_rcp_f32 v137, v137
  v_mfma_f32_16x16x32_bf16 v[64:67], a[192:195], a[40:43], v[64:67]
  v_rcp_f32 v138, v138
  v_mfma_f32_16x16x32_bf16 v[64:67], a[196:199], a[56:59], v[64:67]
  v_rcp_f32 v139, v139
  v_mfma_f32_16x16x32_bf16 v[68:71], a[192:195], a[44:47], v[68:71]
  buffer_load_dwordx4 a[192:195], v4, s[28:31], s58 offen offset:2048 sc1
  v_mul_f32 v136, v136, v40
  v_mfma_f32_16x16x32_bf16 v[68:71], a[196:199], a[60:63], v[68:71]
  buffer_load_dwordx4 a[196:199], v4, s[28:31], s58 offen offset:3072 sc1
  s_waitcnt vmcnt(16)
  v_mfma_f32_16x16x32_bf16 v[56:59], a[200:203], a[64:67], v[56:59]
  v_mul_f32 v137, v137, v41
  v_mul_f32 v138, v138, v42
  v_mfma_f32_16x16x32_bf16 v[56:59], a[204:207], a[80:83], v[56:59]
  v_mul_f32 v139, v139, v43
  v_cvt_pk_bf16_f32 v72, v136, v137
  v_mfma_f32_16x16x32_bf16 v[60:63], a[200:203], a[68:71], v[60:63]
  v_cvt_pk_bf16_f32 v73, v138, v139
  ds_write_b64 v5, v[72:73] offset:0
  v_mfma_f32_16x16x32_bf16 v[60:63], a[204:207], a[84:87], v[60:63]
  v_exp_f32 v140, -v140
  v_mfma_f32_16x16x32_bf16 v[64:67], a[200:203], a[72:75], v[64:67]
  v_exp_f32 v141, -v141
  v_mfma_f32_16x16x32_bf16 v[64:67], a[204:207], a[88:91], v[64:67]
  v_exp_f32 v142, -v142
  v_mfma_f32_16x16x32_bf16 v[68:71], a[200:203], a[76:79], v[68:71]
  buffer_load_dwordx4 a[200:203], v84, s[28:31], s58 offen offset:0 sc1
  v_mfma_f32_16x16x32_bf16 v[68:71], a[204:207], a[92:95], v[68:71]
  buffer_load_dwordx4 a[204:207], v84, s[28:31], s58 offen offset:1024 sc1
  s_waitcnt vmcnt(16)
  v_mfma_f32_16x16x32_bf16 v[56:59], a[208:211], a[96:99], v[56:59]
  v_exp_f32 v143, -v143
  v_mfma_f32_16x16x32_bf16 v[56:59], a[212:215], a[112:115], v[56:59]
  v_fma_f32 v140, v140, s48, s48
  v_fma_f32 v141, v141, s48, s48
  v_mfma_f32_16x16x32_bf16 v[60:63], a[208:211], a[100:103], v[60:63]
  v_fma_f32 v142, v142, s48, s48
  v_fma_f32 v143, v143, s48, s48
  v_mfma_f32_16x16x32_bf16 v[60:63], a[212:215], a[116:119], v[60:63]
  v_rcp_f32 v140, v140
  v_mfma_f32_16x16x32_bf16 v[64:67], a[208:211], a[104:107], v[64:67]
  v_rcp_f32 v141, v141
  v_mfma_f32_16x16x32_bf16 v[64:67], a[212:215], a[120:123], v[64:67]
  v_rcp_f32 v142, v142
  v_mfma_f32_16x16x32_bf16 v[68:71], a[208:211], a[108:111], v[68:71]
  buffer_load_dwordx4 a[208:211], v84, s[28:31], s58 offen offset:2048 sc1
  v_mfma_f32_16x16x32_bf16 v[68:71], a[212:215], a[124:127], v[68:71]
  buffer_load_dwordx4 a[212:215], v84, s[28:31], s58 offen offset:3072 sc1
  s_waitcnt vmcnt(16)
  v_mfma_f32_16x16x32_bf16 v[56:59], a[216:219], a[128:131], v[56:59]
  v_rcp_f32 v143, v143
  v_mfma_f32_16x16x32_bf16 v[56:59], a[220:223], a[144:147], v[56:59]
  v_mul_f32 v140, v140, v44
  v_mul_f32 v141, v141, v45
  v_mfma_f32_16x16x32_bf16 v[60:63], a[216:219], a[132:135], v[60:63]
  v_mul_f32 v142, v142, v46
  v_mul_f32 v143, v143, v47
  v_mfma_f32_16x16x32_bf16 v[60:63], a[220:223], a[148:151], v[60:63]
  v_cvt_pk_bf16_f32 v74, v140, v141
  v_cvt_pk_bf16_f32 v75, v142, v143
  v_mfma_f32_16x16x32_bf16 v[12:15], v[36:39], v[104:107], 0
  v_mfma_f32_16x16x32_bf16 v[16:19], v[36:39], v[108:111], 0
  v_mfma_f32_16x16x32_bf16 v[20:23], v[36:39], v[112:115], 0
  v_mfma_f32_16x16x32_bf16 v[24:27], v[36:39], v[116:119], 0
  v_mfma_f32_16x16x32_bf16 v[12:15], v[36:39], v[120:123], v[12:15]
  v_mfma_f32_16x16x32_bf16 v[16:19], v[36:39], v[124:127], v[16:19]
  v_mfma_f32_16x16x32_bf16 v[20:23], v[36:39], v[128:131], v[20:23]
  v_mfma_f32_16x16x32_bf16 v[24:27], v[36:39], v[132:135], v[24:27]
  v_mfma_f32_16x16x32_bf16 v[64:67], a[216:219], a[136:139], v[64:67]
  ds_write_b64 v5, v[74:75] offset:1024
  v_mfma_f32_16x16x32_bf16 v[64:67], a[220:223], a[152:155], v[64:67]
  v_exp_f32 v144, -v144
  v_mfma_f32_16x16x32_bf16 v[68:71], a[216:219], a[140:143], v[68:71]
  buffer_load_dwordx4 a[216:219], v85, s[28:31], s58 offen offset:0 sc1
  v_mfma_f32_16x16x32_bf16 v[68:71], a[220:223], a[156:159], v[68:71]
  buffer_load_dwordx4 a[220:223], v85, s[28:31], s58 offen offset:1024 sc1
  s_waitcnt vmcnt(16)
  v_mfma_f32_16x16x32_bf16 v[56:59], a[224:227], a[160:163], v[56:59]
  v_exp_f32 v145, -v145
  v_mfma_f32_16x16x32_bf16 v[56:59], a[228:231], a[176:179], v[56:59]
  v_exp_f32 v146, -v146
  v_mfma_f32_16x16x32_bf16 v[60:63], a[224:227], a[164:167], v[60:63]
  v_exp_f32 v147, -v147
  v_mfma_f32_16x16x32_bf16 v[60:63], a[228:231], a[180:183], v[60:63]
  v_fma_f32 v144, v144, s48, s48
  v_fma_f32 v145, v145, s48, s48
  v_mfma_f32_16x16x32_bf16 v[64:67], a[224:227], a[168:171], v[64:67]
  v_fma_f32 v146, v146, s48, s48
  v_fma_f32 v147, v147, s48, s48
  v_mfma_f32_16x16x32_bf16 v[64:67], a[228:231], v[152:155], v[64:67]
  v_rcp_f32 v144, v144
  v_mfma_f32_16x16x32_bf16 v[68:71], a[224:227], a[172:175], v[68:71]
  buffer_load_dwordx4 a[224:227], v85, s[28:31], s58 offen offset:2048 sc1
  v_mfma_f32_16x16x32_bf16 v[68:71], a[228:231], v[156:159], v[68:71]
  buffer_load_dwordx4 a[228:231], v85, s[28:31], s58 offen offset:3072 sc1
  s_waitcnt vmcnt(16)
  v_mfma_f32_16x16x32_bf16 v[56:59], a[232:235], v[160:163], v[56:59]
  v_rcp_f32 v145, v145
  v_mfma_f32_16x16x32_bf16 v[56:59], a[236:239], v[176:179], v[56:59]
  v_rcp_f32 v146, v146
  v_mfma_f32_16x16x32_bf16 v[60:63], a[232:235], v[164:167], v[60:63]
  v_rcp_f32 v147, v147
  v_mfma_f32_16x16x32_bf16 v[60:63], a[236:239], v[180:183], v[60:63]
  v_mul_f32 v144, v144, v48
  v_mul_f32 v145, v145, v49
  v_mfma_f32_16x16x32_bf16 v[64:67], a[232:235], v[168:171], v[64:67]
  v_mul_f32 v146, v146, v50
  v_mul_f32 v147, v147, v51
  v_mfma_f32_16x16x32_bf16 v[64:67], a[236:239], v[184:187], v[64:67]
  v_cvt_pk_bf16_f32 v76, v144, v145
  v_cvt_pk_bf16_f32 v77, v146, v147
  v_mfma_f32_16x16x32_bf16 v[68:71], a[232:235], v[172:175], v[68:71]
  buffer_load_dwordx4 a[232:235], v86, s[28:31], s58 offen offset:0 sc1
  ds_write_b64 v5, v[76:77] offset:2048
  v_mfma_f32_16x16x32_bf16 v[68:71], a[236:239], v[188:191], v[68:71]
  buffer_load_dwordx4 a[236:239], v86, s[28:31], s58 offen offset:1024 sc1
  s_waitcnt vmcnt(16)
  v_mfma_f32_16x16x32_bf16 v[56:59], a[240:243], v[192:195], v[56:59]
  v_exp_f32 v148, -v148
  v_mfma_f32_16x16x32_bf16 v[56:59], a[244:247], v[208:211], v[56:59]
  v_exp_f32 v149, -v149
  v_mfma_f32_16x16x32_bf16 v[60:63], a[240:243], v[196:199], v[60:63]
  v_exp_f32 v150, -v150
  v_mfma_f32_16x16x32_bf16 v[60:63], a[244:247], v[212:215], v[60:63]
  v_exp_f32 v151, -v151
  v_mfma_f32_16x16x32_bf16 v[64:67], a[240:243], v[200:203], v[64:67]
  v_fma_f32 v148, v148, s48, s48
  v_fma_f32 v149, v149, s48, s48
  v_mfma_f32_16x16x32_bf16 v[64:67], a[244:247], v[216:219], v[64:67]
  v_fma_f32 v150, v150, s48, s48
  v_fma_f32 v151, v151, s48, s48
  v_mfma_f32_16x16x32_bf16 v[68:71], a[240:243], v[204:207], v[68:71]
  buffer_load_dwordx4 a[240:243], v86, s[28:31], s58 offen offset:2048 sc1
  v_rcp_f32 v148, v148
  v_mfma_f32_16x16x32_bf16 v[68:71], a[244:247], v[220:223], v[68:71]
  buffer_load_dwordx4 a[244:247], v86, s[28:31], s58 offen offset:3072 sc1
  s_waitcnt vmcnt(16)
  v_mfma_f32_16x16x32_bf16 v[56:59], a[248:251], v[224:227], v[56:59]
  v_rcp_f32 v149, v149
  v_mfma_f32_16x16x32_bf16 v[56:59], a[252:255], v[240:243], v[56:59]
  v_rcp_f32 v150, v150
  v_mfma_f32_16x16x32_bf16 v[60:63], a[248:251], v[228:231], v[60:63]
  v_rcp_f32 v151, v151
  v_mfma_f32_16x16x32_bf16 v[60:63], a[252:255], v[244:247], v[60:63]
  v_mul_f32 v148, v148, v52
  v_mul_f32 v149, v149, v53
  v_mfma_f32_16x16x32_bf16 v[64:67], a[248:251], v[232:235], v[64:67]
  v_mul_f32 v150, v150, v54
  v_mul_f32 v151, v151, v55
  v_mfma_f32_16x16x32_bf16 v[64:67], a[252:255], v[248:251], v[64:67]
  v_cvt_pk_bf16_f32 v78, v148, v149
  v_cvt_pk_bf16_f32 v79, v150, v151
  v_mfma_f32_16x16x32_bf16 v[68:71], a[248:251], v[236:239], v[68:71]
  buffer_load_dwordx4 a[248:251], v87, s[28:31], s58 offen offset:0 sc1
  ds_write_b64 v5, v[78:79] offset:3072
  v_mfma_f32_16x16x32_bf16 v[68:71], a[252:255], v[252:255], v[68:71]
  buffer_load_dwordx4 a[252:255], v87, s[28:31], s58 offen offset:1024 sc1
  s_add_u32 s64, s55, 1024
  s_add_u32 s46, s51, 1
  s_and_b32 s46, s46, 7
  s_lshl_b32 s46, s46, 7
  s_add_u32 s65, s55, s46
  s_waitcnt vmcnt(16)
  v_mfma_f32_16x16x32_bf16 v[40:43], a[184:187], a[0:3], 0
  s_add_u32 s58, s58, 18432
  v_add_u32 v5, 8192, v5
  v_mfma_f32_16x16x32_bf16 v[40:43], a[188:191], a[16:19], v[40:43]
  v_pk_fma_f32 v[136:137], v[56:57], v[56:57], s[48:49] op_sel:[0,0,1] op_sel_hi:[1,1,1]
  v_pk_fma_f32 v[138:139], v[58:59], v[58:59], s[48:49] op_sel:[0,0,1] op_sel_hi:[1,1,1]
  v_pk_fma_f32 v[140:141], v[60:61], v[60:61], s[48:49] op_sel:[0,0,1] op_sel_hi:[1,1,1]
  v_pk_fma_f32 v[142:143], v[62:63], v[62:63], s[48:49] op_sel:[0,0,1] op_sel_hi:[1,1,1]
  v_pk_fma_f32 v[144:145], v[64:65], v[64:65], s[48:49] op_sel:[0,0,1] op_sel_hi:[1,1,1]
  v_pk_fma_f32 v[146:147], v[66:67], v[66:67], s[48:49] op_sel:[0,0,1] op_sel_hi:[1,1,1]
  v_pk_fma_f32 v[148:149], v[68:69], v[68:69], s[48:49] op_sel:[0,0,1] op_sel_hi:[1,1,1]
  v_pk_fma_f32 v[150:151], v[70:71], v[70:71], s[48:49] op_sel:[0,0,1] op_sel_hi:[1,1,1]
  v_pk_mul_f32 v[136:137], v[136:137], v[56:57]
  v_pk_mul_f32 v[138:139], v[138:139], v[58:59]
  v_pk_mul_f32 v[140:141], v[140:141], v[60:61]
  v_pk_mul_f32 v[142:143], v[142:143], v[62:63]
  v_pk_mul_f32 v[144:145], v[144:145], v[64:65]
  v_pk_mul_f32 v[146:147], v[146:147], v[66:67]
  v_pk_mul_f32 v[148:149], v[148:149], v[68:69]
  v_pk_mul_f32 v[150:151], v[150:151], v[70:71]
  v_mfma_f32_16x16x32_bf16 v[44:47], a[184:187], a[4:7], 0
  v_exp_f32 v136, -v136
  v_mfma_f32_16x16x32_bf16 v[44:47], a[188:191], a[20:23], v[44:47]
  v_exp_f32 v137, -v137
  v_mfma_f32_16x16x32_bf16 v[48:51], a[184:187], a[8:11], 0
  v_exp_f32 v138, -v138
  v_mfma_f32_16x16x32_bf16 v[48:51], a[188:191], a[24:27], v[48:51]
  v_exp_f32 v139, -v139
  v_mfma_f32_16x16x32_bf16 v[52:55], a[184:187], a[12:15], 0
  s_add_u32 m0, s63, 0
  s_add_u32 s58, s64, 0
  buffer_load_dwordx4 v96, s[36:39], s58 offen offset:0 lds
  v_mfma_f32_16x16x32_bf16 v[52:55], a[188:191], a[28:31], v[52:55]
  buffer_load_dwordx4 v97, s[36:39], s58 offen offset:1024 lds
  s_waitcnt vmcnt(16)
  v_mfma_f32_16x16x32_bf16 v[40:43], a[192:195], a[32:35], v[40:43]
  v_fma_f32 v136, v136, s48, s48
  v_fma_f32 v137, v137, s48, s48
  v_mfma_f32_16x16x32_bf16 v[40:43], a[196:199], a[48:51], v[40:43]
  v_fma_f32 v138, v138, s48, s48
  v_fma_f32 v139, v139, s48, s48
  v_mfma_f32_16x16x32_bf16 v[44:47], a[192:195], a[36:39], v[44:47]
  v_rcp_f32 v136, v136
  v_mfma_f32_16x16x32_bf16 v[44:47], a[196:199], a[52:55], v[44:47]
  v_rcp_f32 v137, v137
  v_mfma_f32_16x16x32_bf16 v[48:51], a[192:195], a[40:43], v[48:51]
  v_rcp_f32 v138, v138
  v_mfma_f32_16x16x32_bf16 v[48:51], a[196:199], a[56:59], v[48:51]
  v_rcp_f32 v139, v139
  v_mfma_f32_16x16x32_bf16 v[52:55], a[192:195], a[44:47], v[52:55]
  buffer_load_dwordx4 v98, s[36:39], s58 offen offset:2048 lds
  v_mul_f32 v136, v136, v56
  v_mfma_f32_16x16x32_bf16 v[52:55], a[196:199], a[60:63], v[52:55]
  s_add_u32 m0, s63, 3072
  s_nop 0
  buffer_load_dwordx4 v99, s[36:39], s58 offen offset:0 lds
  s_waitcnt vmcnt(16)
  v_mfma_f32_16x16x32_bf16 v[40:43], a[200:203], a[64:67], v[40:43]
  v_mul_f32 v137, v137, v57
  v_mul_f32 v138, v138, v58
  v_mfma_f32_16x16x32_bf16 v[40:43], a[204:207], a[80:83], v[40:43]
  v_mul_f32 v139, v139, v59
  v_cvt_pk_bf16_f32 v72, v136, v137
  v_mfma_f32_16x16x32_bf16 v[44:47], a[200:203], a[68:71], v[44:47]
  v_cvt_pk_bf16_f32 v73, v138, v139
  ds_write_b64 v5, v[72:73] offset:0
  v_mfma_f32_16x16x32_bf16 v[44:47], a[204:207], a[84:87], v[44:47]
  v_exp_f32 v140, -v140
  v_mfma_f32_16x16x32_bf16 v[48:51], a[200:203], a[72:75], v[48:51]
  v_exp_f32 v141, -v141
  v_mfma_f32_16x16x32_bf16 v[48:51], a[204:207], a[88:91], v[48:51]
  v_exp_f32 v142, -v142
  v_mfma_f32_16x16x32_bf16 v[52:55], a[200:203], a[76:79], v[52:55]
  buffer_load_dwordx4 v100, s[36:39], s58 offen offset:1024 lds
  v_mfma_f32_16x16x32_bf16 v[52:55], a[204:207], a[92:95], v[52:55]
  buffer_load_dwordx4 v101, s[36:39], s58 offen offset:2048 lds
  s_waitcnt vmcnt(16)
  v_mfma_f32_16x16x32_bf16 v[40:43], a[208:211], a[96:99], v[40:43]
  v_exp_f32 v143, -v143
  v_mfma_f32_16x16x32_bf16 v[40:43], a[212:215], a[112:115], v[40:43]
  v_fma_f32 v140, v140, s48, s48
  v_fma_f32 v141, v141, s48, s48
  v_mfma_f32_16x16x32_bf16 v[44:47], a[208:211], a[100:103], v[44:47]
  v_fma_f32 v142, v142, s48, s48
  v_fma_f32 v143, v143, s48, s48
  v_mfma_f32_16x16x32_bf16 v[44:47], a[212:215], a[116:119], v[44:47]
  v_rcp_f32 v140, v140
  v_mfma_f32_16x16x32_bf16 v[48:51], a[208:211], a[104:107], v[48:51]
  v_rcp_f32 v141, v141
  v_mfma_f32_16x16x32_bf16 v[48:51], a[212:215], a[120:123], v[48:51]
  v_rcp_f32 v142, v142
  v_mfma_f32_16x16x32_bf16 v[52:55], a[208:211], a[108:111], v[52:55]
  s_add_u32 m0, s63, 24576
  s_add_u32 s58, s64, 221184
  buffer_load_dwordx4 v96, s[36:39], s58 offen offset:0 lds
  v_mfma_f32_16x16x32_bf16 v[52:55], a[212:215], a[124:127], v[52:55]
  buffer_load_dwordx4 v97, s[36:39], s58 offen offset:1024 lds
  s_waitcnt vmcnt(16)
  v_mfma_f32_16x16x32_bf16 v[40:43], a[216:219], a[128:131], v[40:43]
  v_rcp_f32 v143, v143
  v_mfma_f32_16x16x32_bf16 v[40:43], a[220:223], a[144:147], v[40:43]
  v_mul_f32 v140, v140, v60
  v_mul_f32 v141, v141, v61
  v_mfma_f32_16x16x32_bf16 v[44:47], a[216:219], a[132:135], v[44:47]
  v_mul_f32 v142, v142, v62
  v_mul_f32 v143, v143, v63
  v_mfma_f32_16x16x32_bf16 v[44:47], a[220:223], a[148:151], v[44:47]
  v_cvt_pk_bf16_f32 v74, v140, v141
  v_cvt_pk_bf16_f32 v75, v142, v143
  v_mfma_f32_16x16x32_bf16 v[48:51], a[216:219], a[136:139], v[48:51]
  ds_write_b64 v5, v[74:75] offset:1024
  v_mfma_f32_16x16x32_bf16 v[48:51], a[220:223], a[152:155], v[48:51]
  v_exp_f32 v144, -v144
  v_mfma_f32_16x16x32_bf16 v[52:55], a[216:219], a[140:143], v[52:55]
  buffer_load_dwordx4 v98, s[36:39], s58 offen offset:2048 lds
  v_mfma_f32_16x16x32_bf16 v[52:55], a[220:223], a[156:159], v[52:55]
  s_add_u32 m0, s63, 27648
  s_nop 0
  buffer_load_dwordx4 v99, s[36:39], s58 offen offset:0 lds
  s_waitcnt vmcnt(16)
  v_mfma_f32_16x16x32_bf16 v[40:43], a[224:227], a[160:163], v[40:43]
  v_exp_f32 v145, -v145
  v_mfma_f32_16x16x32_bf16 v[40:43], a[228:231], a[176:179], v[40:43]
  v_exp_f32 v146, -v146
  v_mfma_f32_16x16x32_bf16 v[44:47], a[224:227], a[164:167], v[44:47]
  v_exp_f32 v147, -v147
  v_mfma_f32_16x16x32_bf16 v[44:47], a[228:231], a[180:183], v[44:47]
  v_fma_f32 v144, v144, s48, s48
  v_fma_f32 v145, v145, s48, s48
  v_mfma_f32_16x16x32_bf16 v[48:51], a[224:227], a[168:171], v[48:51]
  v_fma_f32 v146, v146, s48, s48
  v_fma_f32 v147, v147, s48, s48
  v_mfma_f32_16x16x32_bf16 v[48:51], a[228:231], v[152:155], v[48:51]
  v_rcp_f32 v144, v144
  v_mfma_f32_16x16x32_bf16 v[52:55], a[224:227], a[172:175], v[52:55]
  buffer_load_dwordx4 v100, s[36:39], s58 offen offset:1024 lds
  v_mfma_f32_16x16x32_bf16 v[52:55], a[228:231], v[156:159], v[52:55]
  buffer_load_dwordx4 v101, s[36:39], s58 offen offset:2048 lds
  s_waitcnt vmcnt(16)
  v_mfma_f32_16x16x32_bf16 v[40:43], a[232:235], v[160:163], v[40:43]
  v_rcp_f32 v145, v145
  v_mfma_f32_16x16x32_bf16 v[40:43], a[236:239], v[176:179], v[40:43]
  v_rcp_f32 v146, v146
  v_mfma_f32_16x16x32_bf16 v[44:47], a[232:235], v[164:167], v[44:47]
  v_rcp_f32 v147, v147
  v_mfma_f32_16x16x32_bf16 v[44:47], a[236:239], v[180:183], v[44:47]
  v_mul_f32 v144, v144, v64
  v_mul_f32 v145, v145, v65
  v_mfma_f32_16x16x32_bf16 v[48:51], a[232:235], v[168:171], v[48:51]
  v_mul_f32 v146, v146, v66
  v_mul_f32 v147, v147, v67
  v_mfma_f32_16x16x32_bf16 v[48:51], a[236:239], v[184:187], v[48:51]
  v_cvt_pk_bf16_f32 v76, v144, v145
  v_cvt_pk_bf16_f32 v77, v146, v147
  v_mfma_f32_16x16x32_bf16 v[52:55], a[232:235], v[172:175], v[52:55]
  s_add_u32 m0, s63, 49152
  s_add_u32 s58, s64, 442368
  buffer_load_dwordx4 v96, s[36:39], s58 offen offset:0 lds
  ds_write_b64 v5, v[76:77] offset:2048
  v_mfma_f32_16x16x32_bf16 v[52:55], a[236:239], v[188:191], v[52:55]
  buffer_load_dwordx4 v97, s[36:39], s58 offen offset:1024 lds
  s_waitcnt vmcnt(16)
  v_mfma_f32_16x16x32_bf16 v[40:43], a[240:243], v[192:195], v[40:43]
  v_exp_f32 v148, -v148
  v_mfma_f32_16x16x32_bf16 v[40:43], a[244:247], v[208:211], v[40:43]
  v_exp_f32 v149, -v149
  v_mfma_f32_16x16x32_bf16 v[44:47], a[240:243], v[196:199], v[44:47]
  v_exp_f32 v150, -v150
  v_mfma_f32_16x16x32_bf16 v[44:47], a[244:247], v[212:215], v[44:47]
  v_exp_f32 v151, -v151
  v_mfma_f32_16x16x32_bf16 v[48:51], a[240:243], v[200:203], v[48:51]
  v_fma_f32 v148, v148, s48, s48
  v_fma_f32 v149, v149, s48, s48
  v_mfma_f32_16x16x32_bf16 v[48:51], a[244:247], v[216:219], v[48:51]
  v_fma_f32 v150, v150, s48, s48
  v_fma_f32 v151, v151, s48, s48
  v_mfma_f32_16x16x32_bf16 v[52:55], a[240:243], v[204:207], v[52:55]
  buffer_load_dwordx4 v98, s[36:39], s58 offen offset:2048 lds
  v_rcp_f32 v148, v148
  v_mfma_f32_16x16x32_bf16 v[52:55], a[244:247], v[220:223], v[52:55]
  s_add_u32 m0, s63, 52224
  s_nop 0
  buffer_load_dwordx4 v99, s[36:39], s58 offen offset:0 lds
  s_waitcnt vmcnt(16)
  v_mfma_f32_16x16x32_bf16 v[40:43], a[248:251], v[224:227], v[40:43]
  v_rcp_f32 v149, v149
  v_mfma_f32_16x16x32_bf16 v[40:43], a[252:255], v[240:243], v[40:43]
  v_rcp_f32 v150, v150
  v_mfma_f32_16x16x32_bf16 v[44:47], a[248:251], v[228:231], v[44:47]
  v_rcp_f32 v151, v151
  v_mfma_f32_16x16x32_bf16 v[44:47], a[252:255], v[244:247], v[44:47]
  v_mul_f32 v148, v148, v68
  v_mul_f32 v149, v149, v69
  v_mfma_f32_16x16x32_bf16 v[48:51], a[248:251], v[232:235], v[48:51]
  v_mul_f32 v150, v150, v70
  v_mul_f32 v151, v151, v71
  v_mfma_f32_16x16x32_bf16 v[48:51], a[252:255], v[248:251], v[48:51]
  v_cvt_pk_bf16_f32 v78, v148, v149
  v_cvt_pk_bf16_f32 v79, v150, v151
  v_mfma_f32_16x16x32_bf16 v[52:55], a[248:251], v[236:239], v[52:55]
  buffer_load_dwordx4 v100, s[36:39], s58 offen offset:1024 lds
  ds_write_b64 v5, v[78:79] offset:3072
  v_mfma_f32_16x16x32_bf16 v[52:55], a[252:255], v[252:255], v[52:55]
  buffer_load_dwordx4 v101, s[36:39], s58 offen offset:2048 lds
  v_add_u32 v5, 8192, v5
  s_waitcnt vmcnt(12) lgkmcnt(0)
  s_barrier
  s_lshl_b32 s70, s50, 10
  s_add_u32 s70, s70, 213120
  s_lshl_b32 s46, s51, 7
  s_add_u32 s68, s70, s46
  s_mul_i32 s46, s50, 9
  s_add_u32 s46, s46, s51
  s_lshl_b32 s46, s46, 16
  s_lshl_b32 s47, s40, 11
  s_add_u32 s46, s46, s47
  s_add_u32 s69, s46, 29908992
  v_mov_b32 v104, v33
  v_mov_b32 v105, v34
  v_add_u32 v103, 0, v102
  ds_read_b64_tr_b16 v[80:81], v103 offset:0
  ds_read_b64_tr_b16 v[82:83], v103 offset:512
  ds_read_b64_tr_b16 v[84:85], v103 offset:4096
  ds_read_b64_tr_b16 v[86:87], v103 offset:4608
  ds_read_b64_tr_b16 v[88:89], v103 offset:8192
  ds_read_b64_tr_b16 v[90:91], v103 offset:8704
  ds_read_b64_tr_b16 v[92:93], v103 offset:12288
  ds_read_b64_tr_b16 v[94:95], v103 offset:12800
  ds_read_b128 a[0:3], v104 offset:0
  ds_read_b128 a[16:19], v104 offset:4096
  ds_read_b128 a[4:7], v104 offset:1024
  ds_read_b128 a[20:23], v104 offset:5120
  ds_read_b128 a[8:11], v104 offset:2048
  ds_read_b128 a[24:27], v104 offset:6144
  ds_read_b128 a[12:15], v104 offset:3072
  ds_read_b128 a[28:31], v104 offset:7168
  s_waitcnt lgkmcnt(12)
  s_waitcnt lgkmcnt(6)
  v_mfma_f32_16x16x32_bf16 v[56:59], v[80:83], a[0:3], 0
  ds_read_b64_tr_b16 v[32:33], v103 offset:16384
  ds_read_b128 a[32:35], v104 offset:8192
  s_add_u32 s46, s51, 2
  s_and_b32 s46, s46, 7
  v_mfma_f32_16x16x32_bf16 v[56:59], v[84:87], a[16:19], v[56:59]
  ds_read_b64_tr_b16 v[34:35], v103 offset:16896
  ds_read_b128 a[48:51], v104 offset:12288
  s_lshl_b32 s46, s46, 7
  s_waitcnt lgkmcnt(8)
  v_mfma_f32_16x16x32_bf16 v[60:63], v[80:83], a[4:7], 0
  ds_read_b64_tr_b16 v[36:37], v103 offset:20480
  ds_read_b128 a[36:39], v104 offset:9216
  s_add_u32 s64, s55, s46
  v_mfma_f32_16x16x32_bf16 v[60:63], v[84:87], a[20:23], v[60:63]
  ds_read_b64_tr_b16 v[38:39], v103 offset:20992
  ds_read_b128 a[52:55], v104 offset:13312
  v_pk_fma_f32 v[136:137], v[40:41], v[40:41], s[48:49] op_sel:[0,0,1] op_sel_hi:[1,1,1]
  v_pk_fma_f32 v[138:139], v[42:43], v[42:43], s[48:49] op_sel:[0,0,1] op_sel_hi:[1,1,1]
  v_pk_fma_f32 v[140:141], v[44:45], v[44:45], s[48:49] op_sel:[0,0,1] op_sel_hi:[1,1,1]
  v_pk_fma_f32 v[142:143], v[46:47], v[46:47], s[48:49] op_sel:[0,0,1] op_sel_hi:[1,1,1]
  v_pk_fma_f32 v[144:145], v[48:49], v[48:49], s[48:49] op_sel:[0,0,1] op_sel_hi:[1,1,1]
  v_pk_fma_f32 v[146:147], v[50:51], v[50:51], s[48:49] op_sel:[0,0,1] op_sel_hi:[1,1,1]
  v_pk_fma_f32 v[148:149], v[52:53], v[52:53], s[48:49] op_sel:[0,0,1] op_sel_hi:[1,1,1]
  v_pk_fma_f32 v[150:151], v[54:55], v[54:55], s[48:49] op_sel:[0,0,1] op_sel_hi:[1,1,1]
  v_pk_mul_f32 v[136:137], v[136:137], v[40:41]
  v_pk_mul_f32 v[138:139], v[138:139], v[42:43]
  v_pk_mul_f32 v[140:141], v[140:141], v[44:45]
  v_pk_mul_f32 v[142:143], v[142:143], v[46:47]
  v_pk_mul_f32 v[144:145], v[144:145], v[48:49]
  v_pk_mul_f32 v[146:147], v[146:147], v[50:51]
  v_pk_mul_f32 v[148:149], v[148:149], v[52:53]
  v_pk_mul_f32 v[150:151], v[150:151], v[54:55]
  s_waitcnt lgkmcnt(10)
  v_mfma_f32_16x16x32_bf16 v[64:67], v[80:83], a[8:11], 0
  ds_read_b128 a[40:43], v104 offset:10240
  v_exp_f32 v136, -v136
  v_exp_f32 v137, -v137
  v_mfma_f32_16x16x32_bf16 v[64:67], v[84:87], a[24:27], v[64:67]
  ds_read_b128 a[56:59], v104 offset:14336
  v_exp_f32 v138, -v138
  v_exp_f32 v139, -v139
  s_waitcnt lgkmcnt(10)
  v_mfma_f32_16x16x32_bf16 v[68:71], v[80:83], a[12:15], 0
  ds_read_b128 a[44:47], v104 offset:11264
  v_fma_f32 v136, v136, s48, s48
  v_fma_f32 v137, v137, s48, s48
  v_mfma_f32_16x16x32_bf16 v[68:71], v[84:87], a[28:31], v[68:71]
  ds_read_b128 a[60:63], v104 offset:15360
  v_fma_f32 v138, v138, s48, s48
  s_waitcnt vmcnt(6)
  s_barrier
  s_waitcnt lgkmcnt(8)
  v_mfma_f32_16x16x32_bf16 v[56:59], v[88:91], a[32:35], v[56:59]
  v_add_u32 v103, 24576, v102
  ds_read_b128 a[64:67], v104 offset:16384
  v_fma_f32 v139, v139, s48, s48
  v_rcp_f32 v136, v136
  v_mfma_f32_16x16x32_bf16 v[56:59], v[92:95], a[48:51], v[56:59]
  ds_read_b64_tr_b16 v[80:81], v103 offset:0
  ds_read_b128 a[80:83], v104 offset:20480
  v_rcp_f32 v137, v137
  v_rcp_f32 v138, v138
  s_waitcnt lgkmcnt(7)
  v_mfma_f32_16x16x32_bf16 v[60:63], v[88:91], a[36:39], v[60:63]
  ds_read_b64_tr_b16 v[82:83], v103 offset:512
  ds_read_b128 a[68:71], v104 offset:17408
  v_rcp_f32 v139, v139
  v_mfma_f32_16x16x32_bf16 v[60:63], v[92:95], a[52:55], v[60:63]
  ds_read_b64_tr_b16 v[84:85], v103 offset:4096
  ds_read_b128 a[84:87], v104 offset:21504
  v_mul_f32 v136, v136, v40
  v_mul_f32 v137, v137, v41
  s_waitcnt lgkmcnt(9)
  v_mfma_f32_16x16x32_bf16 v[64:67], v[88:91], a[40:43], v[64:67]
  ds_read_b64_tr_b16 v[86:87], v103 offset:4608
  ds_read_b128 a[72:75], v104 offset:18432
  v_mul_f32 v138, v138, v42
  v_mul_f32 v139, v139, v43
  v_mfma_f32_16x16x32_bf16 v[64:67], v[92:95], a[56:59], v[64:67]
  ds_read_b128 a[88:91], v104 offset:22528
  v_cvt_pk_bf16_f32 v72, v136, v137
  s_waitcnt lgkmcnt(10)
  v_mfma_f32_16x16x32_bf16 v[68:71], v[88:91], a[44:47], v[68:71]
  ds_read_b128 a[76:79], v104 offset:19456
  v_cvt_pk_bf16_f32 v73, v138, v139
  ds_write_b64 v5, v[72:73] offset:0
  v_mfma_f32_16x16x32_bf16 v[68:71], v[92:95], a[60:63], v[68:71]
  ds_read_b128 a[92:95], v104 offset:23552
  v_exp_f32 v140, -v140
  v_exp_f32 v141, -v141
  s_waitcnt lgkmcnt(10)
  v_mfma_f32_16x16x32_bf16 v[56:59], v[32:35], a[64:67], v[56:59]
  ds_read_b64_tr_b16 v[88:89], v103 offset:8192
  ds_read_b128 a[96:99], v104 offset:24576
  v_exp_f32 v142, -v142
  v_mfma_f32_16x16x32_bf16 v[56:59], v[36:39], a[80:83], v[56:59]
  ds_read_b64_tr_b16 v[90:91], v103 offset:8704
  ds_read_b128 a[112:115], v104 offset:28672
  v_exp_f32 v143, -v143
  v_fma_f32 v140, v140, s48, s48
  s_waitcnt lgkmcnt(10)
  v_mfma_f32_16x16x32_bf16 v[60:63], v[32:35], a[68:71], v[60:63]
  ds_read_b64_tr_b16 v[92:93], v103 offset:12288
  ds_read_b128 a[100:103], v104 offset:25600
  v_fma_f32 v141, v141, s48, s48
  v_fma_f32 v142, v142, s48, s48
  v_mfma_f32_16x16x32_bf16 v[60:63], v[36:39], a[84:87], v[60:63]
  ds_read_b64_tr_b16 v[94:95], v103 offset:12800
  ds_read_b128 a[116:119], v104 offset:29696
  v_fma_f32 v143, v143, s48, s48
  v_rcp_f32 v140, v140
  s_waitcnt lgkmcnt(11)
  v_mfma_f32_16x16x32_bf16 v[64:67], v[32:35], a[72:75], v[64:67]
  ds_read_b128 a[104:107], v104 offset:26624
  v_rcp_f32 v141, v141
  v_mfma_f32_16x16x32_bf16 v[64:67], v[36:39], a[88:91], v[64:67]
  ds_read_b128 a[120:123], v104 offset:30720
  v_rcp_f32 v142, v142
  v_rcp_f32 v143, v143
  s_waitcnt lgkmcnt(10)
  v_mfma_f32_16x16x32_bf16 v[68:71], v[32:35], a[76:79], v[68:71]
  ds_read_b128 a[108:111], v104 offset:27648
  v_mul_f32 v140, v140, v44
  v_mul_f32 v141, v141, v45
  v_mfma_f32_16x16x32_bf16 v[68:71], v[36:39], a[92:95], v[68:71]
  ds_read_b128 a[124:127], v104 offset:31744
  v_mul_f32 v142, v142, v46
  s_waitcnt lgkmcnt(8)
  v_mfma_f32_16x16x32_bf16 v[56:59], v[80:83], a[96:99], v[56:59]
  ds_read_b64_tr_b16 v[32:33], v103 offset:16384
  ds_read_b128 a[128:131], v104 offset:32768
  v_mul_f32 v143, v143, v47
  v_cvt_pk_bf16_f32 v74, v140, v141
  v_mfma_f32_16x16x32_bf16 v[56:59], v[84:87], a[112:115], v[56:59]
  ds_read_b64_tr_b16 v[34:35], v103 offset:16896
  ds_read_b128 a[144:147], v105 offset:0
  v_cvt_pk_bf16_f32 v75, v142, v143
  ds_write_b64 v5, v[74:75] offset:1024
  s_waitcnt lgkmcnt(9)
  v_mfma_f32_16x16x32_bf16 v[60:63], v[80:83], a[100:103], v[60:63]
  ds_read_b64_tr_b16 v[36:37], v103 offset:20480
  ds_read_b128 a[132:135], v104 offset:33792
  v_exp_f32 v144, -v144
  v_mfma_f32_16x16x32_bf16 v[60:63], v[84:87], a[116:119], v[60:63]
  ds_read_b64_tr_b16 v[38:39], v103 offset:20992
  ds_read_b128 a[148:151], v105 offset:1024
  v_exp_f32 v145, -v145
  v_exp_f32 v146, -v146
  s_waitcnt lgkmcnt(11)
  v_mfma_f32_16x16x32_bf16 v[64:67], v[80:83], a[104:107], v[64:67]
  ds_read_b128 a[136:139], v104 offset:34816
  v_exp_f32 v147, -v147
  v_fma_f32 v144, v144, s48, s48
  v_mfma_f32_16x16x32_bf16 v[64:67], v[84:87], a[120:123], v[64:67]
  ds_read_b128 a[152:155], v105 offset:2048
  v_fma_f32 v145, v145, s48, s48
  s_waitcnt lgkmcnt(11)
  v_mfma_f32_16x16x32_bf16 v[68:71], v[80:83], a[108:111], v[68:71]
  ds_read_b128 a[140:143], v104 offset:35840
  v_fma_f32 v146, v146, s48, s48
  v_fma_f32 v147, v147, s48, s48
  v_mfma_f32_16x16x32_bf16 v[68:71], v[84:87], a[124:127], v[68:71]
  ds_read_b128 a[156:159], v105 offset:3072
  v_rcp_f32 v144, v144
  v_rcp_f32 v145, v145
  s_waitcnt vmcnt(0)
  s_waitcnt lgkmcnt(8)
  s_barrier
  v_mfma_f32_16x16x32_bf16 v[56:59], v[88:91], a[128:131], v[56:59]
  v_add_u32 v103, 49152, v102
  ds_read_b128 a[160:163], v105 offset:4096
  s_add_u32 m0, s63, 0
  s_add_u32 s58, s65, 0
  buffer_load_dwordx4 v96, s[36:39], s58 offen offset:0 lds
  v_rcp_f32 v146, v146
  v_mfma_f32_16x16x32_bf16 v[56:59], v[92:95], a[144:147], v[56:59]
  ds_read_b64_tr_b16 v[80:81], v103 offset:0
  ds_read_b128 a[176:179], v105 offset:8192
  v_rcp_f32 v147, v147
  v_mul_f32 v144, v144, v48
  s_waitcnt lgkmcnt(7)
  v_mfma_f32_16x16x32_bf16 v[60:63], v[88:91], a[132:135], v[60:63]
  ds_read_b64_tr_b16 v[82:83], v103 offset:512
  ds_read_b128 a[164:167], v105 offset:5120
  buffer_load_dwordx4 v97, s[36:39], s58 offen offset:1024 lds
  v_mul_f32 v145, v145, v49
  v_mul_f32 v146, v146, v50
  v_mfma_f32_16x16x32_bf16 v[60:63], v[92:95], a[148:151], v[60:63]
  ds_read_b64_tr_b16 v[84:85], v103 offset:4096
  ds_read_b128 a[180:183], v105 offset:9216
  v_mul_f32 v147, v147, v51
  v_cvt_pk_bf16_f32 v76, v144, v145
  s_waitcnt lgkmcnt(9)
  v_mfma_f32_16x16x32_bf16 v[64:67], v[88:91], a[136:139], v[64:67]
  ds_read_b64_tr_b16 v[86:87], v103 offset:4608
  ds_read_b128 a[168:171], v105 offset:6144
  buffer_load_dwordx4 v98, s[36:39], s58 offen offset:2048 lds
  v_cvt_pk_bf16_f32 v77, v146, v147
  v_mfma_f32_16x16x32_bf16 v[64:67], v[92:95], a[152:155], v[64:67]
  ds_read_b128 a[184:187], v105 offset:10240
  ds_write_b64 v5, v[76:77] offset:2048
  v_exp_f32 v148, -v148
  s_waitcnt lgkmcnt(11)
  v_mfma_f32_16x16x32_bf16 v[68:71], v[88:91], a[140:143], v[68:71]
  ds_read_b128 a[172:175], v105 offset:7168
  s_add_u32 m0, s63, 3072
  s_nop 0
  buffer_load_dwordx4 v99, s[36:39], s58 offen offset:0 lds
  v_exp_f32 v149, -v149
  v_exp_f32 v150, -v150
  v_mfma_f32_16x16x32_bf16 v[68:71], v[92:95], a[156:159], v[68:71]
  ds_read_b128 a[188:191], v105 offset:11264
  v_exp_f32 v151, -v151
  s_waitcnt lgkmcnt(10)
  v_mfma_f32_16x16x32_bf16 v[56:59], v[32:35], a[160:163], v[56:59]
  ds_read_b64_tr_b16 v[88:89], v103 offset:8192
  ds_read_b128 a[192:195], v105 offset:12288
  buffer_load_dwordx4 v100, s[36:39], s58 offen offset:1024 lds
  v_fma_f32 v148, v148, s48, s48
  v_fma_f32 v149, v149, s48, s48
  v_mfma_f32_16x16x32_bf16 v[56:59], v[36:39], a[176:179], v[56:59]
  ds_read_b64_tr_b16 v[90:91], v103 offset:8704
  ds_read_b128 a[208:211], v105 offset:16384
  v_fma_f32 v150, v150, s48, s48
  v_fma_f32 v151, v151, s48, s48
  s_waitcnt lgkmcnt(10)
  v_mfma_f32_16x16x32_bf16 v[60:63], v[32:35], a[164:167], v[60:63]
  ds_read_b64_tr_b16 v[92:93], v103 offset:12288
  ds_read_b128 a[196:199], v105 offset:13312
  buffer_load_dwordx4 v101, s[36:39], s58 offen offset:2048 lds
  v_rcp_f32 v148, v148
  v_mfma_f32_16x16x32_bf16 v[60:63], v[36:39], a[180:183], v[60:63]
  ds_read_b64_tr_b16 v[94:95], v103 offset:12800
  ds_read_b128 a[212:215], v105 offset:17408
  v_rcp_f32 v149, v149
  v_rcp_f32 v150, v150
  s_waitcnt lgkmcnt(11)
  v_mfma_f32_16x16x32_bf16 v[64:67], v[32:35], a[168:171], v[64:67]
  ds_read_b128 a[200:203], v105 offset:14336
  s_add_u32 m0, s63, 73728
  s_add_u32 s58, s65, 221184
  buffer_load_dwordx4 v96, s[36:39], s58 offen offset:0 lds
  v_rcp_f32 v151, v151
  v_mul_f32 v148, v148, v52
  v_mfma_f32_16x16x32_bf16 v[64:67], v[36:39], a[184:187], v[64:67]
  ds_read_b128 a[216:219], v105 offset:18432
  v_mul_f32 v149, v149, v53
  s_waitcnt lgkmcnt(10)
  v_mfma_f32_16x16x32_bf16 v[68:71], v[32:35], a[172:175], v[68:71]
  ds_read_b128 a[204:207], v105 offset:15360
  buffer_load_dwordx4 v97, s[36:39], s58 offen offset:1024 lds
  v_mul_f32 v150, v150, v54
  v_mul_f32 v151, v151, v55
  v_mfma_f32_16x16x32_bf16 v[68:71], v[36:39], a[188:191], v[68:71]
  ds_read_b128 a[220:223], v105 offset:19456
  v_cvt_pk_bf16_f32 v78, v148, v149
  v_cvt_pk_bf16_f32 v79, v150, v151
  s_waitcnt lgkmcnt(8)
  v_mfma_f32_16x16x32_bf16 v[56:59], v[80:83], a[192:195], v[56:59]
  ds_read_b64_tr_b16 v[32:33], v103 offset:16384
  ds_read_b128 a[224:227], v105 offset:20480
  buffer_load_dwordx4 v98, s[36:39], s58 offen offset:2048 lds
  ds_write_b64 v5, v[78:79] offset:3072
  v_mfma_f32_16x16x32_bf16 v[56:59], v[84:87], a[208:211], v[56:59]
  ds_read_b64_tr_b16 v[34:35], v103 offset:16896
  ds_read_b128 a[240:243], v105 offset:24576
  s_waitcnt lgkmcnt(9)
  v_mfma_f32_16x16x32_bf16 v[60:63], v[80:83], a[196:199], v[60:63]
  ds_read_b64_tr_b16 v[36:37], v103 offset:20480
  ds_read_b128 a[228:231], v105 offset:21504
  s_add_u32 m0, s63, 76800
  s_nop 0
  buffer_load_dwordx4 v99, s[36:39], s58 offen offset:0 lds
  v_mfma_f32_16x16x32_bf16 v[60:63], v[84:87], a[212:215], v[60:63]
  ds_read_b64_tr_b16 v[38:39], v103 offset:20992
  ds_read_b128 a[244:247], v105 offset:25600
  s_waitcnt lgkmcnt(11)
  v_mfma_f32_16x16x32_bf16 v[64:67], v[80:83], a[200:203], v[64:67]
  ds_read_b128 a[232:235], v105 offset:22528
  buffer_load_dwordx4 v100, s[36:39], s58 offen offset:1024 lds
  v_mfma_f32_16x16x32_bf16 v[64:67], v[84:87], a[216:219], v[64:67]
  ds_read_b128 a[248:251], v105 offset:26624
  s_waitcnt lgkmcnt(11)
  v_mfma_f32_16x16x32_bf16 v[68:71], v[80:83], a[204:207], v[68:71]
  ds_read_b128 a[236:239], v105 offset:23552
  buffer_load_dwordx4 v101, s[36:39], s58 offen offset:2048 lds
  v_mfma_f32_16x16x32_bf16 v[68:71], v[84:87], a[220:223], v[68:71]
  ds_read_b128 a[252:255], v105 offset:27648
  s_waitcnt vmcnt(6)
  s_waitcnt lgkmcnt(10)
  s_barrier
  s_waitcnt lgkmcnt(8)
  v_mfma_f32_16x16x32_bf16 v[56:59], v[88:91], a[224:227], v[56:59]
  v_add_u32 v103, 0, v102
  ds_read_b128 v[224:227], v105 offset:28672
  s_add_u32 m0, s63, 24576
  s_add_u32 s58, s65, 442368
  buffer_load_dwordx4 v96, s[36:39], s58 offen offset:0 lds
  v_mfma_f32_16x16x32_bf16 v[56:59], v[92:95], a[240:243], v[56:59]
  ds_read_b64_tr_b16 v[80:81], v103 offset:0
  ds_read_b128 v[240:243], v105 offset:32768
  s_waitcnt lgkmcnt(7)
  v_mfma_f32_16x16x32_bf16 v[60:63], v[88:91], a[228:231], v[60:63]
  ds_read_b64_tr_b16 v[82:83], v103 offset:512
  ds_read_b128 v[228:231], v105 offset:29696
  buffer_load_dwordx4 v97, s[36:39], s58 offen offset:1024 lds
  v_mfma_f32_16x16x32_bf16 v[60:63], v[92:95], a[244:247], v[60:63]
  ds_read_b64_tr_b16 v[84:85], v103 offset:4096
  ds_read_b128 v[244:247], v105 offset:33792
  s_waitcnt lgkmcnt(9)
  v_mfma_f32_16x16x32_bf16 v[64:67], v[88:91], a[232:235], v[64:67]
  ds_read_b64_tr_b16 v[86:87], v103 offset:4608
  ds_read_b128 v[232:235], v105 offset:30720
  buffer_load_dwordx4 v98, s[36:39], s58 offen offset:2048 lds
  v_mfma_f32_16x16x32_bf16 v[64:67], v[92:95], a[248:251], v[64:67]
  ds_read_b128 v[248:251], v105 offset:34816
  s_waitcnt lgkmcnt(10)
  v_mfma_f32_16x16x32_bf16 v[68:71], v[88:91], a[236:239], v[68:71]
  ds_read_b128 v[236:239], v105 offset:31744
  s_add_u32 m0, s63, 27648
  s_nop 0
  buffer_load_dwordx4 v99, s[36:39], s58 offen offset:0 lds
  v_mfma_f32_16x16x32_bf16 v[68:71], v[92:95], a[252:255], v[68:71]
  ds_read_b128 v[252:255], v105 offset:35840
  s_waitcnt lgkmcnt(9)
  v_mfma_f32_16x16x32_bf16 v[56:59], v[32:35], v[224:227], v[56:59]
  ds_read_b64_tr_b16 v[88:89], v103 offset:8192
  buffer_load_dwordx4 v100, s[36:39], s58 offen offset:1024 lds
  v_mfma_f32_16x16x32_bf16 v[56:59], v[36:39], v[240:243], v[56:59]
  ds_read_b64_tr_b16 v[90:91], v103 offset:8704
  s_waitcnt lgkmcnt(7)
  v_mfma_f32_16x16x32_bf16 v[60:63], v[32:35], v[228:231], v[60:63]
  ds_read_b64_tr_b16 v[92:93], v103 offset:12288
  buffer_load_dwordx4 v101, s[36:39], s58 offen offset:2048 lds
  v_mfma_f32_16x16x32_bf16 v[60:63], v[36:39], v[244:247], v[60:63]
  ds_read_b64_tr_b16 v[94:95], v103 offset:12800
  s_waitcnt lgkmcnt(6)
  v_mfma_f32_16x16x32_bf16 v[64:67], v[32:35], v[232:235], v[64:67]
  s_add_u32 m0, s63, 98304
  s_add_u32 s58, s64, 0
  buffer_load_dwordx4 v96, s[36:39], s58 offen offset:0 lds
  v_mfma_f32_16x16x32_bf16 v[64:67], v[36:39], v[248:251], v[64:67]
  s_waitcnt lgkmcnt(4)
  v_mfma_f32_16x16x32_bf16 v[68:71], v[32:35], v[236:239], v[68:71]
  buffer_load_dwordx4 v97, s[36:39], s58 offen offset:1024 lds
  v_mfma_f32_16x16x32_bf16 v[68:71], v[36:39], v[252:255], v[68:71]
  v_and_b32 v5, 7, v1
  v_cmp_eq_u32 vcc, s51, v5
  v_xor_b32 v30, 1, v5
  s_nop 0
  v_cndmask_b32 v5, v5, v30, vcc
  v_lshlrev_b32 v5, 7, v5
  v_mfma_f32_16x16x32_bf16 v[40:43], v[80:83], a[0:3], 0
  ds_read_b64_tr_b16 v[32:33], v103 offset:16384
  s_add_u32 s62, s56, 524288
  s_add_u32 s46, s51, 3
  buffer_load_dwordx4 v98, s[36:39], s58 offen offset:2048 lds
  v_mfma_f32_16x16x32_bf16 v[40:43], v[84:87], a[16:19], v[40:43]
  ds_read_b64_tr_b16 v[34:35], v103 offset:16896
  s_and_b32 s46, s46, 7
  s_lshl_b32 s46, s46, 7
  v_mfma_f32_16x16x32_bf16 v[44:47], v[80:83], a[4:7], 0
  ds_read_b64_tr_b16 v[36:37], v103 offset:20480
  s_add_u32 s65, s55, s46
  s_add_u32 m0, s63, 101376
  s_nop 0
  buffer_load_dwordx4 v99, s[36:39], s58 offen offset:0 lds
  v_mfma_f32_16x16x32_bf16 v[44:47], v[84:87], a[20:23], v[44:47]
  ds_read_b64_tr_b16 v[38:39], v103 offset:20992
  v_mfma_f32_16x16x32_bf16 v[48:51], v[80:83], a[8:11], 0
  buffer_load_dwordx4 v100, s[36:39], s58 offen offset:1024 lds
  v_cvt_pk_bf16_f32 v72, v56, v57
  v_mfma_f32_16x16x32_bf16 v[48:51], v[84:87], a[24:27], v[48:51]
  v_cvt_pk_bf16_f32 v73, v58, v59
  v_cvt_pk_bf16_f32 v74, v60, v61
  v_mfma_f32_16x16x32_bf16 v[52:55], v[80:83], a[12:15], 0
  buffer_load_dwordx4 v101, s[36:39], s58 offen offset:2048 lds
  v_cvt_pk_bf16_f32 v75, v62, v63
  v_mfma_f32_16x16x32_bf16 v[52:55], v[84:87], a[28:31], v[52:55]
  v_cvt_pk_bf16_f32 v76, v64, v65
  v_cvt_pk_bf16_f32 v77, v66, v67
  s_waitcnt vmcnt(12)
  s_barrier
  s_waitcnt lgkmcnt(4)
  v_mfma_f32_16x16x32_bf16 v[40:43], v[88:91], a[32:35], v[40:43]
  v_add_u32 v103, 73728, v102
  s_add_u32 m0, s63, 49152
  s_add_u32 s58, s64, 221184
  buffer_load_dwordx4 v96, s[36:39], s58 offen offset:0 lds
  v_mfma_f32_16x16x32_bf16 v[40:43], v[92:95], a[48:51], v[40:43]
  ds_read_b64_tr_b16 v[80:81], v103 offset:0
  v_cvt_pk_bf16_f32 v78, v68, v69
  v_mfma_f32_16x16x32_bf16 v[44:47], v[88:91], a[36:39], v[44:47]
  ds_read_b64_tr_b16 v[82:83], v103 offset:512
  buffer_load_dwordx4 v97, s[36:39], s58 offen offset:1024 lds
  v_mfma_f32_16x16x32_bf16 v[44:47], v[92:95], a[52:55], v[44:47]
  ds_read_b64_tr_b16 v[84:85], v103 offset:4096
  v_cvt_pk_bf16_f32 v79, v70, v71
  v_mfma_f32_16x16x32_bf16 v[48:51], v[88:91], a[40:43], v[48:51]
  ds_read_b64_tr_b16 v[86:87], v103 offset:4608
  buffer_load_dwordx4 v98, s[36:39], s58 offen offset:2048 lds
  v_mfma_f32_16x16x32_bf16 v[48:51], v[92:95], a[56:59], v[48:51]
  buffer_store_dwordx4 v[72:75], v4, s[28:31], s62 offen offset:0 sc1
  buffer_store_dwordx4 v[76:79], v4, s[28:31], s62 offen offset:1024 sc1
  v_mfma_f32_16x16x32_bf16 v[52:55], v[88:91], a[44:47], v[52:55]
  s_add_u32 m0, s63, 52224
  s_nop 0
  buffer_load_dwordx4 v99, s[36:39], s58 offen offset:0 lds
  v_mfma_f32_16x16x32_bf16 v[52:55], v[92:95], a[60:63], v[52:55]
  s_waitcnt lgkmcnt(4)
  v_mfma_f32_16x16x32_bf16 v[40:43], v[32:35], a[64:67], v[40:43]
  ds_read_b64_tr_b16 v[88:89], v103 offset:8192
  buffer_load_dwordx4 v100, s[36:39], s58 offen offset:1024 lds
  v_mfma_f32_16x16x32_bf16 v[40:43], v[36:39], a[80:83], v[40:43]
  ds_read_b64_tr_b16 v[90:91], v103 offset:8704
  v_mfma_f32_16x16x32_bf16 v[44:47], v[32:35], a[68:71], v[44:47]
  ds_read_b64_tr_b16 v[92:93], v103 offset:12288
  buffer_load_dwordx4 v101, s[36:39], s58 offen offset:2048 lds
  v_mfma_f32_16x16x32_bf16 v[44:47], v[36:39], a[84:87], v[44:47]
  ds_read_b64_tr_b16 v[94:95], v103 offset:12800
  v_mfma_f32_16x16x32_bf16 v[48:51], v[32:35], a[72:75], v[48:51]
  s_add_u32 m0, s63, 122880
  s_add_u32 s58, s64, 442368
  buffer_load_dwordx4 v96, s[36:39], s58 offen offset:0 lds
  v_mfma_f32_16x16x32_bf16 v[48:51], v[36:39], a[88:91], v[48:51]
  v_mfma_f32_16x16x32_bf16 v[52:55], v[32:35], a[76:79], v[52:55]
  buffer_load_dwordx4 v97, s[36:39], s58 offen offset:1024 lds
  v_mfma_f32_16x16x32_bf16 v[52:55], v[36:39], a[92:95], v[52:55]
  s_waitcnt lgkmcnt(4)
  v_mfma_f32_16x16x32_bf16 v[40:43], v[80:83], a[96:99], v[40:43]
  ds_read_b64_tr_b16 v[32:33], v103 offset:16384
  buffer_load_dwordx4 v98, s[36:39], s58 offen offset:2048 lds
  v_mfma_f32_16x16x32_bf16 v[40:43], v[84:87], a[112:115], v[40:43]
  ds_read_b64_tr_b16 v[34:35], v103 offset:16896
  v_mfma_f32_16x16x32_bf16 v[44:47], v[80:83], a[100:103], v[44:47]
  ds_read_b64_tr_b16 v[36:37], v103 offset:20480
  s_add_u32 m0, s63, 125952
  s_nop 0
  buffer_load_dwordx4 v99, s[36:39], s58 offen offset:0 lds
  v_mfma_f32_16x16x32_bf16 v[44:47], v[84:87], a[116:119], v[44:47]
  ds_read_b64_tr_b16 v[38:39], v103 offset:20992
  v_mfma_f32_16x16x32_bf16 v[48:51], v[80:83], a[104:107], v[48:51]
  buffer_load_dwordx4 v100, s[36:39], s58 offen offset:1024 lds
  v_mfma_f32_16x16x32_bf16 v[48:51], v[84:87], a[120:123], v[48:51]
  v_mfma_f32_16x16x32_bf16 v[52:55], v[80:83], a[108:111], v[52:55]
  buffer_load_dwordx4 v101, s[36:39], s58 offen offset:2048 lds
  v_mfma_f32_16x16x32_bf16 v[52:55], v[84:87], a[124:127], v[52:55]
  s_waitcnt vmcnt(18)
  s_barrier
  s_waitcnt lgkmcnt(4)
  v_mfma_f32_16x16x32_bf16 v[40:43], v[88:91], a[128:131], v[40:43]
  v_add_u32 v103, 24576, v102
  s_add_u32 m0, s63, 0
  s_add_u32 s58, s65, 0
  buffer_load_dwordx4 v96, s[36:39], s58 offen offset:0 lds
  v_mfma_f32_16x16x32_bf16 v[40:43], v[92:95], a[144:147], v[40:43]
  ds_read_b64_tr_b16 v[80:81], v103 offset:0
  v_mfma_f32_16x16x32_bf16 v[44:47], v[88:91], a[132:135], v[44:47]
  ds_read_b64_tr_b16 v[82:83], v103 offset:512
  v_mfma_f32_16x16x32_bf16 v[44:47], v[92:95], a[148:151], v[44:47]
  ds_read_b64_tr_b16 v[84:85], v103 offset:4096
  v_mfma_f32_16x16x32_bf16 v[48:51], v[88:91], a[136:139], v[48:51]
  ds_read_b64_tr_b16 v[86:87], v103 offset:4608
  buffer_load_dwordx4 v97, s[36:39], s58 offen offset:1024 lds
  v_mfma_f32_16x16x32_bf16 v[48:51], v[92:95], a[152:155], v[48:51]
  v_mfma_f32_16x16x32_bf16 v[52:55], v[88:91], a[140:143], v[52:55]
  v_mfma_f32_16x16x32_bf16 v[52:55], v[92:95], a[156:159], v[52:55]
  s_waitcnt lgkmcnt(4)
  v_mfma_f32_16x16x32_bf16 v[40:43], v[32:35], a[160:163], v[40:43]
  ds_read_b64_tr_b16 v[88:89], v103 offset:8192
  buffer_load_dwordx4 v98, s[36:39], s58 offen offset:2048 lds
  v_mfma_f32_16x16x32_bf16 v[40:43], v[36:39], a[176:179], v[40:43]
  ds_read_b64_tr_b16 v[90:91], v103 offset:8704
  v_mfma_f32_16x16x32_bf16 v[44:47], v[32:35], a[164:167], v[44:47]
  ds_read_b64_tr_b16 v[92:93], v103 offset:12288
  v_mfma_f32_16x16x32_bf16 v[44:47], v[36:39], a[180:183], v[44:47]
  ds_read_b64_tr_b16 v[94:95], v103 offset:12800
  v_mfma_f32_16x16x32_bf16 v[48:51], v[32:35], a[168:171], v[48:51]
  s_add_u32 m0, s63, 3072
  s_nop 0
  buffer_load_dwordx4 v99, s[36:39], s58 offen offset:0 lds
  v_mfma_f32_16x16x32_bf16 v[48:51], v[36:39], a[184:187], v[48:51]
  v_mfma_f32_16x16x32_bf16 v[52:55], v[32:35], a[172:175], v[52:55]
  v_mfma_f32_16x16x32_bf16 v[52:55], v[36:39], a[188:191], v[52:55]
  s_waitcnt lgkmcnt(4)
  v_mfma_f32_16x16x32_bf16 v[40:43], v[80:83], a[192:195], v[40:43]
  ds_read_b64_tr_b16 v[32:33], v103 offset:16384
  buffer_load_dwordx4 v100, s[36:39], s58 offen offset:1024 lds
  v_mfma_f32_16x16x32_bf16 v[40:43], v[84:87], a[208:211], v[40:43]
  ds_read_b64_tr_b16 v[34:35], v103 offset:16896
  v_mfma_f32_16x16x32_bf16 v[44:47], v[80:83], a[196:199], v[44:47]
  ds_read_b64_tr_b16 v[36:37], v103 offset:20480
  v_mfma_f32_16x16x32_bf16 v[44:47], v[84:87], a[212:215], v[44:47]
  ds_read_b64_tr_b16 v[38:39], v103 offset:20992
  v_mfma_f32_16x16x32_bf16 v[48:51], v[80:83], a[200:203], v[48:51]
  buffer_load_dwordx4 v101, s[36:39], s58 offen offset:2048 lds
  v_mfma_f32_16x16x32_bf16 v[48:51], v[84:87], a[216:219], v[48:51]
  v_mfma_f32_16x16x32_bf16 v[52:55], v[80:83], a[204:207], v[52:55]
  v_mfma_f32_16x16x32_bf16 v[52:55], v[84:87], a[220:223], v[52:55]
  s_waitcnt vmcnt(18)
  s_barrier
  s_waitcnt lgkmcnt(4)
  v_mfma_f32_16x16x32_bf16 v[40:43], v[88:91], a[224:227], v[40:43]
  v_add_u32 v103, 98304, v102
  s_add_u32 m0, s63, 73728
  s_add_u32 s58, s65, 221184
  buffer_load_dwordx4 v96, s[36:39], s58 offen offset:0 lds
  v_mfma_f32_16x16x32_bf16 v[40:43], v[92:95], a[240:243], v[40:43]
  ds_read_b64_tr_b16 v[80:81], v103 offset:0
  v_mfma_f32_16x16x32_bf16 v[44:47], v[88:91], a[228:231], v[44:47]
  ds_read_b64_tr_b16 v[82:83], v103 offset:512
  v_mfma_f32_16x16x32_bf16 v[44:47], v[92:95], a[244:247], v[44:47]
  ds_read_b64_tr_b16 v[84:85], v103 offset:4096
  v_mfma_f32_16x16x32_bf16 v[48:51], v[88:91], a[232:235], v[48:51]
  ds_read_b64_tr_b16 v[86:87], v103 offset:4608
  buffer_load_dwordx4 v97, s[36:39], s58 offen offset:1024 lds
  v_mfma_f32_16x16x32_bf16 v[48:51], v[92:95], a[248:251], v[48:51]
  v_mfma_f32_16x16x32_bf16 v[52:55], v[88:91], a[236:239], v[52:55]
  v_mfma_f32_16x16x32_bf16 v[52:55], v[92:95], a[252:255], v[52:55]
  s_waitcnt lgkmcnt(4)
  v_mfma_f32_16x16x32_bf16 v[40:43], v[32:35], v[224:227], v[40:43]
  ds_read_b64_tr_b16 v[88:89], v103 offset:8192
  buffer_load_dwordx4 v98, s[36:39], s58 offen offset:2048 lds
  v_mfma_f32_16x16x32_bf16 v[40:43], v[36:39], v[240:243], v[40:43]
  ds_read_b64_tr_b16 v[90:91], v103 offset:8704
  v_mfma_f32_16x16x32_bf16 v[44:47], v[32:35], v[228:231], v[44:47]
  ds_read_b64_tr_b16 v[92:93], v103 offset:12288
  v_mfma_f32_16x16x32_bf16 v[44:47], v[36:39], v[244:247], v[44:47]
  ds_read_b64_tr_b16 v[94:95], v103 offset:12800
  v_mfma_f32_16x16x32_bf16 v[48:51], v[32:35], v[232:235], v[48:51]
  s_add_u32 m0, s63, 76800
  s_nop 0
  buffer_load_dwordx4 v99, s[36:39], s58 offen offset:0 lds
  v_mfma_f32_16x16x32_bf16 v[48:51], v[36:39], v[248:251], v[48:51]
  v_mfma_f32_16x16x32_bf16 v[52:55], v[32:35], v[236:239], v[52:55]
  v_mfma_f32_16x16x32_bf16 v[52:55], v[36:39], v[252:255], v[52:55]
  s_mov_b32 s71, 2
L_p6_b:
  s_waitcnt lgkmcnt(4)
  v_mfma_f32_16x16x32_bf16 v[56:59], v[80:83], a[0:3], 0
  ds_read_b64_tr_b16 v[32:33], v103 offset:16384
  s_sub_u32 s72, s71, 1
  s_add_u32 s46, s51, s72
  s_and_b32 s46, s46, 7
  s_lshl_b32 s46, s46, 16
  buffer_load_dwordx4 v100, s[36:39], s58 offen offset:1024 lds
  v_mfma_f32_16x16x32_bf16 v[56:59], v[84:87], a[16:19], v[56:59]
  ds_read_b64_tr_b16 v[34:35], v103 offset:16896
  s_add_u32 s62, s46, s56
  s_add_u32 s72, s71, 2
  s_add_u32 s46, s51, s72
  v_mfma_f32_16x16x32_bf16 v[60:63], v[80:83], a[4:7], 0
  ds_read_b64_tr_b16 v[36:37], v103 offset:20480
  s_and_b32 s46, s46, 7
  s_lshl_b32 s46, s46, 7
  s_add_u32 s64, s55, s46
  v_mfma_f32_16x16x32_bf16 v[60:63], v[84:87], a[20:23], v[60:63]
  ds_read_b64_tr_b16 v[38:39], v103 offset:20992
  v_mfma_f32_16x16x32_bf16 v[64:67], v[80:83], a[8:11], 0
  buffer_load_dwordx4 v101, s[36:39], s58 offen offset:2048 lds
  v_cvt_pk_bf16_f32 v74, v40, v41
  v_mfma_f32_16x16x32_bf16 v[64:67], v[84:87], a[24:27], v[64:67]
  v_cvt_pk_bf16_f32 v75, v42, v43
  v_cvt_pk_bf16_f32 v72, v44, v45
  v_mfma_f32_16x16x32_bf16 v[68:71], v[80:83], a[12:15], 0
  v_cvt_pk_bf16_f32 v73, v46, v47
  v_cvt_pk_bf16_f32 v78, v48, v49
  v_mfma_f32_16x16x32_bf16 v[68:71], v[84:87], a[28:31], v[68:71]
  v_cvt_pk_bf16_f32 v79, v50, v51
  v_cvt_pk_bf16_f32 v76, v52, v53
  s_waitcnt vmcnt(18)
  s_barrier
  s_waitcnt lgkmcnt(4)
  v_mfma_f32_16x16x32_bf16 v[56:59], v[88:91], a[32:35], v[56:59]
  v_add_u32 v103, 49152, v102
  s_add_u32 m0, s63, 24576
  s_add_u32 s58, s65, 442368
  buffer_load_dwordx4 v96, s[36:39], s58 offen offset:0 lds
  v_mfma_f32_16x16x32_bf16 v[56:59], v[92:95], a[48:51], v[56:59]
  ds_read_b64_tr_b16 v[80:81], v103 offset:0
  v_cvt_pk_bf16_f32 v77, v54, v55
  v_mfma_f32_16x16x32_bf16 v[60:63], v[88:91], a[36:39], v[60:63]
  ds_read_b64_tr_b16 v[82:83], v103 offset:512
  buffer_store_dwordx4 v[72:75], v4, s[28:31], s62 offen offset:0 sc1
  v_mfma_f32_16x16x32_bf16 v[60:63], v[92:95], a[52:55], v[60:63]
  ds_read_b64_tr_b16 v[84:85], v103 offset:4096
  buffer_store_dwordx4 v[76:79], v4, s[28:31], s62 offen offset:1024 sc1
  v_mfma_f32_16x16x32_bf16 v[64:67], v[88:91], a[40:43], v[64:67]
  ds_read_b64_tr_b16 v[86:87], v103 offset:4608
  buffer_load_dwordx4 v97, s[36:39], s58 offen offset:1024 lds
  v_mfma_f32_16x16x32_bf16 v[64:67], v[92:95], a[56:59], v[64:67]
  v_mfma_f32_16x16x32_bf16 v[68:71], v[88:91], a[44:47], v[68:71]
  v_mfma_f32_16x16x32_bf16 v[68:71], v[92:95], a[60:63], v[68:71]
  s_waitcnt lgkmcnt(4)
  v_mfma_f32_16x16x32_bf16 v[56:59], v[32:35], a[64:67], v[56:59]
  ds_read_b64_tr_b16 v[88:89], v103 offset:8192
  buffer_load_dwordx4 v98, s[36:39], s58 offen offset:2048 lds
  v_mfma_f32_16x16x32_bf16 v[56:59], v[36:39], a[80:83], v[56:59]
  ds_read_b64_tr_b16 v[90:91], v103 offset:8704
  v_mfma_f32_16x16x32_bf16 v[60:63], v[32:35], a[68:71], v[60:63]
  ds_read_b64_tr_b16 v[92:93], v103 offset:12288
  v_mfma_f32_16x16x32_bf16 v[60:63], v[36:39], a[84:87], v[60:63]
  ds_read_b64_tr_b16 v[94:95], v103 offset:12800
  v_mfma_f32_16x16x32_bf16 v[64:67], v[32:35], a[72:75], v[64:67]
  s_add_u32 m0, s63, 27648
  s_nop 0
  buffer_load_dwordx4 v99, s[36:39], s58 offen offset:0 lds
  v_mfma_f32_16x16x32_bf16 v[64:67], v[36:39], a[88:91], v[64:67]
  v_mfma_f32_16x16x32_bf16 v[68:71], v[32:35], a[76:79], v[68:71]
  v_mfma_f32_16x16x32_bf16 v[68:71], v[36:39], a[92:95], v[68:71]
  s_waitcnt lgkmcnt(4)
  v_mfma_f32_16x16x32_bf16 v[56:59], v[80:83], a[96:99], v[56:59]
  ds_read_b64_tr_b16 v[32:33], v103 offset:16384
  buffer_load_dwordx4 v100, s[36:39], s58 offen offset:1024 lds
  v_mfma_f32_16x16x32_bf16 v[56:59], v[84:87], a[112:115], v[56:59]
  ds_read_b64_tr_b16 v[34:35], v103 offset:16896
  v_mfma_f32_16x16x32_bf16 v[60:63], v[80:83], a[100:103], v[60:63]
  ds_read_b64_tr_b16 v[36:37], v103 offset:20480
  v_mfma_f32_16x16x32_bf16 v[60:63], v[84:87], a[116:119], v[60:63]
  ds_read_b64_tr_b16 v[38:39], v103 offset:20992
  v_mfma_f32_16x16x32_bf16 v[64:67], v[80:83], a[104:107], v[64:67]
  buffer_load_dwordx4 v101, s[36:39], s58 offen offset:2048 lds
  v_mfma_f32_16x16x32_bf16 v[64:67], v[84:87], a[120:123], v[64:67]
  v_mfma_f32_16x16x32_bf16 v[68:71], v[80:83], a[108:111], v[68:71]
  v_mfma_f32_16x16x32_bf16 v[68:71], v[84:87], a[124:127], v[68:71]
  s_waitcnt vmcnt(18)
  s_barrier
  s_waitcnt lgkmcnt(4)
  v_mfma_f32_16x16x32_bf16 v[56:59], v[88:91], a[128:131], v[56:59]
  v_add_u32 v103, 122880, v102
  s_add_u32 m0, s63, 98304
  s_add_u32 s58, s64, 0
  buffer_load_dwordx4 v96, s[36:39], s58 offen offset:0 lds
  v_mfma_f32_16x16x32_bf16 v[56:59], v[92:95], a[144:147], v[56:59]
  ds_read_b64_tr_b16 v[80:81], v103 offset:0
  v_mfma_f32_16x16x32_bf16 v[60:63], v[88:91], a[132:135], v[60:63]
  ds_read_b64_tr_b16 v[82:83], v103 offset:512
  v_mfma_f32_16x16x32_bf16 v[60:63], v[92:95], a[148:151], v[60:63]
  ds_read_b64_tr_b16 v[84:85], v103 offset:4096
  v_mfma_f32_16x16x32_bf16 v[64:67], v[88:91], a[136:139], v[64:67]
  ds_read_b64_tr_b16 v[86:87], v103 offset:4608
  buffer_load_dwordx4 v97, s[36:39], s58 offen offset:1024 lds
  v_mfma_f32_16x16x32_bf16 v[64:67], v[92:95], a[152:155], v[64:67]
  v_mfma_f32_16x16x32_bf16 v[68:71], v[88:91], a[140:143], v[68:71]
  v_mfma_f32_16x16x32_bf16 v[68:71], v[92:95], a[156:159], v[68:71]
  s_waitcnt lgkmcnt(4)
  v_mfma_f32_16x16x32_bf16 v[56:59], v[32:35], a[160:163], v[56:59]
  ds_read_b64_tr_b16 v[88:89], v103 offset:8192
  buffer_load_dwordx4 v98, s[36:39], s58 offen offset:2048 lds
  v_mfma_f32_16x16x32_bf16 v[56:59], v[36:39], a[176:179], v[56:59]
  ds_read_b64_tr_b16 v[90:91], v103 offset:8704
  v_mfma_f32_16x16x32_bf16 v[60:63], v[32:35], a[164:167], v[60:63]
  ds_read_b64_tr_b16 v[92:93], v103 offset:12288
  v_mfma_f32_16x16x32_bf16 v[60:63], v[36:39], a[180:183], v[60:63]
  ds_read_b64_tr_b16 v[94:95], v103 offset:12800
  v_mfma_f32_16x16x32_bf16 v[64:67], v[32:35], a[168:171], v[64:67]
  s_add_u32 m0, s63, 101376
  s_nop 0
  buffer_load_dwordx4 v99, s[36:39], s58 offen offset:0 lds
  v_mfma_f32_16x16x32_bf16 v[64:67], v[36:39], a[184:187], v[64:67]
  v_mfma_f32_16x16x32_bf16 v[68:71], v[32:35], a[172:175], v[68:71]
  v_mfma_f32_16x16x32_bf16 v[68:71], v[36:39], a[188:191], v[68:71]
  s_waitcnt lgkmcnt(4)
  v_mfma_f32_16x16x32_bf16 v[56:59], v[80:83], a[192:195], v[56:59]
  ds_read_b64_tr_b16 v[32:33], v103 offset:16384
  buffer_load_dwordx4 v100, s[36:39], s58 offen offset:1024 lds
  v_mfma_f32_16x16x32_bf16 v[56:59], v[84:87], a[208:211], v[56:59]
  ds_read_b64_tr_b16 v[34:35], v103 offset:16896
  v_mfma_f32_16x16x32_bf16 v[60:63], v[80:83], a[196:199], v[60:63]
  ds_read_b64_tr_b16 v[36:37], v103 offset:20480
  v_mfma_f32_16x16x32_bf16 v[60:63], v[84:87], a[212:215], v[60:63]
  ds_read_b64_tr_b16 v[38:39], v103 offset:20992
  v_mfma_f32_16x16x32_bf16 v[64:67], v[80:83], a[200:203], v[64:67]
  buffer_load_dwordx4 v101, s[36:39], s58 offen offset:2048 lds
  v_mfma_f32_16x16x32_bf16 v[64:67], v[84:87], a[216:219], v[64:67]
  v_mfma_f32_16x16x32_bf16 v[68:71], v[80:83], a[204:207], v[68:71]
  v_mfma_f32_16x16x32_bf16 v[68:71], v[84:87], a[220:223], v[68:71]
  s_waitcnt vmcnt(18)
  s_barrier
  s_waitcnt lgkmcnt(4)
  v_mfma_f32_16x16x32_bf16 v[56:59], v[88:91], a[224:227], v[56:59]
  v_add_u32 v103, 0, v102
  s_add_u32 m0, s63, 49152
  s_add_u32 s58, s64, 221184
  buffer_load_dwordx4 v96, s[36:39], s58 offen offset:0 lds
  v_mfma_f32_16x16x32_bf16 v[56:59], v[92:95], a[240:243], v[56:59]
  ds_read_b64_tr_b16 v[80:81], v103 offset:0
  v_mfma_f32_16x16x32_bf16 v[60:63], v[88:91], a[228:231], v[60:63]
  ds_read_b64_tr_b16 v[82:83], v103 offset:512
  v_mfma_f32_16x16x32_bf16 v[60:63], v[92:95], a[244:247], v[60:63]
  ds_read_b64_tr_b16 v[84:85], v103 offset:4096
  v_mfma_f32_16x16x32_bf16 v[64:67], v[88:91], a[232:235], v[64:67]
  ds_read_b64_tr_b16 v[86:87], v103 offset:4608
  buffer_load_dwordx4 v97, s[36:39], s58 offen offset:1024 lds
  v_mfma_f32_16x16x32_bf16 v[64:67], v[92:95], a[248:251], v[64:67]
  v_mfma_f32_16x16x32_bf16 v[68:71], v[88:91], a[236:239], v[68:71]
  v_mfma_f32_16x16x32_bf16 v[68:71], v[92:95], a[252:255], v[68:71]
  s_waitcnt lgkmcnt(4)
  v_mfma_f32_16x16x32_bf16 v[56:59], v[32:35], v[224:227], v[56:59]
  ds_read_b64_tr_b16 v[88:89], v103 offset:8192
  buffer_load_dwordx4 v98, s[36:39], s58 offen offset:2048 lds
  v_mfma_f32_16x16x32_bf16 v[56:59], v[36:39], v[240:243], v[56:59]
  ds_read_b64_tr_b16 v[90:91], v103 offset:8704
  v_mfma_f32_16x16x32_bf16 v[60:63], v[32:35], v[228:231], v[60:63]
  ds_read_b64_tr_b16 v[92:93], v103 offset:12288
  v_mfma_f32_16x16x32_bf16 v[60:63], v[36:39], v[244:247], v[60:63]
  ds_read_b64_tr_b16 v[94:95], v103 offset:12800
  v_mfma_f32_16x16x32_bf16 v[64:67], v[32:35], v[232:235], v[64:67]
  s_add_u32 m0, s63, 52224
  s_nop 0
  buffer_load_dwordx4 v99, s[36:39], s58 offen offset:0 lds
  v_mfma_f32_16x16x32_bf16 v[64:67], v[36:39], v[248:251], v[64:67]
  v_mfma_f32_16x16x32_bf16 v[68:71], v[32:35], v[236:239], v[68:71]
  v_mfma_f32_16x16x32_bf16 v[68:71], v[36:39], v[252:255], v[68:71]
  s_waitcnt lgkmcnt(4)
  v_mfma_f32_16x16x32_bf16 v[40:43], v[80:83], a[0:3], 0
  ds_read_b64_tr_b16 v[32:33], v103 offset:16384
  s_add_u32 s46, s51, s71
  s_and_b32 s46, s46, 7
  s_lshl_b32 s46, s46, 16
  buffer_load_dwordx4 v100, s[36:39], s58 offen offset:1024 lds
  v_mfma_f32_16x16x32_bf16 v[40:43], v[84:87], a[16:19], v[40:43]
  ds_read_b64_tr_b16 v[34:35], v103 offset:16896
  s_add_u32 s62, s46, s56
  s_add_u32 s72, s71, 3
  s_add_u32 s46, s51, s72
  v_mfma_f32_16x16x32_bf16 v[44:47], v[80:83], a[4:7], 0
  ds_read_b64_tr_b16 v[36:37], v103 offset:20480
  s_and_b32 s46, s46, 7
  s_lshl_b32 s46, s46, 7
  s_add_u32 s65, s55, s46
  v_mfma_f32_16x16x32_bf16 v[44:47], v[84:87], a[20:23], v[44:47]
  ds_read_b64_tr_b16 v[38:39], v103 offset:20992
  v_mfma_f32_16x16x32_bf16 v[48:51], v[80:83], a[8:11], 0
  buffer_load_dwordx4 v101, s[36:39], s58 offen offset:2048 lds
  v_cvt_pk_bf16_f32 v72, v56, v57
  v_mfma_f32_16x16x32_bf16 v[48:51], v[84:87], a[24:27], v[48:51]
  v_cvt_pk_bf16_f32 v73, v58, v59
  v_cvt_pk_bf16_f32 v74, v60, v61
  v_mfma_f32_16x16x32_bf16 v[52:55], v[80:83], a[12:15], 0
  v_cvt_pk_bf16_f32 v75, v62, v63
  v_cvt_pk_bf16_f32 v76, v64, v65
  v_mfma_f32_16x16x32_bf16 v[52:55], v[84:87], a[28:31], v[52:55]
  v_cvt_pk_bf16_f32 v77, v66, v67
  v_cvt_pk_bf16_f32 v78, v68, v69
  s_waitcnt vmcnt(18)
  s_barrier
  s_waitcnt lgkmcnt(4)
  v_mfma_f32_16x16x32_bf16 v[40:43], v[88:91], a[32:35], v[40:43]
  v_add_u32 v103, 73728, v102
  s_add_u32 m0, s63, 122880
  s_add_u32 s58, s64, 442368
  buffer_load_dwordx4 v96, s[36:39], s58 offen offset:0 lds
  v_mfma_f32_16x16x32_bf16 v[40:43], v[92:95], a[48:51], v[40:43]
  ds_read_b64_tr_b16 v[80:81], v103 offset:0
  v_cvt_pk_bf16_f32 v79, v70, v71
  v_mfma_f32_16x16x32_bf16 v[44:47], v[88:91], a[36:39], v[44:47]
  ds_read_b64_tr_b16 v[82:83], v103 offset:512
  buffer_store_dwordx4 v[72:75], v4, s[28:31], s62 offen offset:0 sc1
  v_mfma_f32_16x16x32_bf16 v[44:47], v[92:95], a[52:55], v[44:47]
  ds_read_b64_tr_b16 v[84:85], v103 offset:4096
  buffer_store_dwordx4 v[76:79], v4, s[28:31], s62 offen offset:1024 sc1
  v_mfma_f32_16x16x32_bf16 v[48:51], v[88:91], a[40:43], v[48:51]
  ds_read_b64_tr_b16 v[86:87], v103 offset:4608
  buffer_load_dwordx4 v97, s[36:39], s58 offen offset:1024 lds
  v_mfma_f32_16x16x32_bf16 v[48:51], v[92:95], a[56:59], v[48:51]
  v_mfma_f32_16x16x32_bf16 v[52:55], v[88:91], a[44:47], v[52:55]
  v_mfma_f32_16x16x32_bf16 v[52:55], v[92:95], a[60:63], v[52:55]
  s_waitcnt lgkmcnt(4)
  v_mfma_f32_16x16x32_bf16 v[40:43], v[32:35], a[64:67], v[40:43]
  ds_read_b64_tr_b16 v[88:89], v103 offset:8192
  buffer_load_dwordx4 v98, s[36:39], s58 offen offset:2048 lds
  v_mfma_f32_16x16x32_bf16 v[40:43], v[36:39], a[80:83], v[40:43]
  ds_read_b64_tr_b16 v[90:91], v103 offset:8704
  v_mfma_f32_16x16x32_bf16 v[44:47], v[32:35], a[68:71], v[44:47]
  ds_read_b64_tr_b16 v[92:93], v103 offset:12288
  v_mfma_f32_16x16x32_bf16 v[44:47], v[36:39], a[84:87], v[44:47]
  ds_read_b64_tr_b16 v[94:95], v103 offset:12800
  v_mfma_f32_16x16x32_bf16 v[48:51], v[32:35], a[72:75], v[48:51]
  s_add_u32 m0, s63, 125952
  s_nop 0
  buffer_load_dwordx4 v99, s[36:39], s58 offen offset:0 lds
  v_mfma_f32_16x16x32_bf16 v[48:51], v[36:39], a[88:91], v[48:51]
  v_mfma_f32_16x16x32_bf16 v[52:55], v[32:35], a[76:79], v[52:55]
  v_mfma_f32_16x16x32_bf16 v[52:55], v[36:39], a[92:95], v[52:55]
  s_waitcnt lgkmcnt(4)
  v_mfma_f32_16x16x32_bf16 v[40:43], v[80:83], a[96:99], v[40:43]
  ds_read_b64_tr_b16 v[32:33], v103 offset:16384
  buffer_load_dwordx4 v100, s[36:39], s58 offen offset:1024 lds
  v_mfma_f32_16x16x32_bf16 v[40:43], v[84:87], a[112:115], v[40:43]
  ds_read_b64_tr_b16 v[34:35], v103 offset:16896
  v_mfma_f32_16x16x32_bf16 v[44:47], v[80:83], a[100:103], v[44:47]
  ds_read_b64_tr_b16 v[36:37], v103 offset:20480
  v_mfma_f32_16x16x32_bf16 v[44:47], v[84:87], a[116:119], v[44:47]
  ds_read_b64_tr_b16 v[38:39], v103 offset:20992
  v_mfma_f32_16x16x32_bf16 v[48:51], v[80:83], a[104:107], v[48:51]
  buffer_load_dwordx4 v101, s[36:39], s58 offen offset:2048 lds
  v_mfma_f32_16x16x32_bf16 v[48:51], v[84:87], a[120:123], v[48:51]
  v_mfma_f32_16x16x32_bf16 v[52:55], v[80:83], a[108:111], v[52:55]
  v_mfma_f32_16x16x32_bf16 v[52:55], v[84:87], a[124:127], v[52:55]
  s_waitcnt vmcnt(18)
  s_barrier
  s_waitcnt lgkmcnt(4)
  v_mfma_f32_16x16x32_bf16 v[40:43], v[88:91], a[128:131], v[40:43]
  v_add_u32 v103, 24576, v102
  s_add_u32 m0, s63, 0
  s_add_u32 s58, s65, 0
  buffer_load_dwordx4 v96, s[36:39], s58 offen offset:0 lds
  v_mfma_f32_16x16x32_bf16 v[40:43], v[92:95], a[144:147], v[40:43]
  ds_read_b64_tr_b16 v[80:81], v103 offset:0
  v_mfma_f32_16x16x32_bf16 v[44:47], v[88:91], a[132:135], v[44:47]
  ds_read_b64_tr_b16 v[82:83], v103 offset:512
  v_mfma_f32_16x16x32_bf16 v[44:47], v[92:95], a[148:151], v[44:47]
  ds_read_b64_tr_b16 v[84:85], v103 offset:4096
  v_mfma_f32_16x16x32_bf16 v[48:51], v[88:91], a[136:139], v[48:51]
  ds_read_b64_tr_b16 v[86:87], v103 offset:4608
  buffer_load_dwordx4 v97, s[36:39], s58 offen offset:1024 lds
  v_mfma_f32_16x16x32_bf16 v[48:51], v[92:95], a[152:155], v[48:51]
  v_mfma_f32_16x16x32_bf16 v[52:55], v[88:91], a[140:143], v[52:55]
  v_mfma_f32_16x16x32_bf16 v[52:55], v[92:95], a[156:159], v[52:55]
  s_waitcnt lgkmcnt(4)
  v_mfma_f32_16x16x32_bf16 v[40:43], v[32:35], a[160:163], v[40:43]
  ds_read_b64_tr_b16 v[88:89], v103 offset:8192
  buffer_load_dwordx4 v98, s[36:39], s58 offen offset:2048 lds
  v_mfma_f32_16x16x32_bf16 v[40:43], v[36:39], a[176:179], v[40:43]
  ds_read_b64_tr_b16 v[90:91], v103 offset:8704
  v_mfma_f32_16x16x32_bf16 v[44:47], v[32:35], a[164:167], v[44:47]
  ds_read_b64_tr_b16 v[92:93], v103 offset:12288
  v_mfma_f32_16x16x32_bf16 v[44:47], v[36:39], a[180:183], v[44:47]
  ds_read_b64_tr_b16 v[94:95], v103 offset:12800
  v_mfma_f32_16x16x32_bf16 v[48:51], v[32:35], a[168:171], v[48:51]
  s_add_u32 m0, s63, 3072
  s_nop 0
  buffer_load_dwordx4 v99, s[36:39], s58 offen offset:0 lds
  v_mfma_f32_16x16x32_bf16 v[48:51], v[36:39], a[184:187], v[48:51]
  v_mfma_f32_16x16x32_bf16 v[52:55], v[32:35], a[172:175], v[52:55]
  v_mfma_f32_16x16x32_bf16 v[52:55], v[36:39], a[188:191], v[52:55]
  s_waitcnt lgkmcnt(4)
  v_mfma_f32_16x16x32_bf16 v[40:43], v[80:83], a[192:195], v[40:43]
  ds_read_b64_tr_b16 v[32:33], v103 offset:16384
  buffer_load_dwordx4 v100, s[36:39], s58 offen offset:1024 lds
  v_mfma_f32_16x16x32_bf16 v[40:43], v[84:87], a[208:211], v[40:43]
  ds_read_b64_tr_b16 v[34:35], v103 offset:16896
  v_mfma_f32_16x16x32_bf16 v[44:47], v[80:83], a[196:199], v[44:47]
  ds_read_b64_tr_b16 v[36:37], v103 offset:20480
  v_mfma_f32_16x16x32_bf16 v[44:47], v[84:87], a[212:215], v[44:47]
  ds_read_b64_tr_b16 v[38:39], v103 offset:20992
  v_mfma_f32_16x16x32_bf16 v[48:51], v[80:83], a[200:203], v[48:51]
  buffer_load_dwordx4 v101, s[36:39], s58 offen offset:2048 lds
  v_mfma_f32_16x16x32_bf16 v[48:51], v[84:87], a[216:219], v[48:51]
  v_mfma_f32_16x16x32_bf16 v[52:55], v[80:83], a[204:207], v[52:55]
  v_mfma_f32_16x16x32_bf16 v[52:55], v[84:87], a[220:223], v[52:55]
  s_waitcnt vmcnt(18)
  s_cmp_eq_u32 s71, 4
  s_cbranch_scc0 Ll_132
  s_waitcnt vmcnt(10)
Ll_132:
  s_barrier
  s_waitcnt lgkmcnt(4)
  v_mfma_f32_16x16x32_bf16 v[40:43], v[88:91], a[224:227], v[40:43]
  v_add_u32 v103, 98304, v102
  s_add_u32 m0, s63, 73728
  s_add_u32 s58, s65, 221184
  buffer_load_dwordx4 v96, s[36:39], s58 offen offset:0 lds
  v_mfma_f32_16x16x32_bf16 v[40:43], v[92:95], a[240:243], v[40:43]
  ds_read_b64_tr_b16 v[80:81], v103 offset:0
  v_mfma_f32_16x16x32_bf16 v[44:47], v[88:91], a[228:231], v[44:47]
  ds_read_b64_tr_b16 v[82:83], v103 offset:512
  v_mfma_f32_16x16x32_bf16 v[44:47], v[92:95], a[244:247], v[44:47]
  ds_read_b64_tr_b16 v[84:85], v103 offset:4096
  s_cmp_eq_u32 s71, 4
  s_cbranch_scc0 Ll_133
  s_cmp_lg_u32 s40, 0
  s_cbranch_scc1 Lex_134
  s_add_u32 s46, s43, 4
  v_mov_b32 v29, s46
  s_mov_b64 exec, 1
  buffer_store_dword v29, v28, s[28:31], s68 offen sc1
  s_mov_b64 exec, -1
Lex_134:
Ll_133:
  v_mfma_f32_16x16x32_bf16 v[48:51], v[88:91], a[232:235], v[48:51]
  ds_read_b64_tr_b16 v[86:87], v103 offset:4608
  buffer_load_dwordx4 v97, s[36:39], s58 offen offset:1024 lds
  v_mfma_f32_16x16x32_bf16 v[48:51], v[92:95], a[248:251], v[48:51]
  v_mfma_f32_16x16x32_bf16 v[52:55], v[88:91], a[236:239], v[52:55]
  v_mfma_f32_16x16x32_bf16 v[52:55], v[92:95], a[252:255], v[52:55]
  s_waitcnt lgkmcnt(4)
  v_mfma_f32_16x16x32_bf16 v[40:43], v[32:35], v[224:227], v[40:43]
  ds_read_b64_tr_b16 v[88:89], v103 offset:8192
  buffer_load_dwordx4 v98, s[36:39], s58 offen offset:2048 lds
  v_mfma_f32_16x16x32_bf16 v[40:43], v[36:39], v[240:243], v[40:43]
  ds_read_b64_tr_b16 v[90:91], v103 offset:8704
  v_mfma_f32_16x16x32_bf16 v[44:47], v[32:35], v[228:231], v[44:47]
  ds_read_b64_tr_b16 v[92:93], v103 offset:12288
  v_mfma_f32_16x16x32_bf16 v[44:47], v[36:39], v[244:247], v[44:47]
  ds_read_b64_tr_b16 v[94:95], v103 offset:12800
  v_mfma_f32_16x16x32_bf16 v[48:51], v[32:35], v[232:235], v[48:51]
  s_add_u32 m0, s63, 76800
  s_nop 0
  buffer_load_dwordx4 v99, s[36:39], s58 offen offset:0 lds
  v_mfma_f32_16x16x32_bf16 v[48:51], v[36:39], v[248:251], v[48:51]
  v_mfma_f32_16x16x32_bf16 v[52:55], v[32:35], v[236:239], v[52:55]
  v_mfma_f32_16x16x32_bf16 v[52:55], v[36:39], v[252:255], v[52:55]
  s_add_u32 s71, s71, 2
  s_cmp_lt_u32 s71, 6
  s_cbranch_scc1 L_p6_b
  s_sub_u32 s54, s51, 1
  s_and_b32 s54, s54, 7
  s_lshl_b32 s54, s54, 13
  s_add_u32 s54, s54, s69
  s_sub_u32 s57, s51, 2
  s_and_b32 s57, s57, 7
  s_lshl_b32 s57, s57, 13
  s_add_u32 s57, s57, s69
  s_sub_u32 s59, s51, 3
  s_and_b32 s59, s59, 7
  s_lshl_b32 s59, s59, 13
  s_add_u32 s59, s59, s69
  s_sub_u32 s61, s51, 4
  s_and_b32 s61, s61, 7
  s_lshl_b32 s61, s61, 13
  s_add_u32 s61, s61, s69
  s_sub_u32 s72, s51, 5
  s_and_b32 s72, s72, 7
  s_lshl_b32 s72, s72, 13
  s_add_u32 s72, s72, s69
  s_sub_u32 s75, s51, 6
  s_and_b32 s75, s75, 7
  s_lshl_b32 s75, s75, 13
  s_add_u32 s75, s75, s69
  s_sub_u32 s76, s51, 7
  s_and_b32 s76, s76, 7
  s_lshl_b32 s76, s76, 13
  s_add_u32 s76, s76, s69
  s_waitcnt lgkmcnt(4)
  v_mfma_f32_16x16x32_bf16 v[56:59], v[80:83], a[0:3], 0
  ds_read_b64_tr_b16 v[32:33], v103 offset:16384
  s_add_u32 s46, s51, 5
  s_and_b32 s46, s46, 7
  s_lshl_b32 s46, s46, 16
  buffer_load_dwordx4 v100, s[36:39], s58 offen offset:1024 lds
  v_mfma_f32_16x16x32_bf16 v[56:59], v[84:87], a[16:19], v[56:59]
  ds_read_b64_tr_b16 v[34:35], v103 offset:16896
  s_add_u32 s62, s46, s56
  s_add_u32 s46, s51, 8
  s_and_b32 s46, s46, 7
  v_mfma_f32_16x16x32_bf16 v[60:63], v[80:83], a[4:7], 0
  ds_read_b64_tr_b16 v[36:37], v103 offset:20480
  s_lshl_b32 s46, s46, 7
  s_add_u32 s64, s55, s46
  v_mfma_f32_16x16x32_bf16 v[60:63], v[84:87], a[20:23], v[60:63]
  ds_read_b64_tr_b16 v[38:39], v103 offset:20992
  v_mfma_f32_16x16x32_bf16 v[64:67], v[80:83], a[8:11], 0
  buffer_load_dwordx4 v101, s[36:39], s58 offen offset:2048 lds
  v_cvt_pk_bf16_f32 v74, v40, v41
  v_mfma_f32_16x16x32_bf16 v[64:67], v[84:87], a[24:27], v[64:67]
  v_cvt_pk_bf16_f32 v75, v42, v43
  v_cvt_pk_bf16_f32 v72, v44, v45
  v_mfma_f32_16x16x32_bf16 v[68:71], v[80:83], a[12:15], 0
  v_cvt_pk_bf16_f32 v73, v46, v47
  v_cvt_pk_bf16_f32 v78, v48, v49
  v_mfma_f32_16x16x32_bf16 v[68:71], v[84:87], a[28:31], v[68:71]
  v_cvt_pk_bf16_f32 v79, v50, v51
  v_cvt_pk_bf16_f32 v76, v52, v53
  s_waitcnt vmcnt(18)
  s_barrier
  s_waitcnt lgkmcnt(4)
  v_mfma_f32_16x16x32_bf16 v[56:59], v[88:91], a[32:35], v[56:59]
  v_add_u32 v103, 49152, v102
  s_add_u32 m0, s63, 24576
  s_add_u32 s58, s65, 442368
  buffer_load_dwordx4 v96, s[36:39], s58 offen offset:0 lds
  v_mfma_f32_16x16x32_bf16 v[56:59], v[92:95], a[48:51], v[56:59]
  ds_read_b64_tr_b16 v[80:81], v103 offset:0
  v_cvt_pk_bf16_f32 v77, v54, v55
  v_mfma_f32_16x16x32_bf16 v[60:63], v[88:91], a[36:39], v[60:63]
  ds_read_b64_tr_b16 v[82:83], v103 offset:512
  buffer_store_dwordx4 v[72:75], v4, s[28:31], s62 offen offset:0 sc1
  v_mfma_f32_16x16x32_bf16 v[60:63], v[92:95], a[52:55], v[60:63]
  ds_read_b64_tr_b16 v[84:85], v103 offset:4096
  buffer_store_dwordx4 v[76:79], v4, s[28:31], s62 offen offset:1024 sc1
  v_mfma_f32_16x16x32_bf16 v[64:67], v[88:91], a[40:43], v[64:67]
  ds_read_b64_tr_b16 v[86:87], v103 offset:4608
  buffer_load_dwordx4 v97, s[36:39], s58 offen offset:1024 lds
  v_mfma_f32_16x16x32_bf16 v[64:67], v[92:95], a[56:59], v[64:67]
  v_mfma_f32_16x16x32_bf16 v[68:71], v[88:91], a[44:47], v[68:71]
  v_mfma_f32_16x16x32_bf16 v[68:71], v[92:95], a[60:63], v[68:71]
  s_waitcnt lgkmcnt(4)
  v_mfma_f32_16x16x32_bf16 v[56:59], v[32:35], a[64:67], v[56:59]
  ds_read_b64_tr_b16 v[88:89], v103 offset:8192
  buffer_load_dwordx4 v98, s[36:39], s58 offen offset:2048 lds
  v_mfma_f32_16x16x32_bf16 v[56:59], v[36:39], a[80:83], v[56:59]
  ds_read_b64_tr_b16 v[90:91], v103 offset:8704
  v_mfma_f32_16x16x32_bf16 v[60:63], v[32:35], a[68:71], v[60:63]
  ds_read_b64_tr_b16 v[92:93], v103 offset:12288
  v_mfma_f32_16x16x32_bf16 v[60:63], v[36:39], a[84:87], v[60:63]
  ds_read_b64_tr_b16 v[94:95], v103 offset:12800
  v_mfma_f32_16x16x32_bf16 v[64:67], v[32:35], a[72:75], v[64:67]
  s_add_u32 m0, s63, 27648
  s_nop 0
  buffer_load_dwordx4 v99, s[36:39], s58 offen offset:0 lds
  v_mfma_f32_16x16x32_bf16 v[64:67], v[36:39], a[88:91], v[64:67]
  v_mfma_f32_16x16x32_bf16 v[68:71], v[32:35], a[76:79], v[68:71]
  v_mfma_f32_16x16x32_bf16 v[68:71], v[36:39], a[92:95], v[68:71]
  s_waitcnt lgkmcnt(4)
  s_cmp_lg_u32 s40, 0
  s_cbranch_scc1 Lex_135
  buffer_load_dword v31, v5, s[28:31], s70 offen sc1
Lex_135:
  v_mfma_f32_16x16x32_bf16 v[56:59], v[80:83], a[96:99], v[56:59]
  ds_read_b64_tr_b16 v[32:33], v103 offset:16384
  buffer_load_dwordx4 v100, s[36:39], s58 offen offset:1024 lds
  v_mfma_f32_16x16x32_bf16 v[56:59], v[84:87], a[112:115], v[56:59]
  ds_read_b64_tr_b16 v[34:35], v103 offset:16896
  v_mfma_f32_16x16x32_bf16 v[60:63], v[80:83], a[100:103], v[60:63]
  ds_read_b64_tr_b16 v[36:37], v103 offset:20480
  v_mfma_f32_16x16x32_bf16 v[60:63], v[84:87], a[116:119], v[60:63]
  ds_read_b64_tr_b16 v[38:39], v103 offset:20992
  v_mfma_f32_16x16x32_bf16 v[64:67], v[80:83], a[104:107], v[64:67]
  buffer_load_dwordx4 v101, s[36:39], s58 offen offset:2048 lds
  v_mfma_f32_16x16x32_bf16 v[64:67], v[84:87], a[120:123], v[64:67]
  v_mfma_f32_16x16x32_bf16 v[68:71], v[80:83], a[108:111], v[68:71]
  v_mfma_f32_16x16x32_bf16 v[68:71], v[84:87], a[124:127], v[68:71]
  s_waitcnt vmcnt(18)
  s_barrier
  s_waitcnt lgkmcnt(4)
  v_mfma_f32_16x16x32_bf16 v[56:59], v[88:91], a[128:131], v[56:59]
  v_add_u32 v103, 122880, v102
  s_add_u32 m0, s63, 98304
  s_add_u32 s58, s64, 0
  buffer_load_dwordx4 v96, s[36:39], s58 offen offset:0 lds
  v_mfma_f32_16x16x32_bf16 v[56:59], v[92:95], a[144:147], v[56:59]
  ds_read_b64_tr_b16 v[80:81], v103 offset:0
  v_mfma_f32_16x16x32_bf16 v[60:63], v[88:91], a[132:135], v[60:63]
  ds_read_b64_tr_b16 v[82:83], v103 offset:512
  v_mfma_f32_16x16x32_bf16 v[60:63], v[92:95], a[148:151], v[60:63]
  ds_read_b64_tr_b16 v[84:85], v103 offset:4096
  v_mfma_f32_16x16x32_bf16 v[64:67], v[88:91], a[136:139], v[64:67]
  ds_read_b64_tr_b16 v[86:87], v103 offset:4608
  buffer_load_dwordx4 v97, s[36:39], s58 offen offset:1024 lds
  v_mfma_f32_16x16x32_bf16 v[64:67], v[92:95], a[152:155], v[64:67]
  v_mfma_f32_16x16x32_bf16 v[68:71], v[88:91], a[140:143], v[68:71]
  v_mfma_f32_16x16x32_bf16 v[68:71], v[92:95], a[156:159], v[68:71]
  s_waitcnt lgkmcnt(4)
  v_mfma_f32_16x16x32_bf16 v[56:59], v[32:35], a[160:163], v[56:59]
  ds_read_b64_tr_b16 v[88:89], v103 offset:8192
  buffer_load_dwordx4 v98, s[36:39], s58 offen offset:2048 lds
  v_mfma_f32_16x16x32_bf16 v[56:59], v[36:39], a[176:179], v[56:59]
  ds_read_b64_tr_b16 v[90:91], v103 offset:8704
  v_mfma_f32_16x16x32_bf16 v[60:63], v[32:35], a[164:167], v[60:63]
  ds_read_b64_tr_b16 v[92:93], v103 offset:12288
  v_mfma_f32_16x16x32_bf16 v[60:63], v[36:39], a[180:183], v[60:63]
  ds_read_b64_tr_b16 v[94:95], v103 offset:12800
  v_mfma_f32_16x16x32_bf16 v[64:67], v[32:35], a[168:171], v[64:67]
  s_add_u32 m0, s63, 101376
  s_nop 0
  buffer_load_dwordx4 v99, s[36:39], s58 offen offset:0 lds
  v_mfma_f32_16x16x32_bf16 v[64:67], v[36:39], a[184:187], v[64:67]
  v_mfma_f32_16x16x32_bf16 v[68:71], v[32:35], a[172:175], v[68:71]
  v_mfma_f32_16x16x32_bf16 v[68:71], v[36:39], a[188:191], v[68:71]
  s_waitcnt lgkmcnt(4)
  v_mfma_f32_16x16x32_bf16 v[56:59], v[80:83], a[192:195], v[56:59]
  ds_read_b64_tr_b16 v[32:33], v103 offset:16384
  buffer_load_dwordx4 v100, s[36:39], s58 offen offset:1024 lds
  v_mfma_f32_16x16x32_bf16 v[56:59], v[84:87], a[208:211], v[56:59]
  ds_read_b64_tr_b16 v[34:35], v103 offset:16896
  v_mfma_f32_16x16x32_bf16 v[60:63], v[80:83], a[196:199], v[60:63]
  ds_read_b64_tr_b16 v[36:37], v103 offset:20480
  v_mfma_f32_16x16x32_bf16 v[60:63], v[84:87], a[212:215], v[60:63]
  ds_read_b64_tr_b16 v[38:39], v103 offset:20992
  v_mfma_f32_16x16x32_bf16 v[64:67], v[80:83], a[200:203], v[64:67]
  buffer_load_dwordx4 v101, s[36:39], s58 offen offset:2048 lds
  v_mfma_f32_16x16x32_bf16 v[64:67], v[84:87], a[216:219], v[64:67]
  v_mfma_f32_16x16x32_bf16 v[68:71], v[80:83], a[204:207], v[68:71]
  v_mfma_f32_16x16x32_bf16 v[68:71], v[84:87], a[220:223], v[68:71]
  s_cmp_lg_u32 s40, 0
  s_cbranch_scc1 Lex_136
  s_add_u32 s73, s43, 4
  s_mov_b32 s47, 100000
  s_waitcnt vmcnt(6)
Lcf_137:
  v_subrev_u32 v30, s73, v31
  v_cmp_lt_u32 vcc, 7, v30
  s_cbranch_vccz Lcf_137_x
  s_sleep 1
  buffer_load_dword v31, v5, s[28:31], s70 offen sc1
  s_waitcnt vmcnt(0)
  s_sub_u32 s47, s47, 1
  s_cbranch_scc0 Lcf_137
Lcf_137_x:
Lex_136:
  s_waitcnt vmcnt(10)
  s_barrier
  s_waitcnt lgkmcnt(4)
  v_mfma_f32_16x16x32_bf16 v[56:59], v[88:91], a[224:227], v[56:59]
  v_add_u32 v103, 0, v102
  s_add_u32 m0, s63, 49152
  s_add_u32 s58, s64, 221184
  buffer_load_dwordx4 v96, s[36:39], s58 offen offset:0 lds
  v_mfma_f32_16x16x32_bf16 v[56:59], v[92:95], a[240:243], v[56:59]
  ds_read_b64_tr_b16 v[80:81], v103 offset:0
  v_mfma_f32_16x16x32_bf16 v[60:63], v[88:91], a[228:231], v[60:63]
  ds_read_b64_tr_b16 v[82:83], v103 offset:512
  v_mfma_f32_16x16x32_bf16 v[60:63], v[92:95], a[244:247], v[60:63]
  ds_read_b64_tr_b16 v[84:85], v103 offset:4096
  s_cmp_lg_u32 s40, 0
  s_cbranch_scc1 Lex_138
  s_add_u32 s46, s43, 5
  v_mov_b32 v29, s46
  s_mov_b64 exec, 1
  buffer_store_dword v29, v28, s[28:31], s68 offen sc1
  s_mov_b64 exec, -1
Lex_138:
  v_mfma_f32_16x16x32_bf16 v[64:67], v[88:91], a[232:235], v[64:67]
  ds_read_b64_tr_b16 v[86:87], v103 offset:4608
  buffer_load_dwordx4 v97, s[36:39], s58 offen offset:1024 lds
  v_mfma_f32_16x16x32_bf16 v[64:67], v[92:95], a[248:251], v[64:67]
  v_mfma_f32_16x16x32_bf16 v[68:71], v[88:91], a[236:239], v[68:71]
  v_mfma_f32_16x16x32_bf16 v[68:71], v[92:95], a[252:255], v[68:71]
  s_waitcnt lgkmcnt(4)
  buffer_load_dwordx4 v[104:107], v4, s[28:31], s54 offen offset:0 sc1
  buffer_load_dwordx4 v[132:135], v4, s[28:31], s54 offen offset:1024 sc1
  v_mfma_f32_16x16x32_bf16 v[56:59], v[32:35], v[224:227], v[56:59]
  ds_read_b64_tr_b16 v[88:89], v103 offset:8192
  buffer_load_dwordx4 v98, s[36:39], s58 offen offset:2048 lds
  v_mfma_f32_16x16x32_bf16 v[56:59], v[36:39], v[240:243], v[56:59]
  ds_read_b64_tr_b16 v[90:91], v103 offset:8704
  v_mfma_f32_16x16x32_bf16 v[60:63], v[32:35], v[228:231], v[60:63]
  ds_read_b64_tr_b16 v[92:93], v103 offset:12288
  v_mfma_f32_16x16x32_bf16 v[60:63], v[36:39], v[244:247], v[60:63]
  ds_read_b64_tr_b16 v[94:95], v103 offset:12800
  v_mfma_f32_16x16x32_bf16 v[64:67], v[32:35], v[232:235], v[64:67]
  s_add_u32 m0, s63, 52224
  s_nop 0
  buffer_load_dwordx4 v99, s[36:39], s58 offen offset:0 lds
  v_mfma_f32_16x16x32_bf16 v[64:67], v[36:39], v[248:251], v[64:67]
  v_mfma_f32_16x16x32_bf16 v[68:71], v[32:35], v[236:239], v[68:71]
  v_mfma_f32_16x16x32_bf16 v[68:71], v[36:39], v[252:255], v[68:71]
  s_mul_i32 s46, s50, 9
  s_add_u32 s46, s46, 8
  s_lshl_b32 s46, s46, 16
  s_lshl_b32 s47, s51, 10
  s_add_u32 s46, s46, s47
  s_add_u32 s78, s46, 29908992
  s_and_b32 s46, s51, 1
  s_mul_i32 s74, s46, 36864
  s_add_u32 s74, s74, s60
  s_lshr_b32 s47, s51, 2
  s_add_u32 s47, s47, 16
  s_lshl_b32 s46, s47, 10
  s_add_u32 s79, s46, s74
  s_lshr_b32 s46, s51, 1
  s_lshl_b32 s46, s46, 5
  s_add_u32 s46, s46, 1024
  s_add_u32 s74, s74, s46
  s_waitcnt lgkmcnt(4)
  v_mfma_f32_16x16x32_bf16 v[40:43], v[80:83], a[0:3], 0
  ds_read_b64_tr_b16 v[32:33], v103 offset:16384
  s_add_u32 s46, s51, 6
  s_and_b32 s46, s46, 7
  buffer_load_dwordx4 v100, s[36:39], s58 offen offset:1024 lds
  v_mfma_f32_16x16x32_bf16 v[40:43], v[84:87], a[16:19], v[40:43]
  ds_read_b64_tr_b16 v[34:35], v103 offset:16896
  s_lshl_b32 s46, s46, 16
  v_mfma_f32_16x16x32_bf16 v[44:47], v[80:83], a[4:7], 0
  ds_read_b64_tr_b16 v[36:37], v103 offset:20480
  s_add_u32 s62, s46, s56
  v_mfma_f32_16x16x32_bf16 v[44:47], v[84:87], a[20:23], v[44:47]
  ds_read_b64_tr_b16 v[38:39], v103 offset:20992
  v_mfma_f32_16x16x32_bf16 v[48:51], v[80:83], a[8:11], 0
  buffer_load_dwordx4 v101, s[36:39], s58 offen offset:2048 lds
  v_cvt_pk_bf16_f32 v72, v56, v57
  v_mfma_f32_16x16x32_bf16 v[48:51], v[84:87], a[24:27], v[48:51]
  v_cvt_pk_bf16_f32 v73, v58, v59
  v_cvt_pk_bf16_f32 v74, v60, v61
  v_mfma_f32_16x16x32_bf16 v[52:55], v[80:83], a[12:15], 0
  v_cvt_pk_bf16_f32 v75, v62, v63
  v_cvt_pk_bf16_f32 v76, v64, v65
  v_mfma_f32_16x16x32_bf16 v[52:55], v[84:87], a[28:31], v[52:55]
  v_cvt_pk_bf16_f32 v77, v66, v67
  v_cvt_pk_bf16_f32 v78, v68, v69
  s_waitcnt vmcnt(18)
  s_barrier
  s_waitcnt lgkmcnt(4)
  v_mfma_f32_16x16x32_bf16 v[40:43], v[88:91], a[32:35], v[40:43]
  v_add_u32 v103, 73728, v102
  s_add_u32 m0, s63, 122880
  s_add_u32 s58, s64, 442368
  buffer_load_dwordx4 v96, s[36:39], s58 offen offset:0 lds
  v_mfma_f32_16x16x32_bf16 v[40:43], v[92:95], a[48:51], v[40:43]
  ds_read_b64_tr_b16 v[80:81], v103 offset:0
  v_cvt_pk_bf16_f32 v79, v70, v71
  v_mfma_f32_16x16x32_bf16 v[44:47], v[88:91], a[36:39], v[44:47]
  ds_read_b64_tr_b16 v[82:83], v103 offset:512
  buffer_store_dwordx4 v[72:75], v4, s[28:31], s62 offen offset:0 sc1
  v_mfma_f32_16x16x32_bf16 v[44:47], v[92:95], a[52:55], v[44:47]
  ds_read_b64_tr_b16 v[84:85], v103 offset:4096
  buffer_store_dwordx4 v[76:79], v4, s[28:31], s62 offen offset:1024 sc1
  buffer_load_dwordx4 v[108:111], v4, s[28:31], s57 offen offset:0 sc1
  buffer_load_dwordx4 v[136:139], v4, s[28:31], s57 offen offset:1024 sc1
  v_mfma_f32_16x16x32_bf16 v[48:51], v[88:91], a[40:43], v[48:51]
  ds_read_b64_tr_b16 v[86:87], v103 offset:4608
  buffer_load_dwordx4 v97, s[36:39], s58 offen offset:1024 lds
  v_mfma_f32_16x16x32_bf16 v[48:51], v[92:95], a[56:59], v[48:51]
  v_mfma_f32_16x16x32_bf16 v[52:55], v[88:91], a[44:47], v[52:55]
  v_mfma_f32_16x16x32_bf16 v[52:55], v[92:95], a[60:63], v[52:55]
  s_waitcnt lgkmcnt(4)
  v_mfma_f32_16x16x32_bf16 v[40:43], v[32:35], a[64:67], v[40:43]
  ds_read_b64_tr_b16 v[88:89], v103 offset:8192
  buffer_load_dwordx4 v98, s[36:39], s58 offen offset:2048 lds
  v_mfma_f32_16x16x32_bf16 v[40:43], v[36:39], a[80:83], v[40:43]
  ds_read_b64_tr_b16 v[90:91], v103 offset:8704
  v_mfma_f32_16x16x32_bf16 v[44:47], v[32:35], a[68:71], v[44:47]
  ds_read_b64_tr_b16 v[92:93], v103 offset:12288
  v_mfma_f32_16x16x32_bf16 v[44:47], v[36:39], a[84:87], v[44:47]
  ds_read_b64_tr_b16 v[94:95], v103 offset:12800
  v_mfma_f32_16x16x32_bf16 v[48:51], v[32:35], a[72:75], v[48:51]
  s_add_u32 m0, s63, 125952
  s_nop 0
  buffer_load_dwordx4 v99, s[36:39], s58 offen offset:0 lds
  v_mfma_f32_16x16x32_bf16 v[48:51], v[36:39], a[88:91], v[48:51]
  v_mfma_f32_16x16x32_bf16 v[52:55], v[32:35], a[76:79], v[52:55]
  v_mfma_f32_16x16x32_bf16 v[52:55], v[36:39], a[92:95], v[52:55]
  s_waitcnt lgkmcnt(4)
  buffer_load_dwordx4 v[112:115], v4, s[28:31], s59 offen offset:0 sc1
  buffer_load_dwordx4 v[140:143], v4, s[28:31], s59 offen offset:1024 sc1
  v_mfma_f32_16x16x32_bf16 v[40:43], v[80:83], a[96:99], v[40:43]
  ds_read_b64_tr_b16 v[32:33], v103 offset:16384
  buffer_load_dwordx4 v100, s[36:39], s58 offen offset:1024 lds
  v_mfma_f32_16x16x32_bf16 v[40:43], v[84:87], a[112:115], v[40:43]
  ds_read_b64_tr_b16 v[34:35], v103 offset:16896
  v_mfma_f32_16x16x32_bf16 v[44:47], v[80:83], a[100:103], v[44:47]
  ds_read_b64_tr_b16 v[36:37], v103 offset:20480
  v_mfma_f32_16x16x32_bf16 v[44:47], v[84:87], a[116:119], v[44:47]
  ds_read_b64_tr_b16 v[38:39], v103 offset:20992
  v_mfma_f32_16x16x32_bf16 v[48:51], v[80:83], a[104:107], v[48:51]
  buffer_load_dwordx4 v101, s[36:39], s58 offen offset:2048 lds
  v_mfma_f32_16x16x32_bf16 v[48:51], v[84:87], a[120:123], v[48:51]
  v_mfma_f32_16x16x32_bf16 v[52:55], v[80:83], a[108:111], v[52:55]
  v_mfma_f32_16x16x32_bf16 v[52:55], v[84:87], a[124:127], v[52:55]
  s_waitcnt vmcnt(18)
  s_barrier
  s_waitcnt lgkmcnt(4)
  v_mfma_f32_16x16x32_bf16 v[40:43], v[88:91], a[128:131], v[40:43]
  v_add_u32 v103, 24576, v102
  v_mfma_f32_16x16x32_bf16 v[40:43], v[92:95], a[144:147], v[40:43]
  ds_read_b64_tr_b16 v[80:81], v103 offset:0
  v_mfma_f32_16x16x32_bf16 v[44:47], v[88:91], a[132:135], v[44:47]
  ds_read_b64_tr_b16 v[82:83], v103 offset:512
  v_mfma_f32_16x16x32_bf16 v[44:47], v[92:95], a[148:151], v[44:47]
  ds_read_b64_tr_b16 v[84:85], v103 offset:4096
  s_cmp_lg_u32 s40, 0
  s_cbranch_scc1 Lex_139
  buffer_load_dword v31, v5, s[28:31], s70 offen sc1
Lex_139:
  v_mfma_f32_16x16x32_bf16 v[48:51], v[88:91], a[136:139], v[48:51]
  ds_read_b64_tr_b16 v[86:87], v103 offset:4608
  v_mfma_f32_16x16x32_bf16 v[48:51], v[92:95], a[152:155], v[48:51]
  v_mfma_f32_16x16x32_bf16 v[52:55], v[88:91], a[140:143], v[52:55]
  v_mfma_f32_16x16x32_bf16 v[52:55], v[92:95], a[156:159], v[52:55]
  s_waitcnt lgkmcnt(4)
  buffer_load_dwordx4 v[116:119], v4, s[28:31], s61 offen offset:0 sc1
  buffer_load_dwordx4 v[144:147], v4, s[28:31], s61 offen offset:1024 sc1
  v_mfma_f32_16x16x32_bf16 v[40:43], v[32:35], a[160:163], v[40:43]
  ds_read_b64_tr_b16 v[88:89], v103 offset:8192
  v_mfma_f32_16x16x32_bf16 v[40:43], v[36:39], a[176:179], v[40:43]
  ds_read_b64_tr_b16 v[90:91], v103 offset:8704
  v_mfma_f32_16x16x32_bf16 v[44:47], v[32:35], a[164:167], v[44:47]
  ds_read_b64_tr_b16 v[92:93], v103 offset:12288
  v_mfma_f32_16x16x32_bf16 v[44:47], v[36:39], a[180:183], v[44:47]
  ds_read_b64_tr_b16 v[94:95], v103 offset:12800
  v_mfma_f32_16x16x32_bf16 v[48:51], v[32:35], a[168:171], v[48:51]
  v_mfma_f32_16x16x32_bf16 v[48:51], v[36:39], a[184:187], v[48:51]
  v_mfma_f32_16x16x32_bf16 v[52:55], v[32:35], a[172:175], v[52:55]
  v_mfma_f32_16x16x32_bf16 v[52:55], v[36:39], a[188:191], v[52:55]
  s_waitcnt lgkmcnt(4)
  v_mfma_f32_16x16x32_bf16 v[40:43], v[80:83], a[192:195], v[40:43]
  ds_read_b64_tr_b16 v[32:33], v103 offset:16384
  v_mfma_f32_16x16x32_bf16 v[40:43], v[84:87], a[208:211], v[40:43]
  ds_read_b64_tr_b16 v[34:35], v103 offset:16896
  v_mfma_f32_16x16x32_bf16 v[44:47], v[80:83], a[196:199], v[44:47]
  ds_read_b64_tr_b16 v[36:37], v103 offset:20480
  v_mfma_f32_16x16x32_bf16 v[44:47], v[84:87], a[212:215], v[44:47]
  ds_read_b64_tr_b16 v[38:39], v103 offset:20992
  v_mfma_f32_16x16x32_bf16 v[48:51], v[80:83], a[200:203], v[48:51]
  v_mfma_f32_16x16x32_bf16 v[48:51], v[84:87], a[216:219], v[48:51]
  v_mfma_f32_16x16x32_bf16 v[52:55], v[80:83], a[204:207], v[52:55]
  v_mfma_f32_16x16x32_bf16 v[52:55], v[84:87], a[220:223], v[52:55]
  s_cmp_lg_u32 s40, 0
  s_cbranch_scc1 Lex_140
  s_add_u32 s73, s43, 5
  s_mov_b32 s47, 100000
  s_waitcnt vmcnt(2)
Lcf_141:
  v_subrev_u32 v30, s73, v31
  v_cmp_lt_u32 vcc, 7, v30
  s_cbranch_vccz Lcf_141_x
  s_sleep 1
  buffer_load_dword v31, v5, s[28:31], s70 offen sc1
  s_waitcnt vmcnt(0)
  s_sub_u32 s47, s47, 1
  s_cbranch_scc0 Lcf_141
Lcf_141_x:
Lex_140:
  s_waitcnt vmcnt(18)
  s_barrier
  s_waitcnt lgkmcnt(4)
  v_mfma_f32_16x16x32_bf16 v[40:43], v[88:91], a[224:227], v[40:43]
  v_add_u32 v103, 98304, v102
  v_mfma_f32_16x16x32_bf16 v[40:43], v[92:95], a[240:243], v[40:43]
  ds_read_b64_tr_b16 v[80:81], v103 offset:0
  v_mfma_f32_16x16x32_bf16 v[44:47], v[88:91], a[228:231], v[44:47]
  ds_read_b64_tr_b16 v[82:83], v103 offset:512
  v_mfma_f32_16x16x32_bf16 v[44:47], v[92:95], a[244:247], v[44:47]
  ds_read_b64_tr_b16 v[84:85], v103 offset:4096
  buffer_load_dwordx4 v[120:123], v4, s[28:31], s72 offen offset:0 sc1
  buffer_load_dwordx4 v[148:151], v4, s[28:31], s72 offen offset:1024 sc1
  v_mfma_f32_16x16x32_bf16 v[48:51], v[88:91], a[232:235], v[48:51]
  ds_read_b64_tr_b16 v[86:87], v103 offset:4608
  v_mfma_f32_16x16x32_bf16 v[48:51], v[92:95], a[248:251], v[48:51]
  v_mfma_f32_16x16x32_bf16 v[52:55], v[88:91], a[236:239], v[52:55]
  v_mfma_f32_16x16x32_bf16 v[52:55], v[92:95], a[252:255], v[52:55]
  s_waitcnt lgkmcnt(4)
  v_mfma_f32_16x16x32_bf16 v[40:43], v[32:35], v[224:227], v[40:43]
  ds_read_b64_tr_b16 v[88:89], v103 offset:8192
  v_mfma_f32_16x16x32_bf16 v[40:43], v[36:39], v[240:243], v[40:43]
  ds_read_b64_tr_b16 v[90:91], v103 offset:8704
  v_mfma_f32_16x16x32_bf16 v[44:47], v[32:35], v[228:231], v[44:47]
  ds_read_b64_tr_b16 v[92:93], v103 offset:12288
  v_mfma_f32_16x16x32_bf16 v[44:47], v[36:39], v[244:247], v[44:47]
  ds_read_b64_tr_b16 v[94:95], v103 offset:12800
  v_mfma_f32_16x16x32_bf16 v[48:51], v[32:35], v[232:235], v[48:51]
  v_mfma_f32_16x16x32_bf16 v[48:51], v[36:39], v[248:251], v[48:51]
  v_mfma_f32_16x16x32_bf16 v[52:55], v[32:35], v[236:239], v[52:55]
  v_mfma_f32_16x16x32_bf16 v[52:55], v[36:39], v[252:255], v[52:55]
  s_waitcnt lgkmcnt(4)
  v_mfma_f32_16x16x32_bf16 v[56:59], v[80:83], a[0:3], v[12:15]
  ds_read_b64_tr_b16 v[32:33], v103 offset:16384
  s_add_u32 s46, s51, 7
  s_and_b32 s46, s46, 7
  v_mfma_f32_16x16x32_bf16 v[56:59], v[84:87], a[16:19], v[56:59]
  ds_read_b64_tr_b16 v[34:35], v103 offset:16896
  s_lshl_b32 s46, s46, 16
  v_mfma_f32_16x16x32_bf16 v[60:63], v[80:83], a[4:7], v[16:19]
  ds_read_b64_tr_b16 v[36:37], v103 offset:20480
  s_add_u32 s62, s46, s56
  v_mfma_f32_16x16x32_bf16 v[60:63], v[84:87], a[20:23], v[60:63]
  ds_read_b64_tr_b16 v[38:39], v103 offset:20992
  v_mfma_f32_16x16x32_bf16 v[64:67], v[80:83], a[8:11], v[20:23]
  v_cvt_pk_bf16_f32 v74, v40, v41
  v_cvt_pk_bf16_f32 v75, v42, v43
  v_mfma_f32_16x16x32_bf16 v[64:67], v[84:87], a[24:27], v[64:67]
  v_cvt_pk_bf16_f32 v72, v44, v45
  v_cvt_pk_bf16_f32 v73, v46, v47
  v_mfma_f32_16x16x32_bf16 v[68:71], v[80:83], a[12:15], v[24:27]
  v_cvt_pk_bf16_f32 v78, v48, v49
  v_cvt_pk_bf16_f32 v79, v50, v51
  v_mfma_f32_16x16x32_bf16 v[68:71], v[84:87], a[28:31], v[68:71]
  v_cvt_pk_bf16_f32 v76, v52, v53
  v_cvt_pk_bf16_f32 v77, v54, v55
  s_waitcnt vmcnt(10)
  s_barrier
  s_waitcnt lgkmcnt(4)
  v_mfma_f32_16x16x32_bf16 v[56:59], v[88:91], a[32:35], v[56:59]
  v_add_u32 v103, 49152, v102
  buffer_store_dwordx4 v[72:75], v4, s[28:31], s62 offen offset:0 sc1
  v_mfma_f32_16x16x32_bf16 v[56:59], v[92:95], a[48:51], v[56:59]
  ds_read_b64_tr_b16 v[80:81], v103 offset:0
  buffer_store_dwordx4 v[76:79], v4, s[28:31], s62 offen offset:1024 sc1
  v_mfma_f32_16x16x32_bf16 v[60:63], v[88:91], a[36:39], v[60:63]
  ds_read_b64_tr_b16 v[82:83], v103 offset:512
  v_mov_b32 v12, v8
  v_mfma_f32_16x16x32_bf16 v[60:63], v[92:95], a[52:55], v[60:63]
  ds_read_b64_tr_b16 v[84:85], v103 offset:4096
  v_mov_b32 v13, v9
  v_mfma_f32_16x16x32_bf16 v[64:67], v[88:91], a[40:43], v[64:67]
  ds_read_b64_tr_b16 v[86:87], v103 offset:4608
  v_mov_b32 v14, v8
  v_mfma_f32_16x16x32_bf16 v[64:67], v[92:95], a[56:59], v[64:67]
  v_mov_b32 v15, v9
  s_bfe_u32 s66, s51, 65537
  v_mfma_f32_16x16x32_bf16 v[68:71], v[88:91], a[44:47], v[68:71]
  s_lshl_b32 s66, s66, 1
  v_lshrrev_b32 v48, 3, v2
  v_mfma_f32_16x16x32_bf16 v[68:71], v[92:95], a[60:63], v[68:71]
  v_add_u32 v48, s66, v48
  v_cmp_eq_u32 s[66:67], v48, v3
  s_waitcnt lgkmcnt(4)
  v_mfma_f32_16x16x32_bf16 v[56:59], v[32:35], a[64:67], v[56:59]
  ds_read_b64_tr_b16 v[88:89], v103 offset:8192
  v_and_b32 v48, 1, v2
  v_mfma_f32_16x16x32_bf16 v[56:59], v[36:39], a[80:83], v[56:59]
  ds_read_b64_tr_b16 v[90:91], v103 offset:8704
  v_lshlrev_b32 v48, 4, v48
  v_mfma_f32_16x16x32_bf16 v[60:63], v[32:35], a[68:71], v[60:63]
  ds_read_b64_tr_b16 v[92:93], v103 offset:12288
  v_mov_b32 v49, 0x3f80
  v_mfma_f32_16x16x32_bf16 v[60:63], v[36:39], a[84:87], v[60:63]
  ds_read_b64_tr_b16 v[94:95], v103 offset:12800
  v_lshlrev_b32 v49, v48, v49
  v_mfma_f32_16x16x32_bf16 v[64:67], v[32:35], a[72:75], v[64:67]
  v_cndmask_b32 v49, 0, v49, s[66:67]
  v_bfe_u32 v48, v2, 1, 2
  v_mfma_f32_16x16x32_bf16 v[64:67], v[36:39], a[88:91], v[64:67]
  v_cmp_eq_u32 s[66:67], 0, v48
  s_nop 1
  v_cndmask_b32 v40, 0, v49, s[66:67]
  v_mfma_f32_16x16x32_bf16 v[68:71], v[32:35], a[76:79], v[68:71]
  v_cmp_eq_u32 s[66:67], 1, v48
  s_nop 1
  v_cndmask_b32 v41, 0, v49, s[66:67]
  v_mfma_f32_16x16x32_bf16 v[68:71], v[36:39], a[92:95], v[68:71]
  v_cmp_eq_u32 s[66:67], 2, v48
  s_nop 1
  v_cndmask_b32 v42, 0, v49, s[66:67]
  s_waitcnt lgkmcnt(4)
  v_mfma_f32_16x16x32_bf16 v[56:59], v[80:83], a[96:99], v[56:59]
  ds_read_b64_tr_b16 v[32:33], v103 offset:16384
  v_cmp_eq_u32 s[66:67], 3, v48
  v_mfma_f32_16x16x32_bf16 v[56:59], v[84:87], a[112:115], v[56:59]
  ds_read_b64_tr_b16 v[34:35], v103 offset:16896
  v_cndmask_b32 v43, 0, v49, s[66:67]
  v_mfma_f32_16x16x32_bf16 v[60:63], v[80:83], a[100:103], v[60:63]
  ds_read_b64_tr_b16 v[36:37], v103 offset:20480
  v_mul_u32_u24 v44, 144, v2
  v_mfma_f32_16x16x32_bf16 v[60:63], v[84:87], a[116:119], v[60:63]
  ds_read_b64_tr_b16 v[38:39], v103 offset:20992
  v_lshl_add_u32 v44, v3, 3, v44
  v_mfma_f32_16x16x32_bf16 v[64:67], v[80:83], a[104:107], v[64:67]
  s_lshl_b32 s66, s40, 5
  s_add_u32 s66, s66, 147456
  v_mfma_f32_16x16x32_bf16 v[64:67], v[84:87], a[120:123], v[64:67]
  v_add_u32 v44, s66, v44
  v_lshrrev_b32 v48, 3, v0
  v_mfma_f32_16x16x32_bf16 v[68:71], v[80:83], a[108:111], v[68:71]
  v_and_b32 v49, 7, v0
  v_lshlrev_b32 v49, 4, v49
  v_mfma_f32_16x16x32_bf16 v[68:71], v[84:87], a[124:127], v[68:71]
  v_mul_u32_u24 v45, 144, v48
  v_add_u32 v45, v45, v49
  s_waitcnt vmcnt(2)
  s_barrier
  s_waitcnt lgkmcnt(4)
  v_mfma_f32_16x16x32_bf16 v[60:63], v[8:11], v[104:107], v[60:63]
  v_mfma_f32_16x16x32_bf16 v[68:71], v[8:11], v[132:135], v[68:71]
  v_mfma_f32_16x16x32_bf16 v[56:59], v[88:91], a[128:131], v[56:59]
  v_add_u32 v103, 122880, v102
  v_add_u32 v45, 147456, v45
  v_mfma_f32_16x16x32_bf16 v[56:59], v[92:95], a[144:147], v[56:59]
  ds_read_b64_tr_b16 v[80:81], v103 offset:0
  v_mul_u32_u24 v46, 1152, v48
  v_mfma_f32_16x16x32_bf16 v[60:63], v[88:91], a[132:135], v[60:63]
  ds_read_b64_tr_b16 v[82:83], v103 offset:512
  v_add_u32 v46, v46, v49
  v_mfma_f32_16x16x32_bf16 v[60:63], v[92:95], a[148:151], v[60:63]
  ds_read_b64_tr_b16 v[84:85], v103 offset:4096
  v_mul_u32_u24 v47, 1152, v2
  s_cmp_lg_u32 s40, 3
  s_cbranch_scc1 Lex_142
  buffer_load_dwordx4 v[160:163], v4, s[28:31], s78 offen offset:0 sc1
  s_add_u32 s78, s78, 8192
  buffer_load_dwordx4 v[164:167], v4, s[28:31], s78 offen offset:0 sc1
  s_add_u32 s78, s78, 8192
  buffer_load_dwordx4 v[168:171], v4, s[28:31], s78 offen offset:0 sc1
  s_add_u32 s78, s78, 8192
  buffer_load_dwordx4 v[172:175], v4, s[28:31], s78 offen offset:0 sc1
  s_add_u32 s78, s78, 8192
  buffer_load_dwordx4 v[176:179], v4, s[28:31], s78 offen offset:0 sc1
  s_add_u32 s78, s78, 8192
  buffer_load_dwordx4 v[180:183], v4, s[28:31], s78 offen offset:0 sc1
  s_add_u32 s78, s78, 8192
  buffer_load_dwordx4 v[184:187], v4, s[28:31], s78 offen offset:0 sc1
  s_add_u32 s78, s78, 8192
  buffer_load_dwordx4 v[188:191], v4, s[28:31], s78 offen offset:0 sc1
  s_add_u32 s78, s78, 8192
  s_add_u32 s46, s79, 10027008
  buffer_load_dwordx4 v[192:195], v4, s[28:31], s46 offen offset:0 sc1
  s_add_u32 s46, s79, 10045440
  buffer_load_dwordx4 v[196:199], v4, s[28:31], s46 offen offset:0 sc1
  s_add_u32 s46, s79, 14843904
  buffer_load_dwordx4 v[200:203], v4, s[28:31], s46 offen offset:0 sc1
  s_add_u32 s46, s79, 14862336
  buffer_load_dwordx4 v[204:207], v4, s[28:31], s46 offen offset:0 sc1
Lex_142:
  v_mfma_f32_16x16x32_bf16 v[64:67], v[88:91], a[136:139], v[64:67]
  ds_read_b64_tr_b16 v[86:87], v103 offset:4608
  v_lshl_add_u32 v47, v3, 3, v47
  v_mfma_f32_16x16x32_bf16 v[64:67], v[92:95], a[152:155], v[64:67]
  v_mfma_f32_16x16x32_bf16 v[68:71], v[88:91], a[140:143], v[68:71]
  v_mfma_f32_16x16x32_bf16 v[68:71], v[92:95], a[156:159], v[68:71]
  s_waitcnt lgkmcnt(4)
  v_mfma_f32_16x16x32_bf16 v[56:59], v[12:15], v[106:109], v[56:59]
  v_mfma_f32_16x16x32_bf16 v[64:67], v[12:15], v[134:137], v[64:67]
  v_mfma_f32_16x16x32_bf16 v[56:59], v[32:35], a[160:163], v[56:59]
  ds_read_b64_tr_b16 v[88:89], v103 offset:8192
  v_mfma_f32_16x16x32_bf16 v[56:59], v[36:39], a[176:179], v[56:59]
  ds_read_b64_tr_b16 v[90:91], v103 offset:8704
  v_mfma_f32_16x16x32_bf16 v[60:63], v[32:35], a[164:167], v[60:63]
  ds_read_b64_tr_b16 v[92:93], v103 offset:12288
  v_mfma_f32_16x16x32_bf16 v[60:63], v[36:39], a[180:183], v[60:63]
  ds_read_b64_tr_b16 v[94:95], v103 offset:12800
  v_mfma_f32_16x16x32_bf16 v[64:67], v[32:35], a[168:171], v[64:67]
  v_mfma_f32_16x16x32_bf16 v[64:67], v[36:39], a[184:187], v[64:67]
  v_mfma_f32_16x16x32_bf16 v[68:71], v[32:35], a[172:175], v[68:71]
  v_mfma_f32_16x16x32_bf16 v[68:71], v[36:39], a[188:191], v[68:71]
  s_waitcnt lgkmcnt(4)
  v_mfma_f32_16x16x32_bf16 v[60:63], v[12:15], v[110:113], v[60:63]
  v_mfma_f32_16x16x32_bf16 v[68:71], v[12:15], v[138:141], v[68:71]
  buffer_load_dwordx4 v[124:127], v4, s[28:31], s75 offen offset:0 sc1
  buffer_load_dwordx4 v[152:155], v4, s[28:31], s75 offen offset:1024 sc1
  v_mfma_f32_16x16x32_bf16 v[56:59], v[80:83], a[192:195], v[56:59]
  ds_read_b64_tr_b16 v[32:33], v103 offset:16384
  v_mfma_f32_16x16x32_bf16 v[56:59], v[84:87], a[208:211], v[56:59]
  ds_read_b64_tr_b16 v[34:35], v103 offset:16896
  v_mfma_f32_16x16x32_bf16 v[60:63], v[80:83], a[196:199], v[60:63]
  ds_read_b64_tr_b16 v[36:37], v103 offset:20480
  v_mfma_f32_16x16x32_bf16 v[60:63], v[84:87], a[212:215], v[60:63]
  ds_read_b64_tr_b16 v[38:39], v103 offset:20992
  v_mfma_f32_16x16x32_bf16 v[64:67], v[80:83], a[200:203], v[64:67]
  v_mfma_f32_16x16x32_bf16 v[64:67], v[84:87], a[216:219], v[64:67]
  v_mfma_f32_16x16x32_bf16 v[68:71], v[80:83], a[204:207], v[68:71]
  v_mfma_f32_16x16x32_bf16 v[68:71], v[84:87], a[220:223], v[68:71]
  s_waitcnt lgkmcnt(4)
  v_mfma_f32_16x16x32_bf16 v[56:59], v[12:15], v[114:117], v[56:59]
  v_mfma_f32_16x16x32_bf16 v[64:67], v[12:15], v[142:145], v[64:67]
  v_mfma_f32_16x16x32_bf16 v[56:59], v[88:91], a[224:227], v[56:59]
  v_mfma_f32_16x16x32_bf16 v[56:59], v[92:95], a[240:243], v[56:59]
  v_mfma_f32_16x16x32_bf16 v[60:63], v[88:91], a[228:231], v[60:63]
  v_mfma_f32_16x16x32_bf16 v[60:63], v[92:95], a[244:247], v[60:63]
  v_mfma_f32_16x16x32_bf16 v[64:67], v[88:91], a[232:235], v[64:67]
  v_mfma_f32_16x16x32_bf16 v[64:67], v[92:95], a[248:251], v[64:67]
  v_mfma_f32_16x16x32_bf16 v[68:71], v[88:91], a[236:239], v[68:71]
  v_mfma_f32_16x16x32_bf16 v[68:71], v[92:95], a[252:255], v[68:71]
  s_waitcnt lgkmcnt(0)
  v_mfma_f32_16x16x32_bf16 v[60:63], v[12:15], v[118:121], v[60:63]
  v_mfma_f32_16x16x32_bf16 v[68:71], v[12:15], v[146:149], v[68:71]
  v_mfma_f32_16x16x32_bf16 v[56:59], v[32:35], v[224:227], v[56:59]
  v_mfma_f32_16x16x32_bf16 v[56:59], v[36:39], v[240:243], v[56:59]
  v_mfma_f32_16x16x32_bf16 v[60:63], v[32:35], v[228:231], v[60:63]
  v_mfma_f32_16x16x32_bf16 v[60:63], v[36:39], v[244:247], v[60:63]
  buffer_load_dwordx4 v[128:131], v4, s[28:31], s76 offen offset:0 sc1
  buffer_load_dwordx4 v[156:159], v4, s[28:31], s76 offen offset:1024 sc1
  v_mfma_f32_16x16x32_bf16 v[64:67], v[32:35], v[232:235], v[64:67]
  v_mfma_f32_16x16x32_bf16 v[64:67], v[36:39], v[248:251], v[64:67]
  v_mfma_f32_16x16x32_bf16 v[68:71], v[32:35], v[236:239], v[68:71]
  v_mfma_f32_16x16x32_bf16 v[68:71], v[36:39], v[252:255], v[68:71]
  s_add_u32 s32, s20, 0
  s_addc_u32 s33, s21, 0
  s_mov_b32 s34, 2359296
  s_mov_b32 s35, 0x20000
  s_cmp_lg_u32 s40, 3
  s_cbranch_scc1 L_p7_main
  s_waitcnt vmcnt(4)
  v_mfma_f32_16x16x32_bf16 v[48:51], v[8:11], v[160:163], 0
  v_mfma_f32_16x16x32_bf16 v[52:55], v[6:9], v[160:163], 0
  v_mfma_f32_16x16x32_bf16 v[48:51], v[8:11], v[164:167], v[48:51]
  v_mfma_f32_16x16x32_bf16 v[52:55], v[6:9], v[164:167], v[52:55]
  v_mfma_f32_16x16x32_bf16 v[48:51], v[8:11], v[168:171], v[48:51]
  v_mfma_f32_16x16x32_bf16 v[52:55], v[6:9], v[168:171], v[52:55]
  v_mfma_f32_16x16x32_bf16 v[48:51], v[8:11], v[172:175], v[48:51]
  v_mfma_f32_16x16x32_bf16 v[52:55], v[6:9], v[172:175], v[52:55]
  v_mfma_f32_16x16x32_bf16 v[48:51], v[8:11], v[176:179], v[48:51]
  v_mfma_f32_16x16x32_bf16 v[52:55], v[6:9], v[176:179], v[52:55]
  v_mfma_f32_16x16x32_bf16 v[48:51], v[8:11], v[180:183], v[48:51]
  v_mfma_f32_16x16x32_bf16 v[52:55], v[6:9], v[180:183], v[52:55]
  v_mfma_f32_16x16x32_bf16 v[48:51], v[8:11], v[184:187], v[48:51]
  v_mfma_f32_16x16x32_bf16 v[52:55], v[6:9], v[184:187], v[52:55]
  v_mfma_f32_16x16x32_bf16 v[48:51], v[8:11], v[188:191], v[48:51]
  v_mfma_f32_16x16x32_bf16 v[52:55], v[6:9], v[188:191], v[52:55]
  v_mfma_f32_16x16x32_bf16 v[48:51], v[40:43], v[192:195], v[48:51]
  v_mfma_f32_16x16x32_bf16 v[52:55], v[40:43], v[196:199], v[52:55]
  v_mfma_f32_16x16x32_bf16 v[48:51], v[40:43], v[200:203], v[48:51]
  v_mfma_f32_16x16x32_bf16 v[52:55], v[40:43], v[204:207], v[52:55]
  s_nop 6
  v_cvt_pk_bf16_f32 v72, v48, v49
  v_cvt_pk_bf16_f32 v73, v50, v51
  v_cvt_pk_bf16_f32 v74, v52, v53
  v_cvt_pk_bf16_f32 v75, v54, v55
L_p7_main:
  s_mov_b32 s47, 100000
  s_waitcnt vmcnt(2)
Ltag_143:
  v_max3_u32 v30, v124, v125, v126
  v_max3_u32 v30, v30, v127, v152
  v_max3_u32 v30, v30, v153, v154
  v_max_u32 v30, v30, v155
  v_cmp_eq_u32 vcc, -1, v30
  s_cbranch_vccz Ltag_143_x
  buffer_load_dwordx4 v[124:127], v4, s[28:31], s75 offen offset:0 sc1
  buffer_load_dwordx4 v[152:155], v4, s[28:31], s75 offen offset:1024 sc1
  s_waitcnt vmcnt(0)
  s_sub_u32 s47, s47, 1
  s_cbranch_scc0 Ltag_143
Ltag_143_x:
  v_mfma_f32_16x16x32_bf16 v[56:59], v[12:15], v[122:125], v[56:59]
  v_mfma_f32_16x16x32_bf16 v[64:67], v[12:15], v[150:153], v[64:67]
  s_mov_b32 s47, 100000
  s_waitcnt vmcnt(0)
Ltag_144:
  v_max3_u32 v30, v128, v129, v130
  v_max3_u32 v30, v30, v131, v156
  v_max3_u32 v30, v30, v157, v158
  v_max_u32 v30, v30, v159
  v_cmp_eq_u32 vcc, -1, v30
  s_cbranch_vccz Ltag_144_x
  buffer_load_dwordx4 v[128:131], v4, s[28:31], s76 offen offset:0 sc1
  buffer_load_dwordx4 v[156:159], v4, s[28:31], s76 offen offset:1024 sc1
  s_waitcnt vmcnt(0)
  s_sub_u32 s47, s47, 1
  s_cbranch_scc0 Ltag_144
Ltag_144_x:
  v_mfma_f32_16x16x32_bf16 v[60:63], v[12:15], v[126:129], v[60:63]
  v_mfma_f32_16x16x32_bf16 v[68:71], v[12:15], v[154:157], v[68:71]
  v_mfma_f32_16x16x32_bf16 v[56:59], v[6:9], v[128:131], v[56:59]
  v_mfma_f32_16x16x32_bf16 v[64:67], v[6:9], v[156:159], v[64:67]
  s_cmp_lg_u32 s40, 3
  s_nop 1
  s_cbranch_scc1 L_p7_acc
  buffer_store_dwordx2 v[72:73], v47, s[32:35], s74 offen
  s_add_u32 s74, s74, 18432
  buffer_store_dwordx2 v[74:75], v47, s[32:35], s74 offen
  s_add_u32 s74, s74, 18432
L_p7_acc:
  s_lshl_b32 s46, s51, 7
  s_add_u32 s46, s46, s60
  s_add_u32 s47, s46, 36864
  v_cvt_pk_bf16_f32 v12, v56, v57
  v_cvt_pk_bf16_f32 v13, v58, v59
  ds_write_b64 v44, v[12:13] offset:0
  v_cvt_pk_bf16_f32 v14, v60, v61
  v_cvt_pk_bf16_f32 v15, v62, v63
  ds_write_b64 v44, v[14:15] offset:2304
  v_cvt_pk_bf16_f32 v16, v64, v65
  v_cvt_pk_bf16_f32 v17, v66, v67
  ds_write_b64 v44, v[16:17] offset:4608
  v_cvt_pk_bf16_f32 v18, v68, v69
  v_cvt_pk_bf16_f32 v19, v70, v71
  ds_write_b64 v44, v[18:19] offset:6912
  s_waitcnt lgkmcnt(0)
  s_barrier
  ds_read_b128 v[20:23], v45 offset:0
  ds_read_b128 v[24:27], v45 offset:4608
  s_waitcnt lgkmcnt(1)
  buffer_store_dwordx4 v[20:23], v46, s[32:35], s46 offen
  s_waitcnt lgkmcnt(0)
  buffer_store_dwordx4 v[24:27], v46, s[32:35], s47 offen
L_fin:
L_end:
  s_endpgm
Ltg_87:
  buffer_load_dwordx4 v[64:67], v4, s[28:31], s60 offen offset:0 sc1
  buffer_load_dwordx4 v[68:71], v4, s[28:31], s60 offen offset:1024 sc1
  s_waitcnt vmcnt(0)
  v_max3_u32 v30, v64, v65, v66
  v_max3_u32 v30, v30, v67, v68
  v_max3_u32 v30, v30, v69, v70
  v_max_u32 v30, v30, v71
  v_cmp_eq_u32 vcc, -1, v30
  s_cmp_eq_u32 s79, 0
  s_cbranch_scc1 Ltg_87_b
  s_sub_u32 s79, s79, 1
  s_cbranch_vccnz Ltg_87
  buffer_load_dwordx4 v[72:75], v4, s[28:31], s60 offen offset:2048 sc1
  buffer_load_dwordx4 v[76:79], v4, s[28:31], s60 offen offset:3072 sc1
  buffer_load_dwordx4 v[80:83], v4, s[28:31], s61 offen offset:0 sc1
  buffer_load_dwordx4 v[84:87], v4, s[28:31], s61 offen offset:1024 sc1
  buffer_load_dwordx4 v[88:91], v4, s[28:31], s61 offen offset:2048 sc1
  buffer_load_dwordx4 v[92:95], v4, s[28:31], s61 offen offset:3072 sc1
  s_branch Ltg_87_b
Ltg_88:
  buffer_load_dwordx4 v[72:75], v4, s[28:31], s60 offen offset:2048 sc1
  buffer_load_dwordx4 v[76:79], v4, s[28:31], s60 offen offset:3072 sc1
  s_waitcnt vmcnt(0)
  v_max3_u32 v30, v72, v73, v74
  v_max3_u32 v30, v30, v75, v76
  v_max3_u32 v30, v30, v77, v78
  v_max_u32 v30, v30, v79
  v_cmp_eq_u32 vcc, -1, v30
  s_cmp_eq_u32 s79, 0
  s_cbranch_scc1 Ltg_88_b
  s_sub_u32 s79, s79, 1
  s_cbranch_vccnz Ltg_88
  buffer_load_dwordx4 v[80:83], v4, s[28:31], s61 offen offset:0 sc1
  buffer_load_dwordx4 v[84:87], v4, s[28:31], s61 offen offset:1024 sc1
  buffer_load_dwordx4 v[88:91], v4, s[28:31], s61 offen offset:2048 sc1
  buffer_load_dwordx4 v[92:95], v4, s[28:31], s61 offen offset:3072 sc1
  buffer_load_dwordx4 v[96:99], v4, s[28:31], s62 offen offset:0 sc1
  buffer_load_dwordx4 v[100:103], v4, s[28:31], s62 offen offset:1024 sc1
  s_branch Ltg_88_b
Ltg_89:
  buffer_load_dwordx4 v[80:83], v4, s[28:31], s61 offen offset:0 sc1
  buffer_load_dwordx4 v[84:87], v4, s[28:31], s61 offen offset:1024 sc1
  s_waitcnt vmcnt(0)
  v_max3_u32 v30, v80, v81, v82
  v_max3_u32 v30, v30, v83, v84
  v_max3_u32 v30, v30, v85, v86
  v_max_u32 v30, v30, v87
  v_cmp_eq_u32 vcc, -1, v30
  s_cmp_eq_u32 s79, 0
  s_cbranch_scc1 Ltg_89_b
  s_sub_u32 s79, s79, 1
  s_cbranch_vccnz Ltg_89
  buffer_load_dwordx4 v[88:91], v4, s[28:31], s61 offen offset:2048 sc1
  buffer_load_dwordx4 v[92:95], v4, s[28:31], s61 offen offset:3072 sc1
  buffer_load_dwordx4 v[96:99], v4, s[28:31], s62 offen offset:0 sc1
  buffer_load_dwordx4 v[100:103], v4, s[28:31], s62 offen offset:1024 sc1
  buffer_load_dwordx4 v[104:107], v4, s[28:31], s62 offen offset:2048 sc1
  buffer_load_dwordx4 v[108:111], v4, s[28:31], s62 offen offset:3072 sc1
  s_branch Ltg_89_b
Ltg_90:
  buffer_load_dwordx4 v[88:91], v4, s[28:31], s61 offen offset:2048 sc1
  buffer_load_dwordx4 v[92:95], v4, s[28:31], s61 offen offset:3072 sc1
  s_waitcnt vmcnt(0)
  v_max3_u32 v30, v88, v89, v90
  v_max3_u32 v30, v30, v91, v92
  v_max3_u32 v30, v30, v93, v94
  v_max_u32 v30, v30, v95
  v_cmp_eq_u32 vcc, -1, v30
  s_cmp_eq_u32 s79, 0
  s_cbranch_scc1 Ltg_90_b
  s_sub_u32 s79, s79, 1
  s_cbranch_vccnz Ltg_90
  buffer_load_dwordx4 v[96:99], v4, s[28:31], s62 offen offset:0 sc1
  buffer_load_dwordx4 v[100:103], v4, s[28:31], s62 offen offset:1024 sc1
  buffer_load_dwordx4 v[104:107], v4, s[28:31], s62 offen offset:2048 sc1
  buffer_load_dwordx4 v[108:111], v4, s[28:31], s62 offen offset:3072 sc1
  buffer_load_dwordx4 v[112:115], v4, s[28:31], s63 offen offset:0 sc1
  buffer_load_dwordx4 v[116:119], v4, s[28:31], s63 offen offset:1024 sc1
  s_branch Ltg_90_b
Ltg_91:
  buffer_load_dwordx4 v[96:99], v4, s[28:31], s62 offen offset:0 sc1
  buffer_load_dwordx4 v[100:103], v4, s[28:31], s62 offen offset:1024 sc1
  s_waitcnt vmcnt(0)
  v_max3_u32 v30, v96, v97, v98
  v_max3_u32 v30, v30, v99, v100
  v_max3_u32 v30, v30, v101, v102
  v_max_u32 v30, v30, v103
  v_cmp_eq_u32 vcc, -1, v30
  s_cmp_eq_u32 s79, 0
  s_cbranch_scc1 Ltg_91_b
  s_sub_u32 s79, s79, 1
  s_cbranch_vccnz Ltg_91
  buffer_load_dwordx4 v[104:107], v4, s[28:31], s62 offen offset:2048 sc1
  buffer_load_dwordx4 v[108:111], v4, s[28:31], s62 offen offset:3072 sc1
  buffer_load_dwordx4 v[112:115], v4, s[28:31], s63 offen offset:0 sc1
  buffer_load_dwordx4 v[116:119], v4, s[28:31], s63 offen offset:1024 sc1
  buffer_load_dwordx4 v[120:123], v4, s[28:31], s63 offen offset:2048 sc1
  buffer_load_dwordx4 v[124:127], v4, s[28:31], s63 offen offset:3072 sc1
  s_branch Ltg_91_b
Ltg_92:
  buffer_load_dwordx4 v[104:107], v4, s[28:31], s62 offen offset:2048 sc1
  buffer_load_dwordx4 v[108:111], v4, s[28:31], s62 offen offset:3072 sc1
  s_waitcnt vmcnt(0)
  v_max3_u32 v30, v104, v105, v106
  v_max3_u32 v30, v30, v107, v108
  v_max3_u32 v30, v30, v109, v110
  v_max_u32 v30, v30, v111
  v_cmp_eq_u32 vcc, -1, v30
  s_cmp_eq_u32 s79, 0
  s_cbranch_scc1 Ltg_92_b
  s_sub_u32 s79, s79, 1
  s_cbranch_vccnz Ltg_92
  buffer_load_dwordx4 v[112:115], v4, s[28:31], s63 offen offset:0 sc1
  buffer_load_dwordx4 v[116:119], v4, s[28:31], s63 offen offset:1024 sc1
  buffer_load_dwordx4 v[120:123], v4, s[28:31], s63 offen offset:2048 sc1
  buffer_load_dwordx4 v[124:127], v4, s[28:31], s63 offen offset:3072 sc1
  buffer_load_dwordx4 v[128:131], v4, s[28:31], s64 offen offset:0 sc1
  buffer_load_dwordx4 v[132:135], v4, s[28:31], s64 offen offset:1024 sc1
  s_waitcnt vmcnt(0)
  s_branch Ltg_92_b
Ltg_93:
  buffer_load_dwordx4 v[112:115], v4, s[28:31], s63 offen offset:0 sc1
  buffer_load_dwordx4 v[116:119], v4, s[28:31], s63 offen offset:1024 sc1
  s_waitcnt vmcnt(0)
  v_max3_u32 v30, v112, v113, v114
  v_max3_u32 v30, v30, v115, v116
  v_max3_u32 v30, v30, v117, v118
  v_max_u32 v30, v30, v119
  v_cmp_eq_u32 vcc, -1, v30
  s_cmp_eq_u32 s79, 0
  s_cbranch_scc1 Ltg_93_b
  s_sub_u32 s79, s79, 1
  s_cbranch_vccnz Ltg_93
  buffer_load_dwordx4 v[120:123], v4, s[28:31], s63 offen offset:2048 sc1
  buffer_load_dwordx4 v[124:127], v4, s[28:31], s63 offen offset:3072 sc1
  buffer_load_dwordx4 v[128:131], v4, s[28:31], s64 offen offset:0 sc1
  buffer_load_dwordx4 v[132:135], v4, s[28:31], s64 offen offset:1024 sc1
  s_waitcnt vmcnt(0)
  s_branch Ltg_93_b
Ltg_94:
  buffer_load_dwordx4 v[120:123], v4, s[28:31], s63 offen offset:2048 sc1
  buffer_load_dwordx4 v[124:127], v4, s[28:31], s63 offen offset:3072 sc1
  s_waitcnt vmcnt(0)
  v_max3_u32 v30, v120, v121, v122
  v_max3_u32 v30, v30, v123, v124
  v_max3_u32 v30, v30, v125, v126
  v_max_u32 v30, v30, v127
  v_cmp_eq_u32 vcc, -1, v30
  s_cmp_eq_u32 s79, 0
  s_cbranch_scc1 Ltg_94_b
  s_sub_u32 s79, s79, 1
  s_cbranch_vccnz Ltg_94
  buffer_load_dwordx4 v[128:131], v4, s[28:31], s64 offen offset:0 sc1
  buffer_load_dwordx4 v[132:135], v4, s[28:31], s64 offen offset:1024 sc1
  s_waitcnt vmcnt(0)
  s_branch Ltg_94_b
Ltg_95:
  buffer_load_dwordx4 v[128:131], v4, s[28:31], s64 offen offset:0 sc1
  buffer_load_dwordx4 v[132:135], v4, s[28:31], s64 offen offset:1024 sc1
  s_waitcnt vmcnt(0)
  v_max3_u32 v30, v128, v129, v130
  v_max3_u32 v30, v30, v131, v132
  v_max3_u32 v30, v30, v133, v134
  v_max_u32 v30, v30, v135
  v_cmp_eq_u32 vcc, -1, v30
  s_cmp_eq_u32 s79, 0
  s_cbranch_scc1 Ltg_95_b
  s_sub_u32 s79, s79, 1
  s_cbranch_vccnz Ltg_95
  s_branch Ltg_95_b
Ltg_97:
  buffer_load_dwordx2 v[10:11], v14, s[28:31], s65 offen sc1
  buffer_load_dwordx2 v[12:13], v15, s[28:31], s65 offen sc1
  s_waitcnt vmcnt(0)
  v_max3_u32 v30, v10, v11, v12
  v_max_u32 v30, v30, v13
  v_cmp_eq_u32 vcc, -1, v30
  s_cmp_eq_u32 s79, 0
  s_cbranch_scc1 Ltg_97_b
  s_sub_u32 s79, s79, 1
  s_cbranch_vccnz Ltg_97
  buffer_load_dwordx4 v[64:67], v4, s[28:31], s60 offen offset:0 sc1
  buffer_load_dwordx4 v[68:71], v4, s[28:31], s60 offen offset:1024 sc1
  buffer_load_dwordx4 v[72:75], v4, s[28:31], s60 offen offset:2048 sc1
  buffer_load_dwordx4 v[76:79], v4, s[28:31], s60 offen offset:3072 sc1
  buffer_load_dwordx4 v[80:83], v4, s[28:31], s61 offen offset:0 sc1
  buffer_load_dwordx4 v[84:87], v4, s[28:31], s61 offen offset:1024 sc1
  buffer_load_dwordx4 v[88:91], v4, s[28:31], s61 offen offset:2048 sc1
  buffer_load_dwordx4 v[92:95], v4, s[28:31], s61 offen offset:3072 sc1
  s_branch Ltg_97_b
Ltg_98:
  buffer_load_dwordx4 v[64:67], v4, s[28:31], s60 offen offset:0 sc1
  buffer_load_dwordx4 v[68:71], v4, s[28:31], s60 offen offset:1024 sc1
  s_waitcnt vmcnt(0)
  v_max3_u32 v30, v64, v65, v66
  v_max3_u32 v30, v30, v67, v68
  v_max3_u32 v30, v30, v69, v70
  v_max_u32 v30, v30, v71
  v_cmp_eq_u32 vcc, -1, v30
  s_cmp_eq_u32 s79, 0
  s_cbranch_scc1 Ltg_98_b
  s_sub_u32 s79, s79, 1
  s_cbranch_vccnz Ltg_98
  buffer_load_dwordx4 v[72:75], v4, s[28:31], s60 offen offset:2048 sc1
  buffer_load_dwordx4 v[76:79], v4, s[28:31], s60 offen offset:3072 sc1
  buffer_load_dwordx4 v[80:83], v4, s[28:31], s61 offen offset:0 sc1
  buffer_load_dwordx4 v[84:87], v4, s[28:31], s61 offen offset:1024 sc1
  buffer_load_dwordx4 v[88:91], v4, s[28:31], s61 offen offset:2048 sc1
  buffer_load_dwordx4 v[92:95], v4, s[28:31], s61 offen offset:3072 sc1
  s_branch Ltg_98_b
Ltg_99:
  buffer_load_dwordx4 v[72:75], v4, s[28:31], s60 offen offset:2048 sc1
  buffer_load_dwordx4 v[76:79], v4, s[28:31], s60 offen offset:3072 sc1
  s_waitcnt vmcnt(0)
  v_max3_u32 v30, v72, v73, v74
  v_max3_u32 v30, v30, v75, v76
  v_max3_u32 v30, v30, v77, v78
  v_max_u32 v30, v30, v79
  v_cmp_eq_u32 vcc, -1, v30
  s_cmp_eq_u32 s79, 0
  s_cbranch_scc1 Ltg_99_b
  s_sub_u32 s79, s79, 1
  s_cbranch_vccnz Ltg_99
  buffer_load_dwordx4 v[80:83], v4, s[28:31], s61 offen offset:0 sc1
  buffer_load_dwordx4 v[84:87], v4, s[28:31], s61 offen offset:1024 sc1
  buffer_load_dwordx4 v[88:91], v4, s[28:31], s61 offen offset:2048 sc1
  buffer_load_dwordx4 v[92:95], v4, s[28:31], s61 offen offset:3072 sc1
  buffer_load_dwordx4 v[96:99], v4, s[28:31], s62 offen offset:0 sc1
  buffer_load_dwordx4 v[100:103], v4, s[28:31], s62 offen offset:1024 sc1
  s_branch Ltg_99_b
Ltg_100:
  buffer_load_dwordx4 v[80:83], v4, s[28:31], s61 offen offset:0 sc1
  buffer_load_dwordx4 v[84:87], v4, s[28:31], s61 offen offset:1024 sc1
  s_waitcnt vmcnt(0)
  v_max3_u32 v30, v80, v81, v82
  v_max3_u32 v30, v30, v83, v84
  v_max3_u32 v30, v30, v85, v86
  v_max_u32 v30, v30, v87
  v_cmp_eq_u32 vcc, -1, v30
  s_cmp_eq_u32 s79, 0
  s_cbranch_scc1 Ltg_100_b
  s_sub_u32 s79, s79, 1
  s_cbranch_vccnz Ltg_100
  buffer_load_dwordx4 v[88:91], v4, s[28:31], s61 offen offset:2048 sc1
  buffer_load_dwordx4 v[92:95], v4, s[28:31], s61 offen offset:3072 sc1
  buffer_load_dwordx4 v[96:99], v4, s[28:31], s62 offen offset:0 sc1
  buffer_load_dwordx4 v[100:103], v4, s[28:31], s62 offen offset:1024 sc1
  buffer_load_dwordx4 v[104:107], v4, s[28:31], s62 offen offset:2048 sc1
  buffer_load_dwordx4 v[108:111], v4, s[28:31], s62 offen offset:3072 sc1
  s_branch Ltg_100_b
Ltg_101:
  buffer_load_dwordx4 v[88:91], v4, s[28:31], s61 offen offset:2048 sc1
  buffer_load_dwordx4 v[92:95], v4, s[28:31], s61 offen offset:3072 sc1
  s_waitcnt vmcnt(0)
  v_max3_u32 v30, v88, v89, v90
  v_max3_u32 v30, v30, v91, v92
  v_max3_u32 v30, v30, v93, v94
  v_max_u32 v30, v30, v95
  v_cmp_eq_u32 vcc, -1, v30
  s_cmp_eq_u32 s79, 0
  s_cbranch_scc1 Ltg_101_b
  s_sub_u32 s79, s79, 1
  s_cbranch_vccnz Ltg_101
  buffer_load_dwordx4 v[96:99], v4, s[28:31], s62 offen offset:0 sc1
  buffer_load_dwordx4 v[100:103], v4, s[28:31], s62 offen offset:1024 sc1
  buffer_load_dwordx4 v[104:107], v4, s[28:31], s62 offen offset:2048 sc1
  buffer_load_dwordx4 v[108:111], v4, s[28:31], s62 offen offset:3072 sc1
  buffer_load_dwordx4 v[112:115], v4, s[28:31], s63 offen offset:0 sc1
  buffer_load_dwordx4 v[116:119], v4, s[28:31], s63 offen offset:1024 sc1
  s_branch Ltg_101_b
Ltg_102:
  buffer_load_dwordx4 v[96:99], v4, s[28:31], s62 offen offset:0 sc1
  buffer_load_dwordx4 v[100:103], v4, s[28:31], s62 offen offset:1024 sc1
  s_waitcnt vmcnt(0)
  v_max3_u32 v30, v96, v97, v98
  v_max3_u32 v30, v30, v99, v100
  v_max3_u32 v30, v30, v101, v102
  v_max_u32 v30, v30, v103
  v_cmp_eq_u32 vcc, -1, v30
  s_cmp_eq_u32 s79, 0
  s_cbranch_scc1 Ltg_102_b
  s_sub_u32 s79, s79, 1
  s_cbranch_vccnz Ltg_102
  buffer_load_dwordx4 v[104:107], v4, s[28:31], s62 offen offset:2048 sc1
  buffer_load_dwordx4 v[108:111], v4, s[28:31], s62 offen offset:3072 sc1
  buffer_load_dwordx4 v[112:115], v4, s[28:31], s63 offen offset:0 sc1
  buffer_load_dwordx4 v[116:119], v4, s[28:31], s63 offen offset:1024 sc1
  buffer_load_dwordx4 v[120:123], v4, s[28:31], s63 offen offset:2048 sc1
  buffer_load_dwordx4 v[124:127], v4, s[28:31], s63 offen offset:3072 sc1
  s_branch Ltg_102_b
Ltg_103:
  buffer_load_dwordx4 v[104:107], v4, s[28:31], s62 offen offset:2048 sc1
  buffer_load_dwordx4 v[108:111], v4, s[28:31], s62 offen offset:3072 sc1
  s_waitcnt vmcnt(0)
  v_max3_u32 v30, v104, v105, v106
  v_max3_u32 v30, v30, v107, v108
  v_max3_u32 v30, v30, v109, v110
  v_max_u32 v30, v30, v111
  v_cmp_eq_u32 vcc, -1, v30
  s_cmp_eq_u32 s79, 0
  s_cbranch_scc1 Ltg_103_b
  s_sub_u32 s79, s79, 1
  s_cbranch_vccnz Ltg_103
  buffer_load_dwordx4 v[112:115], v4, s[28:31], s63 offen offset:0 sc1
  buffer_load_dwordx4 v[116:119], v4, s[28:31], s63 offen offset:1024 sc1
  buffer_load_dwordx4 v[120:123], v4, s[28:31], s63 offen offset:2048 sc1
  buffer_load_dwordx4 v[124:127], v4, s[28:31], s63 offen offset:3072 sc1
  buffer_load_dwordx4 v[128:131], v4, s[28:31], s64 offen offset:0 sc1
  buffer_load_dwordx4 v[132:135], v4, s[28:31], s64 offen offset:1024 sc1
  s_waitcnt vmcnt(0)
  s_branch Ltg_103_b
Ltg_104:
  buffer_load_dwordx4 v[112:115], v4, s[28:31], s63 offen offset:0 sc1
  buffer_load_dwordx4 v[116:119], v4, s[28:31], s63 offen offset:1024 sc1
  s_waitcnt vmcnt(0)
  v_max3_u32 v30, v112, v113, v114
  v_max3_u32 v30, v30, v115, v116
  v_max3_u32 v30, v30, v117, v118
  v_max_u32 v30, v30, v119
  v_cmp_eq_u32 vcc, -1, v30
  s_cmp_eq_u32 s79, 0
  s_cbranch_scc1 Ltg_104_b
  s_sub_u32 s79, s79, 1
  s_cbranch_vccnz Ltg_104
  buffer_load_dwordx4 v[120:123], v4, s[28:31], s63 offen offset:2048 sc1
  buffer_load_dwordx4 v[124:127], v4, s[28:31], s63 offen offset:3072 sc1
  buffer_load_dwordx4 v[128:131], v4, s[28:31], s64 offen offset:0 sc1
  buffer_load_dwordx4 v[132:135], v4, s[28:31], s64 offen offset:1024 sc1
  s_waitcnt vmcnt(0)
  s_branch Ltg_104_b
Ltg_105:
  buffer_load_dwordx4 v[120:123], v4, s[28:31], s63 offen offset:2048 sc1
  buffer_load_dwordx4 v[124:127], v4, s[28:31], s63 offen offset:3072 sc1
  s_waitcnt vmcnt(0)
  v_max3_u32 v30, v120, v121, v122
  v_max3_u32 v30, v30, v123, v124
  v_max3_u32 v30, v30, v125, v126
  v_max_u32 v30, v30, v127
  v_cmp_eq_u32 vcc, -1, v30
  s_cmp_eq_u32 s79, 0
  s_cbranch_scc1 Ltg_105_b
  s_sub_u32 s79, s79, 1
  s_cbranch_vccnz Ltg_105
  buffer_load_dwordx4 v[128:131], v4, s[28:31], s64 offen offset:0 sc1
  buffer_load_dwordx4 v[132:135], v4, s[28:31], s64 offen offset:1024 sc1
  s_waitcnt vmcnt(0)
  s_branch Ltg_105_b
Ltg_106:
  buffer_load_dwordx4 v[128:131], v4, s[28:31], s64 offen offset:0 sc1
  buffer_load_dwordx4 v[132:135], v4, s[28:31], s64 offen offset:1024 sc1
  s_waitcnt vmcnt(0)
  v_max3_u32 v30, v128, v129, v130
  v_max3_u32 v30, v30, v131, v132
  v_max3_u32 v30, v30, v133, v134
  v_max_u32 v30, v30, v135
  v_cmp_eq_u32 vcc, -1, v30
  s_cmp_eq_u32 s79, 0
  s_cbranch_scc1 Ltg_106_b
  s_sub_u32 s79, s79, 1
  s_cbranch_vccnz Ltg_106
  s_branch Ltg_106_b
Ltg_107:
  buffer_load_dwordx4 v[64:67], v56, s[32:35], s70 offen offset:0 sc1
  buffer_load_dwordx4 v[68:71], v56, s[32:35], s70 offen offset:1024 sc1
  s_waitcnt vmcnt(0)
  v_max3_u32 v30, v64, v65, v66
  v_max3_u32 v30, v30, v67, v68
  v_max3_u32 v30, v30, v69, v70
  v_max_u32 v30, v30, v71
  v_cmp_eq_u32 vcc, -1, v30
  s_cmp_eq_u32 s79, 0
  s_cbranch_scc1 Ltg_107_b
  s_sub_u32 s79, s79, 1
  s_cbranch_vccnz Ltg_107
  buffer_load_dwordx4 v[72:75], v56, s[32:35], s70 offen offset:2048 sc1
  buffer_load_dwordx4 v[76:79], v56, s[32:35], s70 offen offset:3072 sc1
  buffer_load_dwordx4 v[80:83], v60, s[32:35], s71 offen offset:0 sc1
  buffer_load_dwordx4 v[84:87], v57, s[32:35], s71 offen offset:1024 sc1
  buffer_load_dwordx4 v[88:91], v57, s[32:35], s71 offen offset:2048 sc1
  buffer_load_dwordx4 v[92:95], v57, s[32:35], s71 offen offset:3072 sc1
  s_branch Ltg_107_b
Ltg_108:
  buffer_load_dwordx4 v[72:75], v56, s[32:35], s70 offen offset:2048 sc1
  buffer_load_dwordx4 v[76:79], v56, s[32:35], s70 offen offset:3072 sc1
  s_waitcnt vmcnt(0)
  v_max3_u32 v30, v72, v73, v74
  v_max3_u32 v30, v30, v75, v76
  v_max3_u32 v30, v30, v77, v78
  v_max_u32 v30, v30, v79
  v_cmp_eq_u32 vcc, -1, v30
  s_cmp_eq_u32 s79, 0
  s_cbranch_scc1 Ltg_108_b
  s_sub_u32 s79, s79, 1
  s_cbranch_vccnz Ltg_108
  buffer_load_dwordx4 v[80:83], v60, s[32:35], s71 offen offset:0 sc1
  buffer_load_dwordx4 v[84:87], v57, s[32:35], s71 offen offset:1024 sc1
  buffer_load_dwordx4 v[88:91], v57, s[32:35], s71 offen offset:2048 sc1
  buffer_load_dwordx4 v[92:95], v57, s[32:35], s71 offen offset:3072 sc1
  buffer_load_dwordx4 v[96:99], v57, s[32:35], s72 offen offset:0 sc1
  buffer_load_dwordx4 v[100:103], v58, s[32:35], s72 offen offset:1024 sc1
  s_branch Ltg_108_b
Ltg_109:
  buffer_load_dwordx4 v[80:83], v60, s[32:35], s71 offen offset:0 sc1
  buffer_load_dwordx4 v[84:87], v57, s[32:35], s71 offen offset:1024 sc1
  s_waitcnt vmcnt(0)
  v_max3_u32 v30, v80, v81, v82
  v_max3_u32 v30, v30, v83, v84
  v_max3_u32 v30, v30, v85, v86
  v_max_u32 v30, v30, v87
  v_cmp_eq_u32 vcc, -1, v30
  s_cmp_eq_u32 s79, 0
  s_cbranch_scc1 Ltg_109_b
  s_sub_u32 s79, s79, 1
  s_cbranch_vccnz Ltg_109
  buffer_load_dwordx4 v[88:91], v57, s[32:35], s71 offen offset:2048 sc1
  buffer_load_dwordx4 v[92:95], v57, s[32:35], s71 offen offset:3072 sc1
  buffer_load_dwordx4 v[96:99], v57, s[32:35], s72 offen offset:0 sc1
  buffer_load_dwordx4 v[100:103], v58, s[32:35], s72 offen offset:1024 sc1
  buffer_load_dwordx4 v[104:107], v58, s[32:35], s72 offen offset:2048 sc1
  buffer_load_dwordx4 v[108:111], v58, s[32:35], s72 offen offset:3072 sc1
  s_branch Ltg_109_b
Ltg_110:
  buffer_load_dwordx4 v[88:91], v57, s[32:35], s71 offen offset:2048 sc1
  buffer_load_dwordx4 v[92:95], v57, s[32:35], s71 offen offset:3072 sc1
  s_waitcnt vmcnt(0)
  v_max3_u32 v30, v88, v89, v90
  v_max3_u32 v30, v30, v91, v92
  v_max3_u32 v30, v30, v93, v94
  v_max_u32 v30, v30, v95
  v_cmp_eq_u32 vcc, -1, v30
  s_cmp_eq_u32 s79, 0
  s_cbranch_scc1 Ltg_110_b
  s_sub_u32 s79, s79, 1
  s_cbranch_vccnz Ltg_110
  buffer_load_dwordx4 v[96:99], v57, s[32:35], s72 offen offset:0 sc1
  buffer_load_dwordx4 v[100:103], v58, s[32:35], s72 offen offset:1024 sc1
  buffer_load_dwordx4 v[104:107], v58, s[32:35], s72 offen offset:2048 sc1
  buffer_load_dwordx4 v[108:111], v58, s[32:35], s72 offen offset:3072 sc1
  buffer_load_dwordx4 v[112:115], v58, s[32:35], s73 offen offset:0 sc1
  buffer_load_dwordx4 v[116:119], v61, s[32:35], s73 offen offset:1024 sc1
  s_branch Ltg_110_b
Ltg_111:
  buffer_load_dwordx4 v[96:99], v57, s[32:35], s72 offen offset:0 sc1
  buffer_load_dwordx4 v[100:103], v58, s[32:35], s72 offen offset:1024 sc1
  s_waitcnt vmcnt(0)
  v_max3_u32 v30, v96, v97, v98
  v_max3_u32 v30, v30, v99, v100
  v_max3_u32 v30, v30, v101, v102
  v_max_u32 v30, v30, v103
  v_cmp_eq_u32 vcc, -1, v30
  s_cmp_eq_u32 s79, 0
  s_cbranch_scc1 Ltg_111_b
  s_sub_u32 s79, s79, 1
  s_cbranch_vccnz Ltg_111
  buffer_load_dwordx4 v[104:107], v58, s[32:35], s72 offen offset:2048 sc1
  buffer_load_dwordx4 v[108:111], v58, s[32:35], s72 offen offset:3072 sc1
  buffer_load_dwordx4 v[112:115], v58, s[32:35], s73 offen offset:0 sc1
  buffer_load_dwordx4 v[116:119], v61, s[32:35], s73 offen offset:1024 sc1
  buffer_load_dwordx4 v[120:123], v59, s[32:35], s73 offen offset:2048 sc1
  buffer_load_dwordx4 v[124:127], v59, s[32:35], s73 offen offset:3072 sc1
  s_branch Ltg_111_b
Ltg_112:
  buffer_load_dwordx4 v[104:107], v58, s[32:35], s72 offen offset:2048 sc1
  buffer_load_dwordx4 v[108:111], v58, s[32:35], s72 offen offset:3072 sc1
  s_waitcnt vmcnt(0)
  v_max3_u32 v30, v104, v105, v106
  v_max3_u32 v30, v30, v107, v108
  v_max3_u32 v30, v30, v109, v110
  v_max_u32 v30, v30, v111
  v_cmp_eq_u32 vcc, -1, v30
  s_cmp_eq_u32 s79, 0
  s_cbranch_scc1 Ltg_112_b
  s_sub_u32 s79, s79, 1
  s_cbranch_vccnz Ltg_112
  buffer_load_dwordx4 v[112:115], v58, s[32:35], s73 offen offset:0 sc1
  buffer_load_dwordx4 v[116:119], v61, s[32:35], s73 offen offset:1024 sc1
  buffer_load_dwordx4 v[120:123], v59, s[32:35], s73 offen offset:2048 sc1
  buffer_load_dwordx4 v[124:127], v59, s[32:35], s73 offen offset:3072 sc1
  buffer_load_dwordx4 v[128:131], v59, s[32:35], s74 offen offset:0 sc1
  buffer_load_dwordx4 v[132:135], v59, s[32:35], s74 offen offset:1024 sc1
  s_branch Ltg_112_b
Ltg_113:
  buffer_load_dwordx4 v[112:115], v58, s[32:35], s73 offen offset:0 sc1
  buffer_load_dwordx4 v[116:119], v61, s[32:35], s73 offen offset:1024 sc1
  s_waitcnt vmcnt(0)
  v_max3_u32 v30, v112, v113, v114
  v_max3_u32 v30, v30, v115, v116
  v_max3_u32 v30, v30, v117, v118
  v_max_u32 v30, v30, v119
  v_cmp_eq_u32 vcc, -1, v30
  s_cmp_eq_u32 s79, 0
  s_cbranch_scc1 Ltg_113_b
  s_sub_u32 s79, s79, 1
  s_cbranch_vccnz Ltg_113
  buffer_load_dwordx4 v[120:123], v59, s[32:35], s73 offen offset:2048 sc1
  buffer_load_dwordx4 v[124:127], v59, s[32:35], s73 offen offset:3072 sc1
  buffer_load_dwordx4 v[128:131], v59, s[32:35], s74 offen offset:0 sc1
  buffer_load_dwordx4 v[132:135], v59, s[32:35], s74 offen offset:1024 sc1
  s_branch Ltg_113_b
Ltg_114:
  buffer_load_dwordx4 v[120:123], v59, s[32:35], s73 offen offset:2048 sc1
  buffer_load_dwordx4 v[124:127], v59, s[32:35], s73 offen offset:3072 sc1
  s_waitcnt vmcnt(0)
  v_max3_u32 v30, v120, v121, v122
  v_max3_u32 v30, v30, v123, v124
  v_max3_u32 v30, v30, v125, v126
  v_max_u32 v30, v30, v127
  v_cmp_eq_u32 vcc, -1, v30
  s_cmp_eq_u32 s79, 0
  s_cbranch_scc1 Ltg_114_b
  s_sub_u32 s79, s79, 1
  s_cbranch_vccnz Ltg_114
  buffer_load_dwordx4 v[128:131], v59, s[32:35], s74 offen offset:0 sc1
  buffer_load_dwordx4 v[132:135], v59, s[32:35], s74 offen offset:1024 sc1
  s_branch Ltg_114_b
Ltg_115:
  buffer_load_dwordx4 v[128:131], v59, s[32:35], s74 offen offset:0 sc1
  buffer_load_dwordx4 v[132:135], v59, s[32:35], s74 offen offset:1024 sc1
  s_waitcnt vmcnt(0)
  v_max3_u32 v30, v128, v129, v130
  v_max3_u32 v30, v30, v131, v132
  v_max3_u32 v30, v30, v133, v134
  v_max_u32 v30, v30, v135
  v_cmp_eq_u32 vcc, -1, v30
  s_cmp_eq_u32 s79, 0
  s_cbranch_scc1 Ltg_115_b
  s_sub_u32 s79, s79, 1
  s_cbranch_vccnz Ltg_115
  s_branch Ltg_115_b
Ltg_120:
  buffer_load_dwordx2 v[10:11], v14, s[28:31], s60 offen sc1
  buffer_load_dwordx2 v[12:13], v15, s[28:31], s60 offen sc1
  s_waitcnt vmcnt(0)
  v_max3_u32 v30, v10, v11, v12
  v_max_u32 v30, v30, v13
  v_cmp_eq_u32 vcc, -1, v30
  s_cmp_eq_u32 s79, 0
  s_cbranch_scc1 Ltg_120_b
  s_sub_u32 s79, s79, 1
  s_cbranch_vccnz Ltg_120
  buffer_load_dwordx4 v[64:67], v4, s[28:31], s70 offen offset:0 sc1
  buffer_load_dwordx4 v[68:71], v4, s[28:31], s70 offen offset:1024 sc1
  buffer_load_dwordx4 v[72:75], v4, s[28:31], s70 offen offset:2048 sc1
  buffer_load_dwordx4 v[76:79], v4, s[28:31], s70 offen offset:3072 sc1
  buffer_load_dwordx4 v[80:83], v4, s[28:31], s71 offen offset:0 sc1
  buffer_load_dwordx4 v[84:87], v4, s[28:31], s71 offen offset:1024 sc1
  buffer_load_dwordx4 v[88:91], v4, s[28:31], s71 offen offset:2048 sc1
  buffer_load_dwordx4 v[92:95], v4, s[28:31], s71 offen offset:3072 sc1
  s_branch Ltg_120_b
Ltg_121:
  buffer_load_dwordx4 v[64:67], v4, s[28:31], s70 offen offset:0 sc1
  buffer_load_dwordx4 v[68:71], v4, s[28:31], s70 offen offset:1024 sc1
  s_waitcnt vmcnt(0)
  v_max3_u32 v30, v64, v65, v66
  v_max3_u32 v30, v30, v67, v68
  v_max3_u32 v30, v30, v69, v70
  v_max_u32 v30, v30, v71
  v_cmp_eq_u32 vcc, -1, v30
  s_cmp_eq_u32 s79, 0
  s_cbranch_scc1 Ltg_121_b
  s_sub_u32 s79, s79, 1
  s_cbranch_vccnz Ltg_121
  buffer_load_dwordx4 v[72:75], v4, s[28:31], s70 offen offset:2048 sc1
  buffer_load_dwordx4 v[76:79], v4, s[28:31], s70 offen offset:3072 sc1
  buffer_load_dwordx4 v[80:83], v4, s[28:31], s71 offen offset:0 sc1
  buffer_load_dwordx4 v[84:87], v4, s[28:31], s71 offen offset:1024 sc1
  buffer_load_dwordx4 v[88:91], v4, s[28:31], s71 offen offset:2048 sc1
  buffer_load_dwordx4 v[92:95], v4, s[28:31], s71 offen offset:3072 sc1
  buffer_load_dwordx4 v[96:99], v4, s[28:31], s72 offen offset:0 sc1
  buffer_load_dwordx4 v[100:103], v4, s[28:31], s72 offen offset:1024 sc1
  s_branch Ltg_121_b
Ltg_122:
  buffer_load_dwordx4 v[72:75], v4, s[28:31], s70 offen offset:2048 sc1
  buffer_load_dwordx4 v[76:79], v4, s[28:31], s70 offen offset:3072 sc1
  s_waitcnt vmcnt(0)
  v_max3_u32 v30, v72, v73, v74
  v_max3_u32 v30, v30, v75, v76
  v_max3_u32 v30, v30, v77, v78
  v_max_u32 v30, v30, v79
  v_cmp_eq_u32 vcc, -1, v30
  s_cmp_eq_u32 s79, 0
  s_cbranch_scc1 Ltg_122_b
  s_sub_u32 s79, s79, 1
  s_cbranch_vccnz Ltg_122
  buffer_load_dwordx4 v[80:83], v4, s[28:31], s71 offen offset:0 sc1
  buffer_load_dwordx4 v[84:87], v4, s[28:31], s71 offen offset:1024 sc1
  buffer_load_dwordx4 v[88:91], v4, s[28:31], s71 offen offset:2048 sc1
  buffer_load_dwordx4 v[92:95], v4, s[28:31], s71 offen offset:3072 sc1
  buffer_load_dwordx4 v[96:99], v4, s[28:31], s72 offen offset:0 sc1
  buffer_load_dwordx4 v[100:103], v4, s[28:31], s72 offen offset:1024 sc1
  buffer_load_dwordx4 v[104:107], v4, s[28:31], s72 offen offset:2048 sc1
  buffer_load_dwordx4 v[108:111], v4, s[28:31], s72 offen offset:3072 sc1
  s_branch Ltg_122_b
Ltg_123:
  buffer_load_dwordx4 v[80:83], v4, s[28:31], s71 offen offset:0 sc1
  buffer_load_dwordx4 v[84:87], v4, s[28:31], s71 offen offset:1024 sc1
  s_waitcnt vmcnt(0)
  v_max3_u32 v30, v80, v81, v82
  v_max3_u32 v30, v30, v83, v84
  v_max3_u32 v30, v30, v85, v86
  v_max_u32 v30, v30, v87
  v_cmp_eq_u32 vcc, -1, v30
  s_cmp_eq_u32 s79, 0
  s_cbranch_scc1 Ltg_123_b
  s_sub_u32 s79, s79, 1
  s_cbranch_vccnz Ltg_123
  buffer_load_dwordx4 v[88:91], v4, s[28:31], s71 offen offset:2048 sc1
  buffer_load_dwordx4 v[92:95], v4, s[28:31], s71 offen offset:3072 sc1
  buffer_load_dwordx4 v[96:99], v4, s[28:31], s72 offen offset:0 sc1
  buffer_load_dwordx4 v[100:103], v4, s[28:31], s72 offen offset:1024 sc1
  buffer_load_dwordx4 v[104:107], v4, s[28:31], s72 offen offset:2048 sc1
  buffer_load_dwordx4 v[108:111], v4, s[28:31], s72 offen offset:3072 sc1
  buffer_load_dwordx4 v[112:115], v4, s[28:31], s73 offen offset:0 sc1
  buffer_load_dwordx4 v[116:119], v4, s[28:31], s73 offen offset:1024 sc1
  s_branch Ltg_123_b
Ltg_124:
  buffer_load_dwordx4 v[88:91], v4, s[28:31], s71 offen offset:2048 sc1
  buffer_load_dwordx4 v[92:95], v4, s[28:31], s71 offen offset:3072 sc1
  s_waitcnt vmcnt(0)
  v_max3_u32 v30, v88, v89, v90
  v_max3_u32 v30, v30, v91, v92
  v_max3_u32 v30, v30, v93, v94
  v_max_u32 v30, v30, v95
  v_cmp_eq_u32 vcc, -1, v30
  s_cmp_eq_u32 s79, 0
  s_cbranch_scc1 Ltg_124_b
  s_sub_u32 s79, s79, 1
  s_cbranch_vccnz Ltg_124
  buffer_load_dwordx4 v[96:99], v4, s[28:31], s72 offen offset:0 sc1
  buffer_load_dwordx4 v[100:103], v4, s[28:31], s72 offen offset:1024 sc1
  buffer_load_dwordx4 v[104:107], v4, s[28:31], s72 offen offset:2048 sc1
  buffer_load_dwordx4 v[108:111], v4, s[28:31], s72 offen offset:3072 sc1
  buffer_load_dwordx4 v[112:115], v4, s[28:31], s73 offen offset:0 sc1
  buffer_load_dwordx4 v[116:119], v4, s[28:31], s73 offen offset:1024 sc1
  buffer_load_dwordx4 v[120:123], v4, s[28:31], s73 offen offset:2048 sc1
  buffer_load_dwordx4 v[124:127], v4, s[28:31], s73 offen offset:3072 sc1
  s_branch Ltg_124_b
Ltg_125:
  buffer_load_dwordx4 v[96:99], v4, s[28:31], s72 offen offset:0 sc1
  buffer_load_dwordx4 v[100:103], v4, s[28:31], s72 offen offset:1024 sc1
  s_waitcnt vmcnt(0)
  v_max3_u32 v30, v96, v97, v98
  v_max3_u32 v30, v30, v99, v100
  v_max3_u32 v30, v30, v101, v102
  v_max_u32 v30, v30, v103
  v_cmp_eq_u32 vcc, -1, v30
  s_cmp_eq_u32 s79, 0
  s_cbranch_scc1 Ltg_125_b
  s_sub_u32 s79, s79, 1
  s_cbranch_vccnz Ltg_125
  buffer_load_dwordx4 v[104:107], v4, s[28:31], s72 offen offset:2048 sc1
  buffer_load_dwordx4 v[108:111], v4, s[28:31], s72 offen offset:3072 sc1
  buffer_load_dwordx4 v[112:115], v4, s[28:31], s73 offen offset:0 sc1
  buffer_load_dwordx4 v[116:119], v4, s[28:31], s73 offen offset:1024 sc1
  buffer_load_dwordx4 v[120:123], v4, s[28:31], s73 offen offset:2048 sc1
  buffer_load_dwordx4 v[124:127], v4, s[28:31], s73 offen offset:3072 sc1
  buffer_load_dwordx4 v[128:131], v4, s[28:31], s74 offen offset:0 sc1
  buffer_load_dwordx4 v[132:135], v4, s[28:31], s74 offen offset:1024 sc1
  s_branch Ltg_125_b
Ltg_126:
  buffer_load_dwordx4 v[104:107], v4, s[28:31], s72 offen offset:2048 sc1
  buffer_load_dwordx4 v[108:111], v4, s[28:31], s72 offen offset:3072 sc1
  s_waitcnt vmcnt(0)
  v_max3_u32 v30, v104, v105, v106
  v_max3_u32 v30, v30, v107, v108
  v_max3_u32 v30, v30, v109, v110
  v_max_u32 v30, v30, v111
  v_cmp_eq_u32 vcc, -1, v30
  s_cmp_eq_u32 s79, 0
  s_cbranch_scc1 Ltg_126_b
  s_sub_u32 s79, s79, 1
  s_cbranch_vccnz Ltg_126
  buffer_load_dwordx4 v[112:115], v4, s[28:31], s73 offen offset:0 sc1
  buffer_load_dwordx4 v[116:119], v4, s[28:31], s73 offen offset:1024 sc1
  buffer_load_dwordx4 v[120:123], v4, s[28:31], s73 offen offset:2048 sc1
  buffer_load_dwordx4 v[124:127], v4, s[28:31], s73 offen offset:3072 sc1
  buffer_load_dwordx4 v[128:131], v4, s[28:31], s74 offen offset:0 sc1
  buffer_load_dwordx4 v[132:135], v4, s[28:31], s74 offen offset:1024 sc1
  s_branch Ltg_126_b
Ltg_127:
  buffer_load_dwordx4 v[112:115], v4, s[28:31], s73 offen offset:0 sc1
  buffer_load_dwordx4 v[116:119], v4, s[28:31], s73 offen offset:1024 sc1
  s_waitcnt vmcnt(0)
  v_max3_u32 v30, v112, v113, v114
  v_max3_u32 v30, v30, v115, v116
  v_max3_u32 v30, v30, v117, v118
  v_max_u32 v30, v30, v119
  v_cmp_eq_u32 vcc, -1, v30
  s_cmp_eq_u32 s79, 0
  s_cbranch_scc1 Ltg_127_b
  s_sub_u32 s79, s79, 1
  s_cbranch_vccnz Ltg_127
  buffer_load_dwordx4 v[120:123], v4, s[28:31], s73 offen offset:2048 sc1
  buffer_load_dwordx4 v[124:127], v4, s[28:31], s73 offen offset:3072 sc1
  buffer_load_dwordx4 v[128:131], v4, s[28:31], s74 offen offset:0 sc1
  buffer_load_dwordx4 v[132:135], v4, s[28:31], s74 offen offset:1024 sc1
  s_branch Ltg_127_b
Ltg_128:
  buffer_load_dwordx4 v[120:123], v4, s[28:31], s73 offen offset:2048 sc1
  buffer_load_dwordx4 v[124:127], v4, s[28:31], s73 offen offset:3072 sc1
  s_waitcnt vmcnt(0)
  v_max3_u32 v30, v120, v121, v122
  v_max3_u32 v30, v30, v123, v124
  v_max3_u32 v30, v30, v125, v126
  v_max_u32 v30, v30, v127
  v_cmp_eq_u32 vcc, -1, v30
  s_cmp_eq_u32 s79, 0
  s_cbranch_scc1 Ltg_128_b
  s_sub_u32 s79, s79, 1
  s_cbranch_vccnz Ltg_128
  buffer_load_dwordx4 v[128:131], v4, s[28:31], s74 offen offset:0 sc1
  buffer_load_dwordx4 v[132:135], v4, s[28:31], s74 offen offset:1024 sc1
  s_branch Ltg_128_b
Ltg_129:
  buffer_load_dwordx4 v[128:131], v4, s[28:31], s74 offen offset:0 sc1
  buffer_load_dwordx4 v[132:135], v4, s[28:31], s74 offen offset:1024 sc1
  s_waitcnt vmcnt(0)
  v_max3_u32 v30, v128, v129, v130
  v_max3_u32 v30, v30, v131, v132
  v_max3_u32 v30, v30, v133, v134
  v_max_u32 v30, v30, v135
  v_cmp_eq_u32 vcc, -1, v30
  s_cmp_eq_u32 s79, 0
  s_cbranch_scc1 Ltg_129_b
  s_sub_u32 s79, s79, 1
  s_cbranch_vccnz Ltg_129
  s_branch Ltg_129_b
L_last:
.section .rodata,"a"
.p2align 6
.amdhsa_kernel sequential_preLN__sliding_block__mixer_s_mlp__prompt_kernel
  .amdhsa_next_free_vgpr 512
  .amdhsa_next_free_sgpr 102
  .amdhsa_accum_offset 256
  .amdhsa_group_segment_fixed_size 0
  .amdhsa_kernarg_size 88
  .amdhsa_user_sgpr_count 2
  .amdhsa_user_sgpr_kernarg_segment_ptr 1
  .amdhsa_system_sgpr_workgroup_id_x 1
.end_amdhsa_kernel
```
